```python
import torch

def _softmax(x, axis=-1):
    return torch.softmax(x, dim=axis)
def _gelu(x):
    return torch.nn.functional.gelu(x, approximate="tanh")
def _silu(x):
    return torch.nn.functional.silu(x)
def _sigmoid(x):
    return torch.sigmoid(x)
def _layernorm(x, axis=-1, eps=1e-5):
    m = x.mean(dim=axis, keepdim=True)
    v = x.var(dim=axis, keepdim=True, unbiased=False)
    return (x - m) / torch.sqrt(v + eps)
def _scatter_add(tgt, idx, src, axis=0):
    return tgt.clone().index_add_(axis, idx, src)
def _segment_sum(src, seg, n):
    out = torch.zeros((n,) + src.shape[1:], dtype=src.dtype)
    return out.index_add_(0, seg, src)
def _pad(x, pw):
    flat = tuple(v for pair in reversed(pw) for v in pair)
    return torch.nn.functional.pad(x, flat)

kernel_name = 'sequential_preLN__compressed_kv_cla__glu_gated_bilinear__prompt'

def setup_inputs():

    _w = (lambda a: (lambda t: t.to(torch.bfloat16) if t.is_floating_point() else t)(torch.as_tensor(a)))
    def _A_setup():
        B, H, Sq, Sk, D, M = 1, 16, 2048, 2048, 256, 448
        Dc = 4 * D
        return {
            "x": _w((lambda *s: torch.randn(*s, dtype=torch.bfloat16) * 0.05)(B, Sq, M)),
            "c_kv": _w((lambda *s: torch.randn(*s, dtype=torch.bfloat16) * 0.4)(B, Sk, Dc)),
            "w_q": _w((lambda *s: torch.randn(*s, dtype=torch.bfloat16) * 1.6)(M, H, D) * (M ** -0.5)),
            "w_uk": _w((lambda *s: torch.randn(*s, dtype=torch.bfloat16) * 1.6)(Dc, H, D) * (Dc ** -0.5)),
            "w_uv": _w((lambda *s: torch.randn(*s, dtype=torch.bfloat16) * 0.4)(Dc, H, D) * (Dc ** -0.5)),
            "w_o": _w((lambda *s: torch.randn(*s, dtype=torch.bfloat16) * 0.4)(H, D, M) * ((H * D) ** -0.5)),
        }
    _A_in = _A_setup()

    def _B_setup():
        B, S, D, F = 1, 2048, 448, 1792
        return {
            "x": _w((lambda *s: torch.randn(*s, dtype=torch.bfloat16) * 0.05)(B, S, D)),
            "w_gate": _w((lambda *s: torch.randn(*s, dtype=torch.bfloat16) * 0.4)(D, F) * (D ** -0.5)),
            "w_up": _w((lambda *s: torch.randn(*s, dtype=torch.bfloat16) * 0.4)(D, F) * (D ** -0.5)),
            "w_down": _w((lambda *s: torch.randn(*s, dtype=torch.bfloat16) * 0.4)(F, D) * (F ** -0.5)),
        }
    _B_in = _B_setup()

    return {
        "A_x": _A_in["x"],
        "A_c_kv": _A_in["c_kv"],
        "A_w_q": _A_in["w_q"],
        "A_w_uk": _A_in["w_uk"],
        "A_w_uv": _A_in["w_uv"],
        "A_w_o": _A_in["w_o"],
        "B_x": _B_in["x"],
        "B_w_gate": _B_in["w_gate"],
        "B_w_up": _B_in["w_up"],
        "B_w_down": _B_in["w_down"],
    }

def reference(A_x, A_c_kv, A_w_q, A_w_uk, A_w_uv, A_w_o, B_x, B_w_gate, B_w_up, B_w_down):
    def _A_ref(x, c_kv, w_q, w_uk, w_uv, w_o):
        B, Sq, M = x.shape[0], x.shape[1], x.shape[2]
        Sk = c_kv.shape[1]
        H, D = w_q.shape[1], w_q.shape[2]
        q = torch.einsum("bqm,mhd->bhqd", x, w_q)
        k = torch.einsum("bkc,chd->bhkd", c_kv, w_uk)
        v = torch.einsum("bkc,chd->bhkd", c_kv, w_uv)
        scores = torch.einsum("bhqd,bhkd->bhqk", q, k) * (D ** -0.5)
        off = Sk - Sq
        qi = torch.arange(Sq)[:, None]
        kj = torch.arange(Sk)[None, :]
        cmask = kj <= (qi + off)
        scores = torch.where(cmask[None, None], scores, -1e9)
        p = _softmax(scores, axis=-1)
        ctx = torch.einsum("bhqk,bhkd->bhqd", p, v)
        return torch.einsum("bhqd,hdm->bqm", ctx, w_o)

    def _B_ref(x, w_gate, w_up, w_down):
        g = torch.einsum("bsd,df->bsf", x, w_gate)
        u = torch.einsum("bsd,df->bsf", x, w_up)
        h = g * u
        return torch.einsum("bsf,fd->bsd", h, w_down)

    x = A_x
    h = x + _A_ref(_layernorm(x, axis=-1), A_c_kv, A_w_q, A_w_uk, A_w_uv, A_w_o)
    h2 = h + _B_ref(_layernorm(h, axis=-1), B_w_gate, B_w_up, B_w_down)
    return h2
```

```asm
; @launch grid=(256,1,1) block=(256,1,1) lds=163840
.amdgcn_target "amdgcn-amd-amdhsa--gfx950"
.text
.globl sequential_preLN__compressed_kv_cla__glu_gated_bilinear__prompt_kernel
.p2align 8
.type sequential_preLN__compressed_kv_cla__glu_gated_bilinear__prompt_kernel,@function
sequential_preLN__compressed_kv_cla__glu_gated_bilinear__prompt_kernel:
L_begin:
 s_cmp_ge_u32 s2, 256
 s_cbranch_scc1 L_end_seque
 s_load_dwordx2 s[4:5], s[0:1], 96
 s_load_dwordx2 s[12:13], s[0:1], 8
 s_load_dwordx2 s[72:73], s[0:1], 24
 s_load_dwordx2 s[74:75], s[0:1], 32
 s_load_dwordx2 s[24:25], s[0:1], 0
 s_load_dwordx2 s[28:29], s[0:1], 88
 s_load_dwordx2 s[48:49], s[0:1], 16
 s_load_dwordx2 s[52:53], s[0:1], 40
 v_lshrrev_b32 v1, 6, v0
 s_nop 0
 v_readfirstlane_b32 s3, v1
 s_nop 0
 v_and_b32 v2, 63, v0
 v_lshlrev_b32 v2, 4, v2
 s_getpc_b64 s[16:17]
L_ct0:
 s_sub_u32 s16, s16, L_ct0-L_begin
 s_subb_u32 s17, s17, 0
 s_and_b32 s17, s17, 0xffff
 s_mov_b32 s18, L_last-L_begin
 s_mov_b32 s19, 0x20000
 s_lshr_b32 s9, s2, 3
 s_lshl_b32 s9, s9, 2
 s_add_u32 s9, s9, s3
 s_lshl_b32 s9, s9, 10
 buffer_load_dwordx4 v[8:11], v2, s[16:19], s9 offen
 s_lshl_b32 s8, s3, 12
 v_and_b32 v1, 63, v0
 s_and_b32 s9, s2, 7
 s_lshr_b32 s10, s2, 3
 s_lshl_b32 s45, s9, 1
 s_and_b32 s9, s10, 1
 s_add_u32 s45, s45, s9
 s_bfe_u32 s46, s10, 0x10001
 s_lshr_b32 s47, s10, 2
 v_lshrrev_b32 v148, 3, v1
 v_and_b32 v149, 7, v1
 v_mul_u32_u24 v152, 896, v149
 v_lshl_add_u32 v152, v148, 4, v152
 v_lshlrev_b32 v153, 4, v149
 v_bfe_u32 v151, v1, 3, 2
 v_lshl_add_u32 v153, v151, 8, v153
 v_lshrrev_b32 v151, 5, v1
 v_lshl_add_u32 v153, v151, 10, v153
 s_lshl_b32 s9, s3, 6
 v_add_u32 v148, s9, v148
 v_lshlrev_b32 v148, 11, v148
 v_lshrrev_b32 v150, 4, v1
 v_xor_b32 v149, v149, v150
 v_lshl_add_u32 v148, v149, 4, v148
 v_xor_b32 v149, 64, v148
 v_add_u32 v132, 0x0, v148
 v_add_u32 v133, 0x3c00, v149
 v_add_u32 v134, 0x7800, v148
 v_add_u32 v135, 0xb400, v149
 v_add_u32 v136, 0x10000, v148
 v_add_u32 v137, 0x13c00, v149
 v_add_u32 v138, 0x17800, v148
 v_add_u32 v139, 0x1b400, v149
 v_bfe_u32 v148, v1, 2, 2
 s_lshl_b32 s9, s3, 3
 v_add_u32 v148, s9, v148
 v_lshlrev_b32 v148, 13, v148
 v_lshl_add_u32 v148, v150, 6, v148
 v_and_b32 v149, 3, v1
 s_and_b32 s9, s3, 1
 s_lshl_b32 s9, s9, 1
 v_xor_b32 v149, s9, v149
 v_lshl_add_u32 v148, v149, 4, v148
 v_add_u32 v140, 0x1000, v148
 v_add_u32 v141, 0xd00, v148
 v_add_u32 v142, 0x8800, v148
 v_add_u32 v143, 0x8500, v148
 v_and_b32 v148, 15, v1
 v_lshlrev_b32 v148, 7, v148
 v_bfe_u32 v151, v1, 1, 3
 v_xor_b32 v151, v151, v150
 v_lshl_add_u32 v148, v151, 4, v148
 s_lshr_b32 s9, s3, 1
 s_lshl_b32 s9, s9, 14
 s_add_u32 s9, s9, 0x10000
 v_add_u32 v144, s9, v148
 v_xor_b32 v145, 64, v144
 v_lshlrev_b32 v148, 12, v150
 v_bfe_u32 v151, v1, 2, 2
 v_lshl_add_u32 v148, v151, 6, v148
 v_bfe_u32 v151, v1, 4, 1
 v_lshl_add_u32 v148, v151, 5, v148
 v_and_b32 v151, 3, v1
 v_lshl_add_u32 v148, v151, 3, v148
 s_and_b32 s9, s3, 1
 s_lshl_b32 s9, s9, 10
 v_add_u32 v146, s9, v148
 v_xor_b32 v147, 32, v146
 v_lshlrev_b32 v2, 4, v1
 s_waitcnt lgkmcnt(0)
 s_and_b32 s5, s5, 0xffff
 s_mov_b32 s6, 0x6200000
 s_mov_b32 s7, 0x20000
 s_and_b32 s13, s13, 0xffff
 s_mov_b32 s14, 0x400000
 s_mov_b32 s15, 0x20000
 s_cmp_eq_u32 s46, 0
 s_cselect_b32 s16, s72, s74
 s_cselect_b32 s17, s73, s75
 s_cselect_b32 s36, 2, 1
 s_cselect_b32 s37, 2, 3
 s_lshl_b32 s36, s36, 12
 s_lshl_b32 s37, s37, 12
 s_add_u32 s37, s37, 0
 s_sub_u32 s16, s16, 4096
 s_subb_u32 s17, s17, 0
 s_and_b32 s17, s17, 0xffff
 s_mov_b32 s18, 0x801000
 s_mov_b32 s19, 0x20000
 s_and_b32 s25, s25, 0xffff
 s_mov_b32 s26, 0x1c0000
 s_mov_b32 s27, 0x20000
 s_sub_u32 s20, s48, 4096
 s_subb_u32 s21, s49, 0
 s_and_b32 s21, s21, 0xffff
 s_mov_b32 s22, 0x381000
 s_mov_b32 s23, 0x20000
 s_and_b32 s29, s29, 0xffff
 s_mov_b32 s30, 0x100
 s_mov_b32 s31, 0x20000
 s_lshl_b32 s41, s47, 19
 s_lshl_b32 s32, s45, 9
 s_mov_b32 s38, s32
 s_lshl_b32 s42, s3, 13
 s_add_u32 s42, s42, 0x10000
 s_mov_b32 s43, s8
 s_mul_i32 s39, s2, 7168
 s_cmp_eq_u32 s3, 0
 s_cselect_b32 s70, 0, 0x40000000
 s_cbranch_scc0 L1_noln1
 buffer_load_dwordx4 v[168:171], v152, s[24:27], s39 offen offset:0
 buffer_load_dwordx4 v[172:175], v152, s[24:27], s39 offen offset:128
 buffer_load_dwordx4 v[176:179], v152, s[24:27], s39 offen offset:256
 buffer_load_dwordx4 v[180:183], v152, s[24:27], s39 offen offset:384
 buffer_load_dwordx4 v[184:187], v152, s[24:27], s39 offen offset:512
 buffer_load_dwordx4 v[188:191], v152, s[24:27], s39 offen offset:640
 buffer_load_dwordx4 v[192:195], v152, s[24:27], s39 offen offset:768
L1_noln1:
 s_mov_b32 m0, s42
 s_nop 0
 buffer_load_dwordx4 v132, s[12:15], s41 offen offset:0 lds
 buffer_load_dwordx4 v133, s[12:15], s41 offen offset:1024 lds
 buffer_load_dwordx4 v134, s[12:15], s41 offen offset:2048 lds
 buffer_load_dwordx4 v135, s[12:15], s41 offen offset:3072 lds
 s_mov_b32 m0, s43
 s_nop 0
 buffer_load_dwordx4 v140, s[16:19], s32 offen offset:0 lds
 buffer_load_dwordx4 v141, s[16:19], s32 offen offset:1024 lds
 buffer_load_dwordx4 v142, s[16:19], s32 offen offset:2048 lds
 buffer_load_dwordx4 v143, s[16:19], s32 offen offset:3072 lds
 s_add_u32 s43, s43, 0x4000
 s_and_b32 s43, s43, 0xffff
 s_add_u32 s32, s32, 0x40000
 s_add_u32 m0, s42, 0x1000
 s_nop 0
 buffer_load_dwordx4 v136, s[12:15], s41 offen offset:0 lds
 buffer_load_dwordx4 v137, s[12:15], s41 offen offset:1024 lds
 buffer_load_dwordx4 v138, s[12:15], s41 offen offset:2048 lds
 buffer_load_dwordx4 v139, s[12:15], s41 offen offset:3072 lds
 s_add_u32 s42, s42, 0x8000
 s_cmp_ge_u32 s42, 0x28000
 s_cselect_b32 s9, 0x18000, 0
 s_sub_u32 s42, s42, s9
 s_add_u32 s41, s41, 128
 s_mov_b32 m0, s43
 s_nop 0
 buffer_load_dwordx4 v140, s[16:19], s32 offen offset:0 lds
 buffer_load_dwordx4 v141, s[16:19], s32 offen offset:1024 lds
 buffer_load_dwordx4 v142, s[16:19], s32 offen offset:2048 lds
 buffer_load_dwordx4 v143, s[16:19], s32 offen offset:3072 lds
 s_add_u32 s43, s43, 0x4000
 s_and_b32 s43, s43, 0xffff
 s_add_u32 s32, s32, 0x40000
 s_mov_b32 m0, s42
 s_nop 0
 buffer_load_dwordx4 v132, s[12:15], s41 offen offset:0 lds
 buffer_load_dwordx4 v133, s[12:15], s41 offen offset:1024 lds
 buffer_load_dwordx4 v134, s[12:15], s41 offen offset:2048 lds
 buffer_load_dwordx4 v135, s[12:15], s41 offen offset:3072 lds
 s_add_u32 m0, s42, 0x1000
 s_nop 0
 buffer_load_dwordx4 v136, s[12:15], s41 offen offset:0 lds
 buffer_load_dwordx4 v137, s[12:15], s41 offen offset:1024 lds
 buffer_load_dwordx4 v138, s[12:15], s41 offen offset:2048 lds
 buffer_load_dwordx4 v139, s[12:15], s41 offen offset:3072 lds
 s_add_u32 s42, s42, 0x8000
 s_cmp_ge_u32 s42, 0x28000
 s_cselect_b32 s9, 0x18000, 0
 s_sub_u32 s42, s42, s9
 s_add_u32 s41, s41, 128
 s_mov_b32 m0, s43
 s_nop 0
 buffer_load_dwordx4 v140, s[16:19], s32 offen offset:0 lds
 buffer_load_dwordx4 v141, s[16:19], s32 offen offset:1024 lds
 buffer_load_dwordx4 v142, s[16:19], s32 offen offset:2048 lds
 buffer_load_dwordx4 v143, s[16:19], s32 offen offset:3072 lds
 s_add_u32 s43, s43, 0x4000
 s_and_b32 s43, s43, 0xffff
 s_add_u32 s32, s32, 0x40000
 s_mov_b32 m0, s43
 s_nop 0
 buffer_load_dwordx4 v140, s[16:19], s32 offen offset:0 lds
 buffer_load_dwordx4 v141, s[16:19], s32 offen offset:1024 lds
 buffer_load_dwordx4 v142, s[16:19], s32 offen offset:2048 lds
 buffer_load_dwordx4 v143, s[16:19], s32 offen offset:3072 lds
 s_add_u32 s43, s43, 0x4000
 s_and_b32 s43, s43, 0xffff
 s_add_u32 s32, s32, 0x40000
 s_cmp_lt_u32 s3, 2
 s_cselect_b32 s48, s48, s52
 s_cselect_b32 s49, s49, s53
 s_and_b32 s49, s49, 0xffff
 s_mov_b32 s50, 0x380000
 s_mov_b32 s51, 0x20000
 s_and_b32 s9, s3, 1
 s_lshl_b32 s56, s2, 1
 s_add_u32 s56, s56, s9
 s_mul_i32 s56, s56, 7168
 s_add_u32 s50, s56, 7168
 s_getpc_b64 s[64:65]
L_ct4:
 s_sub_u32 s64, s64, L_ct4-L_begin
 s_subb_u32 s65, s65, 0
 s_and_b32 s65, s65, 0xffff
 s_mov_b32 s66, L_last-L_begin
 s_mov_b32 s67, 0x20000
 s_lshr_b32 s57, s2, 3
 s_lshl_b32 s57, s57, 2
 s_add_u32 s57, s57, s3
 s_lshl_b32 s57, s57, 10
 s_cmp_lt_u32 s2, 128
 s_cselect_b32 s72, s72, s74
 s_cselect_b32 s73, s73, s75
 s_and_b32 s73, s73, 0xffff
 s_mov_b32 s74, 0x800000
 s_mov_b32 s75, 0x20000
 s_and_b32 s58, s2, 127
 s_lshl_b32 s58, s58, 2
 s_add_u32 s58, s58, s3
 s_lshl_b32 s58, s58, 10
 s_add_u32 s58, s58, 0x0
 s_mov_b32 s44, 0
 s_lshr_b32 s9, s2, 1
 s_mul_i32 s39, s9, 14336
 s_and_b32 s9, s2, 1
 s_lshl_b32 s9, s9, 7
 s_add_u32 s39, s39, s9
 s_add_u32 s39, s39, 0x5c00000
 s_add_u32 s39, s39, s70
 s_min_u32 s34, s2, 159
 s_lshl_b32 s34, s34, 9
 s_add_u32 s34, s34, 0x5300000
 s_add_u32 s34, s34, s70
 s_getreg_b32 s9, hwreg(HW_REG_XCC_ID, 0, 4)
 s_mul_i32 s10, s9, s9
 s_lshl_b32 s10, s10, 18
 s_lshl_b32 s9, s9, 8
 s_add_u32 s9, s9, s10
 s_add_u32 s9, s9, 1
 v_mov_b32 v155, s9
 s_and_b32 s35, s2, 7
 s_lshl_b32 s35, s35, 5
 s_add_u32 s35, s35, s70
 v_min_u32 v151, 1, v1
 v_lshlrev_b32 v154, 12, v151
 v_and_b32 v151, 7, v1
 v_lshlrev_b32 v151, 5, v151
 v_lshlrev_b32 v150, 3, v1
 v_mov_b32 v216, 0
 v_mov_b32 v217, 0
 v_mov_b32 v149, 0
 v_mov_b32 v148, 1
 s_cmp_eq_u32 s3, 0
 s_cbranch_scc0 L1_noln2
 v_mov_b32 v204, 0x3f803f80
 v_mov_b32 v200, 0
 v_mov_b32 v201, 0
 v_mov_b32 v202, 0
 v_mov_b32 v203, 0
 s_waitcnt vmcnt(32)
 v_dot2c_f32_bf16 v200, v168, v204
 v_dot2c_f32_bf16 v202, v168, v168
 v_dot2c_f32_bf16 v201, v169, v204
 v_dot2c_f32_bf16 v203, v169, v169
 v_dot2c_f32_bf16 v200, v170, v204
 v_dot2c_f32_bf16 v202, v170, v170
 v_dot2c_f32_bf16 v201, v171, v204
 v_dot2c_f32_bf16 v203, v171, v171
 v_dot2c_f32_bf16 v200, v172, v204
 v_dot2c_f32_bf16 v202, v172, v172
 v_dot2c_f32_bf16 v201, v173, v204
 v_dot2c_f32_bf16 v203, v173, v173
 v_dot2c_f32_bf16 v200, v174, v204
 v_dot2c_f32_bf16 v202, v174, v174
 v_dot2c_f32_bf16 v201, v175, v204
 v_dot2c_f32_bf16 v203, v175, v175
 v_dot2c_f32_bf16 v200, v176, v204
 v_dot2c_f32_bf16 v202, v176, v176
 v_dot2c_f32_bf16 v201, v177, v204
 v_dot2c_f32_bf16 v203, v177, v177
 v_dot2c_f32_bf16 v200, v178, v204
 v_dot2c_f32_bf16 v202, v178, v178
 v_dot2c_f32_bf16 v201, v179, v204
 v_dot2c_f32_bf16 v203, v179, v179
 v_dot2c_f32_bf16 v200, v180, v204
 v_dot2c_f32_bf16 v202, v180, v180
 v_dot2c_f32_bf16 v201, v181, v204
 v_dot2c_f32_bf16 v203, v181, v181
 v_dot2c_f32_bf16 v200, v182, v204
 v_dot2c_f32_bf16 v202, v182, v182
 v_dot2c_f32_bf16 v201, v183, v204
 v_dot2c_f32_bf16 v203, v183, v183
 v_dot2c_f32_bf16 v200, v184, v204
 v_dot2c_f32_bf16 v202, v184, v184
 v_dot2c_f32_bf16 v201, v185, v204
 v_dot2c_f32_bf16 v203, v185, v185
 v_dot2c_f32_bf16 v200, v186, v204
 v_dot2c_f32_bf16 v202, v186, v186
 v_dot2c_f32_bf16 v201, v187, v204
 v_dot2c_f32_bf16 v203, v187, v187
 v_dot2c_f32_bf16 v200, v188, v204
 v_dot2c_f32_bf16 v202, v188, v188
 v_dot2c_f32_bf16 v201, v189, v204
 v_dot2c_f32_bf16 v203, v189, v189
 v_dot2c_f32_bf16 v200, v190, v204
 v_dot2c_f32_bf16 v202, v190, v190
 v_dot2c_f32_bf16 v201, v191, v204
 v_dot2c_f32_bf16 v203, v191, v191
 v_dot2c_f32_bf16 v200, v192, v204
 v_dot2c_f32_bf16 v202, v192, v192
 v_dot2c_f32_bf16 v201, v193, v204
 v_dot2c_f32_bf16 v203, v193, v193
 v_dot2c_f32_bf16 v200, v194, v204
 v_dot2c_f32_bf16 v202, v194, v194
 v_dot2c_f32_bf16 v201, v195, v204
 v_dot2c_f32_bf16 v203, v195, v195
 s_nop 2
 v_add_f32 v200, v200, v201
 v_add_f32 v202, v202, v203
 s_nop 0
 v_add_f32_dpp v200, v200, v200 row_ror:8 row_mask:0xf bank_mask:0xf
 v_add_f32_dpp v202, v202, v202 row_ror:8 row_mask:0xf bank_mask:0xf
 v_mov_b32 v201, v200
 v_mov_b32 v203, v202
 s_nop 1
 v_permlane16_swap_b32 v200, v201
 v_permlane16_swap_b32 v202, v203
 v_add_f32 v200, v200, v201
 v_add_f32 v202, v202, v203
 v_mov_b32 v201, v200
 v_mov_b32 v203, v202
 s_nop 1
 v_permlane32_swap_b32 v200, v201
 v_permlane32_swap_b32 v202, v203
 v_add_f32 v200, v200, v201
 v_add_f32 v202, v202, v203
 s_mov_b32 s9, 0x3b124925
 v_mul_f32 v200, s9, v200
 v_mul_f32 v202, s9, v202
 v_fma_f32 v202, -v200, v200, v202
 v_max_f32 v202, 0, v202
 v_cvt_pk_bf16_f32 v200, v200, v200
 v_and_b32 v200, 0xffff0000, v200
 v_cvt_pk_bf16_f32 v202, v202, v202
 v_and_b32 v202, 0xffff0000, v202
 v_add_f32 v202, 0x3727c5ac, v202
 v_cvt_pk_bf16_f32 v202, v202, v202
 v_and_b32 v202, 0xffff0000, v202
 v_sqrt_f32 v202, v202
 s_nop 0
 v_cvt_pk_bf16_f32 v202, v202, v202
 v_and_b32 v202, 0xffff0000, v202
 v_rcp_f32 v202, v202
 s_nop 0
 v_mul_f32 v202, 0x3db8aa3b, v202
 v_mul_f32 v200, -v200, v202
 v_mov_b32 v201, v200
 v_mov_b32 v203, v202
 v_lshlrev_b32 v208, 16, v168
 v_and_b32 v209, 0xffff0000, v168
 v_pk_fma_f32 v[208:209], v[208:209], v[202:203], v[200:201]
 v_cvt_pk_bf16_f32 v168, v208, v209
 v_lshlrev_b32 v210, 16, v169
 v_and_b32 v211, 0xffff0000, v169
 v_pk_fma_f32 v[210:211], v[210:211], v[202:203], v[200:201]
 v_cvt_pk_bf16_f32 v169, v210, v211
 v_lshlrev_b32 v208, 16, v170
 v_and_b32 v209, 0xffff0000, v170
 v_pk_fma_f32 v[208:209], v[208:209], v[202:203], v[200:201]
 v_cvt_pk_bf16_f32 v170, v208, v209
 v_lshlrev_b32 v210, 16, v171
 v_and_b32 v211, 0xffff0000, v171
 v_pk_fma_f32 v[210:211], v[210:211], v[202:203], v[200:201]
 v_cvt_pk_bf16_f32 v171, v210, v211
 v_lshlrev_b32 v208, 16, v172
 v_and_b32 v209, 0xffff0000, v172
 v_pk_fma_f32 v[208:209], v[208:209], v[202:203], v[200:201]
 v_cvt_pk_bf16_f32 v172, v208, v209
 v_lshlrev_b32 v210, 16, v173
 v_and_b32 v211, 0xffff0000, v173
 v_pk_fma_f32 v[210:211], v[210:211], v[202:203], v[200:201]
 v_cvt_pk_bf16_f32 v173, v210, v211
 v_lshlrev_b32 v208, 16, v174
 v_and_b32 v209, 0xffff0000, v174
 v_pk_fma_f32 v[208:209], v[208:209], v[202:203], v[200:201]
 v_cvt_pk_bf16_f32 v174, v208, v209
 v_lshlrev_b32 v210, 16, v175
 v_and_b32 v211, 0xffff0000, v175
 v_pk_fma_f32 v[210:211], v[210:211], v[202:203], v[200:201]
 v_cvt_pk_bf16_f32 v175, v210, v211
 v_lshlrev_b32 v208, 16, v176
 v_and_b32 v209, 0xffff0000, v176
 v_pk_fma_f32 v[208:209], v[208:209], v[202:203], v[200:201]
 v_cvt_pk_bf16_f32 v176, v208, v209
 v_lshlrev_b32 v210, 16, v177
 v_and_b32 v211, 0xffff0000, v177
 v_pk_fma_f32 v[210:211], v[210:211], v[202:203], v[200:201]
 v_cvt_pk_bf16_f32 v177, v210, v211
 v_lshlrev_b32 v208, 16, v178
 v_and_b32 v209, 0xffff0000, v178
 v_pk_fma_f32 v[208:209], v[208:209], v[202:203], v[200:201]
 v_cvt_pk_bf16_f32 v178, v208, v209
 v_lshlrev_b32 v210, 16, v179
 v_and_b32 v211, 0xffff0000, v179
 v_pk_fma_f32 v[210:211], v[210:211], v[202:203], v[200:201]
 v_cvt_pk_bf16_f32 v179, v210, v211
 v_lshlrev_b32 v208, 16, v180
 v_and_b32 v209, 0xffff0000, v180
 v_pk_fma_f32 v[208:209], v[208:209], v[202:203], v[200:201]
 v_cvt_pk_bf16_f32 v180, v208, v209
 v_lshlrev_b32 v210, 16, v181
 v_and_b32 v211, 0xffff0000, v181
 v_pk_fma_f32 v[210:211], v[210:211], v[202:203], v[200:201]
 v_cvt_pk_bf16_f32 v181, v210, v211
 v_lshlrev_b32 v208, 16, v182
 v_and_b32 v209, 0xffff0000, v182
 v_pk_fma_f32 v[208:209], v[208:209], v[202:203], v[200:201]
 v_cvt_pk_bf16_f32 v182, v208, v209
 v_lshlrev_b32 v210, 16, v183
 v_and_b32 v211, 0xffff0000, v183
 v_pk_fma_f32 v[210:211], v[210:211], v[202:203], v[200:201]
 v_cvt_pk_bf16_f32 v183, v210, v211
 v_lshlrev_b32 v208, 16, v184
 v_and_b32 v209, 0xffff0000, v184
 v_pk_fma_f32 v[208:209], v[208:209], v[202:203], v[200:201]
 v_cvt_pk_bf16_f32 v184, v208, v209
 v_lshlrev_b32 v210, 16, v185
 v_and_b32 v211, 0xffff0000, v185
 v_pk_fma_f32 v[210:211], v[210:211], v[202:203], v[200:201]
 v_cvt_pk_bf16_f32 v185, v210, v211
 v_lshlrev_b32 v208, 16, v186
 v_and_b32 v209, 0xffff0000, v186
 v_pk_fma_f32 v[208:209], v[208:209], v[202:203], v[200:201]
 v_cvt_pk_bf16_f32 v186, v208, v209
 v_lshlrev_b32 v210, 16, v187
 v_and_b32 v211, 0xffff0000, v187
 v_pk_fma_f32 v[210:211], v[210:211], v[202:203], v[200:201]
 v_cvt_pk_bf16_f32 v187, v210, v211
 v_lshlrev_b32 v208, 16, v188
 v_and_b32 v209, 0xffff0000, v188
 v_pk_fma_f32 v[208:209], v[208:209], v[202:203], v[200:201]
 v_cvt_pk_bf16_f32 v188, v208, v209
 v_lshlrev_b32 v210, 16, v189
 v_and_b32 v211, 0xffff0000, v189
 v_pk_fma_f32 v[210:211], v[210:211], v[202:203], v[200:201]
 v_cvt_pk_bf16_f32 v189, v210, v211
 v_lshlrev_b32 v208, 16, v190
 v_and_b32 v209, 0xffff0000, v190
 v_pk_fma_f32 v[208:209], v[208:209], v[202:203], v[200:201]
 v_cvt_pk_bf16_f32 v190, v208, v209
 v_lshlrev_b32 v210, 16, v191
 v_and_b32 v211, 0xffff0000, v191
 v_pk_fma_f32 v[210:211], v[210:211], v[202:203], v[200:201]
 v_cvt_pk_bf16_f32 v191, v210, v211
 v_lshlrev_b32 v208, 16, v192
 v_and_b32 v209, 0xffff0000, v192
 v_pk_fma_f32 v[208:209], v[208:209], v[202:203], v[200:201]
 v_cvt_pk_bf16_f32 v192, v208, v209
 v_lshlrev_b32 v210, 16, v193
 v_and_b32 v211, 0xffff0000, v193
 v_pk_fma_f32 v[210:211], v[210:211], v[202:203], v[200:201]
 v_cvt_pk_bf16_f32 v193, v210, v211
 v_lshlrev_b32 v208, 16, v194
 v_and_b32 v209, 0xffff0000, v194
 v_pk_fma_f32 v[208:209], v[208:209], v[202:203], v[200:201]
 v_cvt_pk_bf16_f32 v194, v208, v209
 v_lshlrev_b32 v210, 16, v195
 v_and_b32 v211, 0xffff0000, v195
 v_pk_fma_f32 v[210:211], v[210:211], v[202:203], v[200:201]
 v_cvt_pk_bf16_f32 v195, v210, v211
L1_noln2:
 s_waitcnt vmcnt(20)
 s_barrier
 ds_read_b128 v[4:7], v144 offset:0
 ds_read_b64_tr_b16 v[36:37], v146 offset:0
 ds_read_b64_tr_b16 v[38:39], v146 offset:2048
 ds_read_b64_tr_b16 v[40:41], v147 offset:0
 ds_read_b64_tr_b16 v[42:43], v147 offset:2048
 ds_read_b64_tr_b16 v[44:45], v146 offset:256
 ds_read_b64_tr_b16 v[46:47], v146 offset:2304
 ds_read_b64_tr_b16 v[48:49], v147 offset:256
 ds_read_b64_tr_b16 v[50:51], v147 offset:2304
 ds_read_b64_tr_b16 v[52:53], v146 offset:512
 ds_read_b64_tr_b16 v[54:55], v146 offset:2560
 ds_read_b64_tr_b16 v[56:57], v147 offset:512
 ds_read_b64_tr_b16 v[58:59], v147 offset:2560
 ds_read_b64_tr_b16 v[60:61], v146 offset:768
 ds_read_b64_tr_b16 v[62:63], v146 offset:2816
 ds_read_b64_tr_b16 v[64:65], v147 offset:768
 ds_read_b64_tr_b16 v[66:67], v147 offset:2816
 ds_read_b128 v[8:11], v144 offset:2048
 ds_read_b128 v[12:15], v144 offset:4096
 ds_read_b128 v[16:19], v144 offset:6144
 ds_read_b128 v[20:23], v144 offset:8192
 ds_read_b128 v[24:27], v144 offset:10240
 ds_read_b128 v[28:31], v144 offset:12288
 ds_read_b128 v[32:35], v144 offset:14336
 s_cmp_eq_u32 s46, 0
 s_cbranch_scc0 L1_V_start
L1_K_start:
 s_waitcnt vmcnt(16) lgkmcnt(0)
 s_barrier
 v_mfma_f32_16x16x32_bf16 a[0:3], v[36:39], v[4:7], 0
 ds_read_b128 v[68:71], v145 offset:0
 v_mfma_f32_16x16x32_bf16 a[32:35], v[36:39], v[8:11], 0
 s_add_u32 s10, s44, 0x8000
 s_cmp_eq_u32 s10, 0x18000
 v_mfma_f32_16x16x32_bf16 a[64:67], v[36:39], v[12:15], 0
 s_cselect_b32 s10, 0, s10
 ds_read_b64_tr_b16 v[100:101], v146 offset:16384
 v_mfma_f32_16x16x32_bf16 a[96:99], v[36:39], v[16:19], 0
 s_sub_u32 s69, s10, s44
 s_mov_b32 s44, s10
 v_mfma_f32_16x16x32_bf16 a[128:131], v[36:39], v[20:23], 0
 buffer_store_dwordx4 v[168:171], v153, s[4:7], s39 offen offset:0 sc1
 v_mfma_f32_16x16x32_bf16 a[160:163], v[36:39], v[24:27], 0
 ds_read_b64_tr_b16 v[102:103], v146 offset:18432
 v_mfma_f32_16x16x32_bf16 a[192:195], v[36:39], v[28:31], 0
 ds_read_b64_tr_b16 v[104:105], v147 offset:16384
 v_mfma_f32_16x16x32_bf16 a[224:227], v[36:39], v[32:35], 0
 buffer_store_dwordx4 v[172:175], v153, s[4:7], s39 offen offset:2048 sc1
 v_mfma_f32_16x16x32_bf16 a[4:7], v[40:43], v[4:7], 0
 s_add_u32 s39, s39, 0x1000
 ds_read_b64_tr_b16 v[106:107], v147 offset:18432
 v_mfma_f32_16x16x32_bf16 a[36:39], v[40:43], v[8:11], 0
 buffer_store_dwordx4 v[176:179], v153, s[4:7], s39 offen offset:0 sc1
 v_mfma_f32_16x16x32_bf16 a[68:71], v[40:43], v[12:15], 0
 ds_read_b64_tr_b16 v[108:109], v146 offset:16640
 v_mfma_f32_16x16x32_bf16 a[100:103], v[40:43], v[16:19], 0
 ds_read_b64_tr_b16 v[110:111], v146 offset:18688
 v_mfma_f32_16x16x32_bf16 a[132:135], v[40:43], v[20:23], 0
 buffer_store_dwordx4 v[180:183], v153, s[4:7], s39 offen offset:2048 sc1
 v_mfma_f32_16x16x32_bf16 a[164:167], v[40:43], v[24:27], 0
 s_add_u32 s39, s39, 0x1000
 v_mfma_f32_16x16x32_bf16 a[196:199], v[40:43], v[28:31], 0
 ds_read_b64_tr_b16 v[112:113], v147 offset:16640
 v_mfma_f32_16x16x32_bf16 a[228:231], v[40:43], v[32:35], 0
 buffer_store_dwordx4 v[184:187], v153, s[4:7], s39 offen offset:0 sc1
 v_mfma_f32_16x16x32_bf16 a[8:11], v[44:47], v[4:7], 0
 ds_read_b64_tr_b16 v[114:115], v147 offset:18688
 v_mfma_f32_16x16x32_bf16 a[40:43], v[44:47], v[8:11], 0
 buffer_store_dwordx4 v[188:191], v153, s[4:7], s39 offen offset:2048 sc1
 v_mfma_f32_16x16x32_bf16 a[72:75], v[44:47], v[12:15], 0
 ds_read_b64_tr_b16 v[116:117], v146 offset:16896
 v_mfma_f32_16x16x32_bf16 a[104:107], v[44:47], v[16:19], 0
 s_add_u32 s39, s39, 0x1000
 v_mfma_f32_16x16x32_bf16 a[136:139], v[44:47], v[20:23], 0
 ds_read_b64_tr_b16 v[118:119], v146 offset:18944
 v_mfma_f32_16x16x32_bf16 a[168:171], v[44:47], v[24:27], 0
 buffer_store_dwordx4 v[192:195], v153, s[4:7], s39 offen offset:0 sc1
 v_mfma_f32_16x16x32_bf16 a[200:203], v[44:47], v[28:31], 0
 ds_read_b64_tr_b16 v[120:121], v147 offset:16896
 v_mfma_f32_16x16x32_bf16 a[232:235], v[44:47], v[32:35], 0
 buffer_store_dwordx2 v[216:217], v150, s[4:7], s34 offen sc1
 v_mfma_f32_16x16x32_bf16 a[12:15], v[48:51], v[4:7], 0
 ds_read_b64_tr_b16 v[122:123], v147 offset:18944
 s_mov_b32 m0, s42
 v_mfma_f32_16x16x32_bf16 a[44:47], v[48:51], v[8:11], 0
 ds_read_b64_tr_b16 v[124:125], v146 offset:17152
 v_mfma_f32_16x16x32_bf16 a[76:79], v[48:51], v[12:15], 0
 buffer_load_dwordx4 v132, s[12:15], s41 offen offset:0 lds
 v_mfma_f32_16x16x32_bf16 a[108:111], v[48:51], v[16:19], 0
 v_mfma_f32_16x16x32_bf16 a[140:143], v[48:51], v[20:23], 0
 ds_read_b64_tr_b16 v[126:127], v146 offset:19200
 v_mfma_f32_16x16x32_bf16 a[172:175], v[48:51], v[24:27], 0
 buffer_load_dwordx4 v133, s[12:15], s41 offen offset:1024 lds
 v_mfma_f32_16x16x32_bf16 a[204:207], v[48:51], v[28:31], 0
 ds_read_b64_tr_b16 v[128:129], v147 offset:17152
 v_mfma_f32_16x16x32_bf16 a[236:239], v[48:51], v[32:35], 0
 buffer_load_dwordx4 v134, s[12:15], s41 offen offset:2048 lds
 v_mfma_f32_16x16x32_bf16 a[16:19], v[52:55], v[4:7], 0
 ds_read_b64_tr_b16 v[130:131], v147 offset:19200
 v_mfma_f32_16x16x32_bf16 a[48:51], v[52:55], v[8:11], 0
 ds_read_b128 v[72:75], v145 offset:2048
 v_mfma_f32_16x16x32_bf16 a[80:83], v[52:55], v[12:15], 0
 buffer_load_dwordx4 v135, s[12:15], s41 offen offset:3072 lds
 v_mfma_f32_16x16x32_bf16 a[112:115], v[52:55], v[16:19], 0
 s_mov_b32 m0, s43
 v_mfma_f32_16x16x32_bf16 a[144:147], v[52:55], v[20:23], 0
 ds_read_b128 v[76:79], v145 offset:4096
 v_mfma_f32_16x16x32_bf16 a[176:179], v[52:55], v[24:27], 0
 buffer_load_dwordx4 v140, s[16:19], s32 offen offset:0 lds
 v_mfma_f32_16x16x32_bf16 a[208:211], v[52:55], v[28:31], 0
 ds_read_b128 v[80:83], v145 offset:6144
 v_mfma_f32_16x16x32_bf16 a[240:243], v[52:55], v[32:35], 0
 buffer_load_dwordx4 v141, s[16:19], s32 offen offset:1024 lds
 v_mfma_f32_16x16x32_bf16 a[20:23], v[56:59], v[4:7], 0
 ds_read_b128 v[84:87], v145 offset:8192
 v_mfma_f32_16x16x32_bf16 a[52:55], v[56:59], v[8:11], 0
 v_mfma_f32_16x16x32_bf16 a[84:87], v[56:59], v[12:15], 0
 ds_read_b128 v[88:91], v145 offset:10240
 v_mfma_f32_16x16x32_bf16 a[116:119], v[56:59], v[16:19], 0
 buffer_load_dwordx4 v142, s[16:19], s32 offen offset:2048 lds
 v_mfma_f32_16x16x32_bf16 a[148:151], v[56:59], v[20:23], 0
 ds_read_b128 v[92:95], v145 offset:12288
 v_mfma_f32_16x16x32_bf16 a[180:183], v[56:59], v[24:27], 0
 buffer_load_dwordx4 v143, s[16:19], s32 offen offset:3072 lds
 v_mfma_f32_16x16x32_bf16 a[212:215], v[56:59], v[28:31], 0
 s_add_u32 s43, s43, 0x4000
 s_and_b32 s43, s43, 0xffff
 v_mfma_f32_16x16x32_bf16 a[244:247], v[56:59], v[32:35], 0
 ds_read_b128 v[96:99], v145 offset:14336
 s_add_u32 s32, s32, 0x40000
 v_mfma_f32_16x16x32_bf16 a[24:27], v[60:63], v[4:7], 0
 s_add_u32 m0, s42, 0x1000
 v_mfma_f32_16x16x32_bf16 a[56:59], v[60:63], v[8:11], 0
 buffer_load_dwordx4 v136, s[12:15], s41 offen offset:0 lds
 v_mfma_f32_16x16x32_bf16 a[88:91], v[60:63], v[12:15], 0
 v_add_u32 v144, s69, v144
 v_add_u32 v145, s69, v145
 v_mfma_f32_16x16x32_bf16 a[120:123], v[60:63], v[16:19], 0
 buffer_load_dwordx4 v137, s[12:15], s41 offen offset:1024 lds
 v_mfma_f32_16x16x32_bf16 a[152:155], v[60:63], v[20:23], 0
 v_xor_b32 v146, 0x8000, v146
 v_mfma_f32_16x16x32_bf16 a[184:187], v[60:63], v[24:27], 0
 v_xor_b32 v147, 0x8000, v147
 v_mfma_f32_16x16x32_bf16 a[216:219], v[60:63], v[28:31], 0
 buffer_load_dwordx4 v138, s[12:15], s41 offen offset:2048 lds
 v_mfma_f32_16x16x32_bf16 a[248:251], v[60:63], v[32:35], 0
 v_mfma_f32_16x16x32_bf16 a[28:31], v[64:67], v[4:7], 0
 buffer_load_dwordx4 v139, s[12:15], s41 offen offset:3072 lds
 v_mfma_f32_16x16x32_bf16 a[60:63], v[64:67], v[8:11], 0
 s_add_u32 s42, s42, 0x8000
 s_cmp_ge_u32 s42, 0x28000
 v_mfma_f32_16x16x32_bf16 a[92:95], v[64:67], v[12:15], 0
 s_cselect_b32 s9, 0x18000, 0
 s_sub_u32 s42, s42, s9
 v_mfma_f32_16x16x32_bf16 a[124:127], v[64:67], v[16:19], 0
 s_add_u32 s41, s41, 128
 v_mfma_f32_16x16x32_bf16 a[156:159], v[64:67], v[20:23], 0
 buffer_load_dwordx4 v[156:159], v2, s[48:51], s56 offen
 v_mfma_f32_16x16x32_bf16 a[188:191], v[64:67], v[24:27], 0
 s_add_u32 s56, s56, 1024
 v_mfma_f32_16x16x32_bf16 a[220:223], v[64:67], v[28:31], 0
 v_mfma_f32_16x16x32_bf16 a[252:255], v[64:67], v[32:35], 0
 s_waitcnt vmcnt(25) lgkmcnt(0)
 s_barrier
 v_mfma_f32_16x16x32_bf16 a[0:3], v[100:103], v[68:71], a[0:3]
 ds_read_b128 v[4:7], v144 offset:0
 v_mfma_f32_16x16x32_bf16 a[32:35], v[100:103], v[72:75], a[32:35]
 s_mov_b32 m0, s43
 ds_read_b64_tr_b16 v[36:37], v146 offset:0
 v_mfma_f32_16x16x32_bf16 a[64:67], v[100:103], v[76:79], a[64:67]
 buffer_load_dwordx4 v140, s[16:19], s32 offen offset:0 lds
 v_mfma_f32_16x16x32_bf16 a[96:99], v[100:103], v[80:83], a[96:99]
 v_mfma_f32_16x16x32_bf16 a[128:131], v[100:103], v[84:87], a[128:131]
 ds_read_b64_tr_b16 v[38:39], v146 offset:2048
 v_mfma_f32_16x16x32_bf16 a[160:163], v[100:103], v[88:91], a[160:163]
 v_mfma_f32_16x16x32_bf16 a[192:195], v[100:103], v[92:95], a[192:195]
 ds_read_b64_tr_b16 v[40:41], v147 offset:0
 v_mfma_f32_16x16x32_bf16 a[224:227], v[100:103], v[96:99], a[224:227]
 v_mfma_f32_16x16x32_bf16 a[4:7], v[104:107], v[68:71], a[4:7]
 ds_read_b64_tr_b16 v[42:43], v147 offset:2048
 v_mfma_f32_16x16x32_bf16 a[36:39], v[104:107], v[72:75], a[36:39]
 buffer_load_dwordx4 v141, s[16:19], s32 offen offset:1024 lds
 v_mfma_f32_16x16x32_bf16 a[68:71], v[104:107], v[76:79], a[68:71]
 ds_read_b64_tr_b16 v[44:45], v146 offset:256
 v_mfma_f32_16x16x32_bf16 a[100:103], v[104:107], v[80:83], a[100:103]
 v_mfma_f32_16x16x32_bf16 a[132:135], v[104:107], v[84:87], a[132:135]
 ds_read_b64_tr_b16 v[46:47], v146 offset:2304
 v_mfma_f32_16x16x32_bf16 a[164:167], v[104:107], v[88:91], a[164:167]
 v_mfma_f32_16x16x32_bf16 a[196:199], v[104:107], v[92:95], a[196:199]
 ds_read_b64_tr_b16 v[48:49], v147 offset:256
 v_mfma_f32_16x16x32_bf16 a[228:231], v[104:107], v[96:99], a[228:231]
 v_mfma_f32_16x16x32_bf16 a[8:11], v[108:111], v[68:71], a[8:11]
 ds_read_b64_tr_b16 v[50:51], v147 offset:2304
 v_mfma_f32_16x16x32_bf16 a[40:43], v[108:111], v[72:75], a[40:43]
 buffer_load_dwordx4 v142, s[16:19], s32 offen offset:2048 lds
 v_mfma_f32_16x16x32_bf16 a[72:75], v[108:111], v[76:79], a[72:75]
 ds_read_b64_tr_b16 v[52:53], v146 offset:512
 v_mfma_f32_16x16x32_bf16 a[104:107], v[108:111], v[80:83], a[104:107]
 v_mfma_f32_16x16x32_bf16 a[136:139], v[108:111], v[84:87], a[136:139]
 ds_read_b64_tr_b16 v[54:55], v146 offset:2560
 v_mfma_f32_16x16x32_bf16 a[168:171], v[108:111], v[88:91], a[168:171]
 v_mfma_f32_16x16x32_bf16 a[200:203], v[108:111], v[92:95], a[200:203]
 ds_read_b64_tr_b16 v[56:57], v147 offset:512
 v_mfma_f32_16x16x32_bf16 a[232:235], v[108:111], v[96:99], a[232:235]
 v_mfma_f32_16x16x32_bf16 a[12:15], v[112:115], v[68:71], a[12:15]
 ds_read_b64_tr_b16 v[58:59], v147 offset:2560
 v_mfma_f32_16x16x32_bf16 a[44:47], v[112:115], v[72:75], a[44:47]
 buffer_load_dwordx4 v143, s[16:19], s32 offen offset:3072 lds
 v_mfma_f32_16x16x32_bf16 a[76:79], v[112:115], v[76:79], a[76:79]
 ds_read_b64_tr_b16 v[60:61], v146 offset:768
 s_add_u32 s43, s43, 0x4000
 v_mfma_f32_16x16x32_bf16 a[108:111], v[112:115], v[80:83], a[108:111]
 v_mfma_f32_16x16x32_bf16 a[140:143], v[112:115], v[84:87], a[140:143]
 s_and_b32 s43, s43, 0xffff
 ds_read_b64_tr_b16 v[62:63], v146 offset:2816
 v_mfma_f32_16x16x32_bf16 a[172:175], v[112:115], v[88:91], a[172:175]
 s_add_u32 s32, s32, 0x40000
 v_mfma_f32_16x16x32_bf16 a[204:207], v[112:115], v[92:95], a[204:207]
 ds_read_b64_tr_b16 v[64:65], v147 offset:768
 v_mfma_f32_16x16x32_bf16 a[236:239], v[112:115], v[96:99], a[236:239]
 s_mov_b32 m0, s42
 v_mfma_f32_16x16x32_bf16 a[16:19], v[116:119], v[68:71], a[16:19]
 ds_read_b64_tr_b16 v[66:67], v147 offset:2816
 v_mfma_f32_16x16x32_bf16 a[48:51], v[116:119], v[72:75], a[48:51]
 buffer_load_dwordx4 v132, s[12:15], s41 offen offset:0 lds
 v_mfma_f32_16x16x32_bf16 a[80:83], v[116:119], v[76:79], a[80:83]
 ds_read_b128 v[8:11], v144 offset:2048
 v_mfma_f32_16x16x32_bf16 a[112:115], v[116:119], v[80:83], a[112:115]
 v_mfma_f32_16x16x32_bf16 a[144:147], v[116:119], v[84:87], a[144:147]
 ds_read_b128 v[12:15], v144 offset:4096
 v_mfma_f32_16x16x32_bf16 a[176:179], v[116:119], v[88:91], a[176:179]
 v_mfma_f32_16x16x32_bf16 a[208:211], v[116:119], v[92:95], a[208:211]
 ds_read_b128 v[16:19], v144 offset:6144
 v_mfma_f32_16x16x32_bf16 a[240:243], v[116:119], v[96:99], a[240:243]
 v_mfma_f32_16x16x32_bf16 a[20:23], v[120:123], v[68:71], a[20:23]
 ds_read_b128 v[20:23], v144 offset:8192
 v_mfma_f32_16x16x32_bf16 a[52:55], v[120:123], v[72:75], a[52:55]
 buffer_load_dwordx4 v133, s[12:15], s41 offen offset:1024 lds
 v_mfma_f32_16x16x32_bf16 a[84:87], v[120:123], v[76:79], a[84:87]
 ds_read_b128 v[24:27], v144 offset:10240
 v_mfma_f32_16x16x32_bf16 a[116:119], v[120:123], v[80:83], a[116:119]
 v_mfma_f32_16x16x32_bf16 a[148:151], v[120:123], v[84:87], a[148:151]
 ds_read_b128 v[28:31], v144 offset:12288
 v_mfma_f32_16x16x32_bf16 a[180:183], v[120:123], v[88:91], a[180:183]
 v_mfma_f32_16x16x32_bf16 a[212:215], v[120:123], v[92:95], a[212:215]
 ds_read_b128 v[32:35], v144 offset:14336
 v_mfma_f32_16x16x32_bf16 a[244:247], v[120:123], v[96:99], a[244:247]
 v_mfma_f32_16x16x32_bf16 a[24:27], v[124:127], v[68:71], a[24:27]
 buffer_load_dwordx4 v134, s[12:15], s41 offen offset:2048 lds
 v_mfma_f32_16x16x32_bf16 a[56:59], v[124:127], v[72:75], a[56:59]
 v_mfma_f32_16x16x32_bf16 a[88:91], v[124:127], v[76:79], a[88:91]
 v_mfma_f32_16x16x32_bf16 a[120:123], v[124:127], v[80:83], a[120:123]
 v_mfma_f32_16x16x32_bf16 a[152:155], v[124:127], v[84:87], a[152:155]
 v_mfma_f32_16x16x32_bf16 a[184:187], v[124:127], v[88:91], a[184:187]
 v_mfma_f32_16x16x32_bf16 a[216:219], v[124:127], v[92:95], a[216:219]
 v_mfma_f32_16x16x32_bf16 a[248:251], v[124:127], v[96:99], a[248:251]
 v_mfma_f32_16x16x32_bf16 a[28:31], v[128:131], v[68:71], a[28:31]
 buffer_load_dwordx4 v135, s[12:15], s41 offen offset:3072 lds
 v_mfma_f32_16x16x32_bf16 a[60:63], v[128:131], v[72:75], a[60:63]
 v_mfma_f32_16x16x32_bf16 a[92:95], v[128:131], v[76:79], a[92:95]
 v_mfma_f32_16x16x32_bf16 a[124:127], v[128:131], v[80:83], a[124:127]
 v_mfma_f32_16x16x32_bf16 a[156:159], v[128:131], v[84:87], a[156:159]
 v_mfma_f32_16x16x32_bf16 a[188:191], v[128:131], v[88:91], a[188:191]
 v_mfma_f32_16x16x32_bf16 a[220:223], v[128:131], v[92:95], a[220:223]
 v_mfma_f32_16x16x32_bf16 a[252:255], v[128:131], v[96:99], a[252:255]
 s_waitcnt vmcnt(29) lgkmcnt(0)
 s_barrier
 v_mfma_f32_16x16x32_bf16 a[0:3], v[36:39], v[4:7], a[0:3]
 ds_read_b128 v[68:71], v145 offset:0
 v_mfma_f32_16x16x32_bf16 a[32:35], v[36:39], v[8:11], a[32:35]
 s_add_u32 s10, s44, 0x8000
 s_cmp_eq_u32 s10, 0x18000
 v_mfma_f32_16x16x32_bf16 a[64:67], v[36:39], v[12:15], a[64:67]
 s_cselect_b32 s10, 0, s10
 ds_read_b64_tr_b16 v[100:101], v146 offset:16384
 v_mfma_f32_16x16x32_bf16 a[96:99], v[36:39], v[16:19], a[96:99]
 s_sub_u32 s69, s10, s44
 s_mov_b32 s44, s10
 v_mfma_f32_16x16x32_bf16 a[128:131], v[36:39], v[20:23], a[128:131]
 s_mov_b32 m0, s43
 ds_read_b64_tr_b16 v[102:103], v146 offset:18432
 v_mfma_f32_16x16x32_bf16 a[160:163], v[36:39], v[24:27], a[160:163]
 buffer_load_dwordx4 v140, s[16:19], s32 offen offset:0 lds
 v_mfma_f32_16x16x32_bf16 a[192:195], v[36:39], v[28:31], a[192:195]
 ds_read_b64_tr_b16 v[104:105], v147 offset:16384
 v_mfma_f32_16x16x32_bf16 a[224:227], v[36:39], v[32:35], a[224:227]
 v_mfma_f32_16x16x32_bf16 a[4:7], v[40:43], v[4:7], a[4:7]
 ds_read_b64_tr_b16 v[106:107], v147 offset:18432
 v_mfma_f32_16x16x32_bf16 a[36:39], v[40:43], v[8:11], a[36:39]
 v_mfma_f32_16x16x32_bf16 a[68:71], v[40:43], v[12:15], a[68:71]
 ds_read_b64_tr_b16 v[108:109], v146 offset:16640
 v_mfma_f32_16x16x32_bf16 a[100:103], v[40:43], v[16:19], a[100:103]
 buffer_load_dwordx4 v141, s[16:19], s32 offen offset:1024 lds
 v_mfma_f32_16x16x32_bf16 a[132:135], v[40:43], v[20:23], a[132:135]
 ds_read_b64_tr_b16 v[110:111], v146 offset:18688
 v_mfma_f32_16x16x32_bf16 a[164:167], v[40:43], v[24:27], a[164:167]
 v_mfma_f32_16x16x32_bf16 a[196:199], v[40:43], v[28:31], a[196:199]
 ds_read_b64_tr_b16 v[112:113], v147 offset:16640
 v_mfma_f32_16x16x32_bf16 a[228:231], v[40:43], v[32:35], a[228:231]
 v_mfma_f32_16x16x32_bf16 a[8:11], v[44:47], v[4:7], a[8:11]
 ds_read_b64_tr_b16 v[114:115], v147 offset:18688
 v_mfma_f32_16x16x32_bf16 a[40:43], v[44:47], v[8:11], a[40:43]
 buffer_load_dwordx4 v142, s[16:19], s32 offen offset:2048 lds
 v_mfma_f32_16x16x32_bf16 a[72:75], v[44:47], v[12:15], a[72:75]
 ds_read_b64_tr_b16 v[116:117], v146 offset:16896
 v_mfma_f32_16x16x32_bf16 a[104:107], v[44:47], v[16:19], a[104:107]
 v_mfma_f32_16x16x32_bf16 a[136:139], v[44:47], v[20:23], a[136:139]
 ds_read_b64_tr_b16 v[118:119], v146 offset:18944
 v_mfma_f32_16x16x32_bf16 a[168:171], v[44:47], v[24:27], a[168:171]
 v_mfma_f32_16x16x32_bf16 a[200:203], v[44:47], v[28:31], a[200:203]
 ds_read_b64_tr_b16 v[120:121], v147 offset:16896
 v_mfma_f32_16x16x32_bf16 a[232:235], v[44:47], v[32:35], a[232:235]
 buffer_load_dwordx4 v143, s[16:19], s32 offen offset:3072 lds
 v_mfma_f32_16x16x32_bf16 a[12:15], v[48:51], v[4:7], a[12:15]
 ds_read_b64_tr_b16 v[122:123], v147 offset:18944
 v_mfma_f32_16x16x32_bf16 a[44:47], v[48:51], v[8:11], a[44:47]
 s_add_u32 s43, s43, 0x4000
 v_mfma_f32_16x16x32_bf16 a[76:79], v[48:51], v[12:15], a[76:79]
 ds_read_b64_tr_b16 v[124:125], v146 offset:17152
 s_and_b32 s43, s43, 0xffff
 v_mfma_f32_16x16x32_bf16 a[108:111], v[48:51], v[16:19], a[108:111]
 s_add_u32 s32, s32, 0x40000
 v_mfma_f32_16x16x32_bf16 a[140:143], v[48:51], v[20:23], a[140:143]
 ds_read_b64_tr_b16 v[126:127], v146 offset:19200
 v_mfma_f32_16x16x32_bf16 a[172:175], v[48:51], v[24:27], a[172:175]
 s_add_u32 m0, s42, 0x1000
 ds_read_b64_tr_b16 v[128:129], v147 offset:17152
 v_mfma_f32_16x16x32_bf16 a[204:207], v[48:51], v[28:31], a[204:207]
 buffer_load_dwordx4 v136, s[12:15], s41 offen offset:0 lds
 v_mfma_f32_16x16x32_bf16 a[236:239], v[48:51], v[32:35], a[236:239]
 v_mfma_f32_16x16x32_bf16 a[16:19], v[52:55], v[4:7], a[16:19]
 ds_read_b64_tr_b16 v[130:131], v147 offset:19200
 v_mfma_f32_16x16x32_bf16 a[48:51], v[52:55], v[8:11], a[48:51]
 v_mfma_f32_16x16x32_bf16 a[80:83], v[52:55], v[12:15], a[80:83]
 ds_read_b128 v[72:75], v145 offset:2048
 v_mfma_f32_16x16x32_bf16 a[112:115], v[52:55], v[16:19], a[112:115]
 v_mfma_f32_16x16x32_bf16 a[144:147], v[52:55], v[20:23], a[144:147]
 ds_read_b128 v[76:79], v145 offset:4096
 v_mfma_f32_16x16x32_bf16 a[176:179], v[52:55], v[24:27], a[176:179]
 buffer_load_dwordx4 v137, s[12:15], s41 offen offset:1024 lds
 v_mfma_f32_16x16x32_bf16 a[208:211], v[52:55], v[28:31], a[208:211]
 ds_read_b128 v[80:83], v145 offset:6144
 v_mfma_f32_16x16x32_bf16 a[240:243], v[52:55], v[32:35], a[240:243]
 v_mfma_f32_16x16x32_bf16 a[20:23], v[56:59], v[4:7], a[20:23]
 ds_read_b128 v[84:87], v145 offset:8192
 v_mfma_f32_16x16x32_bf16 a[52:55], v[56:59], v[8:11], a[52:55]
 v_mfma_f32_16x16x32_bf16 a[84:87], v[56:59], v[12:15], a[84:87]
 ds_read_b128 v[88:91], v145 offset:10240
 v_mfma_f32_16x16x32_bf16 a[116:119], v[56:59], v[16:19], a[116:119]
 buffer_load_dwordx4 v138, s[12:15], s41 offen offset:2048 lds
 v_mfma_f32_16x16x32_bf16 a[148:151], v[56:59], v[20:23], a[148:151]
 ds_read_b128 v[92:95], v145 offset:12288
 v_mfma_f32_16x16x32_bf16 a[180:183], v[56:59], v[24:27], a[180:183]
 v_mfma_f32_16x16x32_bf16 a[212:215], v[56:59], v[28:31], a[212:215]
 ds_read_b128 v[96:99], v145 offset:14336
 v_mfma_f32_16x16x32_bf16 a[244:247], v[56:59], v[32:35], a[244:247]
 v_mfma_f32_16x16x32_bf16 a[24:27], v[60:63], v[4:7], a[24:27]
 v_mfma_f32_16x16x32_bf16 a[56:59], v[60:63], v[8:11], a[56:59]
 buffer_load_dwordx4 v139, s[12:15], s41 offen offset:3072 lds
 v_mfma_f32_16x16x32_bf16 a[88:91], v[60:63], v[12:15], a[88:91]
 v_add_u32 v144, s69, v144
 v_mfma_f32_16x16x32_bf16 a[120:123], v[60:63], v[16:19], a[120:123]
 s_add_u32 s42, s42, 0x8000
 v_add_u32 v145, s69, v145
 v_mfma_f32_16x16x32_bf16 a[152:155], v[60:63], v[20:23], a[152:155]
 s_cmp_ge_u32 s42, 0x28000
 v_xor_b32 v146, 0x8000, v146
 v_mfma_f32_16x16x32_bf16 a[184:187], v[60:63], v[24:27], a[184:187]
 s_cselect_b32 s9, 0x18000, 0
 v_xor_b32 v147, 0x8000, v147
 v_mfma_f32_16x16x32_bf16 a[216:219], v[60:63], v[28:31], a[216:219]
 s_sub_u32 s42, s42, s9
 v_mfma_f32_16x16x32_bf16 a[248:251], v[60:63], v[32:35], a[248:251]
 s_add_u32 s41, s41, 128
 v_mfma_f32_16x16x32_bf16 a[28:31], v[64:67], v[4:7], a[28:31]
 buffer_load_dwordx4 v[156:159], v2, s[48:51], s56 offen
 v_mfma_f32_16x16x32_bf16 a[60:63], v[64:67], v[8:11], a[60:63]
 v_mfma_f32_16x16x32_bf16 a[92:95], v[64:67], v[12:15], a[92:95]
 v_mfma_f32_16x16x32_bf16 a[124:127], v[64:67], v[16:19], a[124:127]
 s_add_u32 s56, s56, 1024
 v_mfma_f32_16x16x32_bf16 a[156:159], v[64:67], v[20:23], a[156:159]
 v_mfma_f32_16x16x32_bf16 a[188:191], v[64:67], v[24:27], a[188:191]
 v_mfma_f32_16x16x32_bf16 a[220:223], v[64:67], v[28:31], a[220:223]
 v_mfma_f32_16x16x32_bf16 a[252:255], v[64:67], v[32:35], a[252:255]
 s_waitcnt vmcnt(18) lgkmcnt(0)
 s_barrier
 v_mfma_f32_16x16x32_bf16 a[0:3], v[100:103], v[68:71], a[0:3]
 ds_read_b128 v[4:7], v144 offset:0
 v_mfma_f32_16x16x32_bf16 a[32:35], v[100:103], v[72:75], a[32:35]
 s_mov_b32 m0, s43
 ds_read_b64_tr_b16 v[36:37], v146 offset:0
 v_mfma_f32_16x16x32_bf16 a[64:67], v[100:103], v[76:79], a[64:67]
 buffer_load_dwordx4 v140, s[16:19], s32 offen offset:0 lds
 v_mfma_f32_16x16x32_bf16 a[96:99], v[100:103], v[80:83], a[96:99]
 v_mfma_f32_16x16x32_bf16 a[128:131], v[100:103], v[84:87], a[128:131]
 ds_read_b64_tr_b16 v[38:39], v146 offset:2048
 v_mfma_f32_16x16x32_bf16 a[160:163], v[100:103], v[88:91], a[160:163]
 v_mfma_f32_16x16x32_bf16 a[192:195], v[100:103], v[92:95], a[192:195]
 ds_read_b64_tr_b16 v[40:41], v147 offset:0
 v_mfma_f32_16x16x32_bf16 a[224:227], v[100:103], v[96:99], a[224:227]
 v_mfma_f32_16x16x32_bf16 a[4:7], v[104:107], v[68:71], a[4:7]
 ds_read_b64_tr_b16 v[42:43], v147 offset:2048
 v_mfma_f32_16x16x32_bf16 a[36:39], v[104:107], v[72:75], a[36:39]
 buffer_load_dwordx4 v141, s[16:19], s32 offen offset:1024 lds
 v_mfma_f32_16x16x32_bf16 a[68:71], v[104:107], v[76:79], a[68:71]
 ds_read_b64_tr_b16 v[44:45], v146 offset:256
 v_mfma_f32_16x16x32_bf16 a[100:103], v[104:107], v[80:83], a[100:103]
 v_mfma_f32_16x16x32_bf16 a[132:135], v[104:107], v[84:87], a[132:135]
 ds_read_b64_tr_b16 v[46:47], v146 offset:2304
 v_mfma_f32_16x16x32_bf16 a[164:167], v[104:107], v[88:91], a[164:167]
 v_mfma_f32_16x16x32_bf16 a[196:199], v[104:107], v[92:95], a[196:199]
 ds_read_b64_tr_b16 v[48:49], v147 offset:256
 v_mfma_f32_16x16x32_bf16 a[228:231], v[104:107], v[96:99], a[228:231]
 v_mfma_f32_16x16x32_bf16 a[8:11], v[108:111], v[68:71], a[8:11]
 ds_read_b64_tr_b16 v[50:51], v147 offset:2304
 v_mfma_f32_16x16x32_bf16 a[40:43], v[108:111], v[72:75], a[40:43]
 buffer_load_dwordx4 v142, s[16:19], s32 offen offset:2048 lds
 v_mfma_f32_16x16x32_bf16 a[72:75], v[108:111], v[76:79], a[72:75]
 ds_read_b64_tr_b16 v[52:53], v146 offset:512
 v_mfma_f32_16x16x32_bf16 a[104:107], v[108:111], v[80:83], a[104:107]
 v_mfma_f32_16x16x32_bf16 a[136:139], v[108:111], v[84:87], a[136:139]
 ds_read_b64_tr_b16 v[54:55], v146 offset:2560
 v_mfma_f32_16x16x32_bf16 a[168:171], v[108:111], v[88:91], a[168:171]
 v_mfma_f32_16x16x32_bf16 a[200:203], v[108:111], v[92:95], a[200:203]
 ds_read_b64_tr_b16 v[56:57], v147 offset:512
 v_mfma_f32_16x16x32_bf16 a[232:235], v[108:111], v[96:99], a[232:235]
 v_mfma_f32_16x16x32_bf16 a[12:15], v[112:115], v[68:71], a[12:15]
 ds_read_b64_tr_b16 v[58:59], v147 offset:2560
 v_mfma_f32_16x16x32_bf16 a[44:47], v[112:115], v[72:75], a[44:47]
 buffer_load_dwordx4 v143, s[16:19], s32 offen offset:3072 lds
 v_mfma_f32_16x16x32_bf16 a[76:79], v[112:115], v[76:79], a[76:79]
 ds_read_b64_tr_b16 v[60:61], v146 offset:768
 s_add_u32 s43, s43, 0x4000
 v_mfma_f32_16x16x32_bf16 a[108:111], v[112:115], v[80:83], a[108:111]
 v_mfma_f32_16x16x32_bf16 a[140:143], v[112:115], v[84:87], a[140:143]
 s_and_b32 s43, s43, 0xffff
 ds_read_b64_tr_b16 v[62:63], v146 offset:2816
 v_mfma_f32_16x16x32_bf16 a[172:175], v[112:115], v[88:91], a[172:175]
 s_add_u32 s32, s32, 0x40000
 v_mfma_f32_16x16x32_bf16 a[204:207], v[112:115], v[92:95], a[204:207]
 ds_read_b64_tr_b16 v[64:65], v147 offset:768
 v_mfma_f32_16x16x32_bf16 a[236:239], v[112:115], v[96:99], a[236:239]
 s_mov_b32 m0, s42
 v_mfma_f32_16x16x32_bf16 a[16:19], v[116:119], v[68:71], a[16:19]
 ds_read_b64_tr_b16 v[66:67], v147 offset:2816
 v_mfma_f32_16x16x32_bf16 a[48:51], v[116:119], v[72:75], a[48:51]
 buffer_load_dwordx4 v132, s[12:15], s41 offen offset:0 lds
 v_mfma_f32_16x16x32_bf16 a[80:83], v[116:119], v[76:79], a[80:83]
 ds_read_b128 v[8:11], v144 offset:2048
 v_mfma_f32_16x16x32_bf16 a[112:115], v[116:119], v[80:83], a[112:115]
 v_mfma_f32_16x16x32_bf16 a[144:147], v[116:119], v[84:87], a[144:147]
 ds_read_b128 v[12:15], v144 offset:4096
 v_mfma_f32_16x16x32_bf16 a[176:179], v[116:119], v[88:91], a[176:179]
 v_mfma_f32_16x16x32_bf16 a[208:211], v[116:119], v[92:95], a[208:211]
 ds_read_b128 v[16:19], v144 offset:6144
 v_mfma_f32_16x16x32_bf16 a[240:243], v[116:119], v[96:99], a[240:243]
 v_mfma_f32_16x16x32_bf16 a[20:23], v[120:123], v[68:71], a[20:23]
 ds_read_b128 v[20:23], v144 offset:8192
 v_mfma_f32_16x16x32_bf16 a[52:55], v[120:123], v[72:75], a[52:55]
 buffer_load_dwordx4 v133, s[12:15], s41 offen offset:1024 lds
 v_mfma_f32_16x16x32_bf16 a[84:87], v[120:123], v[76:79], a[84:87]
 ds_read_b128 v[24:27], v144 offset:10240
 v_mfma_f32_16x16x32_bf16 a[116:119], v[120:123], v[80:83], a[116:119]
 v_mfma_f32_16x16x32_bf16 a[148:151], v[120:123], v[84:87], a[148:151]
 ds_read_b128 v[28:31], v144 offset:12288
 v_mfma_f32_16x16x32_bf16 a[180:183], v[120:123], v[88:91], a[180:183]
 v_mfma_f32_16x16x32_bf16 a[212:215], v[120:123], v[92:95], a[212:215]
 ds_read_b128 v[32:35], v144 offset:14336
 v_mfma_f32_16x16x32_bf16 a[244:247], v[120:123], v[96:99], a[244:247]
 v_mfma_f32_16x16x32_bf16 a[24:27], v[124:127], v[68:71], a[24:27]
 buffer_load_dwordx4 v134, s[12:15], s41 offen offset:2048 lds
 v_mfma_f32_16x16x32_bf16 a[56:59], v[124:127], v[72:75], a[56:59]
 v_mfma_f32_16x16x32_bf16 a[88:91], v[124:127], v[76:79], a[88:91]
 v_mfma_f32_16x16x32_bf16 a[120:123], v[124:127], v[80:83], a[120:123]
 v_mfma_f32_16x16x32_bf16 a[152:155], v[124:127], v[84:87], a[152:155]
 v_mfma_f32_16x16x32_bf16 a[184:187], v[124:127], v[88:91], a[184:187]
 v_mfma_f32_16x16x32_bf16 a[216:219], v[124:127], v[92:95], a[216:219]
 v_mfma_f32_16x16x32_bf16 a[248:251], v[124:127], v[96:99], a[248:251]
 v_mfma_f32_16x16x32_bf16 a[28:31], v[128:131], v[68:71], a[28:31]
 buffer_load_dwordx4 v135, s[12:15], s41 offen offset:3072 lds
 v_mfma_f32_16x16x32_bf16 a[60:63], v[128:131], v[72:75], a[60:63]
 v_mfma_f32_16x16x32_bf16 a[92:95], v[128:131], v[76:79], a[92:95]
 v_mfma_f32_16x16x32_bf16 a[124:127], v[128:131], v[80:83], a[124:127]
 v_mfma_f32_16x16x32_bf16 a[156:159], v[128:131], v[84:87], a[156:159]
 v_mfma_f32_16x16x32_bf16 a[188:191], v[128:131], v[88:91], a[188:191]
 v_mfma_f32_16x16x32_bf16 a[220:223], v[128:131], v[92:95], a[220:223]
 v_mfma_f32_16x16x32_bf16 a[252:255], v[128:131], v[96:99], a[252:255]
 s_waitcnt vmcnt(21) lgkmcnt(0)
 s_barrier
 v_mfma_f32_16x16x32_bf16 a[0:3], v[36:39], v[4:7], a[0:3]
 ds_read_b128 v[68:71], v145 offset:0
 v_mfma_f32_16x16x32_bf16 a[32:35], v[36:39], v[8:11], a[32:35]
 s_add_u32 s10, s44, 0x8000
 s_cmp_eq_u32 s10, 0x18000
 v_mfma_f32_16x16x32_bf16 a[64:67], v[36:39], v[12:15], a[64:67]
 s_cselect_b32 s10, 0, s10
 ds_read_b64_tr_b16 v[100:101], v146 offset:16384
 v_mfma_f32_16x16x32_bf16 a[96:99], v[36:39], v[16:19], a[96:99]
 s_sub_u32 s69, s10, s44
 s_mov_b32 s44, s10
 v_mfma_f32_16x16x32_bf16 a[128:131], v[36:39], v[20:23], a[128:131]
 s_mov_b32 m0, s43
 ds_read_b64_tr_b16 v[102:103], v146 offset:18432
 v_mfma_f32_16x16x32_bf16 a[160:163], v[36:39], v[24:27], a[160:163]
 buffer_load_dwordx4 v140, s[16:19], s32 offen offset:0 lds
 v_mfma_f32_16x16x32_bf16 a[192:195], v[36:39], v[28:31], a[192:195]
 ds_read_b64_tr_b16 v[104:105], v147 offset:16384
 v_mfma_f32_16x16x32_bf16 a[224:227], v[36:39], v[32:35], a[224:227]
 v_mfma_f32_16x16x32_bf16 a[4:7], v[40:43], v[4:7], a[4:7]
 ds_read_b64_tr_b16 v[106:107], v147 offset:18432
 v_mfma_f32_16x16x32_bf16 a[36:39], v[40:43], v[8:11], a[36:39]
 v_mfma_f32_16x16x32_bf16 a[68:71], v[40:43], v[12:15], a[68:71]
 ds_read_b64_tr_b16 v[108:109], v146 offset:16640
 v_mfma_f32_16x16x32_bf16 a[100:103], v[40:43], v[16:19], a[100:103]
 buffer_load_dwordx4 v141, s[16:19], s32 offen offset:1024 lds
 v_mfma_f32_16x16x32_bf16 a[132:135], v[40:43], v[20:23], a[132:135]
 ds_read_b64_tr_b16 v[110:111], v146 offset:18688
 v_mfma_f32_16x16x32_bf16 a[164:167], v[40:43], v[24:27], a[164:167]
 v_mfma_f32_16x16x32_bf16 a[196:199], v[40:43], v[28:31], a[196:199]
 ds_read_b64_tr_b16 v[112:113], v147 offset:16640
 v_mfma_f32_16x16x32_bf16 a[228:231], v[40:43], v[32:35], a[228:231]
 v_mfma_f32_16x16x32_bf16 a[8:11], v[44:47], v[4:7], a[8:11]
 ds_read_b64_tr_b16 v[114:115], v147 offset:18688
 v_mfma_f32_16x16x32_bf16 a[40:43], v[44:47], v[8:11], a[40:43]
 buffer_load_dwordx4 v142, s[16:19], s32 offen offset:2048 lds
 v_mfma_f32_16x16x32_bf16 a[72:75], v[44:47], v[12:15], a[72:75]
 ds_read_b64_tr_b16 v[116:117], v146 offset:16896
 v_mfma_f32_16x16x32_bf16 a[104:107], v[44:47], v[16:19], a[104:107]
 v_mfma_f32_16x16x32_bf16 a[136:139], v[44:47], v[20:23], a[136:139]
 ds_read_b64_tr_b16 v[118:119], v146 offset:18944
 v_mfma_f32_16x16x32_bf16 a[168:171], v[44:47], v[24:27], a[168:171]
 v_mfma_f32_16x16x32_bf16 a[200:203], v[44:47], v[28:31], a[200:203]
 ds_read_b64_tr_b16 v[120:121], v147 offset:16896
 v_mfma_f32_16x16x32_bf16 a[232:235], v[44:47], v[32:35], a[232:235]
 buffer_load_dwordx4 v143, s[16:19], s32 offen offset:3072 lds
 v_mfma_f32_16x16x32_bf16 a[12:15], v[48:51], v[4:7], a[12:15]
 ds_read_b64_tr_b16 v[122:123], v147 offset:18944
 v_mfma_f32_16x16x32_bf16 a[44:47], v[48:51], v[8:11], a[44:47]
 s_add_u32 s43, s43, 0x4000
 v_mfma_f32_16x16x32_bf16 a[76:79], v[48:51], v[12:15], a[76:79]
 ds_read_b64_tr_b16 v[124:125], v146 offset:17152
 s_and_b32 s43, s43, 0xffff
 v_mfma_f32_16x16x32_bf16 a[108:111], v[48:51], v[16:19], a[108:111]
 s_add_u32 s32, s32, 0x40000
 v_mfma_f32_16x16x32_bf16 a[140:143], v[48:51], v[20:23], a[140:143]
 ds_read_b64_tr_b16 v[126:127], v146 offset:19200
 v_mfma_f32_16x16x32_bf16 a[172:175], v[48:51], v[24:27], a[172:175]
 s_add_u32 m0, s42, 0x1000
 ds_read_b64_tr_b16 v[128:129], v147 offset:17152
 v_mfma_f32_16x16x32_bf16 a[204:207], v[48:51], v[28:31], a[204:207]
 buffer_load_dwordx4 v136, s[12:15], s41 offen offset:0 lds
 v_mfma_f32_16x16x32_bf16 a[236:239], v[48:51], v[32:35], a[236:239]
 v_mfma_f32_16x16x32_bf16 a[16:19], v[52:55], v[4:7], a[16:19]
 ds_read_b64_tr_b16 v[130:131], v147 offset:19200
 v_mfma_f32_16x16x32_bf16 a[48:51], v[52:55], v[8:11], a[48:51]
 v_mfma_f32_16x16x32_bf16 a[80:83], v[52:55], v[12:15], a[80:83]
 ds_read_b128 v[72:75], v145 offset:2048
 v_mfma_f32_16x16x32_bf16 a[112:115], v[52:55], v[16:19], a[112:115]
 v_mfma_f32_16x16x32_bf16 a[144:147], v[52:55], v[20:23], a[144:147]
 ds_read_b128 v[76:79], v145 offset:4096
 v_mfma_f32_16x16x32_bf16 a[176:179], v[52:55], v[24:27], a[176:179]
 buffer_load_dwordx4 v137, s[12:15], s41 offen offset:1024 lds
 v_mfma_f32_16x16x32_bf16 a[208:211], v[52:55], v[28:31], a[208:211]
 ds_read_b128 v[80:83], v145 offset:6144
 v_mfma_f32_16x16x32_bf16 a[240:243], v[52:55], v[32:35], a[240:243]
 v_mfma_f32_16x16x32_bf16 a[20:23], v[56:59], v[4:7], a[20:23]
 ds_read_b128 v[84:87], v145 offset:8192
 v_mfma_f32_16x16x32_bf16 a[52:55], v[56:59], v[8:11], a[52:55]
 v_mfma_f32_16x16x32_bf16 a[84:87], v[56:59], v[12:15], a[84:87]
 ds_read_b128 v[88:91], v145 offset:10240
 v_mfma_f32_16x16x32_bf16 a[116:119], v[56:59], v[16:19], a[116:119]
 buffer_load_dwordx4 v138, s[12:15], s41 offen offset:2048 lds
 v_mfma_f32_16x16x32_bf16 a[148:151], v[56:59], v[20:23], a[148:151]
 ds_read_b128 v[92:95], v145 offset:12288
 v_mfma_f32_16x16x32_bf16 a[180:183], v[56:59], v[24:27], a[180:183]
 v_mfma_f32_16x16x32_bf16 a[212:215], v[56:59], v[28:31], a[212:215]
 ds_read_b128 v[96:99], v145 offset:14336
 v_mfma_f32_16x16x32_bf16 a[244:247], v[56:59], v[32:35], a[244:247]
 v_mfma_f32_16x16x32_bf16 a[24:27], v[60:63], v[4:7], a[24:27]
 v_mfma_f32_16x16x32_bf16 a[56:59], v[60:63], v[8:11], a[56:59]
 buffer_load_dwordx4 v139, s[12:15], s41 offen offset:3072 lds
 v_mfma_f32_16x16x32_bf16 a[88:91], v[60:63], v[12:15], a[88:91]
 v_add_u32 v144, s69, v144
 v_mfma_f32_16x16x32_bf16 a[120:123], v[60:63], v[16:19], a[120:123]
 s_add_u32 s42, s42, 0x8000
 v_add_u32 v145, s69, v145
 v_mfma_f32_16x16x32_bf16 a[152:155], v[60:63], v[20:23], a[152:155]
 s_cmp_ge_u32 s42, 0x28000
 v_xor_b32 v146, 0x8000, v146
 v_mfma_f32_16x16x32_bf16 a[184:187], v[60:63], v[24:27], a[184:187]
 s_cselect_b32 s9, 0x18000, 0
 v_xor_b32 v147, 0x8000, v147
 v_mfma_f32_16x16x32_bf16 a[216:219], v[60:63], v[28:31], a[216:219]
 s_sub_u32 s42, s42, s9
 v_mfma_f32_16x16x32_bf16 a[248:251], v[60:63], v[32:35], a[248:251]
 s_add_u32 s41, s41, 128
 v_mfma_f32_16x16x32_bf16 a[28:31], v[64:67], v[4:7], a[28:31]
 buffer_load_dwordx4 v[156:159], v2, s[48:51], s56 offen
 v_mfma_f32_16x16x32_bf16 a[60:63], v[64:67], v[8:11], a[60:63]
 v_mfma_f32_16x16x32_bf16 a[92:95], v[64:67], v[12:15], a[92:95]
 v_mfma_f32_16x16x32_bf16 a[124:127], v[64:67], v[16:19], a[124:127]
 s_add_u32 s56, s56, 1024
 v_mfma_f32_16x16x32_bf16 a[156:159], v[64:67], v[20:23], a[156:159]
 v_mfma_f32_16x16x32_bf16 a[188:191], v[64:67], v[24:27], a[188:191]
 v_mfma_f32_16x16x32_bf16 a[220:223], v[64:67], v[28:31], a[220:223]
 v_mfma_f32_16x16x32_bf16 a[252:255], v[64:67], v[32:35], a[252:255]
 s_waitcnt vmcnt(18) lgkmcnt(0)
 s_barrier
 buffer_atomic_add v155, v154, s[28:31], s35 offen sc1
 v_mfma_f32_16x16x32_bf16 a[0:3], v[100:103], v[68:71], a[0:3]
 ds_read_b128 v[4:7], v144 offset:0
 v_mfma_f32_16x16x32_bf16 a[32:35], v[100:103], v[72:75], a[32:35]
 buffer_load_dwordx4 v[156:159], v2, s[64:67], s57 offen
 v_mfma_f32_16x16x32_bf16 a[64:67], v[100:103], v[76:79], a[64:67]
 ds_read_b64_tr_b16 v[36:37], v146 offset:0
 v_mfma_f32_16x16x32_bf16 a[96:99], v[100:103], v[80:83], a[96:99]
 v_mfma_f32_16x16x32_bf16 a[128:131], v[100:103], v[84:87], a[128:131]
 ds_read_b64_tr_b16 v[38:39], v146 offset:2048
 s_mov_b32 m0, s43
 v_mfma_f32_16x16x32_bf16 a[160:163], v[100:103], v[88:91], a[160:163]
 v_mfma_f32_16x16x32_bf16 a[192:195], v[100:103], v[92:95], a[192:195]
 ds_read_b64_tr_b16 v[40:41], v147 offset:0
 v_mfma_f32_16x16x32_bf16 a[224:227], v[100:103], v[96:99], a[224:227]
 ds_read_b64_tr_b16 v[42:43], v147 offset:2048
 v_mfma_f32_16x16x32_bf16 a[4:7], v[104:107], v[68:71], a[4:7]
 buffer_load_dwordx4 v140, s[16:19], s32 offen offset:0 lds
 v_mfma_f32_16x16x32_bf16 a[36:39], v[104:107], v[72:75], a[36:39]
 v_mfma_f32_16x16x32_bf16 a[68:71], v[104:107], v[76:79], a[68:71]
 ds_read_b64_tr_b16 v[44:45], v146 offset:256
 v_mfma_f32_16x16x32_bf16 a[100:103], v[104:107], v[80:83], a[100:103]
 v_mfma_f32_16x16x32_bf16 a[132:135], v[104:107], v[84:87], a[132:135]
 ds_read_b64_tr_b16 v[46:47], v146 offset:2304
 v_mfma_f32_16x16x32_bf16 a[164:167], v[104:107], v[88:91], a[164:167]
 v_mfma_f32_16x16x32_bf16 a[196:199], v[104:107], v[92:95], a[196:199]
 ds_read_b64_tr_b16 v[48:49], v147 offset:256
 v_mfma_f32_16x16x32_bf16 a[228:231], v[104:107], v[96:99], a[228:231]
 buffer_load_dwordx4 v141, s[16:19], s32 offen offset:1024 lds
 v_mfma_f32_16x16x32_bf16 a[8:11], v[108:111], v[68:71], a[8:11]
 ds_read_b64_tr_b16 v[50:51], v147 offset:2304
 v_mfma_f32_16x16x32_bf16 a[40:43], v[108:111], v[72:75], a[40:43]
 v_mfma_f32_16x16x32_bf16 a[72:75], v[108:111], v[76:79], a[72:75]
 ds_read_b64_tr_b16 v[52:53], v146 offset:512
 v_mfma_f32_16x16x32_bf16 a[104:107], v[108:111], v[80:83], a[104:107]
 v_mfma_f32_16x16x32_bf16 a[136:139], v[108:111], v[84:87], a[136:139]
 ds_read_b64_tr_b16 v[54:55], v146 offset:2560
 v_mfma_f32_16x16x32_bf16 a[168:171], v[108:111], v[88:91], a[168:171]
 ds_read_b64_tr_b16 v[56:57], v147 offset:512
 v_mfma_f32_16x16x32_bf16 a[200:203], v[108:111], v[92:95], a[200:203]
 buffer_load_dwordx4 v142, s[16:19], s32 offen offset:2048 lds
 v_mfma_f32_16x16x32_bf16 a[232:235], v[108:111], v[96:99], a[232:235]
 v_mfma_f32_16x16x32_bf16 a[12:15], v[112:115], v[68:71], a[12:15]
 ds_read_b64_tr_b16 v[58:59], v147 offset:2560
 v_mfma_f32_16x16x32_bf16 a[44:47], v[112:115], v[72:75], a[44:47]
 v_mfma_f32_16x16x32_bf16 a[76:79], v[112:115], v[76:79], a[76:79]
 ds_read_b64_tr_b16 v[60:61], v146 offset:768
 v_mfma_f32_16x16x32_bf16 a[108:111], v[112:115], v[80:83], a[108:111]
 v_mfma_f32_16x16x32_bf16 a[140:143], v[112:115], v[84:87], a[140:143]
 ds_read_b64_tr_b16 v[62:63], v146 offset:2816
 v_mfma_f32_16x16x32_bf16 a[172:175], v[112:115], v[88:91], a[172:175]
 buffer_load_dwordx4 v143, s[16:19], s32 offen offset:3072 lds
 v_mfma_f32_16x16x32_bf16 a[204:207], v[112:115], v[92:95], a[204:207]
 s_add_u32 s43, s43, 0x4000
 ds_read_b64_tr_b16 v[64:65], v147 offset:768
 v_mfma_f32_16x16x32_bf16 a[236:239], v[112:115], v[96:99], a[236:239]
 s_and_b32 s43, s43, 0xffff
 v_mfma_f32_16x16x32_bf16 a[16:19], v[116:119], v[68:71], a[16:19]
 ds_read_b64_tr_b16 v[66:67], v147 offset:2816
 v_mfma_f32_16x16x32_bf16 a[48:51], v[116:119], v[72:75], a[48:51]
 s_add_u32 s32, s32, 0x40000
 v_mfma_f32_16x16x32_bf16 a[80:83], v[116:119], v[76:79], a[80:83]
 ds_read_b128 v[8:11], v144 offset:2048
 s_mov_b32 m0, s42
 v_mfma_f32_16x16x32_bf16 a[112:115], v[116:119], v[80:83], a[112:115]
 buffer_load_dwordx4 v132, s[12:15], s41 offen offset:0 lds
 v_mfma_f32_16x16x32_bf16 a[144:147], v[116:119], v[84:87], a[144:147]
 ds_read_b128 v[12:15], v144 offset:4096
 v_mfma_f32_16x16x32_bf16 a[176:179], v[116:119], v[88:91], a[176:179]
 v_mfma_f32_16x16x32_bf16 a[208:211], v[116:119], v[92:95], a[208:211]
 ds_read_b128 v[16:19], v144 offset:6144
 v_mfma_f32_16x16x32_bf16 a[240:243], v[116:119], v[96:99], a[240:243]
 v_mfma_f32_16x16x32_bf16 a[20:23], v[120:123], v[68:71], a[20:23]
 ds_read_b128 v[20:23], v144 offset:8192
 v_mfma_f32_16x16x32_bf16 a[52:55], v[120:123], v[72:75], a[52:55]
 v_mfma_f32_16x16x32_bf16 a[84:87], v[120:123], v[76:79], a[84:87]
 ds_read_b128 v[24:27], v144 offset:10240
 v_mfma_f32_16x16x32_bf16 a[116:119], v[120:123], v[80:83], a[116:119]
 buffer_load_dwordx4 v133, s[12:15], s41 offen offset:1024 lds
 v_mfma_f32_16x16x32_bf16 a[148:151], v[120:123], v[84:87], a[148:151]
 ds_read_b128 v[28:31], v144 offset:12288
 v_mfma_f32_16x16x32_bf16 a[180:183], v[120:123], v[88:91], a[180:183]
 v_mfma_f32_16x16x32_bf16 a[212:215], v[120:123], v[92:95], a[212:215]
 ds_read_b128 v[32:35], v144 offset:14336
 v_mfma_f32_16x16x32_bf16 a[244:247], v[120:123], v[96:99], a[244:247]
 v_mfma_f32_16x16x32_bf16 a[24:27], v[124:127], v[68:71], a[24:27]
 v_mfma_f32_16x16x32_bf16 a[56:59], v[124:127], v[72:75], a[56:59]
 buffer_load_dwordx4 v134, s[12:15], s41 offen offset:2048 lds
 v_mfma_f32_16x16x32_bf16 a[88:91], v[124:127], v[76:79], a[88:91]
 v_mfma_f32_16x16x32_bf16 a[120:123], v[124:127], v[80:83], a[120:123]
 v_mfma_f32_16x16x32_bf16 a[152:155], v[124:127], v[84:87], a[152:155]
 v_mfma_f32_16x16x32_bf16 a[184:187], v[124:127], v[88:91], a[184:187]
 v_mfma_f32_16x16x32_bf16 a[216:219], v[124:127], v[92:95], a[216:219]
 v_mfma_f32_16x16x32_bf16 a[248:251], v[124:127], v[96:99], a[248:251]
 v_mfma_f32_16x16x32_bf16 a[28:31], v[128:131], v[68:71], a[28:31]
 buffer_load_dwordx4 v135, s[12:15], s41 offen offset:3072 lds
 v_mfma_f32_16x16x32_bf16 a[60:63], v[128:131], v[72:75], a[60:63]
 v_mfma_f32_16x16x32_bf16 a[92:95], v[128:131], v[76:79], a[92:95]
 v_mfma_f32_16x16x32_bf16 a[124:127], v[128:131], v[80:83], a[124:127]
 v_mfma_f32_16x16x32_bf16 a[156:159], v[128:131], v[84:87], a[156:159]
 v_mfma_f32_16x16x32_bf16 a[188:191], v[128:131], v[88:91], a[188:191]
 v_mfma_f32_16x16x32_bf16 a[220:223], v[128:131], v[92:95], a[220:223]
 v_mfma_f32_16x16x32_bf16 a[252:255], v[128:131], v[96:99], a[252:255]
 s_mov_b32 s33, 10
.p2align 6
L1_K_top:
 s_waitcnt vmcnt(17) lgkmcnt(0)
 s_barrier
 v_mfma_f32_16x16x32_bf16 a[0:3], v[36:39], v[4:7], a[0:3]
 ds_read_b128 v[68:71], v145 offset:0
 v_mfma_f32_16x16x32_bf16 a[32:35], v[36:39], v[8:11], a[32:35]
 s_add_u32 s10, s44, 0x8000
 s_cmp_eq_u32 s10, 0x18000
 v_mfma_f32_16x16x32_bf16 a[64:67], v[36:39], v[12:15], a[64:67]
 s_cselect_b32 s10, 0, s10
 ds_read_b64_tr_b16 v[100:101], v146 offset:16384
 v_mfma_f32_16x16x32_bf16 a[96:99], v[36:39], v[16:19], a[96:99]
 s_sub_u32 s69, s10, s44
 s_mov_b32 s44, s10
 v_mfma_f32_16x16x32_bf16 a[128:131], v[36:39], v[20:23], a[128:131]
 s_mov_b32 m0, s43
 ds_read_b64_tr_b16 v[102:103], v146 offset:18432
 v_mfma_f32_16x16x32_bf16 a[160:163], v[36:39], v[24:27], a[160:163]
 buffer_load_dwordx4 v140, s[16:19], s32 offen offset:0 lds
 v_mfma_f32_16x16x32_bf16 a[192:195], v[36:39], v[28:31], a[192:195]
 ds_read_b64_tr_b16 v[104:105], v147 offset:16384
 v_mfma_f32_16x16x32_bf16 a[224:227], v[36:39], v[32:35], a[224:227]
 v_mfma_f32_16x16x32_bf16 a[4:7], v[40:43], v[4:7], a[4:7]
 ds_read_b64_tr_b16 v[106:107], v147 offset:18432
 v_mfma_f32_16x16x32_bf16 a[36:39], v[40:43], v[8:11], a[36:39]
 v_mfma_f32_16x16x32_bf16 a[68:71], v[40:43], v[12:15], a[68:71]
 ds_read_b64_tr_b16 v[108:109], v146 offset:16640
 v_mfma_f32_16x16x32_bf16 a[100:103], v[40:43], v[16:19], a[100:103]
 buffer_load_dwordx4 v141, s[16:19], s32 offen offset:1024 lds
 v_mfma_f32_16x16x32_bf16 a[132:135], v[40:43], v[20:23], a[132:135]
 ds_read_b64_tr_b16 v[110:111], v146 offset:18688
 v_mfma_f32_16x16x32_bf16 a[164:167], v[40:43], v[24:27], a[164:167]
 v_mfma_f32_16x16x32_bf16 a[196:199], v[40:43], v[28:31], a[196:199]
 ds_read_b64_tr_b16 v[112:113], v147 offset:16640
 v_mfma_f32_16x16x32_bf16 a[228:231], v[40:43], v[32:35], a[228:231]
 v_mfma_f32_16x16x32_bf16 a[8:11], v[44:47], v[4:7], a[8:11]
 ds_read_b64_tr_b16 v[114:115], v147 offset:18688
 v_mfma_f32_16x16x32_bf16 a[40:43], v[44:47], v[8:11], a[40:43]
 buffer_load_dwordx4 v142, s[16:19], s32 offen offset:2048 lds
 v_mfma_f32_16x16x32_bf16 a[72:75], v[44:47], v[12:15], a[72:75]
 ds_read_b64_tr_b16 v[116:117], v146 offset:16896
 v_mfma_f32_16x16x32_bf16 a[104:107], v[44:47], v[16:19], a[104:107]
 v_mfma_f32_16x16x32_bf16 a[136:139], v[44:47], v[20:23], a[136:139]
 ds_read_b64_tr_b16 v[118:119], v146 offset:18944
 v_mfma_f32_16x16x32_bf16 a[168:171], v[44:47], v[24:27], a[168:171]
 v_mfma_f32_16x16x32_bf16 a[200:203], v[44:47], v[28:31], a[200:203]
 ds_read_b64_tr_b16 v[120:121], v147 offset:16896
 v_mfma_f32_16x16x32_bf16 a[232:235], v[44:47], v[32:35], a[232:235]
 buffer_load_dwordx4 v143, s[16:19], s32 offen offset:3072 lds
 v_mfma_f32_16x16x32_bf16 a[12:15], v[48:51], v[4:7], a[12:15]
 ds_read_b64_tr_b16 v[122:123], v147 offset:18944
 v_mfma_f32_16x16x32_bf16 a[44:47], v[48:51], v[8:11], a[44:47]
 s_add_u32 s43, s43, 0x4000
 v_mfma_f32_16x16x32_bf16 a[76:79], v[48:51], v[12:15], a[76:79]
 ds_read_b64_tr_b16 v[124:125], v146 offset:17152
 s_and_b32 s43, s43, 0xffff
 v_mfma_f32_16x16x32_bf16 a[108:111], v[48:51], v[16:19], a[108:111]
 s_add_u32 s32, s32, 0x40000
 v_mfma_f32_16x16x32_bf16 a[140:143], v[48:51], v[20:23], a[140:143]
 ds_read_b64_tr_b16 v[126:127], v146 offset:19200
 v_mfma_f32_16x16x32_bf16 a[172:175], v[48:51], v[24:27], a[172:175]
 s_add_u32 m0, s42, 0x1000
 ds_read_b64_tr_b16 v[128:129], v147 offset:17152
 v_mfma_f32_16x16x32_bf16 a[204:207], v[48:51], v[28:31], a[204:207]
 buffer_load_dwordx4 v136, s[12:15], s41 offen offset:0 lds
 v_mfma_f32_16x16x32_bf16 a[236:239], v[48:51], v[32:35], a[236:239]
 v_mfma_f32_16x16x32_bf16 a[16:19], v[52:55], v[4:7], a[16:19]
 ds_read_b64_tr_b16 v[130:131], v147 offset:19200
 v_mfma_f32_16x16x32_bf16 a[48:51], v[52:55], v[8:11], a[48:51]
 v_mfma_f32_16x16x32_bf16 a[80:83], v[52:55], v[12:15], a[80:83]
 ds_read_b128 v[72:75], v145 offset:2048
 v_mfma_f32_16x16x32_bf16 a[112:115], v[52:55], v[16:19], a[112:115]
 v_mfma_f32_16x16x32_bf16 a[144:147], v[52:55], v[20:23], a[144:147]
 ds_read_b128 v[76:79], v145 offset:4096
 v_mfma_f32_16x16x32_bf16 a[176:179], v[52:55], v[24:27], a[176:179]
 buffer_load_dwordx4 v137, s[12:15], s41 offen offset:1024 lds
 v_mfma_f32_16x16x32_bf16 a[208:211], v[52:55], v[28:31], a[208:211]
 ds_read_b128 v[80:83], v145 offset:6144
 v_mfma_f32_16x16x32_bf16 a[240:243], v[52:55], v[32:35], a[240:243]
 v_mfma_f32_16x16x32_bf16 a[20:23], v[56:59], v[4:7], a[20:23]
 ds_read_b128 v[84:87], v145 offset:8192
 v_mfma_f32_16x16x32_bf16 a[52:55], v[56:59], v[8:11], a[52:55]
 v_mfma_f32_16x16x32_bf16 a[84:87], v[56:59], v[12:15], a[84:87]
 ds_read_b128 v[88:91], v145 offset:10240
 v_mfma_f32_16x16x32_bf16 a[116:119], v[56:59], v[16:19], a[116:119]
 buffer_load_dwordx4 v138, s[12:15], s41 offen offset:2048 lds
 v_mfma_f32_16x16x32_bf16 a[148:151], v[56:59], v[20:23], a[148:151]
 ds_read_b128 v[92:95], v145 offset:12288
 v_mfma_f32_16x16x32_bf16 a[180:183], v[56:59], v[24:27], a[180:183]
 v_mfma_f32_16x16x32_bf16 a[212:215], v[56:59], v[28:31], a[212:215]
 ds_read_b128 v[96:99], v145 offset:14336
 v_mfma_f32_16x16x32_bf16 a[244:247], v[56:59], v[32:35], a[244:247]
 v_mfma_f32_16x16x32_bf16 a[24:27], v[60:63], v[4:7], a[24:27]
 v_mfma_f32_16x16x32_bf16 a[56:59], v[60:63], v[8:11], a[56:59]
 buffer_load_dwordx4 v139, s[12:15], s41 offen offset:3072 lds
 v_mfma_f32_16x16x32_bf16 a[88:91], v[60:63], v[12:15], a[88:91]
 v_add_u32 v144, s69, v144
 v_mfma_f32_16x16x32_bf16 a[120:123], v[60:63], v[16:19], a[120:123]
 s_add_u32 s42, s42, 0x8000
 v_add_u32 v145, s69, v145
 v_mfma_f32_16x16x32_bf16 a[152:155], v[60:63], v[20:23], a[152:155]
 s_cmp_ge_u32 s42, 0x28000
 v_xor_b32 v146, 0x8000, v146
 v_mfma_f32_16x16x32_bf16 a[184:187], v[60:63], v[24:27], a[184:187]
 s_cselect_b32 s9, 0x18000, 0
 v_xor_b32 v147, 0x8000, v147
 v_mfma_f32_16x16x32_bf16 a[216:219], v[60:63], v[28:31], a[216:219]
 s_sub_u32 s42, s42, s9
 v_mfma_f32_16x16x32_bf16 a[248:251], v[60:63], v[32:35], a[248:251]
 s_add_u32 s41, s41, 128
 v_mfma_f32_16x16x32_bf16 a[28:31], v[64:67], v[4:7], a[28:31]
 buffer_load_dwordx4 v[156:159], v2, s[48:51], s56 offen
 v_mfma_f32_16x16x32_bf16 a[60:63], v[64:67], v[8:11], a[60:63]
 v_mfma_f32_16x16x32_bf16 a[92:95], v[64:67], v[12:15], a[92:95]
 v_mfma_f32_16x16x32_bf16 a[124:127], v[64:67], v[16:19], a[124:127]
 s_add_u32 s56, s56, 1024
 v_mfma_f32_16x16x32_bf16 a[156:159], v[64:67], v[20:23], a[156:159]
 v_mfma_f32_16x16x32_bf16 a[188:191], v[64:67], v[24:27], a[188:191]
 v_mfma_f32_16x16x32_bf16 a[220:223], v[64:67], v[28:31], a[220:223]
 v_mfma_f32_16x16x32_bf16 a[252:255], v[64:67], v[32:35], a[252:255]
 s_waitcnt vmcnt(18) lgkmcnt(0)
 s_barrier
 v_mfma_f32_16x16x32_bf16 a[0:3], v[100:103], v[68:71], a[0:3]
 ds_read_b128 v[4:7], v144 offset:0
 v_mfma_f32_16x16x32_bf16 a[32:35], v[100:103], v[72:75], a[32:35]
 s_mov_b32 m0, s43
 ds_read_b64_tr_b16 v[36:37], v146 offset:0
 v_mfma_f32_16x16x32_bf16 a[64:67], v[100:103], v[76:79], a[64:67]
 buffer_load_dwordx4 v140, s[16:19], s32 offen offset:0 lds
 v_mfma_f32_16x16x32_bf16 a[96:99], v[100:103], v[80:83], a[96:99]
 v_mfma_f32_16x16x32_bf16 a[128:131], v[100:103], v[84:87], a[128:131]
 ds_read_b64_tr_b16 v[38:39], v146 offset:2048
 v_mfma_f32_16x16x32_bf16 a[160:163], v[100:103], v[88:91], a[160:163]
 v_mfma_f32_16x16x32_bf16 a[192:195], v[100:103], v[92:95], a[192:195]
 ds_read_b64_tr_b16 v[40:41], v147 offset:0
 v_mfma_f32_16x16x32_bf16 a[224:227], v[100:103], v[96:99], a[224:227]
 v_mfma_f32_16x16x32_bf16 a[4:7], v[104:107], v[68:71], a[4:7]
 ds_read_b64_tr_b16 v[42:43], v147 offset:2048
 v_mfma_f32_16x16x32_bf16 a[36:39], v[104:107], v[72:75], a[36:39]
 buffer_load_dwordx4 v141, s[16:19], s32 offen offset:1024 lds
 v_mfma_f32_16x16x32_bf16 a[68:71], v[104:107], v[76:79], a[68:71]
 ds_read_b64_tr_b16 v[44:45], v146 offset:256
 v_mfma_f32_16x16x32_bf16 a[100:103], v[104:107], v[80:83], a[100:103]
 v_mfma_f32_16x16x32_bf16 a[132:135], v[104:107], v[84:87], a[132:135]
 ds_read_b64_tr_b16 v[46:47], v146 offset:2304
 v_mfma_f32_16x16x32_bf16 a[164:167], v[104:107], v[88:91], a[164:167]
 v_mfma_f32_16x16x32_bf16 a[196:199], v[104:107], v[92:95], a[196:199]
 ds_read_b64_tr_b16 v[48:49], v147 offset:256
 v_mfma_f32_16x16x32_bf16 a[228:231], v[104:107], v[96:99], a[228:231]
 v_mfma_f32_16x16x32_bf16 a[8:11], v[108:111], v[68:71], a[8:11]
 ds_read_b64_tr_b16 v[50:51], v147 offset:2304
 v_mfma_f32_16x16x32_bf16 a[40:43], v[108:111], v[72:75], a[40:43]
 buffer_load_dwordx4 v142, s[16:19], s32 offen offset:2048 lds
 v_mfma_f32_16x16x32_bf16 a[72:75], v[108:111], v[76:79], a[72:75]
 ds_read_b64_tr_b16 v[52:53], v146 offset:512
 v_mfma_f32_16x16x32_bf16 a[104:107], v[108:111], v[80:83], a[104:107]
 v_mfma_f32_16x16x32_bf16 a[136:139], v[108:111], v[84:87], a[136:139]
 ds_read_b64_tr_b16 v[54:55], v146 offset:2560
 v_mfma_f32_16x16x32_bf16 a[168:171], v[108:111], v[88:91], a[168:171]
 v_mfma_f32_16x16x32_bf16 a[200:203], v[108:111], v[92:95], a[200:203]
 ds_read_b64_tr_b16 v[56:57], v147 offset:512
 v_mfma_f32_16x16x32_bf16 a[232:235], v[108:111], v[96:99], a[232:235]
 v_mfma_f32_16x16x32_bf16 a[12:15], v[112:115], v[68:71], a[12:15]
 ds_read_b64_tr_b16 v[58:59], v147 offset:2560
 v_mfma_f32_16x16x32_bf16 a[44:47], v[112:115], v[72:75], a[44:47]
 buffer_load_dwordx4 v143, s[16:19], s32 offen offset:3072 lds
 v_mfma_f32_16x16x32_bf16 a[76:79], v[112:115], v[76:79], a[76:79]
 s_add_u32 s43, s43, 0x4000
 ds_read_b64_tr_b16 v[60:61], v146 offset:768
 v_mfma_f32_16x16x32_bf16 a[108:111], v[112:115], v[80:83], a[108:111]
 s_and_b32 s43, s43, 0xffff
 v_mfma_f32_16x16x32_bf16 a[140:143], v[112:115], v[84:87], a[140:143]
 ds_read_b64_tr_b16 v[62:63], v146 offset:2816
 v_mfma_f32_16x16x32_bf16 a[172:175], v[112:115], v[88:91], a[172:175]
 s_add_u32 s32, s32, 0x40000
 v_mfma_f32_16x16x32_bf16 a[204:207], v[112:115], v[92:95], a[204:207]
 ds_read_b64_tr_b16 v[64:65], v147 offset:768
 s_mov_b32 m0, s42
 v_mfma_f32_16x16x32_bf16 a[236:239], v[112:115], v[96:99], a[236:239]
 ds_read_b64_tr_b16 v[66:67], v147 offset:2816
 v_mfma_f32_16x16x32_bf16 a[16:19], v[116:119], v[68:71], a[16:19]
 buffer_load_dwordx4 v132, s[12:15], s41 offen offset:0 lds
 v_mfma_f32_16x16x32_bf16 a[48:51], v[116:119], v[72:75], a[48:51]
 v_mfma_f32_16x16x32_bf16 a[80:83], v[116:119], v[76:79], a[80:83]
 ds_read_b128 v[8:11], v144 offset:2048
 v_mfma_f32_16x16x32_bf16 a[112:115], v[116:119], v[80:83], a[112:115]
 v_mfma_f32_16x16x32_bf16 a[144:147], v[116:119], v[84:87], a[144:147]
 ds_read_b128 v[12:15], v144 offset:4096
 v_mfma_f32_16x16x32_bf16 a[176:179], v[116:119], v[88:91], a[176:179]
 v_mfma_f32_16x16x32_bf16 a[208:211], v[116:119], v[92:95], a[208:211]
 ds_read_b128 v[16:19], v144 offset:6144
 v_mfma_f32_16x16x32_bf16 a[240:243], v[116:119], v[96:99], a[240:243]
 buffer_load_dwordx4 v133, s[12:15], s41 offen offset:1024 lds
 v_mfma_f32_16x16x32_bf16 a[20:23], v[120:123], v[68:71], a[20:23]
 ds_read_b128 v[20:23], v144 offset:8192
 v_mfma_f32_16x16x32_bf16 a[52:55], v[120:123], v[72:75], a[52:55]
 v_mfma_f32_16x16x32_bf16 a[84:87], v[120:123], v[76:79], a[84:87]
 ds_read_b128 v[24:27], v144 offset:10240
 v_mfma_f32_16x16x32_bf16 a[116:119], v[120:123], v[80:83], a[116:119]
 v_mfma_f32_16x16x32_bf16 a[148:151], v[120:123], v[84:87], a[148:151]
 ds_read_b128 v[28:31], v144 offset:12288
 v_mfma_f32_16x16x32_bf16 a[180:183], v[120:123], v[88:91], a[180:183]
 v_mfma_f32_16x16x32_bf16 a[212:215], v[120:123], v[92:95], a[212:215]
 ds_read_b128 v[32:35], v144 offset:14336
 v_mfma_f32_16x16x32_bf16 a[244:247], v[120:123], v[96:99], a[244:247]
 buffer_load_dwordx4 v134, s[12:15], s41 offen offset:2048 lds
 v_mfma_f32_16x16x32_bf16 a[24:27], v[124:127], v[68:71], a[24:27]
 v_mfma_f32_16x16x32_bf16 a[56:59], v[124:127], v[72:75], a[56:59]
 v_mfma_f32_16x16x32_bf16 a[88:91], v[124:127], v[76:79], a[88:91]
 v_mfma_f32_16x16x32_bf16 a[120:123], v[124:127], v[80:83], a[120:123]
 v_mfma_f32_16x16x32_bf16 a[152:155], v[124:127], v[84:87], a[152:155]
 v_mfma_f32_16x16x32_bf16 a[184:187], v[124:127], v[88:91], a[184:187]
 v_mfma_f32_16x16x32_bf16 a[216:219], v[124:127], v[92:95], a[216:219]
 v_mfma_f32_16x16x32_bf16 a[248:251], v[124:127], v[96:99], a[248:251]
 buffer_load_dwordx4 v135, s[12:15], s41 offen offset:3072 lds
 v_mfma_f32_16x16x32_bf16 a[28:31], v[128:131], v[68:71], a[28:31]
 v_mfma_f32_16x16x32_bf16 a[60:63], v[128:131], v[72:75], a[60:63]
 s_sub_u32 s33, s33, 1
 v_mfma_f32_16x16x32_bf16 a[92:95], v[128:131], v[76:79], a[92:95]
 v_mfma_f32_16x16x32_bf16 a[124:127], v[128:131], v[80:83], a[124:127]
 v_mfma_f32_16x16x32_bf16 a[156:159], v[128:131], v[84:87], a[156:159]
 s_cmp_lg_u32 s33, 0
 v_mfma_f32_16x16x32_bf16 a[188:191], v[128:131], v[88:91], a[188:191]
 v_mfma_f32_16x16x32_bf16 a[220:223], v[128:131], v[92:95], a[220:223]
 v_mfma_f32_16x16x32_bf16 a[252:255], v[128:131], v[96:99], a[252:255]
 s_cbranch_scc1 L1_K_top
 s_waitcnt vmcnt(21) lgkmcnt(0)
 s_barrier
 v_mfma_f32_16x16x32_bf16 a[0:3], v[36:39], v[4:7], a[0:3]
 ds_read_b128 v[68:71], v145 offset:0
 v_mfma_f32_16x16x32_bf16 a[32:35], v[36:39], v[8:11], a[32:35]
 s_add_u32 s10, s44, 0x8000
 s_cmp_eq_u32 s10, 0x18000
 v_mfma_f32_16x16x32_bf16 a[64:67], v[36:39], v[12:15], a[64:67]
 s_cselect_b32 s10, 0, s10
 ds_read_b64_tr_b16 v[100:101], v146 offset:16384
 v_mfma_f32_16x16x32_bf16 a[96:99], v[36:39], v[16:19], a[96:99]
 s_sub_u32 s69, s10, s44
 s_mov_b32 s44, s10
 v_mfma_f32_16x16x32_bf16 a[128:131], v[36:39], v[20:23], a[128:131]
 buffer_load_dword v3, v151, s[28:31], 0 offen sc1
 v_mfma_f32_16x16x32_bf16 a[160:163], v[36:39], v[24:27], a[160:163]
 ds_read_b64_tr_b16 v[102:103], v146 offset:18432
 v_mfma_f32_16x16x32_bf16 a[192:195], v[36:39], v[28:31], a[192:195]
 ds_read_b64_tr_b16 v[104:105], v147 offset:16384
 s_mov_b32 m0, s43
 v_mfma_f32_16x16x32_bf16 a[224:227], v[36:39], v[32:35], a[224:227]
 v_mfma_f32_16x16x32_bf16 a[4:7], v[40:43], v[4:7], a[4:7]
 ds_read_b64_tr_b16 v[106:107], v147 offset:18432
 v_mfma_f32_16x16x32_bf16 a[36:39], v[40:43], v[8:11], a[36:39]
 buffer_load_dwordx4 v140, s[16:19], s32 offen offset:0 lds
 v_mfma_f32_16x16x32_bf16 a[68:71], v[40:43], v[12:15], a[68:71]
 ds_read_b64_tr_b16 v[108:109], v146 offset:16640
 v_mfma_f32_16x16x32_bf16 a[100:103], v[40:43], v[16:19], a[100:103]
 v_mfma_f32_16x16x32_bf16 a[132:135], v[40:43], v[20:23], a[132:135]
 ds_read_b64_tr_b16 v[110:111], v146 offset:18688
 v_mfma_f32_16x16x32_bf16 a[164:167], v[40:43], v[24:27], a[164:167]
 v_mfma_f32_16x16x32_bf16 a[196:199], v[40:43], v[28:31], a[196:199]
 ds_read_b64_tr_b16 v[112:113], v147 offset:16640
 v_mfma_f32_16x16x32_bf16 a[228:231], v[40:43], v[32:35], a[228:231]
 buffer_load_dwordx4 v141, s[16:19], s32 offen offset:1024 lds
 v_mfma_f32_16x16x32_bf16 a[8:11], v[44:47], v[4:7], a[8:11]
 ds_read_b64_tr_b16 v[114:115], v147 offset:18688
 v_mfma_f32_16x16x32_bf16 a[40:43], v[44:47], v[8:11], a[40:43]
 v_mfma_f32_16x16x32_bf16 a[72:75], v[44:47], v[12:15], a[72:75]
 ds_read_b64_tr_b16 v[116:117], v146 offset:16896
 v_mfma_f32_16x16x32_bf16 a[104:107], v[44:47], v[16:19], a[104:107]
 v_mfma_f32_16x16x32_bf16 a[136:139], v[44:47], v[20:23], a[136:139]
 ds_read_b64_tr_b16 v[118:119], v146 offset:18944
 v_mfma_f32_16x16x32_bf16 a[168:171], v[44:47], v[24:27], a[168:171]
 buffer_load_dwordx4 v142, s[16:19], s32 offen offset:2048 lds
 v_mfma_f32_16x16x32_bf16 a[200:203], v[44:47], v[28:31], a[200:203]
 ds_read_b64_tr_b16 v[120:121], v147 offset:16896
 v_mfma_f32_16x16x32_bf16 a[232:235], v[44:47], v[32:35], a[232:235]
 v_mfma_f32_16x16x32_bf16 a[12:15], v[48:51], v[4:7], a[12:15]
 ds_read_b64_tr_b16 v[122:123], v147 offset:18944
 v_mfma_f32_16x16x32_bf16 a[44:47], v[48:51], v[8:11], a[44:47]
 v_mfma_f32_16x16x32_bf16 a[76:79], v[48:51], v[12:15], a[76:79]
 ds_read_b64_tr_b16 v[124:125], v146 offset:17152
 v_mfma_f32_16x16x32_bf16 a[108:111], v[48:51], v[16:19], a[108:111]
 buffer_load_dwordx4 v143, s[16:19], s32 offen offset:3072 lds
 v_mfma_f32_16x16x32_bf16 a[140:143], v[48:51], v[20:23], a[140:143]
 ds_read_b64_tr_b16 v[126:127], v146 offset:19200
 s_add_u32 s43, s43, 0x4000
 v_mfma_f32_16x16x32_bf16 a[172:175], v[48:51], v[24:27], a[172:175]
 v_mfma_f32_16x16x32_bf16 a[204:207], v[48:51], v[28:31], a[204:207]
 s_and_b32 s43, s43, 0xffff
 ds_read_b64_tr_b16 v[128:129], v147 offset:17152
 v_mfma_f32_16x16x32_bf16 a[236:239], v[48:51], v[32:35], a[236:239]
 s_add_u32 s32, s32, 0x40000
 v_mfma_f32_16x16x32_bf16 a[16:19], v[52:55], v[4:7], a[16:19]
 s_add_u32 m0, s42, 0x1000
 ds_read_b64_tr_b16 v[130:131], v147 offset:19200
 v_mfma_f32_16x16x32_bf16 a[48:51], v[52:55], v[8:11], a[48:51]
 buffer_load_dwordx4 v136, s[12:15], s41 offen offset:0 lds
 v_mfma_f32_16x16x32_bf16 a[80:83], v[52:55], v[12:15], a[80:83]
 ds_read_b128 v[72:75], v145 offset:2048
 v_mfma_f32_16x16x32_bf16 a[112:115], v[52:55], v[16:19], a[112:115]
 v_mfma_f32_16x16x32_bf16 a[144:147], v[52:55], v[20:23], a[144:147]
 ds_read_b128 v[76:79], v145 offset:4096
 v_mfma_f32_16x16x32_bf16 a[176:179], v[52:55], v[24:27], a[176:179]
 v_mfma_f32_16x16x32_bf16 a[208:211], v[52:55], v[28:31], a[208:211]
 ds_read_b128 v[80:83], v145 offset:6144
 v_mfma_f32_16x16x32_bf16 a[240:243], v[52:55], v[32:35], a[240:243]
 buffer_load_dwordx4 v137, s[12:15], s41 offen offset:1024 lds
 v_mfma_f32_16x16x32_bf16 a[20:23], v[56:59], v[4:7], a[20:23]
 ds_read_b128 v[84:87], v145 offset:8192
 v_mfma_f32_16x16x32_bf16 a[52:55], v[56:59], v[8:11], a[52:55]
 v_mfma_f32_16x16x32_bf16 a[84:87], v[56:59], v[12:15], a[84:87]
 ds_read_b128 v[88:91], v145 offset:10240
 v_mfma_f32_16x16x32_bf16 a[116:119], v[56:59], v[16:19], a[116:119]
 v_mfma_f32_16x16x32_bf16 a[148:151], v[56:59], v[20:23], a[148:151]
 ds_read_b128 v[92:95], v145 offset:12288
 v_mfma_f32_16x16x32_bf16 a[180:183], v[56:59], v[24:27], a[180:183]
 buffer_load_dwordx4 v138, s[12:15], s41 offen offset:2048 lds
 v_mfma_f32_16x16x32_bf16 a[212:215], v[56:59], v[28:31], a[212:215]
 ds_read_b128 v[96:99], v145 offset:14336
 v_mfma_f32_16x16x32_bf16 a[244:247], v[56:59], v[32:35], a[244:247]
 v_mfma_f32_16x16x32_bf16 a[24:27], v[60:63], v[4:7], a[24:27]
 v_mfma_f32_16x16x32_bf16 a[56:59], v[60:63], v[8:11], a[56:59]
 v_mfma_f32_16x16x32_bf16 a[88:91], v[60:63], v[12:15], a[88:91]
 v_add_u32 v144, s69, v144
 v_add_u32 v145, s69, v145
 v_mfma_f32_16x16x32_bf16 a[120:123], v[60:63], v[16:19], a[120:123]
 buffer_load_dwordx4 v139, s[12:15], s41 offen offset:3072 lds
 v_mfma_f32_16x16x32_bf16 a[152:155], v[60:63], v[20:23], a[152:155]
 s_add_u32 s42, s42, 0x8000
 v_xor_b32 v146, 0x8000, v146
 v_mfma_f32_16x16x32_bf16 a[184:187], v[60:63], v[24:27], a[184:187]
 s_cmp_ge_u32 s42, 0x28000
 v_xor_b32 v147, 0x8000, v147
 v_mfma_f32_16x16x32_bf16 a[216:219], v[60:63], v[28:31], a[216:219]
 s_cselect_b32 s9, 0x18000, 0
 v_mfma_f32_16x16x32_bf16 a[248:251], v[60:63], v[32:35], a[248:251]
 s_sub_u32 s42, s42, s9
 v_mfma_f32_16x16x32_bf16 a[28:31], v[64:67], v[4:7], a[28:31]
 s_add_u32 s41, s41, 128
 v_mfma_f32_16x16x32_bf16 a[60:63], v[64:67], v[8:11], a[60:63]
 buffer_load_dwordx4 v[156:159], v2, s[64:67], s57 offen
 v_mfma_f32_16x16x32_bf16 a[92:95], v[64:67], v[12:15], a[92:95]
 v_mfma_f32_16x16x32_bf16 a[124:127], v[64:67], v[16:19], a[124:127]
 v_mfma_f32_16x16x32_bf16 a[156:159], v[64:67], v[20:23], a[156:159]
 v_mfma_f32_16x16x32_bf16 a[188:191], v[64:67], v[24:27], a[188:191]
 v_mfma_f32_16x16x32_bf16 a[220:223], v[64:67], v[28:31], a[220:223]
 v_mfma_f32_16x16x32_bf16 a[252:255], v[64:67], v[32:35], a[252:255]
 s_waitcnt vmcnt(19) lgkmcnt(0)
 s_barrier
 v_mfma_f32_16x16x32_bf16 a[0:3], v[100:103], v[68:71], a[0:3]
 ds_read_b128 v[4:7], v144 offset:0
 v_mfma_f32_16x16x32_bf16 a[32:35], v[100:103], v[72:75], a[32:35]
 s_add_u32 m0, s8, 0x18000
 s_add_u32 s11, s38, 0x100000
 v_mfma_f32_16x16x32_bf16 a[64:67], v[100:103], v[76:79], a[64:67]
 ds_read_b64_tr_b16 v[36:37], v146 offset:0
 v_mfma_f32_16x16x32_bf16 a[96:99], v[100:103], v[80:83], a[96:99]
 buffer_load_dwordx4 v140, s[20:23], s11 offen offset:0 lds
 v_mfma_f32_16x16x32_bf16 a[128:131], v[100:103], v[84:87], a[128:131]
 ds_read_b64_tr_b16 v[38:39], v146 offset:2048
 v_mfma_f32_16x16x32_bf16 a[160:163], v[100:103], v[88:91], a[160:163]
 v_mfma_f32_16x16x32_bf16 a[192:195], v[100:103], v[92:95], a[192:195]
 ds_read_b64_tr_b16 v[40:41], v147 offset:0
 v_mfma_f32_16x16x32_bf16 a[224:227], v[100:103], v[96:99], a[224:227]
 v_mfma_f32_16x16x32_bf16 a[4:7], v[104:107], v[68:71], a[4:7]
 ds_read_b64_tr_b16 v[42:43], v147 offset:2048
 v_mfma_f32_16x16x32_bf16 a[36:39], v[104:107], v[72:75], a[36:39]
 buffer_load_dwordx4 v141, s[20:23], s11 offen offset:1024 lds
 v_mfma_f32_16x16x32_bf16 a[68:71], v[104:107], v[76:79], a[68:71]
 ds_read_b64_tr_b16 v[44:45], v146 offset:256
 v_mfma_f32_16x16x32_bf16 a[100:103], v[104:107], v[80:83], a[100:103]
 v_mfma_f32_16x16x32_bf16 a[132:135], v[104:107], v[84:87], a[132:135]
 ds_read_b64_tr_b16 v[46:47], v146 offset:2304
 v_mfma_f32_16x16x32_bf16 a[164:167], v[104:107], v[88:91], a[164:167]
 v_mfma_f32_16x16x32_bf16 a[196:199], v[104:107], v[92:95], a[196:199]
 ds_read_b64_tr_b16 v[48:49], v147 offset:256
 v_mfma_f32_16x16x32_bf16 a[228:231], v[104:107], v[96:99], a[228:231]
 v_mfma_f32_16x16x32_bf16 a[8:11], v[108:111], v[68:71], a[8:11]
 ds_read_b64_tr_b16 v[50:51], v147 offset:2304
 v_mfma_f32_16x16x32_bf16 a[40:43], v[108:111], v[72:75], a[40:43]
 buffer_load_dwordx4 v142, s[20:23], s11 offen offset:2048 lds
 v_mfma_f32_16x16x32_bf16 a[72:75], v[108:111], v[76:79], a[72:75]
 ds_read_b64_tr_b16 v[52:53], v146 offset:512
 v_mfma_f32_16x16x32_bf16 a[104:107], v[108:111], v[80:83], a[104:107]
 v_mfma_f32_16x16x32_bf16 a[136:139], v[108:111], v[84:87], a[136:139]
 ds_read_b64_tr_b16 v[54:55], v146 offset:2560
 v_mfma_f32_16x16x32_bf16 a[168:171], v[108:111], v[88:91], a[168:171]
 v_mfma_f32_16x16x32_bf16 a[200:203], v[108:111], v[92:95], a[200:203]
 ds_read_b64_tr_b16 v[56:57], v147 offset:512
 v_mfma_f32_16x16x32_bf16 a[232:235], v[108:111], v[96:99], a[232:235]
 v_mfma_f32_16x16x32_bf16 a[12:15], v[112:115], v[68:71], a[12:15]
 ds_read_b64_tr_b16 v[58:59], v147 offset:2560
 v_mfma_f32_16x16x32_bf16 a[44:47], v[112:115], v[72:75], a[44:47]
 buffer_load_dwordx4 v143, s[20:23], s11 offen offset:3072 lds
 v_mfma_f32_16x16x32_bf16 a[76:79], v[112:115], v[76:79], a[76:79]
 ds_read_b64_tr_b16 v[60:61], v146 offset:768
 v_mfma_f32_16x16x32_bf16 a[108:111], v[112:115], v[80:83], a[108:111]
 v_mfma_f32_16x16x32_bf16 a[140:143], v[112:115], v[84:87], a[140:143]
 ds_read_b64_tr_b16 v[62:63], v146 offset:2816
 s_mov_b32 m0, s43
 v_mfma_f32_16x16x32_bf16 a[172:175], v[112:115], v[88:91], a[172:175]
 v_mfma_f32_16x16x32_bf16 a[204:207], v[112:115], v[92:95], a[204:207]
 ds_read_b64_tr_b16 v[64:65], v147 offset:768
 v_mfma_f32_16x16x32_bf16 a[236:239], v[112:115], v[96:99], a[236:239]
 ds_read_b64_tr_b16 v[66:67], v147 offset:2816
 v_mfma_f32_16x16x32_bf16 a[16:19], v[116:119], v[68:71], a[16:19]
 buffer_load_dwordx4 v140, s[16:19], s32 offen offset:0 lds
 v_mfma_f32_16x16x32_bf16 a[48:51], v[116:119], v[72:75], a[48:51]
 v_mfma_f32_16x16x32_bf16 a[80:83], v[116:119], v[76:79], a[80:83]
 ds_read_b128 v[8:11], v144 offset:2048
 v_mfma_f32_16x16x32_bf16 a[112:115], v[116:119], v[80:83], a[112:115]
 v_mfma_f32_16x16x32_bf16 a[144:147], v[116:119], v[84:87], a[144:147]
 ds_read_b128 v[12:15], v144 offset:4096
 v_mfma_f32_16x16x32_bf16 a[176:179], v[116:119], v[88:91], a[176:179]
 v_mfma_f32_16x16x32_bf16 a[208:211], v[116:119], v[92:95], a[208:211]
 ds_read_b128 v[16:19], v144 offset:6144
 v_mfma_f32_16x16x32_bf16 a[240:243], v[116:119], v[96:99], a[240:243]
 buffer_load_dwordx4 v141, s[16:19], s32 offen offset:1024 lds
 v_mfma_f32_16x16x32_bf16 a[20:23], v[120:123], v[68:71], a[20:23]
 ds_read_b128 v[20:23], v144 offset:8192
 v_mfma_f32_16x16x32_bf16 a[52:55], v[120:123], v[72:75], a[52:55]
 v_mfma_f32_16x16x32_bf16 a[84:87], v[120:123], v[76:79], a[84:87]
 ds_read_b128 v[24:27], v144 offset:10240
 v_mfma_f32_16x16x32_bf16 a[116:119], v[120:123], v[80:83], a[116:119]
 v_mfma_f32_16x16x32_bf16 a[148:151], v[120:123], v[84:87], a[148:151]
 ds_read_b128 v[28:31], v144 offset:12288
 v_mfma_f32_16x16x32_bf16 a[180:183], v[120:123], v[88:91], a[180:183]
 v_mfma_f32_16x16x32_bf16 a[212:215], v[120:123], v[92:95], a[212:215]
 ds_read_b128 v[32:35], v144 offset:14336
 v_mfma_f32_16x16x32_bf16 a[244:247], v[120:123], v[96:99], a[244:247]
 buffer_load_dwordx4 v142, s[16:19], s32 offen offset:2048 lds
 v_mfma_f32_16x16x32_bf16 a[24:27], v[124:127], v[68:71], a[24:27]
 v_mfma_f32_16x16x32_bf16 a[56:59], v[124:127], v[72:75], a[56:59]
 v_mfma_f32_16x16x32_bf16 a[88:91], v[124:127], v[76:79], a[88:91]
 v_mfma_f32_16x16x32_bf16 a[120:123], v[124:127], v[80:83], a[120:123]
 v_mfma_f32_16x16x32_bf16 a[152:155], v[124:127], v[84:87], a[152:155]
 v_mfma_f32_16x16x32_bf16 a[184:187], v[124:127], v[88:91], a[184:187]
 v_mfma_f32_16x16x32_bf16 a[216:219], v[124:127], v[92:95], a[216:219]
 buffer_load_dwordx4 v143, s[16:19], s32 offen offset:3072 lds
 v_mfma_f32_16x16x32_bf16 a[248:251], v[124:127], v[96:99], a[248:251]
 v_mfma_f32_16x16x32_bf16 a[28:31], v[128:131], v[68:71], a[28:31]
 s_add_u32 s43, s43, 0x4000
 v_mfma_f32_16x16x32_bf16 a[60:63], v[128:131], v[72:75], a[60:63]
 v_mfma_f32_16x16x32_bf16 a[92:95], v[128:131], v[76:79], a[92:95]
 s_and_b32 s43, s43, 0xffff
 v_mfma_f32_16x16x32_bf16 a[124:127], v[128:131], v[80:83], a[124:127]
 v_mfma_f32_16x16x32_bf16 a[156:159], v[128:131], v[84:87], a[156:159]
 s_add_u32 s32, s32, 0x40000
 v_mfma_f32_16x16x32_bf16 a[188:191], v[128:131], v[88:91], a[188:191]
 v_mfma_f32_16x16x32_bf16 a[220:223], v[128:131], v[92:95], a[220:223]
 v_mfma_f32_16x16x32_bf16 a[252:255], v[128:131], v[96:99], a[252:255]
 s_waitcnt vmcnt(17) lgkmcnt(0)
 s_barrier
 v_and_b32 v152, 0xff, v3
 v_cmp_ne_u32 vcc, 32, v152
 s_cbranch_vccnz L1_K_cw
L1_K_got:
 v_mfma_f32_16x16x32_bf16 a[0:3], v[36:39], v[4:7], a[0:3]
 ds_read_b128 v[68:71], v145 offset:0
 s_add_u32 s10, s44, 0x8000
 v_mfma_f32_16x16x32_bf16 a[32:35], v[36:39], v[8:11], a[32:35]
 s_cmp_eq_u32 s10, 0x18000
 s_cselect_b32 s10, 0, s10
 v_mfma_f32_16x16x32_bf16 a[64:67], v[36:39], v[12:15], a[64:67]
 s_sub_u32 s69, s10, s44
 s_mov_b32 s44, s10
 v_mfma_f32_16x16x32_bf16 a[96:99], v[36:39], v[16:19], a[96:99]
 s_and_b32 s10, s2, 7
 v_readfirstlane_b32 s71, v155
 v_mfma_f32_16x16x32_bf16 a[128:131], v[36:39], v[20:23], a[128:131]
 v_readlane_b32 s10, v3, s10
 s_bfe_u32 s9, s2, 0x30004
 v_mfma_f32_16x16x32_bf16 a[160:163], v[36:39], v[24:27], a[160:163]
 ds_read_b64_tr_b16 v[100:101], v146 offset:16384
 s_sub_u32 s11, 15, s9
 v_mfma_f32_16x16x32_bf16 a[192:195], v[36:39], v[28:31], a[192:195]
 s_bitcmp1_b32 s2, 7
 s_cselect_b32 s9, s11, s9
 v_mfma_f32_16x16x32_bf16 a[224:227], v[36:39], v[32:35], a[224:227]
 s_lshl_b32 s9, s9, 2
 s_add_u32 s9, s9, s3
 v_mfma_f32_16x16x32_bf16 a[4:7], v[40:43], v[4:7], a[4:7]
 s_mul_i32 s39, s9, 28672
 s_add_u32 s39, s39, 0x5c00000
 v_mfma_f32_16x16x32_bf16 a[36:39], v[40:43], v[8:11], a[36:39]
 s_add_u32 s40, s39, 14336
 s_lshl_b32 s71, s71, 5
 v_mfma_f32_16x16x32_bf16 a[68:71], v[40:43], v[12:15], a[68:71]
 s_cmp_eq_u32 s10, s71
 ds_read_b64_tr_b16 v[102:103], v146 offset:18432
 v_mfma_f32_16x16x32_bf16 a[100:103], v[40:43], v[16:19], a[100:103]
 s_cselect_b32 s71, 1, 0
 s_bitcmp1_b32 s2, 3
 v_mfma_f32_16x16x32_bf16 a[132:135], v[40:43], v[20:23], a[132:135]
 s_cselect_b32 s70, s40, s39
 s_add_u32 m0, s8, 0x0
 v_mfma_f32_16x16x32_bf16 a[164:167], v[40:43], v[24:27], a[164:167]
 s_add_u32 s11, s38, 0x0
 ds_read_b64_tr_b16 v[104:105], v147 offset:16384
 v_mfma_f32_16x16x32_bf16 a[196:199], v[40:43], v[28:31], a[196:199]
 buffer_load_dwordx4 v140, s[20:23], s11 offen offset:0 lds
 v_mfma_f32_16x16x32_bf16 a[228:231], v[40:43], v[32:35], a[228:231]
 ds_read_b64_tr_b16 v[106:107], v147 offset:18432
 v_mfma_f32_16x16x32_bf16 a[8:11], v[44:47], v[4:7], a[8:11]
 buffer_load_dwordx4 v141, s[20:23], s11 offen offset:1024 lds
 v_mfma_f32_16x16x32_bf16 a[40:43], v[44:47], v[8:11], a[40:43]
 ds_read_b64_tr_b16 v[108:109], v146 offset:16640
 v_mfma_f32_16x16x32_bf16 a[72:75], v[44:47], v[12:15], a[72:75]
 ds_read_b64_tr_b16 v[110:111], v146 offset:18688
 v_mfma_f32_16x16x32_bf16 a[104:107], v[44:47], v[16:19], a[104:107]
 buffer_load_dwordx4 v142, s[20:23], s11 offen offset:2048 lds
 v_mfma_f32_16x16x32_bf16 a[136:139], v[44:47], v[20:23], a[136:139]
 ds_read_b64_tr_b16 v[112:113], v147 offset:16640
 v_mfma_f32_16x16x32_bf16 a[168:171], v[44:47], v[24:27], a[168:171]
 ds_read_b64_tr_b16 v[114:115], v147 offset:18688
 v_mfma_f32_16x16x32_bf16 a[200:203], v[44:47], v[28:31], a[200:203]
 buffer_load_dwordx4 v143, s[20:23], s11 offen offset:3072 lds
 v_mfma_f32_16x16x32_bf16 a[232:235], v[44:47], v[32:35], a[232:235]
 ds_read_b64_tr_b16 v[116:117], v146 offset:16896
 v_mfma_f32_16x16x32_bf16 a[12:15], v[48:51], v[4:7], a[12:15]
 ds_read_b64_tr_b16 v[118:119], v146 offset:18944
 v_mfma_f32_16x16x32_bf16 a[44:47], v[48:51], v[8:11], a[44:47]
 buffer_load_dwordx4 v[168:171], v2, s[4:7], s39 offen offset:0
 v_mfma_f32_16x16x32_bf16 a[76:79], v[48:51], v[12:15], a[76:79]
 ds_read_b64_tr_b16 v[120:121], v147 offset:16896
 v_mfma_f32_16x16x32_bf16 a[108:111], v[48:51], v[16:19], a[108:111]
 ds_read_b64_tr_b16 v[122:123], v147 offset:18944
 v_mfma_f32_16x16x32_bf16 a[140:143], v[48:51], v[20:23], a[140:143]
 buffer_load_dwordx4 v[172:175], v2, s[4:7], s40 offen offset:0
 v_mfma_f32_16x16x32_bf16 a[172:175], v[48:51], v[24:27], a[172:175]
 ds_read_b64_tr_b16 v[124:125], v146 offset:17152
 v_mfma_f32_16x16x32_bf16 a[204:207], v[48:51], v[28:31], a[204:207]
 ds_read_b64_tr_b16 v[126:127], v146 offset:19200
 v_mfma_f32_16x16x32_bf16 a[236:239], v[48:51], v[32:35], a[236:239]
 buffer_load_dwordx4 v[176:179], v2, s[4:7], s39 offen offset:1024
 v_mfma_f32_16x16x32_bf16 a[16:19], v[52:55], v[4:7], a[16:19]
 ds_read_b64_tr_b16 v[128:129], v147 offset:17152
 v_mfma_f32_16x16x32_bf16 a[48:51], v[52:55], v[8:11], a[48:51]
 ds_read_b64_tr_b16 v[130:131], v147 offset:19200
 v_mfma_f32_16x16x32_bf16 a[80:83], v[52:55], v[12:15], a[80:83]
 buffer_load_dwordx4 v[180:183], v2, s[4:7], s40 offen offset:1024
 v_mfma_f32_16x16x32_bf16 a[112:115], v[52:55], v[16:19], a[112:115]
 ds_read_b128 v[72:75], v145 offset:2048
 s_add_u32 m0, s8, 0x1c000
 v_mfma_f32_16x16x32_bf16 a[144:147], v[52:55], v[20:23], a[144:147]
 ds_read_b128 v[76:79], v145 offset:4096
 s_add_u32 s11, s38, 0x140000
 v_mfma_f32_16x16x32_bf16 a[176:179], v[52:55], v[24:27], a[176:179]
 ds_read_b128 v[80:83], v145 offset:6144
 v_mfma_f32_16x16x32_bf16 a[208:211], v[52:55], v[28:31], a[208:211]
 buffer_load_dwordx4 v140, s[20:23], s11 offen offset:0 lds
 v_mfma_f32_16x16x32_bf16 a[240:243], v[52:55], v[32:35], a[240:243]
 v_mfma_f32_16x16x32_bf16 a[20:23], v[56:59], v[4:7], a[20:23]
 ds_read_b128 v[84:87], v145 offset:8192
 v_mfma_f32_16x16x32_bf16 a[52:55], v[56:59], v[8:11], a[52:55]
 ds_read_b128 v[88:91], v145 offset:10240
 v_mfma_f32_16x16x32_bf16 a[84:87], v[56:59], v[12:15], a[84:87]
 buffer_load_dwordx4 v141, s[20:23], s11 offen offset:1024 lds
 v_mfma_f32_16x16x32_bf16 a[116:119], v[56:59], v[16:19], a[116:119]
 v_mfma_f32_16x16x32_bf16 a[148:151], v[56:59], v[20:23], a[148:151]
 ds_read_b128 v[92:95], v145 offset:12288
 v_mfma_f32_16x16x32_bf16 a[180:183], v[56:59], v[24:27], a[180:183]
 ds_read_b128 v[96:99], v145 offset:14336
 v_mfma_f32_16x16x32_bf16 a[212:215], v[56:59], v[28:31], a[212:215]
 buffer_load_dwordx4 v142, s[20:23], s11 offen offset:2048 lds
 v_mfma_f32_16x16x32_bf16 a[244:247], v[56:59], v[32:35], a[244:247]
 v_mfma_f32_16x16x32_bf16 a[24:27], v[60:63], v[4:7], a[24:27]
 v_mfma_f32_16x16x32_bf16 a[56:59], v[60:63], v[8:11], a[56:59]
 v_add_u32 v144, s69, v144
 v_mfma_f32_16x16x32_bf16 a[88:91], v[60:63], v[12:15], a[88:91]
 buffer_load_dwordx4 v143, s[20:23], s11 offen offset:3072 lds
 v_mfma_f32_16x16x32_bf16 a[120:123], v[60:63], v[16:19], a[120:123]
 v_add_u32 v145, s69, v145
 v_mfma_f32_16x16x32_bf16 a[152:155], v[60:63], v[20:23], a[152:155]
 v_xor_b32 v146, 0x8000, v146
 v_mfma_f32_16x16x32_bf16 a[184:187], v[60:63], v[24:27], a[184:187]
 v_xor_b32 v147, 0x8000, v147
 v_mfma_f32_16x16x32_bf16 a[216:219], v[60:63], v[28:31], a[216:219]
 buffer_load_dwordx4 v[184:187], v2, s[4:7], s39 offen offset:2048
 v_mfma_f32_16x16x32_bf16 a[248:251], v[60:63], v[32:35], a[248:251]
 v_mfma_f32_16x16x32_bf16 a[28:31], v[64:67], v[4:7], a[28:31]
 v_mfma_f32_16x16x32_bf16 a[60:63], v[64:67], v[8:11], a[60:63]
 v_mfma_f32_16x16x32_bf16 a[92:95], v[64:67], v[12:15], a[92:95]
 buffer_load_dwordx4 v[188:191], v2, s[4:7], s40 offen offset:2048
 v_mfma_f32_16x16x32_bf16 a[124:127], v[64:67], v[16:19], a[124:127]
 v_mfma_f32_16x16x32_bf16 a[156:159], v[64:67], v[20:23], a[156:159]
 v_mfma_f32_16x16x32_bf16 a[188:191], v[64:67], v[24:27], a[188:191]
 v_mfma_f32_16x16x32_bf16 a[220:223], v[64:67], v[28:31], a[220:223]
 v_mfma_f32_16x16x32_bf16 a[252:255], v[64:67], v[32:35], a[252:255]
 s_waitcnt vmcnt(23) lgkmcnt(0)
 s_barrier
 v_mfma_f32_16x16x32_bf16 a[0:3], v[100:103], v[68:71], a[0:3]
 ds_read_b128 v[4:7], v144 offset:0
 v_mfma_f32_16x16x32_bf16 a[32:35], v[100:103], v[72:75], a[32:35]
 s_add_u32 m0, s8, 0x4000
 s_add_u32 s11, s38, 0x40000
 v_mfma_f32_16x16x32_bf16 a[64:67], v[100:103], v[76:79], a[64:67]
 ds_read_b64_tr_b16 v[36:37], v146 offset:0
 v_mfma_f32_16x16x32_bf16 a[96:99], v[100:103], v[80:83], a[96:99]
 buffer_load_dwordx4 v140, s[20:23], s11 offen offset:0 lds
 v_mfma_f32_16x16x32_bf16 a[128:131], v[100:103], v[84:87], a[128:131]
 ds_read_b64_tr_b16 v[38:39], v146 offset:2048
 v_mfma_f32_16x16x32_bf16 a[160:163], v[100:103], v[88:91], a[160:163]
 v_mfma_f32_16x16x32_bf16 a[192:195], v[100:103], v[92:95], a[192:195]
 ds_read_b64_tr_b16 v[40:41], v147 offset:0
 v_mfma_f32_16x16x32_bf16 a[224:227], v[100:103], v[96:99], a[224:227]
 buffer_load_dwordx4 v141, s[20:23], s11 offen offset:1024 lds
 v_mfma_f32_16x16x32_bf16 a[4:7], v[104:107], v[68:71], a[4:7]
 ds_read_b64_tr_b16 v[42:43], v147 offset:2048
 v_mfma_f32_16x16x32_bf16 a[36:39], v[104:107], v[72:75], a[36:39]
 v_mfma_f32_16x16x32_bf16 a[68:71], v[104:107], v[76:79], a[68:71]
 ds_read_b64_tr_b16 v[44:45], v146 offset:256
 v_mfma_f32_16x16x32_bf16 a[100:103], v[104:107], v[80:83], a[100:103]
 buffer_load_dwordx4 v142, s[20:23], s11 offen offset:2048 lds
 v_mfma_f32_16x16x32_bf16 a[132:135], v[104:107], v[84:87], a[132:135]
 ds_read_b64_tr_b16 v[46:47], v146 offset:2304
 v_mfma_f32_16x16x32_bf16 a[164:167], v[104:107], v[88:91], a[164:167]
 v_mfma_f32_16x16x32_bf16 a[196:199], v[104:107], v[92:95], a[196:199]
 ds_read_b64_tr_b16 v[48:49], v147 offset:256
 v_mfma_f32_16x16x32_bf16 a[228:231], v[104:107], v[96:99], a[228:231]
 buffer_load_dwordx4 v143, s[20:23], s11 offen offset:3072 lds
 v_mfma_f32_16x16x32_bf16 a[8:11], v[108:111], v[68:71], a[8:11]
 ds_read_b64_tr_b16 v[50:51], v147 offset:2304
 v_mfma_f32_16x16x32_bf16 a[40:43], v[108:111], v[72:75], a[40:43]
 v_mfma_f32_16x16x32_bf16 a[72:75], v[108:111], v[76:79], a[72:75]
 ds_read_b64_tr_b16 v[52:53], v146 offset:512
 v_mfma_f32_16x16x32_bf16 a[104:107], v[108:111], v[80:83], a[104:107]
 buffer_load_dwordx4 v[192:195], v2, s[4:7], s39 offen offset:3072
 v_mfma_f32_16x16x32_bf16 a[136:139], v[108:111], v[84:87], a[136:139]
 ds_read_b64_tr_b16 v[54:55], v146 offset:2560
 v_mfma_f32_16x16x32_bf16 a[168:171], v[108:111], v[88:91], a[168:171]
 v_mfma_f32_16x16x32_bf16 a[200:203], v[108:111], v[92:95], a[200:203]
 ds_read_b64_tr_b16 v[56:57], v147 offset:512
 v_mfma_f32_16x16x32_bf16 a[232:235], v[108:111], v[96:99], a[232:235]
 buffer_load_dwordx4 v[196:199], v2, s[4:7], s40 offen offset:3072
 v_mfma_f32_16x16x32_bf16 a[12:15], v[112:115], v[68:71], a[12:15]
 s_add_u32 s39, s39, 0x1000
 ds_read_b64_tr_b16 v[58:59], v147 offset:2560
 v_mfma_f32_16x16x32_bf16 a[44:47], v[112:115], v[72:75], a[44:47]
 s_add_u32 s40, s40, 0x1000
 v_mfma_f32_16x16x32_bf16 a[76:79], v[112:115], v[76:79], a[76:79]
 ds_read_b64_tr_b16 v[60:61], v146 offset:768
 v_mfma_f32_16x16x32_bf16 a[108:111], v[112:115], v[80:83], a[108:111]
 buffer_load_dwordx4 v[200:203], v2, s[4:7], s39 offen offset:0
 v_mfma_f32_16x16x32_bf16 a[140:143], v[112:115], v[84:87], a[140:143]
 ds_read_b64_tr_b16 v[62:63], v146 offset:2816
 v_mfma_f32_16x16x32_bf16 a[172:175], v[112:115], v[88:91], a[172:175]
 v_mfma_f32_16x16x32_bf16 a[204:207], v[112:115], v[92:95], a[204:207]
 ds_read_b64_tr_b16 v[64:65], v147 offset:768
 v_mfma_f32_16x16x32_bf16 a[236:239], v[112:115], v[96:99], a[236:239]
 buffer_load_dwordx4 v[204:207], v2, s[4:7], s40 offen offset:0
 v_mfma_f32_16x16x32_bf16 a[16:19], v[116:119], v[68:71], a[16:19]
 s_add_u32 m0, s8, 0x20000
 ds_read_b64_tr_b16 v[66:67], v147 offset:2816
 v_mfma_f32_16x16x32_bf16 a[48:51], v[116:119], v[72:75], a[48:51]
 s_add_u32 s11, s38, 0x180000
 v_mfma_f32_16x16x32_bf16 a[80:83], v[116:119], v[76:79], a[80:83]
 ds_read_b128 v[8:11], v144 offset:2048
 v_mfma_f32_16x16x32_bf16 a[112:115], v[116:119], v[80:83], a[112:115]
 buffer_load_dwordx4 v140, s[20:23], s11 offen offset:0 lds
 v_mfma_f32_16x16x32_bf16 a[144:147], v[116:119], v[84:87], a[144:147]
 ds_read_b128 v[12:15], v144 offset:4096
 v_mfma_f32_16x16x32_bf16 a[176:179], v[116:119], v[88:91], a[176:179]
 v_mfma_f32_16x16x32_bf16 a[208:211], v[116:119], v[92:95], a[208:211]
 ds_read_b128 v[16:19], v144 offset:6144
 v_mfma_f32_16x16x32_bf16 a[240:243], v[116:119], v[96:99], a[240:243]
 buffer_load_dwordx4 v141, s[20:23], s11 offen offset:1024 lds
 v_mfma_f32_16x16x32_bf16 a[20:23], v[120:123], v[68:71], a[20:23]
 ds_read_b128 v[20:23], v144 offset:8192
 v_mfma_f32_16x16x32_bf16 a[52:55], v[120:123], v[72:75], a[52:55]
 v_mfma_f32_16x16x32_bf16 a[84:87], v[120:123], v[76:79], a[84:87]
 ds_read_b128 v[24:27], v144 offset:10240
 v_mfma_f32_16x16x32_bf16 a[116:119], v[120:123], v[80:83], a[116:119]
 buffer_load_dwordx4 v142, s[20:23], s11 offen offset:2048 lds
 v_mfma_f32_16x16x32_bf16 a[148:151], v[120:123], v[84:87], a[148:151]
 ds_read_b128 v[28:31], v144 offset:12288
 v_mfma_f32_16x16x32_bf16 a[180:183], v[120:123], v[88:91], a[180:183]
 v_mfma_f32_16x16x32_bf16 a[212:215], v[120:123], v[92:95], a[212:215]
 ds_read_b128 v[32:35], v144 offset:14336
 v_mfma_f32_16x16x32_bf16 a[244:247], v[120:123], v[96:99], a[244:247]
 buffer_load_dwordx4 v143, s[20:23], s11 offen offset:3072 lds
 v_mfma_f32_16x16x32_bf16 a[24:27], v[124:127], v[68:71], a[24:27]
 v_mfma_f32_16x16x32_bf16 a[56:59], v[124:127], v[72:75], a[56:59]
 v_mfma_f32_16x16x32_bf16 a[88:91], v[124:127], v[76:79], a[88:91]
 buffer_load_dwordx4 v[208:211], v2, s[4:7], s39 offen offset:1024
 v_mfma_f32_16x16x32_bf16 a[120:123], v[124:127], v[80:83], a[120:123]
 v_mfma_f32_16x16x32_bf16 a[152:155], v[124:127], v[84:87], a[152:155]
 v_mfma_f32_16x16x32_bf16 a[184:187], v[124:127], v[88:91], a[184:187]
 v_mfma_f32_16x16x32_bf16 a[216:219], v[124:127], v[92:95], a[216:219]
 buffer_load_dwordx4 v[212:215], v2, s[4:7], s40 offen offset:1024
 v_mfma_f32_16x16x32_bf16 a[248:251], v[124:127], v[96:99], a[248:251]
 s_lshl_b32 s9, s45, 6
 s_lshl_b32 s10, s47, 3
 v_mfma_f32_16x16x32_bf16 a[28:31], v[128:131], v[68:71], a[28:31]
 s_add_u32 s9, s9, s10
 s_lshr_b32 s10, s3, 1
 v_mfma_f32_16x16x32_bf16 a[60:63], v[128:131], v[72:75], a[60:63]
 s_lshl_b32 s10, s10, 2
 s_add_u32 s9, s9, s10
 v_mfma_f32_16x16x32_bf16 a[92:95], v[128:131], v[76:79], a[92:95]
 s_mul_i32 s35, s9, 16384
 s_and_b32 s10, s3, 1
 v_mfma_f32_16x16x32_bf16 a[124:127], v[128:131], v[80:83], a[124:127]
 s_lshl_b32 s68, s10, 10
 s_add_u32 s9, s46, 12
 v_mfma_f32_16x16x32_bf16 a[156:159], v[128:131], v[84:87], a[156:159]
 s_lshl_b32 s10, s10, s9
 s_add_u32 s35, s35, s10
 v_mfma_f32_16x16x32_bf16 a[188:191], v[128:131], v[88:91], a[188:191]
 s_mul_i32 s10, s46, 0x1200000
 s_add_u32 s35, s35, s10
 v_mfma_f32_16x16x32_bf16 a[220:223], v[128:131], v[92:95], a[220:223]
 s_lshl_b32 s32, s45, 7
 s_lshl_b32 s9, s46, 3
 s_add_u32 s9, s9, s47
 s_lshl_b32 s9, s9, 2
 s_add_u32 s32, s32, 0x5300000
 s_add_u32 s34, s32, s9
 s_add_u32 s36, s36, s35
 v_mfma_f32_16x16x32_bf16 a[252:255], v[128:131], v[96:99], a[252:255]
 s_waitcnt vmcnt(28) lgkmcnt(0)
 s_barrier
 v_mfma_f32_16x16x32_bf16 a[0:3], v[36:39], v[4:7], a[0:3]
 ds_read_b128 v[68:71], v145 offset:0
 v_mfma_f32_16x16x32_bf16 a[32:35], v[36:39], v[8:11], a[32:35]
 s_add_u32 s10, s44, 0x8000
 s_cmp_eq_u32 s10, 0x18000
 v_mfma_f32_16x16x32_bf16 a[64:67], v[36:39], v[12:15], a[64:67]
 s_cselect_b32 s10, 0, s10
 ds_read_b64_tr_b16 v[100:101], v146 offset:16384
 v_mfma_f32_16x16x32_bf16 a[96:99], v[36:39], v[16:19], a[96:99]
 s_sub_u32 s69, s10, s44
 s_mov_b32 s44, s10
 v_mfma_f32_16x16x32_bf16 a[128:131], v[36:39], v[20:23], a[128:131]
 s_add_u32 m0, s8, 0x8000
 s_add_u32 s11, s38, 0x80000
 v_mfma_f32_16x16x32_bf16 a[160:163], v[36:39], v[24:27], a[160:163]
 ds_read_b64_tr_b16 v[102:103], v146 offset:18432
 v_mfma_f32_16x16x32_bf16 a[192:195], v[36:39], v[28:31], a[192:195]
 buffer_load_dwordx4 v140, s[20:23], s11 offen offset:0 lds
 v_mfma_f32_16x16x32_bf16 a[224:227], v[36:39], v[32:35], a[224:227]
 ds_read_b64_tr_b16 v[104:105], v147 offset:16384
 v_mfma_f32_16x16x32_bf16 a[4:7], v[40:43], v[4:7], a[4:7]
 ds_read_b64_tr_b16 v[106:107], v147 offset:18432
 v_mfma_f32_16x16x32_bf16 a[36:39], v[40:43], v[8:11], a[36:39]
 buffer_load_dwordx4 v141, s[20:23], s11 offen offset:1024 lds
 v_mfma_f32_16x16x32_bf16 a[68:71], v[40:43], v[12:15], a[68:71]
 ds_read_b64_tr_b16 v[108:109], v146 offset:16640
 v_mfma_f32_16x16x32_bf16 a[100:103], v[40:43], v[16:19], a[100:103]
 v_mfma_f32_16x16x32_bf16 a[132:135], v[40:43], v[20:23], a[132:135]
 ds_read_b64_tr_b16 v[110:111], v146 offset:18688
 v_mfma_f32_16x16x32_bf16 a[164:167], v[40:43], v[24:27], a[164:167]
 buffer_load_dwordx4 v142, s[20:23], s11 offen offset:2048 lds
 v_mfma_f32_16x16x32_bf16 a[196:199], v[40:43], v[28:31], a[196:199]
 ds_read_b64_tr_b16 v[112:113], v147 offset:16640
 v_mfma_f32_16x16x32_bf16 a[228:231], v[40:43], v[32:35], a[228:231]
 v_mfma_f32_16x16x32_bf16 a[8:11], v[44:47], v[4:7], a[8:11]
 ds_read_b64_tr_b16 v[114:115], v147 offset:18688
 v_mfma_f32_16x16x32_bf16 a[40:43], v[44:47], v[8:11], a[40:43]
 buffer_load_dwordx4 v143, s[20:23], s11 offen offset:3072 lds
 v_mfma_f32_16x16x32_bf16 a[72:75], v[44:47], v[12:15], a[72:75]
 ds_read_b64_tr_b16 v[116:117], v146 offset:16896
 v_mfma_f32_16x16x32_bf16 a[104:107], v[44:47], v[16:19], a[104:107]
 v_mfma_f32_16x16x32_bf16 a[136:139], v[44:47], v[20:23], a[136:139]
 ds_read_b64_tr_b16 v[118:119], v146 offset:18944
 v_mfma_f32_16x16x32_bf16 a[168:171], v[44:47], v[24:27], a[168:171]
 buffer_load_dwordx4 v[232:235], v2, s[4:7], s39 offen offset:2048
 v_mfma_f32_16x16x32_bf16 a[200:203], v[44:47], v[28:31], a[200:203]
 ds_read_b64_tr_b16 v[120:121], v147 offset:16896
 v_mfma_f32_16x16x32_bf16 a[232:235], v[44:47], v[32:35], a[232:235]
 v_mfma_f32_16x16x32_bf16 a[12:15], v[48:51], v[4:7], a[12:15]
 ds_read_b64_tr_b16 v[122:123], v147 offset:18944
 v_mfma_f32_16x16x32_bf16 a[44:47], v[48:51], v[8:11], a[44:47]
 buffer_load_dwordx4 v[236:239], v2, s[4:7], s40 offen offset:2048
 v_mfma_f32_16x16x32_bf16 a[76:79], v[48:51], v[12:15], a[76:79]
 ds_read_b64_tr_b16 v[124:125], v146 offset:17152
 v_mfma_f32_16x16x32_bf16 a[108:111], v[48:51], v[16:19], a[108:111]
 v_mfma_f32_16x16x32_bf16 a[140:143], v[48:51], v[20:23], a[140:143]
 ds_read_b64_tr_b16 v[126:127], v146 offset:19200
 v_mfma_f32_16x16x32_bf16 a[172:175], v[48:51], v[24:27], a[172:175]
 buffer_load_dwordx4 v[240:243], v2, s[4:7], s39 offen offset:3072
 v_mfma_f32_16x16x32_bf16 a[204:207], v[48:51], v[28:31], a[204:207]
 ds_read_b64_tr_b16 v[128:129], v147 offset:17152
 v_mfma_f32_16x16x32_bf16 a[236:239], v[48:51], v[32:35], a[236:239]
 v_mfma_f32_16x16x32_bf16 a[16:19], v[52:55], v[4:7], a[16:19]
 ds_read_b64_tr_b16 v[130:131], v147 offset:19200
 v_mfma_f32_16x16x32_bf16 a[48:51], v[52:55], v[8:11], a[48:51]
 buffer_load_dwordx4 v[244:247], v2, s[4:7], s40 offen offset:3072
 v_mfma_f32_16x16x32_bf16 a[80:83], v[52:55], v[12:15], a[80:83]
 ds_read_b128 v[72:75], v145 offset:2048
 s_add_u32 s39, s39, 0x1000
 v_mfma_f32_16x16x32_bf16 a[112:115], v[52:55], v[16:19], a[112:115]
 s_add_u32 s40, s40, 0x1000
 v_mfma_f32_16x16x32_bf16 a[144:147], v[52:55], v[20:23], a[144:147]
 s_add_u32 m0, s8, 0x24000
 ds_read_b128 v[76:79], v145 offset:4096
 v_mfma_f32_16x16x32_bf16 a[176:179], v[52:55], v[24:27], a[176:179]
 s_add_u32 s11, s38, 0x1c0000
 ds_read_b128 v[80:83], v145 offset:6144
 v_mfma_f32_16x16x32_bf16 a[208:211], v[52:55], v[28:31], a[208:211]
 buffer_load_dwordx4 v140, s[20:23], s11 offen offset:0 lds
 v_mfma_f32_16x16x32_bf16 a[240:243], v[52:55], v[32:35], a[240:243]
 v_mfma_f32_16x16x32_bf16 a[20:23], v[56:59], v[4:7], a[20:23]
 ds_read_b128 v[84:87], v145 offset:8192
 v_mfma_f32_16x16x32_bf16 a[52:55], v[56:59], v[8:11], a[52:55]
 ds_read_b128 v[88:91], v145 offset:10240
 v_mfma_f32_16x16x32_bf16 a[84:87], v[56:59], v[12:15], a[84:87]
 buffer_load_dwordx4 v141, s[20:23], s11 offen offset:1024 lds
 v_mfma_f32_16x16x32_bf16 a[116:119], v[56:59], v[16:19], a[116:119]
 v_mfma_f32_16x16x32_bf16 a[148:151], v[56:59], v[20:23], a[148:151]
 ds_read_b128 v[92:95], v145 offset:12288
 v_mfma_f32_16x16x32_bf16 a[180:183], v[56:59], v[24:27], a[180:183]
 ds_read_b128 v[96:99], v145 offset:14336
 v_mfma_f32_16x16x32_bf16 a[212:215], v[56:59], v[28:31], a[212:215]
 buffer_load_dwordx4 v142, s[20:23], s11 offen offset:2048 lds
 v_mfma_f32_16x16x32_bf16 a[244:247], v[56:59], v[32:35], a[244:247]
 v_mfma_f32_16x16x32_bf16 a[24:27], v[60:63], v[4:7], a[24:27]
 v_mfma_f32_16x16x32_bf16 a[56:59], v[60:63], v[8:11], a[56:59]
 v_add_u32 v144, s69, v144
 v_mfma_f32_16x16x32_bf16 a[88:91], v[60:63], v[12:15], a[88:91]
 buffer_load_dwordx4 v143, s[20:23], s11 offen offset:3072 lds
 v_mfma_f32_16x16x32_bf16 a[120:123], v[60:63], v[16:19], a[120:123]
 v_add_u32 v145, s69, v145
 v_mfma_f32_16x16x32_bf16 a[152:155], v[60:63], v[20:23], a[152:155]
 v_xor_b32 v146, 0x8000, v146
 v_mfma_f32_16x16x32_bf16 a[184:187], v[60:63], v[24:27], a[184:187]
 v_xor_b32 v147, 0x8000, v147
 v_mfma_f32_16x16x32_bf16 a[216:219], v[60:63], v[28:31], a[216:219]
 buffer_load_dwordx4 v[248:251], v2, s[4:7], s39 offen offset:0
 v_mfma_f32_16x16x32_bf16 a[248:251], v[60:63], v[32:35], a[248:251]
 v_mfma_f32_16x16x32_bf16 a[28:31], v[64:67], v[4:7], a[28:31]
 v_mfma_f32_16x16x32_bf16 a[60:63], v[64:67], v[8:11], a[60:63]
 v_mfma_f32_16x16x32_bf16 a[92:95], v[64:67], v[12:15], a[92:95]
 buffer_load_dwordx4 v[252:255], v2, s[4:7], s40 offen offset:0
 v_mfma_f32_16x16x32_bf16 a[124:127], v[64:67], v[16:19], a[124:127]
 v_mfma_f32_16x16x32_bf16 a[156:159], v[64:67], v[20:23], a[156:159]
 v_mfma_f32_16x16x32_bf16 a[188:191], v[64:67], v[24:27], a[188:191]
 v_mfma_f32_16x16x32_bf16 a[220:223], v[64:67], v[28:31], a[220:223]
 v_mfma_f32_16x16x32_bf16 a[252:255], v[64:67], v[32:35], a[252:255]
 s_waitcnt lgkmcnt(0)
 s_barrier
 v_mfma_f32_16x16x32_bf16 a[192:195], v[100:103], v[92:95], a[192:195]
 v_mfma_f32_16x16x32_bf16 a[196:199], v[104:107], v[92:95], a[196:199]
 v_subrev_u32 v146, s68, v146
 v_subrev_u32 v147, s68, v147
 v_mfma_f32_16x16x32_bf16 a[200:203], v[108:111], v[92:95], a[200:203]
 v_min_u32 v150, 15, v1
 v_lshlrev_b32 v150, 2, v150
 v_mfma_f32_16x16x32_bf16 a[204:207], v[112:115], v[92:95], a[204:207]
 s_add_u32 m0, s8, 0xc000
 s_add_u32 s11, s38, 0xc0000
 v_mfma_f32_16x16x32_bf16 a[208:211], v[116:119], v[92:95], a[208:211]
 buffer_load_dwordx4 v140, s[20:23], s11 offen offset:0 lds
 v_mfma_f32_16x16x32_bf16 a[212:215], v[120:123], v[92:95], a[212:215]
 v_mfma_f32_16x16x32_bf16 a[216:219], v[124:127], v[92:95], a[216:219]
 v_accvgpr_read_b32 v216, a192
 v_mfma_f32_16x16x32_bf16 a[220:223], v[128:131], v[92:95], a[220:223]
 v_accvgpr_read_b32 v217, a193
 v_accvgpr_read_b32 v218, a194
 v_mfma_f32_16x16x32_bf16 a[224:227], v[100:103], v[96:99], a[224:227]
 v_accvgpr_read_b32 v219, a195
 v_accvgpr_read_b32 v220, a196
 v_mfma_f32_16x16x32_bf16 a[228:231], v[104:107], v[96:99], a[228:231]
 v_accvgpr_read_b32 v221, a197
 v_accvgpr_read_b32 v222, a198
 v_mfma_f32_16x16x32_bf16 a[232:235], v[108:111], v[96:99], a[232:235]
 v_accvgpr_read_b32 v223, a199
 v_cvt_pk_bf16_f32 v224, v216, v217
 v_mfma_f32_16x16x32_bf16 a[236:239], v[112:115], v[96:99], a[236:239]
 v_cvt_pk_bf16_f32 v225, v218, v219
 v_cvt_pk_bf16_f32 v226, v220, v221
 v_mfma_f32_16x16x32_bf16 a[240:243], v[116:119], v[96:99], a[240:243]
 buffer_load_dwordx4 v141, s[20:23], s11 offen offset:1024 lds
 v_mfma_f32_16x16x32_bf16 a[244:247], v[120:123], v[96:99], a[244:247]
 v_cvt_pk_bf16_f32 v227, v222, v223
 s_add_u32 s33, s35, 49152
 v_mfma_f32_16x16x32_bf16 a[248:251], v[124:127], v[96:99], a[248:251]
 buffer_store_dwordx4 v[224:227], v2, s[4:7], s33 offen offset:0 sc1
 v_mfma_f32_16x16x32_bf16 a[252:255], v[128:131], v[96:99], a[252:255]
 v_accvgpr_read_b32 v216, a200
 v_accvgpr_read_b32 v217, a201
 v_mfma_f32_16x16x32_bf16 a[0:3], v[100:103], v[68:71], a[0:3]
 v_accvgpr_read_b32 v218, a202
 v_accvgpr_read_b32 v219, a203
 v_mfma_f32_16x16x32_bf16 a[4:7], v[104:107], v[68:71], a[4:7]
 v_accvgpr_read_b32 v220, a204
 v_accvgpr_read_b32 v221, a205
 v_mfma_f32_16x16x32_bf16 a[8:11], v[108:111], v[68:71], a[8:11]
 v_accvgpr_read_b32 v222, a206
 v_accvgpr_read_b32 v223, a207
 v_mfma_f32_16x16x32_bf16 a[12:15], v[112:115], v[68:71], a[12:15]
 v_cvt_pk_bf16_f32 v228, v216, v217
 v_cvt_pk_bf16_f32 v229, v218, v219
 v_mfma_f32_16x16x32_bf16 a[16:19], v[116:119], v[68:71], a[16:19]
 buffer_load_dwordx4 v142, s[20:23], s11 offen offset:2048 lds
 v_mfma_f32_16x16x32_bf16 a[20:23], v[120:123], v[68:71], a[20:23]
 v_cvt_pk_bf16_f32 v230, v220, v221
 v_cvt_pk_bf16_f32 v231, v222, v223
 v_mfma_f32_16x16x32_bf16 a[24:27], v[124:127], v[68:71], a[24:27]
 buffer_store_dwordx4 v[228:231], v2, s[4:7], s33 offen offset:1024 sc1
 v_mfma_f32_16x16x32_bf16 a[28:31], v[128:131], v[68:71], a[28:31]
 v_accvgpr_read_b32 v216, a208
 v_accvgpr_read_b32 v217, a209
 v_mfma_f32_16x16x32_bf16 a[32:35], v[100:103], v[72:75], a[32:35]
 v_accvgpr_read_b32 v218, a210
 v_accvgpr_read_b32 v219, a211
 v_mfma_f32_16x16x32_bf16 a[36:39], v[104:107], v[72:75], a[36:39]
 v_accvgpr_read_b32 v220, a212
 v_accvgpr_read_b32 v221, a213
 v_mfma_f32_16x16x32_bf16 a[40:43], v[108:111], v[72:75], a[40:43]
 v_accvgpr_read_b32 v222, a214
 v_accvgpr_read_b32 v223, a215
 v_mfma_f32_16x16x32_bf16 a[44:47], v[112:115], v[72:75], a[44:47]
 v_cvt_pk_bf16_f32 v224, v216, v217
 v_cvt_pk_bf16_f32 v225, v218, v219
 v_mfma_f32_16x16x32_bf16 a[48:51], v[116:119], v[72:75], a[48:51]
 buffer_load_dwordx4 v143, s[20:23], s11 offen offset:3072 lds
 v_mfma_f32_16x16x32_bf16 a[52:55], v[120:123], v[72:75], a[52:55]
 v_cvt_pk_bf16_f32 v226, v220, v221
 v_cvt_pk_bf16_f32 v227, v222, v223
 v_mfma_f32_16x16x32_bf16 a[56:59], v[124:127], v[72:75], a[56:59]
 buffer_store_dwordx4 v[224:227], v2, s[4:7], s33 offen offset:2048 sc1
 v_mfma_f32_16x16x32_bf16 a[60:63], v[128:131], v[72:75], a[60:63]
 s_add_u32 m0, s8, 0x10000
 v_accvgpr_read_b32 v216, a216
 v_mfma_f32_16x16x32_bf16 a[64:67], v[100:103], v[76:79], a[64:67]
 v_accvgpr_read_b32 v217, a217
 v_accvgpr_read_b32 v218, a218
 v_mfma_f32_16x16x32_bf16 a[68:71], v[104:107], v[76:79], a[68:71]
 v_accvgpr_read_b32 v219, a219
 s_add_u32 s11, s38, 0x200000
 v_mfma_f32_16x16x32_bf16 a[72:75], v[108:111], v[76:79], a[72:75]
 v_accvgpr_read_b32 v220, a220
 v_accvgpr_read_b32 v221, a221
 v_mfma_f32_16x16x32_bf16 a[76:79], v[112:115], v[76:79], a[76:79]
 v_accvgpr_read_b32 v222, a222
 v_accvgpr_read_b32 v223, a223
 v_mfma_f32_16x16x32_bf16 a[80:83], v[116:119], v[76:79], a[80:83]
 buffer_load_dwordx4 v140, s[20:23], s11 offen offset:0 lds
 v_mfma_f32_16x16x32_bf16 a[84:87], v[120:123], v[76:79], a[84:87]
 v_cvt_pk_bf16_f32 v228, v216, v217
 v_cvt_pk_bf16_f32 v229, v218, v219
 v_mfma_f32_16x16x32_bf16 a[88:91], v[124:127], v[76:79], a[88:91]
 v_cvt_pk_bf16_f32 v230, v220, v221
 v_cvt_pk_bf16_f32 v231, v222, v223
 v_mfma_f32_16x16x32_bf16 a[92:95], v[128:131], v[76:79], a[92:95]
 buffer_store_dwordx4 v[228:231], v2, s[4:7], s33 offen offset:3072 sc1
 v_mfma_f32_16x16x32_bf16 a[96:99], v[100:103], v[80:83], a[96:99]
 v_accvgpr_read_b32 v216, a224
 v_accvgpr_read_b32 v217, a225
 v_mfma_f32_16x16x32_bf16 a[100:103], v[104:107], v[80:83], a[100:103]
 v_accvgpr_read_b32 v218, a226
 v_accvgpr_read_b32 v219, a227
 v_mfma_f32_16x16x32_bf16 a[104:107], v[108:111], v[80:83], a[104:107]
 v_accvgpr_read_b32 v220, a228
 v_accvgpr_read_b32 v221, a229
 v_mfma_f32_16x16x32_bf16 a[108:111], v[112:115], v[80:83], a[108:111]
 v_accvgpr_read_b32 v222, a230
 v_accvgpr_read_b32 v223, a231
 v_mfma_f32_16x16x32_bf16 a[112:115], v[116:119], v[80:83], a[112:115]
 buffer_load_dwordx4 v141, s[20:23], s11 offen offset:1024 lds
 v_mfma_f32_16x16x32_bf16 a[116:119], v[120:123], v[80:83], a[116:119]
 v_cvt_pk_bf16_f32 v224, v216, v217
 v_cvt_pk_bf16_f32 v225, v218, v219
 v_mfma_f32_16x16x32_bf16 a[120:123], v[124:127], v[80:83], a[120:123]
 v_cvt_pk_bf16_f32 v226, v220, v221
 v_cvt_pk_bf16_f32 v227, v222, v223
 v_mfma_f32_16x16x32_bf16 a[124:127], v[128:131], v[80:83], a[124:127]
 s_add_u32 s33, s36, 49152
 v_mfma_f32_16x16x32_bf16 a[128:131], v[100:103], v[84:87], a[128:131]
 buffer_store_dwordx4 v[224:227], v2, s[4:7], s33 offen offset:0 sc1
 v_mfma_f32_16x16x32_bf16 a[132:135], v[104:107], v[84:87], a[132:135]
 v_accvgpr_read_b32 v216, a232
 v_accvgpr_read_b32 v217, a233
 v_mfma_f32_16x16x32_bf16 a[136:139], v[108:111], v[84:87], a[136:139]
 v_accvgpr_read_b32 v218, a234
 v_accvgpr_read_b32 v219, a235
 v_mfma_f32_16x16x32_bf16 a[140:143], v[112:115], v[84:87], a[140:143]
 v_accvgpr_read_b32 v220, a236
 v_accvgpr_read_b32 v221, a237
 v_mfma_f32_16x16x32_bf16 a[144:147], v[116:119], v[84:87], a[144:147]
 v_accvgpr_read_b32 v222, a238
 v_accvgpr_read_b32 v223, a239
 v_mfma_f32_16x16x32_bf16 a[148:151], v[120:123], v[84:87], a[148:151]
 buffer_load_dwordx4 v142, s[20:23], s11 offen offset:2048 lds
 v_mfma_f32_16x16x32_bf16 a[152:155], v[124:127], v[84:87], a[152:155]
 v_cvt_pk_bf16_f32 v228, v216, v217
 v_cvt_pk_bf16_f32 v229, v218, v219
 v_mfma_f32_16x16x32_bf16 a[156:159], v[128:131], v[84:87], a[156:159]
 v_cvt_pk_bf16_f32 v230, v220, v221
 v_cvt_pk_bf16_f32 v231, v222, v223
 v_mfma_f32_16x16x32_bf16 a[160:163], v[100:103], v[88:91], a[160:163]
 buffer_store_dwordx4 v[228:231], v2, s[4:7], s33 offen offset:1024 sc1
 v_mfma_f32_16x16x32_bf16 a[164:167], v[104:107], v[88:91], a[164:167]
 v_accvgpr_read_b32 v216, a240
 v_accvgpr_read_b32 v217, a241
 v_mfma_f32_16x16x32_bf16 a[168:171], v[108:111], v[88:91], a[168:171]
 v_accvgpr_read_b32 v218, a242
 v_accvgpr_read_b32 v219, a243
 v_mfma_f32_16x16x32_bf16 a[172:175], v[112:115], v[88:91], a[172:175]
 v_accvgpr_read_b32 v220, a244
 v_accvgpr_read_b32 v221, a245
 v_mfma_f32_16x16x32_bf16 a[176:179], v[116:119], v[88:91], a[176:179]
 v_accvgpr_read_b32 v222, a246
 v_accvgpr_read_b32 v223, a247
 v_mfma_f32_16x16x32_bf16 a[180:183], v[120:123], v[88:91], a[180:183]
 buffer_load_dwordx4 v143, s[20:23], s11 offen offset:3072 lds
 v_mfma_f32_16x16x32_bf16 a[184:187], v[124:127], v[88:91], a[184:187]
 s_mov_b32 s56, s52
 s_mov_b32 s57, s53
 s_and_b32 s9, s2, 7
 s_lshl_b32 s67, s9, 1
 s_bfe_u32 s9, s2, 0x10003
 s_add_u32 s67, s67, s9
 s_bfe_u32 s68, s2, 0x30004
 s_lshl_b32 s70, s67, 3
 s_add_u32 s70, s70, s68
 s_lshl_b32 s70, s70, 2
 s_add_u32 s70, s70, s3
 s_mul_i32 s9, s67, 1048576
 s_add_u32 s48, s4, s9
 s_addc_u32 s49, s5, 0
 s_add_u32 s52, s48, 0x1200000
 s_addc_u32 s53, s49, 0
 s_mov_b32 s51, 0x20000
 s_mov_b32 s55, 0x20000
 v_add_u32 v154, s8, v2
 s_lshl_b32 s9, s68, 2
 s_sub_u32 s10, 64, s9
 s_add_u32 s11, s9, 4
 s_sub_u32 s62, 15, s68
 s_cmp_gt_u32 s10, 40
 s_cselect_b32 s69, 1, 0
 s_cselect_b32 s63, 40, 0
 s_cselect_b32 s11, s10, s11
 s_cselect_b32 s10, 40, s10
 s_cselect_b32 s9, s62, s68
 s_xor_b32 s66, s69, 1
 s_lshl_b32 s65, s69, 1
 s_bitcmp1_b32 s2, 7
 s_cselect_b32 s64, s10, s11
 s_cselect_b32 s63, 0, s63
 s_cselect_b32 s62, s62, s9
 s_cselect_b32 s66, s66, 1
 s_cselect_b32 s65, s65, s69
 s_cselect_b32 s69, 0, s69
 s_mul_i32 s50, s64, 16384
 s_mov_b32 s54, s50
 s_mul_i32 s60, s63, 16384
 s_mov_b32 s61, s60
 v_mfma_f32_16x16x32_bf16 a[188:191], v[128:131], v[88:91], a[188:191]
 v_cvt_pk_bf16_f32 v224, v216, v217
 v_cvt_pk_bf16_f32 v225, v218, v219
 v_cvt_pk_bf16_f32 v226, v220, v221
 v_cvt_pk_bf16_f32 v227, v222, v223
 buffer_store_dwordx4 v[224:227], v2, s[4:7], s33 offen offset:2048 sc1
 v_accvgpr_read_b32 v216, a248
 v_accvgpr_read_b32 v217, a249
 v_accvgpr_read_b32 v218, a250
 v_accvgpr_read_b32 v219, a251
 v_accvgpr_read_b32 v220, a252
 v_accvgpr_read_b32 v221, a253
 v_accvgpr_read_b32 v222, a254
 v_accvgpr_read_b32 v223, a255
 v_cvt_pk_bf16_f32 v228, v216, v217
 v_cvt_pk_bf16_f32 v229, v218, v219
 v_cvt_pk_bf16_f32 v230, v220, v221
 v_cvt_pk_bf16_f32 v231, v222, v223
 buffer_store_dwordx4 v[228:231], v2, s[4:7], s33 offen offset:3072 sc1
 s_branch L1_tail
L1_V_start:
 s_waitcnt vmcnt(16) lgkmcnt(0)
 s_barrier
 v_mfma_f32_16x16x32_bf16 a[0:3], v[4:7], v[36:39], 0
 ds_read_b128 v[68:71], v145 offset:0
 v_mfma_f32_16x16x32_bf16 a[8:11], v[4:7], v[40:43], 0
 s_add_u32 s10, s44, 0x8000
 s_cmp_eq_u32 s10, 0x18000
 v_mfma_f32_16x16x32_bf16 a[16:19], v[4:7], v[44:47], 0
 s_cselect_b32 s10, 0, s10
 ds_read_b64_tr_b16 v[100:101], v146 offset:16384
 v_mfma_f32_16x16x32_bf16 a[24:27], v[4:7], v[48:51], 0
 s_sub_u32 s69, s10, s44
 s_mov_b32 s44, s10
 v_mfma_f32_16x16x32_bf16 a[32:35], v[4:7], v[52:55], 0
 buffer_store_dwordx4 v[168:171], v153, s[4:7], s39 offen offset:0 sc1
 v_mfma_f32_16x16x32_bf16 a[40:43], v[4:7], v[56:59], 0
 ds_read_b64_tr_b16 v[102:103], v146 offset:18432
 v_mfma_f32_16x16x32_bf16 a[48:51], v[4:7], v[60:63], 0
 ds_read_b64_tr_b16 v[104:105], v147 offset:16384
 v_mfma_f32_16x16x32_bf16 a[56:59], v[4:7], v[64:67], 0
 buffer_store_dwordx4 v[172:175], v153, s[4:7], s39 offen offset:2048 sc1
 v_mfma_f32_16x16x32_bf16 a[4:7], v[8:11], v[36:39], 0
 s_add_u32 s39, s39, 0x1000
 ds_read_b64_tr_b16 v[106:107], v147 offset:18432
 v_mfma_f32_16x16x32_bf16 a[12:15], v[8:11], v[40:43], 0
 buffer_store_dwordx4 v[176:179], v153, s[4:7], s39 offen offset:0 sc1
 v_mfma_f32_16x16x32_bf16 a[20:23], v[8:11], v[44:47], 0
 ds_read_b64_tr_b16 v[108:109], v146 offset:16640
 v_mfma_f32_16x16x32_bf16 a[28:31], v[8:11], v[48:51], 0
 ds_read_b64_tr_b16 v[110:111], v146 offset:18688
 v_mfma_f32_16x16x32_bf16 a[36:39], v[8:11], v[52:55], 0
 buffer_store_dwordx4 v[180:183], v153, s[4:7], s39 offen offset:2048 sc1
 v_mfma_f32_16x16x32_bf16 a[44:47], v[8:11], v[56:59], 0
 s_add_u32 s39, s39, 0x1000
 v_mfma_f32_16x16x32_bf16 a[52:55], v[8:11], v[60:63], 0
 ds_read_b64_tr_b16 v[112:113], v147 offset:16640
 v_mfma_f32_16x16x32_bf16 a[60:63], v[8:11], v[64:67], 0
 buffer_store_dwordx4 v[184:187], v153, s[4:7], s39 offen offset:0 sc1
 v_mfma_f32_16x16x32_bf16 a[64:67], v[12:15], v[36:39], 0
 ds_read_b64_tr_b16 v[114:115], v147 offset:18688
 v_mfma_f32_16x16x32_bf16 a[72:75], v[12:15], v[40:43], 0
 buffer_store_dwordx4 v[188:191], v153, s[4:7], s39 offen offset:2048 sc1
 v_mfma_f32_16x16x32_bf16 a[80:83], v[12:15], v[44:47], 0
 ds_read_b64_tr_b16 v[116:117], v146 offset:16896
 v_mfma_f32_16x16x32_bf16 a[88:91], v[12:15], v[48:51], 0
 s_add_u32 s39, s39, 0x1000
 v_mfma_f32_16x16x32_bf16 a[96:99], v[12:15], v[52:55], 0
 ds_read_b64_tr_b16 v[118:119], v146 offset:18944
 v_mfma_f32_16x16x32_bf16 a[104:107], v[12:15], v[56:59], 0
 buffer_store_dwordx4 v[192:195], v153, s[4:7], s39 offen offset:0 sc1
 v_mfma_f32_16x16x32_bf16 a[112:115], v[12:15], v[60:63], 0
 ds_read_b64_tr_b16 v[120:121], v147 offset:16896
 v_mfma_f32_16x16x32_bf16 a[120:123], v[12:15], v[64:67], 0
 buffer_store_dwordx2 v[216:217], v150, s[4:7], s34 offen sc1
 v_mfma_f32_16x16x32_bf16 a[68:71], v[16:19], v[36:39], 0
 ds_read_b64_tr_b16 v[122:123], v147 offset:18944
 s_mov_b32 m0, s42
 v_mfma_f32_16x16x32_bf16 a[76:79], v[16:19], v[40:43], 0
 ds_read_b64_tr_b16 v[124:125], v146 offset:17152
 v_mfma_f32_16x16x32_bf16 a[84:87], v[16:19], v[44:47], 0
 buffer_load_dwordx4 v132, s[12:15], s41 offen offset:0 lds
 v_mfma_f32_16x16x32_bf16 a[92:95], v[16:19], v[48:51], 0
 v_mfma_f32_16x16x32_bf16 a[100:103], v[16:19], v[52:55], 0
 ds_read_b64_tr_b16 v[126:127], v146 offset:19200
 v_mfma_f32_16x16x32_bf16 a[108:111], v[16:19], v[56:59], 0
 buffer_load_dwordx4 v133, s[12:15], s41 offen offset:1024 lds
 v_mfma_f32_16x16x32_bf16 a[116:119], v[16:19], v[60:63], 0
 ds_read_b64_tr_b16 v[128:129], v147 offset:17152
 v_mfma_f32_16x16x32_bf16 a[124:127], v[16:19], v[64:67], 0
 buffer_load_dwordx4 v134, s[12:15], s41 offen offset:2048 lds
 v_mfma_f32_16x16x32_bf16 a[128:131], v[20:23], v[36:39], 0
 ds_read_b64_tr_b16 v[130:131], v147 offset:19200
 v_mfma_f32_16x16x32_bf16 a[136:139], v[20:23], v[40:43], 0
 ds_read_b128 v[72:75], v145 offset:2048
 v_mfma_f32_16x16x32_bf16 a[144:147], v[20:23], v[44:47], 0
 buffer_load_dwordx4 v135, s[12:15], s41 offen offset:3072 lds
 v_mfma_f32_16x16x32_bf16 a[152:155], v[20:23], v[48:51], 0
 s_mov_b32 m0, s43
 v_mfma_f32_16x16x32_bf16 a[160:163], v[20:23], v[52:55], 0
 ds_read_b128 v[76:79], v145 offset:4096
 v_mfma_f32_16x16x32_bf16 a[168:171], v[20:23], v[56:59], 0
 buffer_load_dwordx4 v140, s[16:19], s32 offen offset:0 lds
 v_mfma_f32_16x16x32_bf16 a[176:179], v[20:23], v[60:63], 0
 ds_read_b128 v[80:83], v145 offset:6144
 v_mfma_f32_16x16x32_bf16 a[184:187], v[20:23], v[64:67], 0
 buffer_load_dwordx4 v141, s[16:19], s32 offen offset:1024 lds
 v_mfma_f32_16x16x32_bf16 a[132:135], v[24:27], v[36:39], 0
 ds_read_b128 v[84:87], v145 offset:8192
 v_mfma_f32_16x16x32_bf16 a[140:143], v[24:27], v[40:43], 0
 v_mfma_f32_16x16x32_bf16 a[148:151], v[24:27], v[44:47], 0
 ds_read_b128 v[88:91], v145 offset:10240
 v_mfma_f32_16x16x32_bf16 a[156:159], v[24:27], v[48:51], 0
 buffer_load_dwordx4 v142, s[16:19], s32 offen offset:2048 lds
 v_mfma_f32_16x16x32_bf16 a[164:167], v[24:27], v[52:55], 0
 ds_read_b128 v[92:95], v145 offset:12288
 v_mfma_f32_16x16x32_bf16 a[172:175], v[24:27], v[56:59], 0
 buffer_load_dwordx4 v143, s[16:19], s32 offen offset:3072 lds
 v_mfma_f32_16x16x32_bf16 a[180:183], v[24:27], v[60:63], 0
 s_add_u32 s43, s43, 0x4000
 s_and_b32 s43, s43, 0xffff
 v_mfma_f32_16x16x32_bf16 a[188:191], v[24:27], v[64:67], 0
 ds_read_b128 v[96:99], v145 offset:14336
 s_add_u32 s32, s32, 0x40000
 v_mfma_f32_16x16x32_bf16 a[192:195], v[28:31], v[36:39], 0
 s_add_u32 m0, s42, 0x1000
 v_mfma_f32_16x16x32_bf16 a[200:203], v[28:31], v[40:43], 0
 buffer_load_dwordx4 v136, s[12:15], s41 offen offset:0 lds
 v_mfma_f32_16x16x32_bf16 a[208:211], v[28:31], v[44:47], 0
 v_add_u32 v144, s69, v144
 v_add_u32 v145, s69, v145
 v_mfma_f32_16x16x32_bf16 a[216:219], v[28:31], v[48:51], 0
 buffer_load_dwordx4 v137, s[12:15], s41 offen offset:1024 lds
 v_mfma_f32_16x16x32_bf16 a[224:227], v[28:31], v[52:55], 0
 v_xor_b32 v146, 0x8000, v146
 v_mfma_f32_16x16x32_bf16 a[232:235], v[28:31], v[56:59], 0
 v_xor_b32 v147, 0x8000, v147
 v_mfma_f32_16x16x32_bf16 a[240:243], v[28:31], v[60:63], 0
 buffer_load_dwordx4 v138, s[12:15], s41 offen offset:2048 lds
 v_mfma_f32_16x16x32_bf16 a[248:251], v[28:31], v[64:67], 0
 v_mfma_f32_16x16x32_bf16 a[196:199], v[32:35], v[36:39], 0
 buffer_load_dwordx4 v139, s[12:15], s41 offen offset:3072 lds
 v_mfma_f32_16x16x32_bf16 a[204:207], v[32:35], v[40:43], 0
 s_add_u32 s42, s42, 0x8000
 s_cmp_ge_u32 s42, 0x28000
 v_mfma_f32_16x16x32_bf16 a[212:215], v[32:35], v[44:47], 0
 s_cselect_b32 s9, 0x18000, 0
 s_sub_u32 s42, s42, s9
 v_mfma_f32_16x16x32_bf16 a[220:223], v[32:35], v[48:51], 0
 s_add_u32 s41, s41, 128
 v_mfma_f32_16x16x32_bf16 a[228:231], v[32:35], v[52:55], 0
 buffer_load_dwordx4 v[156:159], v2, s[48:51], s56 offen
 v_mfma_f32_16x16x32_bf16 a[236:239], v[32:35], v[56:59], 0
 s_add_u32 s56, s56, 1024
 v_mfma_f32_16x16x32_bf16 a[244:247], v[32:35], v[60:63], 0
 v_mfma_f32_16x16x32_bf16 a[252:255], v[32:35], v[64:67], 0
 s_waitcnt vmcnt(25) lgkmcnt(0)
 s_barrier
 v_mfma_f32_16x16x32_bf16 a[0:3], v[68:71], v[100:103], a[0:3]
 ds_read_b128 v[4:7], v144 offset:0
 v_mfma_f32_16x16x32_bf16 a[8:11], v[68:71], v[104:107], a[8:11]
 s_mov_b32 m0, s43
 ds_read_b64_tr_b16 v[36:37], v146 offset:0
 v_mfma_f32_16x16x32_bf16 a[16:19], v[68:71], v[108:111], a[16:19]
 buffer_load_dwordx4 v140, s[16:19], s32 offen offset:0 lds
 v_mfma_f32_16x16x32_bf16 a[24:27], v[68:71], v[112:115], a[24:27]
 v_mfma_f32_16x16x32_bf16 a[32:35], v[68:71], v[116:119], a[32:35]
 ds_read_b64_tr_b16 v[38:39], v146 offset:2048
 v_mfma_f32_16x16x32_bf16 a[40:43], v[68:71], v[120:123], a[40:43]
 v_mfma_f32_16x16x32_bf16 a[48:51], v[68:71], v[124:127], a[48:51]
 ds_read_b64_tr_b16 v[40:41], v147 offset:0
 v_mfma_f32_16x16x32_bf16 a[56:59], v[68:71], v[128:131], a[56:59]
 v_mfma_f32_16x16x32_bf16 a[4:7], v[72:75], v[100:103], a[4:7]
 ds_read_b64_tr_b16 v[42:43], v147 offset:2048
 v_mfma_f32_16x16x32_bf16 a[12:15], v[72:75], v[104:107], a[12:15]
 buffer_load_dwordx4 v141, s[16:19], s32 offen offset:1024 lds
 v_mfma_f32_16x16x32_bf16 a[20:23], v[72:75], v[108:111], a[20:23]
 ds_read_b64_tr_b16 v[44:45], v146 offset:256
 v_mfma_f32_16x16x32_bf16 a[28:31], v[72:75], v[112:115], a[28:31]
 v_mfma_f32_16x16x32_bf16 a[36:39], v[72:75], v[116:119], a[36:39]
 ds_read_b64_tr_b16 v[46:47], v146 offset:2304
 v_mfma_f32_16x16x32_bf16 a[44:47], v[72:75], v[120:123], a[44:47]
 v_mfma_f32_16x16x32_bf16 a[52:55], v[72:75], v[124:127], a[52:55]
 ds_read_b64_tr_b16 v[48:49], v147 offset:256
 v_mfma_f32_16x16x32_bf16 a[60:63], v[72:75], v[128:131], a[60:63]
 v_mfma_f32_16x16x32_bf16 a[64:67], v[76:79], v[100:103], a[64:67]
 ds_read_b64_tr_b16 v[50:51], v147 offset:2304
 v_mfma_f32_16x16x32_bf16 a[72:75], v[76:79], v[104:107], a[72:75]
 buffer_load_dwordx4 v142, s[16:19], s32 offen offset:2048 lds
 v_mfma_f32_16x16x32_bf16 a[80:83], v[76:79], v[108:111], a[80:83]
 ds_read_b64_tr_b16 v[52:53], v146 offset:512
 v_mfma_f32_16x16x32_bf16 a[88:91], v[76:79], v[112:115], a[88:91]
 v_mfma_f32_16x16x32_bf16 a[96:99], v[76:79], v[116:119], a[96:99]
 ds_read_b64_tr_b16 v[54:55], v146 offset:2560
 v_mfma_f32_16x16x32_bf16 a[104:107], v[76:79], v[120:123], a[104:107]
 v_mfma_f32_16x16x32_bf16 a[112:115], v[76:79], v[124:127], a[112:115]
 ds_read_b64_tr_b16 v[56:57], v147 offset:512
 v_mfma_f32_16x16x32_bf16 a[120:123], v[76:79], v[128:131], a[120:123]
 v_mfma_f32_16x16x32_bf16 a[68:71], v[80:83], v[100:103], a[68:71]
 ds_read_b64_tr_b16 v[58:59], v147 offset:2560
 v_mfma_f32_16x16x32_bf16 a[76:79], v[80:83], v[104:107], a[76:79]
 buffer_load_dwordx4 v143, s[16:19], s32 offen offset:3072 lds
 v_mfma_f32_16x16x32_bf16 a[84:87], v[80:83], v[108:111], a[84:87]
 ds_read_b64_tr_b16 v[60:61], v146 offset:768
 s_add_u32 s43, s43, 0x4000
 v_mfma_f32_16x16x32_bf16 a[92:95], v[80:83], v[112:115], a[92:95]
 v_mfma_f32_16x16x32_bf16 a[100:103], v[80:83], v[116:119], a[100:103]
 s_and_b32 s43, s43, 0xffff
 ds_read_b64_tr_b16 v[62:63], v146 offset:2816
 v_mfma_f32_16x16x32_bf16 a[108:111], v[80:83], v[120:123], a[108:111]
 s_add_u32 s32, s32, 0x40000
 v_mfma_f32_16x16x32_bf16 a[116:119], v[80:83], v[124:127], a[116:119]
 ds_read_b64_tr_b16 v[64:65], v147 offset:768
 v_mfma_f32_16x16x32_bf16 a[124:127], v[80:83], v[128:131], a[124:127]
 s_mov_b32 m0, s42
 v_mfma_f32_16x16x32_bf16 a[128:131], v[84:87], v[100:103], a[128:131]
 ds_read_b64_tr_b16 v[66:67], v147 offset:2816
 v_mfma_f32_16x16x32_bf16 a[136:139], v[84:87], v[104:107], a[136:139]
 buffer_load_dwordx4 v132, s[12:15], s41 offen offset:0 lds
 v_mfma_f32_16x16x32_bf16 a[144:147], v[84:87], v[108:111], a[144:147]
 ds_read_b128 v[8:11], v144 offset:2048
 v_mfma_f32_16x16x32_bf16 a[152:155], v[84:87], v[112:115], a[152:155]
 v_mfma_f32_16x16x32_bf16 a[160:163], v[84:87], v[116:119], a[160:163]
 ds_read_b128 v[12:15], v144 offset:4096
 v_mfma_f32_16x16x32_bf16 a[168:171], v[84:87], v[120:123], a[168:171]
 v_mfma_f32_16x16x32_bf16 a[176:179], v[84:87], v[124:127], a[176:179]
 ds_read_b128 v[16:19], v144 offset:6144
 v_mfma_f32_16x16x32_bf16 a[184:187], v[84:87], v[128:131], a[184:187]
 v_mfma_f32_16x16x32_bf16 a[132:135], v[88:91], v[100:103], a[132:135]
 ds_read_b128 v[20:23], v144 offset:8192
 v_mfma_f32_16x16x32_bf16 a[140:143], v[88:91], v[104:107], a[140:143]
 buffer_load_dwordx4 v133, s[12:15], s41 offen offset:1024 lds
 v_mfma_f32_16x16x32_bf16 a[148:151], v[88:91], v[108:111], a[148:151]
 ds_read_b128 v[24:27], v144 offset:10240
 v_mfma_f32_16x16x32_bf16 a[156:159], v[88:91], v[112:115], a[156:159]
 v_mfma_f32_16x16x32_bf16 a[164:167], v[88:91], v[116:119], a[164:167]
 ds_read_b128 v[28:31], v144 offset:12288
 v_mfma_f32_16x16x32_bf16 a[172:175], v[88:91], v[120:123], a[172:175]
 v_mfma_f32_16x16x32_bf16 a[180:183], v[88:91], v[124:127], a[180:183]
 ds_read_b128 v[32:35], v144 offset:14336
 v_mfma_f32_16x16x32_bf16 a[188:191], v[88:91], v[128:131], a[188:191]
 v_mfma_f32_16x16x32_bf16 a[192:195], v[92:95], v[100:103], a[192:195]
 buffer_load_dwordx4 v134, s[12:15], s41 offen offset:2048 lds
 v_mfma_f32_16x16x32_bf16 a[200:203], v[92:95], v[104:107], a[200:203]
 v_mfma_f32_16x16x32_bf16 a[208:211], v[92:95], v[108:111], a[208:211]
 v_mfma_f32_16x16x32_bf16 a[216:219], v[92:95], v[112:115], a[216:219]
 v_mfma_f32_16x16x32_bf16 a[224:227], v[92:95], v[116:119], a[224:227]
 v_mfma_f32_16x16x32_bf16 a[232:235], v[92:95], v[120:123], a[232:235]
 v_mfma_f32_16x16x32_bf16 a[240:243], v[92:95], v[124:127], a[240:243]
 v_mfma_f32_16x16x32_bf16 a[248:251], v[92:95], v[128:131], a[248:251]
 v_mfma_f32_16x16x32_bf16 a[196:199], v[96:99], v[100:103], a[196:199]
 buffer_load_dwordx4 v135, s[12:15], s41 offen offset:3072 lds
 v_mfma_f32_16x16x32_bf16 a[204:207], v[96:99], v[104:107], a[204:207]
 v_mfma_f32_16x16x32_bf16 a[212:215], v[96:99], v[108:111], a[212:215]
 v_mfma_f32_16x16x32_bf16 a[220:223], v[96:99], v[112:115], a[220:223]
 v_mfma_f32_16x16x32_bf16 a[228:231], v[96:99], v[116:119], a[228:231]
 v_mfma_f32_16x16x32_bf16 a[236:239], v[96:99], v[120:123], a[236:239]
 v_mfma_f32_16x16x32_bf16 a[244:247], v[96:99], v[124:127], a[244:247]
 v_mfma_f32_16x16x32_bf16 a[252:255], v[96:99], v[128:131], a[252:255]
 s_waitcnt vmcnt(29) lgkmcnt(0)
 s_barrier
 v_mfma_f32_16x16x32_bf16 a[0:3], v[4:7], v[36:39], a[0:3]
 ds_read_b128 v[68:71], v145 offset:0
 v_mfma_f32_16x16x32_bf16 a[8:11], v[4:7], v[40:43], a[8:11]
 s_add_u32 s10, s44, 0x8000
 s_cmp_eq_u32 s10, 0x18000
 v_mfma_f32_16x16x32_bf16 a[16:19], v[4:7], v[44:47], a[16:19]
 s_cselect_b32 s10, 0, s10
 ds_read_b64_tr_b16 v[100:101], v146 offset:16384
 v_mfma_f32_16x16x32_bf16 a[24:27], v[4:7], v[48:51], a[24:27]
 s_sub_u32 s69, s10, s44
 s_mov_b32 s44, s10
 v_mfma_f32_16x16x32_bf16 a[32:35], v[4:7], v[52:55], a[32:35]
 s_mov_b32 m0, s43
 ds_read_b64_tr_b16 v[102:103], v146 offset:18432
 v_mfma_f32_16x16x32_bf16 a[40:43], v[4:7], v[56:59], a[40:43]
 buffer_load_dwordx4 v140, s[16:19], s32 offen offset:0 lds
 v_mfma_f32_16x16x32_bf16 a[48:51], v[4:7], v[60:63], a[48:51]
 ds_read_b64_tr_b16 v[104:105], v147 offset:16384
 v_mfma_f32_16x16x32_bf16 a[56:59], v[4:7], v[64:67], a[56:59]
 v_mfma_f32_16x16x32_bf16 a[4:7], v[8:11], v[36:39], a[4:7]
 ds_read_b64_tr_b16 v[106:107], v147 offset:18432
 v_mfma_f32_16x16x32_bf16 a[12:15], v[8:11], v[40:43], a[12:15]
 v_mfma_f32_16x16x32_bf16 a[20:23], v[8:11], v[44:47], a[20:23]
 ds_read_b64_tr_b16 v[108:109], v146 offset:16640
 v_mfma_f32_16x16x32_bf16 a[28:31], v[8:11], v[48:51], a[28:31]
 buffer_load_dwordx4 v141, s[16:19], s32 offen offset:1024 lds
 v_mfma_f32_16x16x32_bf16 a[36:39], v[8:11], v[52:55], a[36:39]
 ds_read_b64_tr_b16 v[110:111], v146 offset:18688
 v_mfma_f32_16x16x32_bf16 a[44:47], v[8:11], v[56:59], a[44:47]
 v_mfma_f32_16x16x32_bf16 a[52:55], v[8:11], v[60:63], a[52:55]
 ds_read_b64_tr_b16 v[112:113], v147 offset:16640
 v_mfma_f32_16x16x32_bf16 a[60:63], v[8:11], v[64:67], a[60:63]
 v_mfma_f32_16x16x32_bf16 a[64:67], v[12:15], v[36:39], a[64:67]
 ds_read_b64_tr_b16 v[114:115], v147 offset:18688
 v_mfma_f32_16x16x32_bf16 a[72:75], v[12:15], v[40:43], a[72:75]
 buffer_load_dwordx4 v142, s[16:19], s32 offen offset:2048 lds
 v_mfma_f32_16x16x32_bf16 a[80:83], v[12:15], v[44:47], a[80:83]
 ds_read_b64_tr_b16 v[116:117], v146 offset:16896
 v_mfma_f32_16x16x32_bf16 a[88:91], v[12:15], v[48:51], a[88:91]
 v_mfma_f32_16x16x32_bf16 a[96:99], v[12:15], v[52:55], a[96:99]
 ds_read_b64_tr_b16 v[118:119], v146 offset:18944
 v_mfma_f32_16x16x32_bf16 a[104:107], v[12:15], v[56:59], a[104:107]
 v_mfma_f32_16x16x32_bf16 a[112:115], v[12:15], v[60:63], a[112:115]
 ds_read_b64_tr_b16 v[120:121], v147 offset:16896
 v_mfma_f32_16x16x32_bf16 a[120:123], v[12:15], v[64:67], a[120:123]
 buffer_load_dwordx4 v143, s[16:19], s32 offen offset:3072 lds
 v_mfma_f32_16x16x32_bf16 a[68:71], v[16:19], v[36:39], a[68:71]
 ds_read_b64_tr_b16 v[122:123], v147 offset:18944
 v_mfma_f32_16x16x32_bf16 a[76:79], v[16:19], v[40:43], a[76:79]
 s_add_u32 s43, s43, 0x4000
 v_mfma_f32_16x16x32_bf16 a[84:87], v[16:19], v[44:47], a[84:87]
 ds_read_b64_tr_b16 v[124:125], v146 offset:17152
 s_and_b32 s43, s43, 0xffff
 v_mfma_f32_16x16x32_bf16 a[92:95], v[16:19], v[48:51], a[92:95]
 s_add_u32 s32, s32, 0x40000
 v_mfma_f32_16x16x32_bf16 a[100:103], v[16:19], v[52:55], a[100:103]
 ds_read_b64_tr_b16 v[126:127], v146 offset:19200
 v_mfma_f32_16x16x32_bf16 a[108:111], v[16:19], v[56:59], a[108:111]
 s_add_u32 m0, s42, 0x1000
 ds_read_b64_tr_b16 v[128:129], v147 offset:17152
 v_mfma_f32_16x16x32_bf16 a[116:119], v[16:19], v[60:63], a[116:119]
 buffer_load_dwordx4 v136, s[12:15], s41 offen offset:0 lds
 v_mfma_f32_16x16x32_bf16 a[124:127], v[16:19], v[64:67], a[124:127]
 v_mfma_f32_16x16x32_bf16 a[128:131], v[20:23], v[36:39], a[128:131]
 ds_read_b64_tr_b16 v[130:131], v147 offset:19200
 v_mfma_f32_16x16x32_bf16 a[136:139], v[20:23], v[40:43], a[136:139]
 v_mfma_f32_16x16x32_bf16 a[144:147], v[20:23], v[44:47], a[144:147]
 ds_read_b128 v[72:75], v145 offset:2048
 v_mfma_f32_16x16x32_bf16 a[152:155], v[20:23], v[48:51], a[152:155]
 v_mfma_f32_16x16x32_bf16 a[160:163], v[20:23], v[52:55], a[160:163]
 ds_read_b128 v[76:79], v145 offset:4096
 v_mfma_f32_16x16x32_bf16 a[168:171], v[20:23], v[56:59], a[168:171]
 buffer_load_dwordx4 v137, s[12:15], s41 offen offset:1024 lds
 v_mfma_f32_16x16x32_bf16 a[176:179], v[20:23], v[60:63], a[176:179]
 ds_read_b128 v[80:83], v145 offset:6144
 v_mfma_f32_16x16x32_bf16 a[184:187], v[20:23], v[64:67], a[184:187]
 v_mfma_f32_16x16x32_bf16 a[132:135], v[24:27], v[36:39], a[132:135]
 ds_read_b128 v[84:87], v145 offset:8192
 v_mfma_f32_16x16x32_bf16 a[140:143], v[24:27], v[40:43], a[140:143]
 v_mfma_f32_16x16x32_bf16 a[148:151], v[24:27], v[44:47], a[148:151]
 ds_read_b128 v[88:91], v145 offset:10240
 v_mfma_f32_16x16x32_bf16 a[156:159], v[24:27], v[48:51], a[156:159]
 buffer_load_dwordx4 v138, s[12:15], s41 offen offset:2048 lds
 v_mfma_f32_16x16x32_bf16 a[164:167], v[24:27], v[52:55], a[164:167]
 ds_read_b128 v[92:95], v145 offset:12288
 v_mfma_f32_16x16x32_bf16 a[172:175], v[24:27], v[56:59], a[172:175]
 v_mfma_f32_16x16x32_bf16 a[180:183], v[24:27], v[60:63], a[180:183]
 ds_read_b128 v[96:99], v145 offset:14336
 v_mfma_f32_16x16x32_bf16 a[188:191], v[24:27], v[64:67], a[188:191]
 v_mfma_f32_16x16x32_bf16 a[192:195], v[28:31], v[36:39], a[192:195]
 v_mfma_f32_16x16x32_bf16 a[200:203], v[28:31], v[40:43], a[200:203]
 buffer_load_dwordx4 v139, s[12:15], s41 offen offset:3072 lds
 v_mfma_f32_16x16x32_bf16 a[208:211], v[28:31], v[44:47], a[208:211]
 v_add_u32 v144, s69, v144
 v_mfma_f32_16x16x32_bf16 a[216:219], v[28:31], v[48:51], a[216:219]
 s_add_u32 s42, s42, 0x8000
 v_add_u32 v145, s69, v145
 v_mfma_f32_16x16x32_bf16 a[224:227], v[28:31], v[52:55], a[224:227]
 s_cmp_ge_u32 s42, 0x28000
 v_xor_b32 v146, 0x8000, v146
 v_mfma_f32_16x16x32_bf16 a[232:235], v[28:31], v[56:59], a[232:235]
 s_cselect_b32 s9, 0x18000, 0
 v_xor_b32 v147, 0x8000, v147
 v_mfma_f32_16x16x32_bf16 a[240:243], v[28:31], v[60:63], a[240:243]
 s_sub_u32 s42, s42, s9
 v_mfma_f32_16x16x32_bf16 a[248:251], v[28:31], v[64:67], a[248:251]
 s_add_u32 s41, s41, 128
 v_mfma_f32_16x16x32_bf16 a[196:199], v[32:35], v[36:39], a[196:199]
 buffer_load_dwordx4 v[156:159], v2, s[48:51], s56 offen
 v_mfma_f32_16x16x32_bf16 a[204:207], v[32:35], v[40:43], a[204:207]
 v_mfma_f32_16x16x32_bf16 a[212:215], v[32:35], v[44:47], a[212:215]
 v_mfma_f32_16x16x32_bf16 a[220:223], v[32:35], v[48:51], a[220:223]
 s_add_u32 s56, s56, 1024
 v_mfma_f32_16x16x32_bf16 a[228:231], v[32:35], v[52:55], a[228:231]
 v_mfma_f32_16x16x32_bf16 a[236:239], v[32:35], v[56:59], a[236:239]
 v_mfma_f32_16x16x32_bf16 a[244:247], v[32:35], v[60:63], a[244:247]
 v_mfma_f32_16x16x32_bf16 a[252:255], v[32:35], v[64:67], a[252:255]
 s_waitcnt vmcnt(18) lgkmcnt(0)
 s_barrier
 v_mfma_f32_16x16x32_bf16 a[0:3], v[68:71], v[100:103], a[0:3]
 ds_read_b128 v[4:7], v144 offset:0
 v_mfma_f32_16x16x32_bf16 a[8:11], v[68:71], v[104:107], a[8:11]
 s_mov_b32 m0, s43
 ds_read_b64_tr_b16 v[36:37], v146 offset:0
 v_mfma_f32_16x16x32_bf16 a[16:19], v[68:71], v[108:111], a[16:19]
 buffer_load_dwordx4 v140, s[16:19], s32 offen offset:0 lds
 v_mfma_f32_16x16x32_bf16 a[24:27], v[68:71], v[112:115], a[24:27]
 v_mfma_f32_16x16x32_bf16 a[32:35], v[68:71], v[116:119], a[32:35]
 ds_read_b64_tr_b16 v[38:39], v146 offset:2048
 v_mfma_f32_16x16x32_bf16 a[40:43], v[68:71], v[120:123], a[40:43]
 v_mfma_f32_16x16x32_bf16 a[48:51], v[68:71], v[124:127], a[48:51]
 ds_read_b64_tr_b16 v[40:41], v147 offset:0
 v_mfma_f32_16x16x32_bf16 a[56:59], v[68:71], v[128:131], a[56:59]
 v_mfma_f32_16x16x32_bf16 a[4:7], v[72:75], v[100:103], a[4:7]
 ds_read_b64_tr_b16 v[42:43], v147 offset:2048
 v_mfma_f32_16x16x32_bf16 a[12:15], v[72:75], v[104:107], a[12:15]
 buffer_load_dwordx4 v141, s[16:19], s32 offen offset:1024 lds
 v_mfma_f32_16x16x32_bf16 a[20:23], v[72:75], v[108:111], a[20:23]
 ds_read_b64_tr_b16 v[44:45], v146 offset:256
 v_mfma_f32_16x16x32_bf16 a[28:31], v[72:75], v[112:115], a[28:31]
 v_mfma_f32_16x16x32_bf16 a[36:39], v[72:75], v[116:119], a[36:39]
 ds_read_b64_tr_b16 v[46:47], v146 offset:2304
 v_mfma_f32_16x16x32_bf16 a[44:47], v[72:75], v[120:123], a[44:47]
 v_mfma_f32_16x16x32_bf16 a[52:55], v[72:75], v[124:127], a[52:55]
 ds_read_b64_tr_b16 v[48:49], v147 offset:256
 v_mfma_f32_16x16x32_bf16 a[60:63], v[72:75], v[128:131], a[60:63]
 v_mfma_f32_16x16x32_bf16 a[64:67], v[76:79], v[100:103], a[64:67]
 ds_read_b64_tr_b16 v[50:51], v147 offset:2304
 v_mfma_f32_16x16x32_bf16 a[72:75], v[76:79], v[104:107], a[72:75]
 buffer_load_dwordx4 v142, s[16:19], s32 offen offset:2048 lds
 v_mfma_f32_16x16x32_bf16 a[80:83], v[76:79], v[108:111], a[80:83]
 ds_read_b64_tr_b16 v[52:53], v146 offset:512
 v_mfma_f32_16x16x32_bf16 a[88:91], v[76:79], v[112:115], a[88:91]
 v_mfma_f32_16x16x32_bf16 a[96:99], v[76:79], v[116:119], a[96:99]
 ds_read_b64_tr_b16 v[54:55], v146 offset:2560
 v_mfma_f32_16x16x32_bf16 a[104:107], v[76:79], v[120:123], a[104:107]
 v_mfma_f32_16x16x32_bf16 a[112:115], v[76:79], v[124:127], a[112:115]
 ds_read_b64_tr_b16 v[56:57], v147 offset:512
 v_mfma_f32_16x16x32_bf16 a[120:123], v[76:79], v[128:131], a[120:123]
 v_mfma_f32_16x16x32_bf16 a[68:71], v[80:83], v[100:103], a[68:71]
 ds_read_b64_tr_b16 v[58:59], v147 offset:2560
 v_mfma_f32_16x16x32_bf16 a[76:79], v[80:83], v[104:107], a[76:79]
 buffer_load_dwordx4 v143, s[16:19], s32 offen offset:3072 lds
 v_mfma_f32_16x16x32_bf16 a[84:87], v[80:83], v[108:111], a[84:87]
 ds_read_b64_tr_b16 v[60:61], v146 offset:768
 s_add_u32 s43, s43, 0x4000
 v_mfma_f32_16x16x32_bf16 a[92:95], v[80:83], v[112:115], a[92:95]
 v_mfma_f32_16x16x32_bf16 a[100:103], v[80:83], v[116:119], a[100:103]
 s_and_b32 s43, s43, 0xffff
 ds_read_b64_tr_b16 v[62:63], v146 offset:2816
 v_mfma_f32_16x16x32_bf16 a[108:111], v[80:83], v[120:123], a[108:111]
 s_add_u32 s32, s32, 0x40000
 v_mfma_f32_16x16x32_bf16 a[116:119], v[80:83], v[124:127], a[116:119]
 ds_read_b64_tr_b16 v[64:65], v147 offset:768
 v_mfma_f32_16x16x32_bf16 a[124:127], v[80:83], v[128:131], a[124:127]
 s_mov_b32 m0, s42
 v_mfma_f32_16x16x32_bf16 a[128:131], v[84:87], v[100:103], a[128:131]
 ds_read_b64_tr_b16 v[66:67], v147 offset:2816
 v_mfma_f32_16x16x32_bf16 a[136:139], v[84:87], v[104:107], a[136:139]
 buffer_load_dwordx4 v132, s[12:15], s41 offen offset:0 lds
 v_mfma_f32_16x16x32_bf16 a[144:147], v[84:87], v[108:111], a[144:147]
 ds_read_b128 v[8:11], v144 offset:2048
 v_mfma_f32_16x16x32_bf16 a[152:155], v[84:87], v[112:115], a[152:155]
 v_mfma_f32_16x16x32_bf16 a[160:163], v[84:87], v[116:119], a[160:163]
 ds_read_b128 v[12:15], v144 offset:4096
 v_mfma_f32_16x16x32_bf16 a[168:171], v[84:87], v[120:123], a[168:171]
 v_mfma_f32_16x16x32_bf16 a[176:179], v[84:87], v[124:127], a[176:179]
 ds_read_b128 v[16:19], v144 offset:6144
 v_mfma_f32_16x16x32_bf16 a[184:187], v[84:87], v[128:131], a[184:187]
 v_mfma_f32_16x16x32_bf16 a[132:135], v[88:91], v[100:103], a[132:135]
 ds_read_b128 v[20:23], v144 offset:8192
 v_mfma_f32_16x16x32_bf16 a[140:143], v[88:91], v[104:107], a[140:143]
 buffer_load_dwordx4 v133, s[12:15], s41 offen offset:1024 lds
 v_mfma_f32_16x16x32_bf16 a[148:151], v[88:91], v[108:111], a[148:151]
 ds_read_b128 v[24:27], v144 offset:10240
 v_mfma_f32_16x16x32_bf16 a[156:159], v[88:91], v[112:115], a[156:159]
 v_mfma_f32_16x16x32_bf16 a[164:167], v[88:91], v[116:119], a[164:167]
 ds_read_b128 v[28:31], v144 offset:12288
 v_mfma_f32_16x16x32_bf16 a[172:175], v[88:91], v[120:123], a[172:175]
 v_mfma_f32_16x16x32_bf16 a[180:183], v[88:91], v[124:127], a[180:183]
 ds_read_b128 v[32:35], v144 offset:14336
 v_mfma_f32_16x16x32_bf16 a[188:191], v[88:91], v[128:131], a[188:191]
 v_mfma_f32_16x16x32_bf16 a[192:195], v[92:95], v[100:103], a[192:195]
 buffer_load_dwordx4 v134, s[12:15], s41 offen offset:2048 lds
 v_mfma_f32_16x16x32_bf16 a[200:203], v[92:95], v[104:107], a[200:203]
 v_mfma_f32_16x16x32_bf16 a[208:211], v[92:95], v[108:111], a[208:211]
 v_mfma_f32_16x16x32_bf16 a[216:219], v[92:95], v[112:115], a[216:219]
 v_mfma_f32_16x16x32_bf16 a[224:227], v[92:95], v[116:119], a[224:227]
 v_mfma_f32_16x16x32_bf16 a[232:235], v[92:95], v[120:123], a[232:235]
 v_mfma_f32_16x16x32_bf16 a[240:243], v[92:95], v[124:127], a[240:243]
 v_mfma_f32_16x16x32_bf16 a[248:251], v[92:95], v[128:131], a[248:251]
 v_mfma_f32_16x16x32_bf16 a[196:199], v[96:99], v[100:103], a[196:199]
 buffer_load_dwordx4 v135, s[12:15], s41 offen offset:3072 lds
 v_mfma_f32_16x16x32_bf16 a[204:207], v[96:99], v[104:107], a[204:207]
 v_mfma_f32_16x16x32_bf16 a[212:215], v[96:99], v[108:111], a[212:215]
 v_mfma_f32_16x16x32_bf16 a[220:223], v[96:99], v[112:115], a[220:223]
 v_mfma_f32_16x16x32_bf16 a[228:231], v[96:99], v[116:119], a[228:231]
 v_mfma_f32_16x16x32_bf16 a[236:239], v[96:99], v[120:123], a[236:239]
 v_mfma_f32_16x16x32_bf16 a[244:247], v[96:99], v[124:127], a[244:247]
 v_mfma_f32_16x16x32_bf16 a[252:255], v[96:99], v[128:131], a[252:255]
 s_waitcnt vmcnt(21) lgkmcnt(0)
 s_barrier
 v_mfma_f32_16x16x32_bf16 a[0:3], v[4:7], v[36:39], a[0:3]
 ds_read_b128 v[68:71], v145 offset:0
 v_mfma_f32_16x16x32_bf16 a[8:11], v[4:7], v[40:43], a[8:11]
 s_add_u32 s10, s44, 0x8000
 s_cmp_eq_u32 s10, 0x18000
 v_mfma_f32_16x16x32_bf16 a[16:19], v[4:7], v[44:47], a[16:19]
 s_cselect_b32 s10, 0, s10
 ds_read_b64_tr_b16 v[100:101], v146 offset:16384
 v_mfma_f32_16x16x32_bf16 a[24:27], v[4:7], v[48:51], a[24:27]
 s_sub_u32 s69, s10, s44
 s_mov_b32 s44, s10
 v_mfma_f32_16x16x32_bf16 a[32:35], v[4:7], v[52:55], a[32:35]
 s_mov_b32 m0, s43
 ds_read_b64_tr_b16 v[102:103], v146 offset:18432
 v_mfma_f32_16x16x32_bf16 a[40:43], v[4:7], v[56:59], a[40:43]
 buffer_load_dwordx4 v140, s[16:19], s32 offen offset:0 lds
 v_mfma_f32_16x16x32_bf16 a[48:51], v[4:7], v[60:63], a[48:51]
 ds_read_b64_tr_b16 v[104:105], v147 offset:16384
 v_mfma_f32_16x16x32_bf16 a[56:59], v[4:7], v[64:67], a[56:59]
 v_mfma_f32_16x16x32_bf16 a[4:7], v[8:11], v[36:39], a[4:7]
 ds_read_b64_tr_b16 v[106:107], v147 offset:18432
 v_mfma_f32_16x16x32_bf16 a[12:15], v[8:11], v[40:43], a[12:15]
 v_mfma_f32_16x16x32_bf16 a[20:23], v[8:11], v[44:47], a[20:23]
 ds_read_b64_tr_b16 v[108:109], v146 offset:16640
 v_mfma_f32_16x16x32_bf16 a[28:31], v[8:11], v[48:51], a[28:31]
 buffer_load_dwordx4 v141, s[16:19], s32 offen offset:1024 lds
 v_mfma_f32_16x16x32_bf16 a[36:39], v[8:11], v[52:55], a[36:39]
 ds_read_b64_tr_b16 v[110:111], v146 offset:18688
 v_mfma_f32_16x16x32_bf16 a[44:47], v[8:11], v[56:59], a[44:47]
 v_mfma_f32_16x16x32_bf16 a[52:55], v[8:11], v[60:63], a[52:55]
 ds_read_b64_tr_b16 v[112:113], v147 offset:16640
 v_mfma_f32_16x16x32_bf16 a[60:63], v[8:11], v[64:67], a[60:63]
 v_mfma_f32_16x16x32_bf16 a[64:67], v[12:15], v[36:39], a[64:67]
 ds_read_b64_tr_b16 v[114:115], v147 offset:18688
 v_mfma_f32_16x16x32_bf16 a[72:75], v[12:15], v[40:43], a[72:75]
 buffer_load_dwordx4 v142, s[16:19], s32 offen offset:2048 lds
 v_mfma_f32_16x16x32_bf16 a[80:83], v[12:15], v[44:47], a[80:83]
 ds_read_b64_tr_b16 v[116:117], v146 offset:16896
 v_mfma_f32_16x16x32_bf16 a[88:91], v[12:15], v[48:51], a[88:91]
 v_mfma_f32_16x16x32_bf16 a[96:99], v[12:15], v[52:55], a[96:99]
 ds_read_b64_tr_b16 v[118:119], v146 offset:18944
 v_mfma_f32_16x16x32_bf16 a[104:107], v[12:15], v[56:59], a[104:107]
 v_mfma_f32_16x16x32_bf16 a[112:115], v[12:15], v[60:63], a[112:115]
 ds_read_b64_tr_b16 v[120:121], v147 offset:16896
 v_mfma_f32_16x16x32_bf16 a[120:123], v[12:15], v[64:67], a[120:123]
 buffer_load_dwordx4 v143, s[16:19], s32 offen offset:3072 lds
 v_mfma_f32_16x16x32_bf16 a[68:71], v[16:19], v[36:39], a[68:71]
 ds_read_b64_tr_b16 v[122:123], v147 offset:18944
 v_mfma_f32_16x16x32_bf16 a[76:79], v[16:19], v[40:43], a[76:79]
 s_add_u32 s43, s43, 0x4000
 v_mfma_f32_16x16x32_bf16 a[84:87], v[16:19], v[44:47], a[84:87]
 ds_read_b64_tr_b16 v[124:125], v146 offset:17152
 s_and_b32 s43, s43, 0xffff
 v_mfma_f32_16x16x32_bf16 a[92:95], v[16:19], v[48:51], a[92:95]
 s_add_u32 s32, s32, 0x40000
 v_mfma_f32_16x16x32_bf16 a[100:103], v[16:19], v[52:55], a[100:103]
 ds_read_b64_tr_b16 v[126:127], v146 offset:19200
 v_mfma_f32_16x16x32_bf16 a[108:111], v[16:19], v[56:59], a[108:111]
 s_add_u32 m0, s42, 0x1000
 ds_read_b64_tr_b16 v[128:129], v147 offset:17152
 v_mfma_f32_16x16x32_bf16 a[116:119], v[16:19], v[60:63], a[116:119]
 buffer_load_dwordx4 v136, s[12:15], s41 offen offset:0 lds
 v_mfma_f32_16x16x32_bf16 a[124:127], v[16:19], v[64:67], a[124:127]
 v_mfma_f32_16x16x32_bf16 a[128:131], v[20:23], v[36:39], a[128:131]
 ds_read_b64_tr_b16 v[130:131], v147 offset:19200
 v_mfma_f32_16x16x32_bf16 a[136:139], v[20:23], v[40:43], a[136:139]
 v_mfma_f32_16x16x32_bf16 a[144:147], v[20:23], v[44:47], a[144:147]
 ds_read_b128 v[72:75], v145 offset:2048
 v_mfma_f32_16x16x32_bf16 a[152:155], v[20:23], v[48:51], a[152:155]
 v_mfma_f32_16x16x32_bf16 a[160:163], v[20:23], v[52:55], a[160:163]
 ds_read_b128 v[76:79], v145 offset:4096
 v_mfma_f32_16x16x32_bf16 a[168:171], v[20:23], v[56:59], a[168:171]
 buffer_load_dwordx4 v137, s[12:15], s41 offen offset:1024 lds
 v_mfma_f32_16x16x32_bf16 a[176:179], v[20:23], v[60:63], a[176:179]
 ds_read_b128 v[80:83], v145 offset:6144
 v_mfma_f32_16x16x32_bf16 a[184:187], v[20:23], v[64:67], a[184:187]
 v_mfma_f32_16x16x32_bf16 a[132:135], v[24:27], v[36:39], a[132:135]
 ds_read_b128 v[84:87], v145 offset:8192
 v_mfma_f32_16x16x32_bf16 a[140:143], v[24:27], v[40:43], a[140:143]
 v_mfma_f32_16x16x32_bf16 a[148:151], v[24:27], v[44:47], a[148:151]
 ds_read_b128 v[88:91], v145 offset:10240
 v_mfma_f32_16x16x32_bf16 a[156:159], v[24:27], v[48:51], a[156:159]
 buffer_load_dwordx4 v138, s[12:15], s41 offen offset:2048 lds
 v_mfma_f32_16x16x32_bf16 a[164:167], v[24:27], v[52:55], a[164:167]
 ds_read_b128 v[92:95], v145 offset:12288
 v_mfma_f32_16x16x32_bf16 a[172:175], v[24:27], v[56:59], a[172:175]
 v_mfma_f32_16x16x32_bf16 a[180:183], v[24:27], v[60:63], a[180:183]
 ds_read_b128 v[96:99], v145 offset:14336
 v_mfma_f32_16x16x32_bf16 a[188:191], v[24:27], v[64:67], a[188:191]
 v_mfma_f32_16x16x32_bf16 a[192:195], v[28:31], v[36:39], a[192:195]
 v_mfma_f32_16x16x32_bf16 a[200:203], v[28:31], v[40:43], a[200:203]
 buffer_load_dwordx4 v139, s[12:15], s41 offen offset:3072 lds
 v_mfma_f32_16x16x32_bf16 a[208:211], v[28:31], v[44:47], a[208:211]
 v_add_u32 v144, s69, v144
 v_mfma_f32_16x16x32_bf16 a[216:219], v[28:31], v[48:51], a[216:219]
 s_add_u32 s42, s42, 0x8000
 v_add_u32 v145, s69, v145
 v_mfma_f32_16x16x32_bf16 a[224:227], v[28:31], v[52:55], a[224:227]
 s_cmp_ge_u32 s42, 0x28000
 v_xor_b32 v146, 0x8000, v146
 v_mfma_f32_16x16x32_bf16 a[232:235], v[28:31], v[56:59], a[232:235]
 s_cselect_b32 s9, 0x18000, 0
 v_xor_b32 v147, 0x8000, v147
 v_mfma_f32_16x16x32_bf16 a[240:243], v[28:31], v[60:63], a[240:243]
 s_sub_u32 s42, s42, s9
 v_mfma_f32_16x16x32_bf16 a[248:251], v[28:31], v[64:67], a[248:251]
 s_add_u32 s41, s41, 128
 v_mfma_f32_16x16x32_bf16 a[196:199], v[32:35], v[36:39], a[196:199]
 buffer_load_dwordx4 v[156:159], v2, s[48:51], s56 offen
 v_mfma_f32_16x16x32_bf16 a[204:207], v[32:35], v[40:43], a[204:207]
 v_mfma_f32_16x16x32_bf16 a[212:215], v[32:35], v[44:47], a[212:215]
 v_mfma_f32_16x16x32_bf16 a[220:223], v[32:35], v[48:51], a[220:223]
 s_add_u32 s56, s56, 1024
 v_mfma_f32_16x16x32_bf16 a[228:231], v[32:35], v[52:55], a[228:231]
 v_mfma_f32_16x16x32_bf16 a[236:239], v[32:35], v[56:59], a[236:239]
 v_mfma_f32_16x16x32_bf16 a[244:247], v[32:35], v[60:63], a[244:247]
 v_mfma_f32_16x16x32_bf16 a[252:255], v[32:35], v[64:67], a[252:255]
 s_waitcnt vmcnt(18) lgkmcnt(0)
 s_barrier
 buffer_atomic_add v155, v154, s[28:31], s35 offen sc1
 v_mfma_f32_16x16x32_bf16 a[0:3], v[68:71], v[100:103], a[0:3]
 ds_read_b128 v[4:7], v144 offset:0
 v_mfma_f32_16x16x32_bf16 a[8:11], v[68:71], v[104:107], a[8:11]
 buffer_load_dwordx4 v[156:159], v2, s[64:67], s57 offen
 v_mfma_f32_16x16x32_bf16 a[16:19], v[68:71], v[108:111], a[16:19]
 ds_read_b64_tr_b16 v[36:37], v146 offset:0
 v_mfma_f32_16x16x32_bf16 a[24:27], v[68:71], v[112:115], a[24:27]
 v_mfma_f32_16x16x32_bf16 a[32:35], v[68:71], v[116:119], a[32:35]
 ds_read_b64_tr_b16 v[38:39], v146 offset:2048
 s_mov_b32 m0, s43
 v_mfma_f32_16x16x32_bf16 a[40:43], v[68:71], v[120:123], a[40:43]
 v_mfma_f32_16x16x32_bf16 a[48:51], v[68:71], v[124:127], a[48:51]
 ds_read_b64_tr_b16 v[40:41], v147 offset:0
 v_mfma_f32_16x16x32_bf16 a[56:59], v[68:71], v[128:131], a[56:59]
 ds_read_b64_tr_b16 v[42:43], v147 offset:2048
 v_mfma_f32_16x16x32_bf16 a[4:7], v[72:75], v[100:103], a[4:7]
 buffer_load_dwordx4 v140, s[16:19], s32 offen offset:0 lds
 v_mfma_f32_16x16x32_bf16 a[12:15], v[72:75], v[104:107], a[12:15]
 v_mfma_f32_16x16x32_bf16 a[20:23], v[72:75], v[108:111], a[20:23]
 ds_read_b64_tr_b16 v[44:45], v146 offset:256
 v_mfma_f32_16x16x32_bf16 a[28:31], v[72:75], v[112:115], a[28:31]
 v_mfma_f32_16x16x32_bf16 a[36:39], v[72:75], v[116:119], a[36:39]
 ds_read_b64_tr_b16 v[46:47], v146 offset:2304
 v_mfma_f32_16x16x32_bf16 a[44:47], v[72:75], v[120:123], a[44:47]
 v_mfma_f32_16x16x32_bf16 a[52:55], v[72:75], v[124:127], a[52:55]
 ds_read_b64_tr_b16 v[48:49], v147 offset:256
 v_mfma_f32_16x16x32_bf16 a[60:63], v[72:75], v[128:131], a[60:63]
 buffer_load_dwordx4 v141, s[16:19], s32 offen offset:1024 lds
 v_mfma_f32_16x16x32_bf16 a[64:67], v[76:79], v[100:103], a[64:67]
 ds_read_b64_tr_b16 v[50:51], v147 offset:2304
 v_mfma_f32_16x16x32_bf16 a[72:75], v[76:79], v[104:107], a[72:75]
 v_mfma_f32_16x16x32_bf16 a[80:83], v[76:79], v[108:111], a[80:83]
 ds_read_b64_tr_b16 v[52:53], v146 offset:512
 v_mfma_f32_16x16x32_bf16 a[88:91], v[76:79], v[112:115], a[88:91]
 v_mfma_f32_16x16x32_bf16 a[96:99], v[76:79], v[116:119], a[96:99]
 ds_read_b64_tr_b16 v[54:55], v146 offset:2560
 v_mfma_f32_16x16x32_bf16 a[104:107], v[76:79], v[120:123], a[104:107]
 ds_read_b64_tr_b16 v[56:57], v147 offset:512
 v_mfma_f32_16x16x32_bf16 a[112:115], v[76:79], v[124:127], a[112:115]
 buffer_load_dwordx4 v142, s[16:19], s32 offen offset:2048 lds
 v_mfma_f32_16x16x32_bf16 a[120:123], v[76:79], v[128:131], a[120:123]
 v_mfma_f32_16x16x32_bf16 a[68:71], v[80:83], v[100:103], a[68:71]
 ds_read_b64_tr_b16 v[58:59], v147 offset:2560
 v_mfma_f32_16x16x32_bf16 a[76:79], v[80:83], v[104:107], a[76:79]
 v_mfma_f32_16x16x32_bf16 a[84:87], v[80:83], v[108:111], a[84:87]
 ds_read_b64_tr_b16 v[60:61], v146 offset:768
 v_mfma_f32_16x16x32_bf16 a[92:95], v[80:83], v[112:115], a[92:95]
 v_mfma_f32_16x16x32_bf16 a[100:103], v[80:83], v[116:119], a[100:103]
 ds_read_b64_tr_b16 v[62:63], v146 offset:2816
 v_mfma_f32_16x16x32_bf16 a[108:111], v[80:83], v[120:123], a[108:111]
 buffer_load_dwordx4 v143, s[16:19], s32 offen offset:3072 lds
 v_mfma_f32_16x16x32_bf16 a[116:119], v[80:83], v[124:127], a[116:119]
 s_add_u32 s43, s43, 0x4000
 ds_read_b64_tr_b16 v[64:65], v147 offset:768
 v_mfma_f32_16x16x32_bf16 a[124:127], v[80:83], v[128:131], a[124:127]
 s_and_b32 s43, s43, 0xffff
 v_mfma_f32_16x16x32_bf16 a[128:131], v[84:87], v[100:103], a[128:131]
 ds_read_b64_tr_b16 v[66:67], v147 offset:2816
 v_mfma_f32_16x16x32_bf16 a[136:139], v[84:87], v[104:107], a[136:139]
 s_add_u32 s32, s32, 0x40000
 v_mfma_f32_16x16x32_bf16 a[144:147], v[84:87], v[108:111], a[144:147]
 ds_read_b128 v[8:11], v144 offset:2048
 s_mov_b32 m0, s42
 v_mfma_f32_16x16x32_bf16 a[152:155], v[84:87], v[112:115], a[152:155]
 buffer_load_dwordx4 v132, s[12:15], s41 offen offset:0 lds
 v_mfma_f32_16x16x32_bf16 a[160:163], v[84:87], v[116:119], a[160:163]
 ds_read_b128 v[12:15], v144 offset:4096
 v_mfma_f32_16x16x32_bf16 a[168:171], v[84:87], v[120:123], a[168:171]
 v_mfma_f32_16x16x32_bf16 a[176:179], v[84:87], v[124:127], a[176:179]
 ds_read_b128 v[16:19], v144 offset:6144
 v_mfma_f32_16x16x32_bf16 a[184:187], v[84:87], v[128:131], a[184:187]
 v_mfma_f32_16x16x32_bf16 a[132:135], v[88:91], v[100:103], a[132:135]
 ds_read_b128 v[20:23], v144 offset:8192
 v_mfma_f32_16x16x32_bf16 a[140:143], v[88:91], v[104:107], a[140:143]
 v_mfma_f32_16x16x32_bf16 a[148:151], v[88:91], v[108:111], a[148:151]
 ds_read_b128 v[24:27], v144 offset:10240
 v_mfma_f32_16x16x32_bf16 a[156:159], v[88:91], v[112:115], a[156:159]
 buffer_load_dwordx4 v133, s[12:15], s41 offen offset:1024 lds
 v_mfma_f32_16x16x32_bf16 a[164:167], v[88:91], v[116:119], a[164:167]
 ds_read_b128 v[28:31], v144 offset:12288
 v_mfma_f32_16x16x32_bf16 a[172:175], v[88:91], v[120:123], a[172:175]
 v_mfma_f32_16x16x32_bf16 a[180:183], v[88:91], v[124:127], a[180:183]
 ds_read_b128 v[32:35], v144 offset:14336
 v_mfma_f32_16x16x32_bf16 a[188:191], v[88:91], v[128:131], a[188:191]
 v_mfma_f32_16x16x32_bf16 a[192:195], v[92:95], v[100:103], a[192:195]
 v_mfma_f32_16x16x32_bf16 a[200:203], v[92:95], v[104:107], a[200:203]
 buffer_load_dwordx4 v134, s[12:15], s41 offen offset:2048 lds
 v_mfma_f32_16x16x32_bf16 a[208:211], v[92:95], v[108:111], a[208:211]
 v_mfma_f32_16x16x32_bf16 a[216:219], v[92:95], v[112:115], a[216:219]
 v_mfma_f32_16x16x32_bf16 a[224:227], v[92:95], v[116:119], a[224:227]
 v_mfma_f32_16x16x32_bf16 a[232:235], v[92:95], v[120:123], a[232:235]
 v_mfma_f32_16x16x32_bf16 a[240:243], v[92:95], v[124:127], a[240:243]
 v_mfma_f32_16x16x32_bf16 a[248:251], v[92:95], v[128:131], a[248:251]
 v_mfma_f32_16x16x32_bf16 a[196:199], v[96:99], v[100:103], a[196:199]
 buffer_load_dwordx4 v135, s[12:15], s41 offen offset:3072 lds
 v_mfma_f32_16x16x32_bf16 a[204:207], v[96:99], v[104:107], a[204:207]
 v_mfma_f32_16x16x32_bf16 a[212:215], v[96:99], v[108:111], a[212:215]
 v_mfma_f32_16x16x32_bf16 a[220:223], v[96:99], v[112:115], a[220:223]
 v_mfma_f32_16x16x32_bf16 a[228:231], v[96:99], v[116:119], a[228:231]
 v_mfma_f32_16x16x32_bf16 a[236:239], v[96:99], v[120:123], a[236:239]
 v_mfma_f32_16x16x32_bf16 a[244:247], v[96:99], v[124:127], a[244:247]
 v_mfma_f32_16x16x32_bf16 a[252:255], v[96:99], v[128:131], a[252:255]
 s_mov_b32 s33, 10
.p2align 6
L1_V_top:
 s_waitcnt vmcnt(17) lgkmcnt(0)
 s_barrier
 v_mfma_f32_16x16x32_bf16 a[0:3], v[4:7], v[36:39], a[0:3]
 ds_read_b128 v[68:71], v145 offset:0
 v_mfma_f32_16x16x32_bf16 a[8:11], v[4:7], v[40:43], a[8:11]
 s_add_u32 s10, s44, 0x8000
 s_cmp_eq_u32 s10, 0x18000
 v_mfma_f32_16x16x32_bf16 a[16:19], v[4:7], v[44:47], a[16:19]
 s_cselect_b32 s10, 0, s10
 ds_read_b64_tr_b16 v[100:101], v146 offset:16384
 v_mfma_f32_16x16x32_bf16 a[24:27], v[4:7], v[48:51], a[24:27]
 s_sub_u32 s69, s10, s44
 s_mov_b32 s44, s10
 v_mfma_f32_16x16x32_bf16 a[32:35], v[4:7], v[52:55], a[32:35]
 s_mov_b32 m0, s43
 ds_read_b64_tr_b16 v[102:103], v146 offset:18432
 v_mfma_f32_16x16x32_bf16 a[40:43], v[4:7], v[56:59], a[40:43]
 buffer_load_dwordx4 v140, s[16:19], s32 offen offset:0 lds
 v_mfma_f32_16x16x32_bf16 a[48:51], v[4:7], v[60:63], a[48:51]
 ds_read_b64_tr_b16 v[104:105], v147 offset:16384
 v_mfma_f32_16x16x32_bf16 a[56:59], v[4:7], v[64:67], a[56:59]
 v_mfma_f32_16x16x32_bf16 a[4:7], v[8:11], v[36:39], a[4:7]
 ds_read_b64_tr_b16 v[106:107], v147 offset:18432
 v_mfma_f32_16x16x32_bf16 a[12:15], v[8:11], v[40:43], a[12:15]
 v_mfma_f32_16x16x32_bf16 a[20:23], v[8:11], v[44:47], a[20:23]
 ds_read_b64_tr_b16 v[108:109], v146 offset:16640
 v_mfma_f32_16x16x32_bf16 a[28:31], v[8:11], v[48:51], a[28:31]
 buffer_load_dwordx4 v141, s[16:19], s32 offen offset:1024 lds
 v_mfma_f32_16x16x32_bf16 a[36:39], v[8:11], v[52:55], a[36:39]
 ds_read_b64_tr_b16 v[110:111], v146 offset:18688
 v_mfma_f32_16x16x32_bf16 a[44:47], v[8:11], v[56:59], a[44:47]
 v_mfma_f32_16x16x32_bf16 a[52:55], v[8:11], v[60:63], a[52:55]
 ds_read_b64_tr_b16 v[112:113], v147 offset:16640
 v_mfma_f32_16x16x32_bf16 a[60:63], v[8:11], v[64:67], a[60:63]
 v_mfma_f32_16x16x32_bf16 a[64:67], v[12:15], v[36:39], a[64:67]
 ds_read_b64_tr_b16 v[114:115], v147 offset:18688
 v_mfma_f32_16x16x32_bf16 a[72:75], v[12:15], v[40:43], a[72:75]
 buffer_load_dwordx4 v142, s[16:19], s32 offen offset:2048 lds
 v_mfma_f32_16x16x32_bf16 a[80:83], v[12:15], v[44:47], a[80:83]
 ds_read_b64_tr_b16 v[116:117], v146 offset:16896
 v_mfma_f32_16x16x32_bf16 a[88:91], v[12:15], v[48:51], a[88:91]
 v_mfma_f32_16x16x32_bf16 a[96:99], v[12:15], v[52:55], a[96:99]
 ds_read_b64_tr_b16 v[118:119], v146 offset:18944
 v_mfma_f32_16x16x32_bf16 a[104:107], v[12:15], v[56:59], a[104:107]
 v_mfma_f32_16x16x32_bf16 a[112:115], v[12:15], v[60:63], a[112:115]
 ds_read_b64_tr_b16 v[120:121], v147 offset:16896
 v_mfma_f32_16x16x32_bf16 a[120:123], v[12:15], v[64:67], a[120:123]
 buffer_load_dwordx4 v143, s[16:19], s32 offen offset:3072 lds
 v_mfma_f32_16x16x32_bf16 a[68:71], v[16:19], v[36:39], a[68:71]
 ds_read_b64_tr_b16 v[122:123], v147 offset:18944
 v_mfma_f32_16x16x32_bf16 a[76:79], v[16:19], v[40:43], a[76:79]
 s_add_u32 s43, s43, 0x4000
 v_mfma_f32_16x16x32_bf16 a[84:87], v[16:19], v[44:47], a[84:87]
 ds_read_b64_tr_b16 v[124:125], v146 offset:17152
 s_and_b32 s43, s43, 0xffff
 v_mfma_f32_16x16x32_bf16 a[92:95], v[16:19], v[48:51], a[92:95]
 s_add_u32 s32, s32, 0x40000
 v_mfma_f32_16x16x32_bf16 a[100:103], v[16:19], v[52:55], a[100:103]
 ds_read_b64_tr_b16 v[126:127], v146 offset:19200
 v_mfma_f32_16x16x32_bf16 a[108:111], v[16:19], v[56:59], a[108:111]
 s_add_u32 m0, s42, 0x1000
 ds_read_b64_tr_b16 v[128:129], v147 offset:17152
 v_mfma_f32_16x16x32_bf16 a[116:119], v[16:19], v[60:63], a[116:119]
 buffer_load_dwordx4 v136, s[12:15], s41 offen offset:0 lds
 v_mfma_f32_16x16x32_bf16 a[124:127], v[16:19], v[64:67], a[124:127]
 v_mfma_f32_16x16x32_bf16 a[128:131], v[20:23], v[36:39], a[128:131]
 ds_read_b64_tr_b16 v[130:131], v147 offset:19200
 v_mfma_f32_16x16x32_bf16 a[136:139], v[20:23], v[40:43], a[136:139]
 v_mfma_f32_16x16x32_bf16 a[144:147], v[20:23], v[44:47], a[144:147]
 ds_read_b128 v[72:75], v145 offset:2048
 v_mfma_f32_16x16x32_bf16 a[152:155], v[20:23], v[48:51], a[152:155]
 v_mfma_f32_16x16x32_bf16 a[160:163], v[20:23], v[52:55], a[160:163]
 ds_read_b128 v[76:79], v145 offset:4096
 v_mfma_f32_16x16x32_bf16 a[168:171], v[20:23], v[56:59], a[168:171]
 buffer_load_dwordx4 v137, s[12:15], s41 offen offset:1024 lds
 v_mfma_f32_16x16x32_bf16 a[176:179], v[20:23], v[60:63], a[176:179]
 ds_read_b128 v[80:83], v145 offset:6144
 v_mfma_f32_16x16x32_bf16 a[184:187], v[20:23], v[64:67], a[184:187]
 v_mfma_f32_16x16x32_bf16 a[132:135], v[24:27], v[36:39], a[132:135]
 ds_read_b128 v[84:87], v145 offset:8192
 v_mfma_f32_16x16x32_bf16 a[140:143], v[24:27], v[40:43], a[140:143]
 v_mfma_f32_16x16x32_bf16 a[148:151], v[24:27], v[44:47], a[148:151]
 ds_read_b128 v[88:91], v145 offset:10240
 v_mfma_f32_16x16x32_bf16 a[156:159], v[24:27], v[48:51], a[156:159]
 buffer_load_dwordx4 v138, s[12:15], s41 offen offset:2048 lds
 v_mfma_f32_16x16x32_bf16 a[164:167], v[24:27], v[52:55], a[164:167]
 ds_read_b128 v[92:95], v145 offset:12288
 v_mfma_f32_16x16x32_bf16 a[172:175], v[24:27], v[56:59], a[172:175]
 v_mfma_f32_16x16x32_bf16 a[180:183], v[24:27], v[60:63], a[180:183]
 ds_read_b128 v[96:99], v145 offset:14336
 v_mfma_f32_16x16x32_bf16 a[188:191], v[24:27], v[64:67], a[188:191]
 v_mfma_f32_16x16x32_bf16 a[192:195], v[28:31], v[36:39], a[192:195]
 v_mfma_f32_16x16x32_bf16 a[200:203], v[28:31], v[40:43], a[200:203]
 buffer_load_dwordx4 v139, s[12:15], s41 offen offset:3072 lds
 v_mfma_f32_16x16x32_bf16 a[208:211], v[28:31], v[44:47], a[208:211]
 v_add_u32 v144, s69, v144
 v_mfma_f32_16x16x32_bf16 a[216:219], v[28:31], v[48:51], a[216:219]
 s_add_u32 s42, s42, 0x8000
 v_add_u32 v145, s69, v145
 v_mfma_f32_16x16x32_bf16 a[224:227], v[28:31], v[52:55], a[224:227]
 s_cmp_ge_u32 s42, 0x28000
 v_xor_b32 v146, 0x8000, v146
 v_mfma_f32_16x16x32_bf16 a[232:235], v[28:31], v[56:59], a[232:235]
 s_cselect_b32 s9, 0x18000, 0
 v_xor_b32 v147, 0x8000, v147
 v_mfma_f32_16x16x32_bf16 a[240:243], v[28:31], v[60:63], a[240:243]
 s_sub_u32 s42, s42, s9
 v_mfma_f32_16x16x32_bf16 a[248:251], v[28:31], v[64:67], a[248:251]
 s_add_u32 s41, s41, 128
 v_mfma_f32_16x16x32_bf16 a[196:199], v[32:35], v[36:39], a[196:199]
 buffer_load_dwordx4 v[156:159], v2, s[48:51], s56 offen
 v_mfma_f32_16x16x32_bf16 a[204:207], v[32:35], v[40:43], a[204:207]
 v_mfma_f32_16x16x32_bf16 a[212:215], v[32:35], v[44:47], a[212:215]
 v_mfma_f32_16x16x32_bf16 a[220:223], v[32:35], v[48:51], a[220:223]
 s_add_u32 s56, s56, 1024
 v_mfma_f32_16x16x32_bf16 a[228:231], v[32:35], v[52:55], a[228:231]
 v_mfma_f32_16x16x32_bf16 a[236:239], v[32:35], v[56:59], a[236:239]
 v_mfma_f32_16x16x32_bf16 a[244:247], v[32:35], v[60:63], a[244:247]
 v_mfma_f32_16x16x32_bf16 a[252:255], v[32:35], v[64:67], a[252:255]
 s_waitcnt vmcnt(18) lgkmcnt(0)
 s_barrier
 v_mfma_f32_16x16x32_bf16 a[0:3], v[68:71], v[100:103], a[0:3]
 ds_read_b128 v[4:7], v144 offset:0
 v_mfma_f32_16x16x32_bf16 a[8:11], v[68:71], v[104:107], a[8:11]
 s_mov_b32 m0, s43
 ds_read_b64_tr_b16 v[36:37], v146 offset:0
 v_mfma_f32_16x16x32_bf16 a[16:19], v[68:71], v[108:111], a[16:19]
 buffer_load_dwordx4 v140, s[16:19], s32 offen offset:0 lds
 v_mfma_f32_16x16x32_bf16 a[24:27], v[68:71], v[112:115], a[24:27]
 v_mfma_f32_16x16x32_bf16 a[32:35], v[68:71], v[116:119], a[32:35]
 ds_read_b64_tr_b16 v[38:39], v146 offset:2048
 v_mfma_f32_16x16x32_bf16 a[40:43], v[68:71], v[120:123], a[40:43]
 v_mfma_f32_16x16x32_bf16 a[48:51], v[68:71], v[124:127], a[48:51]
 ds_read_b64_tr_b16 v[40:41], v147 offset:0
 v_mfma_f32_16x16x32_bf16 a[56:59], v[68:71], v[128:131], a[56:59]
 v_mfma_f32_16x16x32_bf16 a[4:7], v[72:75], v[100:103], a[4:7]
 ds_read_b64_tr_b16 v[42:43], v147 offset:2048
 v_mfma_f32_16x16x32_bf16 a[12:15], v[72:75], v[104:107], a[12:15]
 buffer_load_dwordx4 v141, s[16:19], s32 offen offset:1024 lds
 v_mfma_f32_16x16x32_bf16 a[20:23], v[72:75], v[108:111], a[20:23]
 ds_read_b64_tr_b16 v[44:45], v146 offset:256
 v_mfma_f32_16x16x32_bf16 a[28:31], v[72:75], v[112:115], a[28:31]
 v_mfma_f32_16x16x32_bf16 a[36:39], v[72:75], v[116:119], a[36:39]
 ds_read_b64_tr_b16 v[46:47], v146 offset:2304
 v_mfma_f32_16x16x32_bf16 a[44:47], v[72:75], v[120:123], a[44:47]
 v_mfma_f32_16x16x32_bf16 a[52:55], v[72:75], v[124:127], a[52:55]
 ds_read_b64_tr_b16 v[48:49], v147 offset:256
 v_mfma_f32_16x16x32_bf16 a[60:63], v[72:75], v[128:131], a[60:63]
 v_mfma_f32_16x16x32_bf16 a[64:67], v[76:79], v[100:103], a[64:67]
 ds_read_b64_tr_b16 v[50:51], v147 offset:2304
 v_mfma_f32_16x16x32_bf16 a[72:75], v[76:79], v[104:107], a[72:75]
 buffer_load_dwordx4 v142, s[16:19], s32 offen offset:2048 lds
 v_mfma_f32_16x16x32_bf16 a[80:83], v[76:79], v[108:111], a[80:83]
 ds_read_b64_tr_b16 v[52:53], v146 offset:512
 v_mfma_f32_16x16x32_bf16 a[88:91], v[76:79], v[112:115], a[88:91]
 v_mfma_f32_16x16x32_bf16 a[96:99], v[76:79], v[116:119], a[96:99]
 ds_read_b64_tr_b16 v[54:55], v146 offset:2560
 v_mfma_f32_16x16x32_bf16 a[104:107], v[76:79], v[120:123], a[104:107]
 v_mfma_f32_16x16x32_bf16 a[112:115], v[76:79], v[124:127], a[112:115]
 ds_read_b64_tr_b16 v[56:57], v147 offset:512
 v_mfma_f32_16x16x32_bf16 a[120:123], v[76:79], v[128:131], a[120:123]
 v_mfma_f32_16x16x32_bf16 a[68:71], v[80:83], v[100:103], a[68:71]
 ds_read_b64_tr_b16 v[58:59], v147 offset:2560
 v_mfma_f32_16x16x32_bf16 a[76:79], v[80:83], v[104:107], a[76:79]
 buffer_load_dwordx4 v143, s[16:19], s32 offen offset:3072 lds
 v_mfma_f32_16x16x32_bf16 a[84:87], v[80:83], v[108:111], a[84:87]
 s_add_u32 s43, s43, 0x4000
 ds_read_b64_tr_b16 v[60:61], v146 offset:768
 v_mfma_f32_16x16x32_bf16 a[92:95], v[80:83], v[112:115], a[92:95]
 s_and_b32 s43, s43, 0xffff
 v_mfma_f32_16x16x32_bf16 a[100:103], v[80:83], v[116:119], a[100:103]
 ds_read_b64_tr_b16 v[62:63], v146 offset:2816
 v_mfma_f32_16x16x32_bf16 a[108:111], v[80:83], v[120:123], a[108:111]
 s_add_u32 s32, s32, 0x40000
 v_mfma_f32_16x16x32_bf16 a[116:119], v[80:83], v[124:127], a[116:119]
 ds_read_b64_tr_b16 v[64:65], v147 offset:768
 s_mov_b32 m0, s42
 v_mfma_f32_16x16x32_bf16 a[124:127], v[80:83], v[128:131], a[124:127]
 ds_read_b64_tr_b16 v[66:67], v147 offset:2816
 v_mfma_f32_16x16x32_bf16 a[128:131], v[84:87], v[100:103], a[128:131]
 buffer_load_dwordx4 v132, s[12:15], s41 offen offset:0 lds
 v_mfma_f32_16x16x32_bf16 a[136:139], v[84:87], v[104:107], a[136:139]
 v_mfma_f32_16x16x32_bf16 a[144:147], v[84:87], v[108:111], a[144:147]
 ds_read_b128 v[8:11], v144 offset:2048
 v_mfma_f32_16x16x32_bf16 a[152:155], v[84:87], v[112:115], a[152:155]
 v_mfma_f32_16x16x32_bf16 a[160:163], v[84:87], v[116:119], a[160:163]
 ds_read_b128 v[12:15], v144 offset:4096
 v_mfma_f32_16x16x32_bf16 a[168:171], v[84:87], v[120:123], a[168:171]
 v_mfma_f32_16x16x32_bf16 a[176:179], v[84:87], v[124:127], a[176:179]
 ds_read_b128 v[16:19], v144 offset:6144
 v_mfma_f32_16x16x32_bf16 a[184:187], v[84:87], v[128:131], a[184:187]
 buffer_load_dwordx4 v133, s[12:15], s41 offen offset:1024 lds
 v_mfma_f32_16x16x32_bf16 a[132:135], v[88:91], v[100:103], a[132:135]
 ds_read_b128 v[20:23], v144 offset:8192
 v_mfma_f32_16x16x32_bf16 a[140:143], v[88:91], v[104:107], a[140:143]
 v_mfma_f32_16x16x32_bf16 a[148:151], v[88:91], v[108:111], a[148:151]
 ds_read_b128 v[24:27], v144 offset:10240
 v_mfma_f32_16x16x32_bf16 a[156:159], v[88:91], v[112:115], a[156:159]
 v_mfma_f32_16x16x32_bf16 a[164:167], v[88:91], v[116:119], a[164:167]
 ds_read_b128 v[28:31], v144 offset:12288
 v_mfma_f32_16x16x32_bf16 a[172:175], v[88:91], v[120:123], a[172:175]
 v_mfma_f32_16x16x32_bf16 a[180:183], v[88:91], v[124:127], a[180:183]
 ds_read_b128 v[32:35], v144 offset:14336
 v_mfma_f32_16x16x32_bf16 a[188:191], v[88:91], v[128:131], a[188:191]
 buffer_load_dwordx4 v134, s[12:15], s41 offen offset:2048 lds
 v_mfma_f32_16x16x32_bf16 a[192:195], v[92:95], v[100:103], a[192:195]
 v_mfma_f32_16x16x32_bf16 a[200:203], v[92:95], v[104:107], a[200:203]
 v_mfma_f32_16x16x32_bf16 a[208:211], v[92:95], v[108:111], a[208:211]
 v_mfma_f32_16x16x32_bf16 a[216:219], v[92:95], v[112:115], a[216:219]
 v_mfma_f32_16x16x32_bf16 a[224:227], v[92:95], v[116:119], a[224:227]
 v_mfma_f32_16x16x32_bf16 a[232:235], v[92:95], v[120:123], a[232:235]
 v_mfma_f32_16x16x32_bf16 a[240:243], v[92:95], v[124:127], a[240:243]
 v_mfma_f32_16x16x32_bf16 a[248:251], v[92:95], v[128:131], a[248:251]
 buffer_load_dwordx4 v135, s[12:15], s41 offen offset:3072 lds
 v_mfma_f32_16x16x32_bf16 a[196:199], v[96:99], v[100:103], a[196:199]
 v_mfma_f32_16x16x32_bf16 a[204:207], v[96:99], v[104:107], a[204:207]
 s_sub_u32 s33, s33, 1
 v_mfma_f32_16x16x32_bf16 a[212:215], v[96:99], v[108:111], a[212:215]
 v_mfma_f32_16x16x32_bf16 a[220:223], v[96:99], v[112:115], a[220:223]
 v_mfma_f32_16x16x32_bf16 a[228:231], v[96:99], v[116:119], a[228:231]
 s_cmp_lg_u32 s33, 0
 v_mfma_f32_16x16x32_bf16 a[236:239], v[96:99], v[120:123], a[236:239]
 v_mfma_f32_16x16x32_bf16 a[244:247], v[96:99], v[124:127], a[244:247]
 v_mfma_f32_16x16x32_bf16 a[252:255], v[96:99], v[128:131], a[252:255]
 s_cbranch_scc1 L1_V_top
 s_waitcnt vmcnt(21) lgkmcnt(0)
 s_barrier
 v_mfma_f32_16x16x32_bf16 a[0:3], v[4:7], v[36:39], a[0:3]
 ds_read_b128 v[68:71], v145 offset:0
 v_mfma_f32_16x16x32_bf16 a[8:11], v[4:7], v[40:43], a[8:11]
 s_add_u32 s10, s44, 0x8000
 s_cmp_eq_u32 s10, 0x18000
 v_mfma_f32_16x16x32_bf16 a[16:19], v[4:7], v[44:47], a[16:19]
 s_cselect_b32 s10, 0, s10
 ds_read_b64_tr_b16 v[100:101], v146 offset:16384
 v_mfma_f32_16x16x32_bf16 a[24:27], v[4:7], v[48:51], a[24:27]
 s_sub_u32 s69, s10, s44
 s_mov_b32 s44, s10
 v_mfma_f32_16x16x32_bf16 a[32:35], v[4:7], v[52:55], a[32:35]
 buffer_load_dword v3, v151, s[28:31], 0 offen sc1
 v_mfma_f32_16x16x32_bf16 a[40:43], v[4:7], v[56:59], a[40:43]
 ds_read_b64_tr_b16 v[102:103], v146 offset:18432
 v_mfma_f32_16x16x32_bf16 a[48:51], v[4:7], v[60:63], a[48:51]
 ds_read_b64_tr_b16 v[104:105], v147 offset:16384
 s_mov_b32 m0, s43
 v_mfma_f32_16x16x32_bf16 a[56:59], v[4:7], v[64:67], a[56:59]
 v_mfma_f32_16x16x32_bf16 a[4:7], v[8:11], v[36:39], a[4:7]
 ds_read_b64_tr_b16 v[106:107], v147 offset:18432
 v_mfma_f32_16x16x32_bf16 a[12:15], v[8:11], v[40:43], a[12:15]
 buffer_load_dwordx4 v140, s[16:19], s32 offen offset:0 lds
 v_mfma_f32_16x16x32_bf16 a[20:23], v[8:11], v[44:47], a[20:23]
 ds_read_b64_tr_b16 v[108:109], v146 offset:16640
 v_mfma_f32_16x16x32_bf16 a[28:31], v[8:11], v[48:51], a[28:31]
 v_mfma_f32_16x16x32_bf16 a[36:39], v[8:11], v[52:55], a[36:39]
 ds_read_b64_tr_b16 v[110:111], v146 offset:18688
 v_mfma_f32_16x16x32_bf16 a[44:47], v[8:11], v[56:59], a[44:47]
 v_mfma_f32_16x16x32_bf16 a[52:55], v[8:11], v[60:63], a[52:55]
 ds_read_b64_tr_b16 v[112:113], v147 offset:16640
 v_mfma_f32_16x16x32_bf16 a[60:63], v[8:11], v[64:67], a[60:63]
 buffer_load_dwordx4 v141, s[16:19], s32 offen offset:1024 lds
 v_mfma_f32_16x16x32_bf16 a[64:67], v[12:15], v[36:39], a[64:67]
 ds_read_b64_tr_b16 v[114:115], v147 offset:18688
 v_mfma_f32_16x16x32_bf16 a[72:75], v[12:15], v[40:43], a[72:75]
 v_mfma_f32_16x16x32_bf16 a[80:83], v[12:15], v[44:47], a[80:83]
 ds_read_b64_tr_b16 v[116:117], v146 offset:16896
 v_mfma_f32_16x16x32_bf16 a[88:91], v[12:15], v[48:51], a[88:91]
 v_mfma_f32_16x16x32_bf16 a[96:99], v[12:15], v[52:55], a[96:99]
 ds_read_b64_tr_b16 v[118:119], v146 offset:18944
 v_mfma_f32_16x16x32_bf16 a[104:107], v[12:15], v[56:59], a[104:107]
 buffer_load_dwordx4 v142, s[16:19], s32 offen offset:2048 lds
 v_mfma_f32_16x16x32_bf16 a[112:115], v[12:15], v[60:63], a[112:115]
 ds_read_b64_tr_b16 v[120:121], v147 offset:16896
 v_mfma_f32_16x16x32_bf16 a[120:123], v[12:15], v[64:67], a[120:123]
 v_mfma_f32_16x16x32_bf16 a[68:71], v[16:19], v[36:39], a[68:71]
 ds_read_b64_tr_b16 v[122:123], v147 offset:18944
 v_mfma_f32_16x16x32_bf16 a[76:79], v[16:19], v[40:43], a[76:79]
 v_mfma_f32_16x16x32_bf16 a[84:87], v[16:19], v[44:47], a[84:87]
 ds_read_b64_tr_b16 v[124:125], v146 offset:17152
 v_mfma_f32_16x16x32_bf16 a[92:95], v[16:19], v[48:51], a[92:95]
 buffer_load_dwordx4 v143, s[16:19], s32 offen offset:3072 lds
 v_mfma_f32_16x16x32_bf16 a[100:103], v[16:19], v[52:55], a[100:103]
 ds_read_b64_tr_b16 v[126:127], v146 offset:19200
 s_add_u32 s43, s43, 0x4000
 v_mfma_f32_16x16x32_bf16 a[108:111], v[16:19], v[56:59], a[108:111]
 v_mfma_f32_16x16x32_bf16 a[116:119], v[16:19], v[60:63], a[116:119]
 s_and_b32 s43, s43, 0xffff
 ds_read_b64_tr_b16 v[128:129], v147 offset:17152
 v_mfma_f32_16x16x32_bf16 a[124:127], v[16:19], v[64:67], a[124:127]
 s_add_u32 s32, s32, 0x40000
 v_mfma_f32_16x16x32_bf16 a[128:131], v[20:23], v[36:39], a[128:131]
 s_add_u32 m0, s42, 0x1000
 ds_read_b64_tr_b16 v[130:131], v147 offset:19200
 v_mfma_f32_16x16x32_bf16 a[136:139], v[20:23], v[40:43], a[136:139]
 buffer_load_dwordx4 v136, s[12:15], s41 offen offset:0 lds
 v_mfma_f32_16x16x32_bf16 a[144:147], v[20:23], v[44:47], a[144:147]
 ds_read_b128 v[72:75], v145 offset:2048
 v_mfma_f32_16x16x32_bf16 a[152:155], v[20:23], v[48:51], a[152:155]
 v_mfma_f32_16x16x32_bf16 a[160:163], v[20:23], v[52:55], a[160:163]
 ds_read_b128 v[76:79], v145 offset:4096
 v_mfma_f32_16x16x32_bf16 a[168:171], v[20:23], v[56:59], a[168:171]
 v_mfma_f32_16x16x32_bf16 a[176:179], v[20:23], v[60:63], a[176:179]
 ds_read_b128 v[80:83], v145 offset:6144
 v_mfma_f32_16x16x32_bf16 a[184:187], v[20:23], v[64:67], a[184:187]
 buffer_load_dwordx4 v137, s[12:15], s41 offen offset:1024 lds
 v_mfma_f32_16x16x32_bf16 a[132:135], v[24:27], v[36:39], a[132:135]
 ds_read_b128 v[84:87], v145 offset:8192
 v_mfma_f32_16x16x32_bf16 a[140:143], v[24:27], v[40:43], a[140:143]
 v_mfma_f32_16x16x32_bf16 a[148:151], v[24:27], v[44:47], a[148:151]
 ds_read_b128 v[88:91], v145 offset:10240
 v_mfma_f32_16x16x32_bf16 a[156:159], v[24:27], v[48:51], a[156:159]
 v_mfma_f32_16x16x32_bf16 a[164:167], v[24:27], v[52:55], a[164:167]
 ds_read_b128 v[92:95], v145 offset:12288
 v_mfma_f32_16x16x32_bf16 a[172:175], v[24:27], v[56:59], a[172:175]
 buffer_load_dwordx4 v138, s[12:15], s41 offen offset:2048 lds
 v_mfma_f32_16x16x32_bf16 a[180:183], v[24:27], v[60:63], a[180:183]
 ds_read_b128 v[96:99], v145 offset:14336
 v_mfma_f32_16x16x32_bf16 a[188:191], v[24:27], v[64:67], a[188:191]
 v_mfma_f32_16x16x32_bf16 a[192:195], v[28:31], v[36:39], a[192:195]
 v_mfma_f32_16x16x32_bf16 a[200:203], v[28:31], v[40:43], a[200:203]
 v_mfma_f32_16x16x32_bf16 a[208:211], v[28:31], v[44:47], a[208:211]
 v_add_u32 v144, s69, v144
 v_add_u32 v145, s69, v145
 v_mfma_f32_16x16x32_bf16 a[216:219], v[28:31], v[48:51], a[216:219]
 buffer_load_dwordx4 v139, s[12:15], s41 offen offset:3072 lds
 v_mfma_f32_16x16x32_bf16 a[224:227], v[28:31], v[52:55], a[224:227]
 s_add_u32 s42, s42, 0x8000
 v_xor_b32 v146, 0x8000, v146
 v_mfma_f32_16x16x32_bf16 a[232:235], v[28:31], v[56:59], a[232:235]
 s_cmp_ge_u32 s42, 0x28000
 v_xor_b32 v147, 0x8000, v147
 v_mfma_f32_16x16x32_bf16 a[240:243], v[28:31], v[60:63], a[240:243]
 s_cselect_b32 s9, 0x18000, 0
 v_mfma_f32_16x16x32_bf16 a[248:251], v[28:31], v[64:67], a[248:251]
 s_sub_u32 s42, s42, s9
 v_mfma_f32_16x16x32_bf16 a[196:199], v[32:35], v[36:39], a[196:199]
 s_add_u32 s41, s41, 128
 v_mfma_f32_16x16x32_bf16 a[204:207], v[32:35], v[40:43], a[204:207]
 buffer_load_dwordx4 v[156:159], v2, s[64:67], s57 offen
 v_mfma_f32_16x16x32_bf16 a[212:215], v[32:35], v[44:47], a[212:215]
 v_mfma_f32_16x16x32_bf16 a[220:223], v[32:35], v[48:51], a[220:223]
 v_mfma_f32_16x16x32_bf16 a[228:231], v[32:35], v[52:55], a[228:231]
 v_mfma_f32_16x16x32_bf16 a[236:239], v[32:35], v[56:59], a[236:239]
 v_mfma_f32_16x16x32_bf16 a[244:247], v[32:35], v[60:63], a[244:247]
 v_mfma_f32_16x16x32_bf16 a[252:255], v[32:35], v[64:67], a[252:255]
 s_waitcnt vmcnt(19) lgkmcnt(0)
 s_barrier
 v_mfma_f32_16x16x32_bf16 a[0:3], v[68:71], v[100:103], a[0:3]
 ds_read_b128 v[4:7], v144 offset:0
 v_mfma_f32_16x16x32_bf16 a[8:11], v[68:71], v[104:107], a[8:11]
 s_add_u32 m0, s8, 0x18000
 s_add_u32 s11, s38, 0x100000
 v_mfma_f32_16x16x32_bf16 a[16:19], v[68:71], v[108:111], a[16:19]
 ds_read_b64_tr_b16 v[36:37], v146 offset:0
 v_mfma_f32_16x16x32_bf16 a[24:27], v[68:71], v[112:115], a[24:27]
 buffer_load_dwordx4 v140, s[20:23], s11 offen offset:0 lds
 v_mfma_f32_16x16x32_bf16 a[32:35], v[68:71], v[116:119], a[32:35]
 ds_read_b64_tr_b16 v[38:39], v146 offset:2048
 v_mfma_f32_16x16x32_bf16 a[40:43], v[68:71], v[120:123], a[40:43]
 v_mfma_f32_16x16x32_bf16 a[48:51], v[68:71], v[124:127], a[48:51]
 ds_read_b64_tr_b16 v[40:41], v147 offset:0
 v_mfma_f32_16x16x32_bf16 a[56:59], v[68:71], v[128:131], a[56:59]
 v_mfma_f32_16x16x32_bf16 a[4:7], v[72:75], v[100:103], a[4:7]
 ds_read_b64_tr_b16 v[42:43], v147 offset:2048
 v_mfma_f32_16x16x32_bf16 a[12:15], v[72:75], v[104:107], a[12:15]
 buffer_load_dwordx4 v141, s[20:23], s11 offen offset:1024 lds
 v_mfma_f32_16x16x32_bf16 a[20:23], v[72:75], v[108:111], a[20:23]
 ds_read_b64_tr_b16 v[44:45], v146 offset:256
 v_mfma_f32_16x16x32_bf16 a[28:31], v[72:75], v[112:115], a[28:31]
 v_mfma_f32_16x16x32_bf16 a[36:39], v[72:75], v[116:119], a[36:39]
 ds_read_b64_tr_b16 v[46:47], v146 offset:2304
 v_mfma_f32_16x16x32_bf16 a[44:47], v[72:75], v[120:123], a[44:47]
 v_mfma_f32_16x16x32_bf16 a[52:55], v[72:75], v[124:127], a[52:55]
 ds_read_b64_tr_b16 v[48:49], v147 offset:256
 v_mfma_f32_16x16x32_bf16 a[60:63], v[72:75], v[128:131], a[60:63]
 v_mfma_f32_16x16x32_bf16 a[64:67], v[76:79], v[100:103], a[64:67]
 ds_read_b64_tr_b16 v[50:51], v147 offset:2304
 v_mfma_f32_16x16x32_bf16 a[72:75], v[76:79], v[104:107], a[72:75]
 buffer_load_dwordx4 v142, s[20:23], s11 offen offset:2048 lds
 v_mfma_f32_16x16x32_bf16 a[80:83], v[76:79], v[108:111], a[80:83]
 ds_read_b64_tr_b16 v[52:53], v146 offset:512
 v_mfma_f32_16x16x32_bf16 a[88:91], v[76:79], v[112:115], a[88:91]
 v_mfma_f32_16x16x32_bf16 a[96:99], v[76:79], v[116:119], a[96:99]
 ds_read_b64_tr_b16 v[54:55], v146 offset:2560
 v_mfma_f32_16x16x32_bf16 a[104:107], v[76:79], v[120:123], a[104:107]
 v_mfma_f32_16x16x32_bf16 a[112:115], v[76:79], v[124:127], a[112:115]
 ds_read_b64_tr_b16 v[56:57], v147 offset:512
 v_mfma_f32_16x16x32_bf16 a[120:123], v[76:79], v[128:131], a[120:123]
 v_mfma_f32_16x16x32_bf16 a[68:71], v[80:83], v[100:103], a[68:71]
 ds_read_b64_tr_b16 v[58:59], v147 offset:2560
 v_mfma_f32_16x16x32_bf16 a[76:79], v[80:83], v[104:107], a[76:79]
 buffer_load_dwordx4 v143, s[20:23], s11 offen offset:3072 lds
 v_mfma_f32_16x16x32_bf16 a[84:87], v[80:83], v[108:111], a[84:87]
 ds_read_b64_tr_b16 v[60:61], v146 offset:768
 v_mfma_f32_16x16x32_bf16 a[92:95], v[80:83], v[112:115], a[92:95]
 v_mfma_f32_16x16x32_bf16 a[100:103], v[80:83], v[116:119], a[100:103]
 ds_read_b64_tr_b16 v[62:63], v146 offset:2816
 s_mov_b32 m0, s43
 v_mfma_f32_16x16x32_bf16 a[108:111], v[80:83], v[120:123], a[108:111]
 v_mfma_f32_16x16x32_bf16 a[116:119], v[80:83], v[124:127], a[116:119]
 ds_read_b64_tr_b16 v[64:65], v147 offset:768
 v_mfma_f32_16x16x32_bf16 a[124:127], v[80:83], v[128:131], a[124:127]
 ds_read_b64_tr_b16 v[66:67], v147 offset:2816
 v_mfma_f32_16x16x32_bf16 a[128:131], v[84:87], v[100:103], a[128:131]
 buffer_load_dwordx4 v140, s[16:19], s32 offen offset:0 lds
 v_mfma_f32_16x16x32_bf16 a[136:139], v[84:87], v[104:107], a[136:139]
 v_mfma_f32_16x16x32_bf16 a[144:147], v[84:87], v[108:111], a[144:147]
 ds_read_b128 v[8:11], v144 offset:2048
 v_mfma_f32_16x16x32_bf16 a[152:155], v[84:87], v[112:115], a[152:155]
 v_mfma_f32_16x16x32_bf16 a[160:163], v[84:87], v[116:119], a[160:163]
 ds_read_b128 v[12:15], v144 offset:4096
 v_mfma_f32_16x16x32_bf16 a[168:171], v[84:87], v[120:123], a[168:171]
 v_mfma_f32_16x16x32_bf16 a[176:179], v[84:87], v[124:127], a[176:179]
 ds_read_b128 v[16:19], v144 offset:6144
 v_mfma_f32_16x16x32_bf16 a[184:187], v[84:87], v[128:131], a[184:187]
 buffer_load_dwordx4 v141, s[16:19], s32 offen offset:1024 lds
 v_mfma_f32_16x16x32_bf16 a[132:135], v[88:91], v[100:103], a[132:135]
 ds_read_b128 v[20:23], v144 offset:8192
 v_mfma_f32_16x16x32_bf16 a[140:143], v[88:91], v[104:107], a[140:143]
 v_mfma_f32_16x16x32_bf16 a[148:151], v[88:91], v[108:111], a[148:151]
 ds_read_b128 v[24:27], v144 offset:10240
 v_mfma_f32_16x16x32_bf16 a[156:159], v[88:91], v[112:115], a[156:159]
 v_mfma_f32_16x16x32_bf16 a[164:167], v[88:91], v[116:119], a[164:167]
 ds_read_b128 v[28:31], v144 offset:12288
 v_mfma_f32_16x16x32_bf16 a[172:175], v[88:91], v[120:123], a[172:175]
 v_mfma_f32_16x16x32_bf16 a[180:183], v[88:91], v[124:127], a[180:183]
 ds_read_b128 v[32:35], v144 offset:14336
 v_mfma_f32_16x16x32_bf16 a[188:191], v[88:91], v[128:131], a[188:191]
 buffer_load_dwordx4 v142, s[16:19], s32 offen offset:2048 lds
 v_mfma_f32_16x16x32_bf16 a[192:195], v[92:95], v[100:103], a[192:195]
 v_mfma_f32_16x16x32_bf16 a[200:203], v[92:95], v[104:107], a[200:203]
 v_mfma_f32_16x16x32_bf16 a[208:211], v[92:95], v[108:111], a[208:211]
 v_mfma_f32_16x16x32_bf16 a[216:219], v[92:95], v[112:115], a[216:219]
 v_mfma_f32_16x16x32_bf16 a[224:227], v[92:95], v[116:119], a[224:227]
 v_mfma_f32_16x16x32_bf16 a[232:235], v[92:95], v[120:123], a[232:235]
 v_mfma_f32_16x16x32_bf16 a[240:243], v[92:95], v[124:127], a[240:243]
 buffer_load_dwordx4 v143, s[16:19], s32 offen offset:3072 lds
 v_mfma_f32_16x16x32_bf16 a[248:251], v[92:95], v[128:131], a[248:251]
 v_mfma_f32_16x16x32_bf16 a[196:199], v[96:99], v[100:103], a[196:199]
 s_add_u32 s43, s43, 0x4000
 v_mfma_f32_16x16x32_bf16 a[204:207], v[96:99], v[104:107], a[204:207]
 v_mfma_f32_16x16x32_bf16 a[212:215], v[96:99], v[108:111], a[212:215]
 s_and_b32 s43, s43, 0xffff
 v_mfma_f32_16x16x32_bf16 a[220:223], v[96:99], v[112:115], a[220:223]
 v_mfma_f32_16x16x32_bf16 a[228:231], v[96:99], v[116:119], a[228:231]
 s_add_u32 s32, s32, 0x40000
 v_mfma_f32_16x16x32_bf16 a[236:239], v[96:99], v[120:123], a[236:239]
 v_mfma_f32_16x16x32_bf16 a[244:247], v[96:99], v[124:127], a[244:247]
 v_mfma_f32_16x16x32_bf16 a[252:255], v[96:99], v[128:131], a[252:255]
 s_waitcnt vmcnt(17) lgkmcnt(0)
 s_barrier
 v_and_b32 v152, 0xff, v3
 v_cmp_ne_u32 vcc, 32, v152
 s_cbranch_vccnz L1_V_cw
L1_V_got:
 v_mfma_f32_16x16x32_bf16 a[0:3], v[4:7], v[36:39], a[0:3]
 ds_read_b128 v[68:71], v145 offset:0
 s_add_u32 s10, s44, 0x8000
 v_mfma_f32_16x16x32_bf16 a[8:11], v[4:7], v[40:43], a[8:11]
 s_cmp_eq_u32 s10, 0x18000
 s_cselect_b32 s10, 0, s10
 v_mfma_f32_16x16x32_bf16 a[16:19], v[4:7], v[44:47], a[16:19]
 s_sub_u32 s69, s10, s44
 s_mov_b32 s44, s10
 v_mfma_f32_16x16x32_bf16 a[24:27], v[4:7], v[48:51], a[24:27]
 s_and_b32 s10, s2, 7
 v_readfirstlane_b32 s71, v155
 v_mfma_f32_16x16x32_bf16 a[32:35], v[4:7], v[52:55], a[32:35]
 v_readlane_b32 s10, v3, s10
 s_bfe_u32 s9, s2, 0x30004
 v_mfma_f32_16x16x32_bf16 a[40:43], v[4:7], v[56:59], a[40:43]
 ds_read_b64_tr_b16 v[100:101], v146 offset:16384
 s_sub_u32 s11, 15, s9
 v_mfma_f32_16x16x32_bf16 a[48:51], v[4:7], v[60:63], a[48:51]
 s_bitcmp1_b32 s2, 7
 s_cselect_b32 s9, s11, s9
 v_mfma_f32_16x16x32_bf16 a[56:59], v[4:7], v[64:67], a[56:59]
 s_lshl_b32 s9, s9, 2
 s_add_u32 s9, s9, s3
 v_mfma_f32_16x16x32_bf16 a[4:7], v[8:11], v[36:39], a[4:7]
 s_mul_i32 s39, s9, 28672
 s_add_u32 s39, s39, 0x5c00000
 v_mfma_f32_16x16x32_bf16 a[12:15], v[8:11], v[40:43], a[12:15]
 s_add_u32 s40, s39, 14336
 s_lshl_b32 s71, s71, 5
 v_mfma_f32_16x16x32_bf16 a[20:23], v[8:11], v[44:47], a[20:23]
 s_cmp_eq_u32 s10, s71
 ds_read_b64_tr_b16 v[102:103], v146 offset:18432
 v_mfma_f32_16x16x32_bf16 a[28:31], v[8:11], v[48:51], a[28:31]
 s_cselect_b32 s71, 1, 0
 s_bitcmp1_b32 s2, 3
 v_mfma_f32_16x16x32_bf16 a[36:39], v[8:11], v[52:55], a[36:39]
 s_cselect_b32 s70, s40, s39
 s_add_u32 m0, s8, 0x0
 v_mfma_f32_16x16x32_bf16 a[44:47], v[8:11], v[56:59], a[44:47]
 s_add_u32 s11, s38, 0x0
 ds_read_b64_tr_b16 v[104:105], v147 offset:16384
 v_mfma_f32_16x16x32_bf16 a[52:55], v[8:11], v[60:63], a[52:55]
 buffer_load_dwordx4 v140, s[20:23], s11 offen offset:0 lds
 v_mfma_f32_16x16x32_bf16 a[60:63], v[8:11], v[64:67], a[60:63]
 ds_read_b64_tr_b16 v[106:107], v147 offset:18432
 v_mfma_f32_16x16x32_bf16 a[64:67], v[12:15], v[36:39], a[64:67]
 buffer_load_dwordx4 v141, s[20:23], s11 offen offset:1024 lds
 v_mfma_f32_16x16x32_bf16 a[72:75], v[12:15], v[40:43], a[72:75]
 ds_read_b64_tr_b16 v[108:109], v146 offset:16640
 v_mfma_f32_16x16x32_bf16 a[80:83], v[12:15], v[44:47], a[80:83]
 ds_read_b64_tr_b16 v[110:111], v146 offset:18688
 v_mfma_f32_16x16x32_bf16 a[88:91], v[12:15], v[48:51], a[88:91]
 buffer_load_dwordx4 v142, s[20:23], s11 offen offset:2048 lds
 v_mfma_f32_16x16x32_bf16 a[96:99], v[12:15], v[52:55], a[96:99]
 ds_read_b64_tr_b16 v[112:113], v147 offset:16640
 v_mfma_f32_16x16x32_bf16 a[104:107], v[12:15], v[56:59], a[104:107]
 ds_read_b64_tr_b16 v[114:115], v147 offset:18688
 v_mfma_f32_16x16x32_bf16 a[112:115], v[12:15], v[60:63], a[112:115]
 buffer_load_dwordx4 v143, s[20:23], s11 offen offset:3072 lds
 v_mfma_f32_16x16x32_bf16 a[120:123], v[12:15], v[64:67], a[120:123]
 ds_read_b64_tr_b16 v[116:117], v146 offset:16896
 v_mfma_f32_16x16x32_bf16 a[68:71], v[16:19], v[36:39], a[68:71]
 ds_read_b64_tr_b16 v[118:119], v146 offset:18944
 v_mfma_f32_16x16x32_bf16 a[76:79], v[16:19], v[40:43], a[76:79]
 buffer_load_dwordx4 v[168:171], v2, s[4:7], s39 offen offset:0
 v_mfma_f32_16x16x32_bf16 a[84:87], v[16:19], v[44:47], a[84:87]
 ds_read_b64_tr_b16 v[120:121], v147 offset:16896
 v_mfma_f32_16x16x32_bf16 a[92:95], v[16:19], v[48:51], a[92:95]
 ds_read_b64_tr_b16 v[122:123], v147 offset:18944
 v_mfma_f32_16x16x32_bf16 a[100:103], v[16:19], v[52:55], a[100:103]
 buffer_load_dwordx4 v[172:175], v2, s[4:7], s40 offen offset:0
 v_mfma_f32_16x16x32_bf16 a[108:111], v[16:19], v[56:59], a[108:111]
 ds_read_b64_tr_b16 v[124:125], v146 offset:17152
 v_mfma_f32_16x16x32_bf16 a[116:119], v[16:19], v[60:63], a[116:119]
 ds_read_b64_tr_b16 v[126:127], v146 offset:19200
 v_mfma_f32_16x16x32_bf16 a[124:127], v[16:19], v[64:67], a[124:127]
 buffer_load_dwordx4 v[176:179], v2, s[4:7], s39 offen offset:1024
 v_mfma_f32_16x16x32_bf16 a[128:131], v[20:23], v[36:39], a[128:131]
 ds_read_b64_tr_b16 v[128:129], v147 offset:17152
 v_mfma_f32_16x16x32_bf16 a[136:139], v[20:23], v[40:43], a[136:139]
 ds_read_b64_tr_b16 v[130:131], v147 offset:19200
 v_mfma_f32_16x16x32_bf16 a[144:147], v[20:23], v[44:47], a[144:147]
 buffer_load_dwordx4 v[180:183], v2, s[4:7], s40 offen offset:1024
 v_mfma_f32_16x16x32_bf16 a[152:155], v[20:23], v[48:51], a[152:155]
 ds_read_b128 v[72:75], v145 offset:2048
 s_add_u32 m0, s8, 0x1c000
 v_mfma_f32_16x16x32_bf16 a[160:163], v[20:23], v[52:55], a[160:163]
 ds_read_b128 v[76:79], v145 offset:4096
 s_add_u32 s11, s38, 0x140000
 v_mfma_f32_16x16x32_bf16 a[168:171], v[20:23], v[56:59], a[168:171]
 ds_read_b128 v[80:83], v145 offset:6144
 v_mfma_f32_16x16x32_bf16 a[176:179], v[20:23], v[60:63], a[176:179]
 buffer_load_dwordx4 v140, s[20:23], s11 offen offset:0 lds
 v_mfma_f32_16x16x32_bf16 a[184:187], v[20:23], v[64:67], a[184:187]
 v_mfma_f32_16x16x32_bf16 a[132:135], v[24:27], v[36:39], a[132:135]
 ds_read_b128 v[84:87], v145 offset:8192
 v_mfma_f32_16x16x32_bf16 a[140:143], v[24:27], v[40:43], a[140:143]
 ds_read_b128 v[88:91], v145 offset:10240
 v_mfma_f32_16x16x32_bf16 a[148:151], v[24:27], v[44:47], a[148:151]
 buffer_load_dwordx4 v141, s[20:23], s11 offen offset:1024 lds
 v_mfma_f32_16x16x32_bf16 a[156:159], v[24:27], v[48:51], a[156:159]
 v_mfma_f32_16x16x32_bf16 a[164:167], v[24:27], v[52:55], a[164:167]
 ds_read_b128 v[92:95], v145 offset:12288
 v_mfma_f32_16x16x32_bf16 a[172:175], v[24:27], v[56:59], a[172:175]
 ds_read_b128 v[96:99], v145 offset:14336
 v_mfma_f32_16x16x32_bf16 a[180:183], v[24:27], v[60:63], a[180:183]
 buffer_load_dwordx4 v142, s[20:23], s11 offen offset:2048 lds
 v_mfma_f32_16x16x32_bf16 a[188:191], v[24:27], v[64:67], a[188:191]
 v_mfma_f32_16x16x32_bf16 a[192:195], v[28:31], v[36:39], a[192:195]
 v_mfma_f32_16x16x32_bf16 a[200:203], v[28:31], v[40:43], a[200:203]
 v_add_u32 v144, s69, v144
 v_mfma_f32_16x16x32_bf16 a[208:211], v[28:31], v[44:47], a[208:211]
 buffer_load_dwordx4 v143, s[20:23], s11 offen offset:3072 lds
 v_mfma_f32_16x16x32_bf16 a[216:219], v[28:31], v[48:51], a[216:219]
 v_add_u32 v145, s69, v145
 v_mfma_f32_16x16x32_bf16 a[224:227], v[28:31], v[52:55], a[224:227]
 v_xor_b32 v146, 0x8000, v146
 v_mfma_f32_16x16x32_bf16 a[232:235], v[28:31], v[56:59], a[232:235]
 v_xor_b32 v147, 0x8000, v147
 v_mfma_f32_16x16x32_bf16 a[240:243], v[28:31], v[60:63], a[240:243]
 buffer_load_dwordx4 v[184:187], v2, s[4:7], s39 offen offset:2048
 v_mfma_f32_16x16x32_bf16 a[248:251], v[28:31], v[64:67], a[248:251]
 v_mfma_f32_16x16x32_bf16 a[196:199], v[32:35], v[36:39], a[196:199]
 v_mfma_f32_16x16x32_bf16 a[204:207], v[32:35], v[40:43], a[204:207]
 v_mfma_f32_16x16x32_bf16 a[212:215], v[32:35], v[44:47], a[212:215]
 buffer_load_dwordx4 v[188:191], v2, s[4:7], s40 offen offset:2048
 v_mfma_f32_16x16x32_bf16 a[220:223], v[32:35], v[48:51], a[220:223]
 v_mfma_f32_16x16x32_bf16 a[228:231], v[32:35], v[52:55], a[228:231]
 v_mfma_f32_16x16x32_bf16 a[236:239], v[32:35], v[56:59], a[236:239]
 v_mfma_f32_16x16x32_bf16 a[244:247], v[32:35], v[60:63], a[244:247]
 v_mfma_f32_16x16x32_bf16 a[252:255], v[32:35], v[64:67], a[252:255]
 s_waitcnt vmcnt(23) lgkmcnt(0)
 s_barrier
 v_mfma_f32_16x16x32_bf16 a[0:3], v[68:71], v[100:103], a[0:3]
 ds_read_b128 v[4:7], v144 offset:0
 v_mfma_f32_16x16x32_bf16 a[8:11], v[68:71], v[104:107], a[8:11]
 s_add_u32 m0, s8, 0x4000
 s_add_u32 s11, s38, 0x40000
 v_mfma_f32_16x16x32_bf16 a[16:19], v[68:71], v[108:111], a[16:19]
 ds_read_b64_tr_b16 v[36:37], v146 offset:0
 v_mfma_f32_16x16x32_bf16 a[24:27], v[68:71], v[112:115], a[24:27]
 buffer_load_dwordx4 v140, s[20:23], s11 offen offset:0 lds
 v_mfma_f32_16x16x32_bf16 a[32:35], v[68:71], v[116:119], a[32:35]
 ds_read_b64_tr_b16 v[38:39], v146 offset:2048
 v_mfma_f32_16x16x32_bf16 a[40:43], v[68:71], v[120:123], a[40:43]
 v_mfma_f32_16x16x32_bf16 a[48:51], v[68:71], v[124:127], a[48:51]
 ds_read_b64_tr_b16 v[40:41], v147 offset:0
 v_mfma_f32_16x16x32_bf16 a[56:59], v[68:71], v[128:131], a[56:59]
 buffer_load_dwordx4 v141, s[20:23], s11 offen offset:1024 lds
 v_mfma_f32_16x16x32_bf16 a[4:7], v[72:75], v[100:103], a[4:7]
 ds_read_b64_tr_b16 v[42:43], v147 offset:2048
 v_mfma_f32_16x16x32_bf16 a[12:15], v[72:75], v[104:107], a[12:15]
 v_mfma_f32_16x16x32_bf16 a[20:23], v[72:75], v[108:111], a[20:23]
 ds_read_b64_tr_b16 v[44:45], v146 offset:256
 v_mfma_f32_16x16x32_bf16 a[28:31], v[72:75], v[112:115], a[28:31]
 buffer_load_dwordx4 v142, s[20:23], s11 offen offset:2048 lds
 v_mfma_f32_16x16x32_bf16 a[36:39], v[72:75], v[116:119], a[36:39]
 ds_read_b64_tr_b16 v[46:47], v146 offset:2304
 v_mfma_f32_16x16x32_bf16 a[44:47], v[72:75], v[120:123], a[44:47]
 v_mfma_f32_16x16x32_bf16 a[52:55], v[72:75], v[124:127], a[52:55]
 ds_read_b64_tr_b16 v[48:49], v147 offset:256
 v_mfma_f32_16x16x32_bf16 a[60:63], v[72:75], v[128:131], a[60:63]
 buffer_load_dwordx4 v143, s[20:23], s11 offen offset:3072 lds
 v_mfma_f32_16x16x32_bf16 a[64:67], v[76:79], v[100:103], a[64:67]
 ds_read_b64_tr_b16 v[50:51], v147 offset:2304
 v_mfma_f32_16x16x32_bf16 a[72:75], v[76:79], v[104:107], a[72:75]
 v_mfma_f32_16x16x32_bf16 a[80:83], v[76:79], v[108:111], a[80:83]
 ds_read_b64_tr_b16 v[52:53], v146 offset:512
 v_mfma_f32_16x16x32_bf16 a[88:91], v[76:79], v[112:115], a[88:91]
 buffer_load_dwordx4 v[192:195], v2, s[4:7], s39 offen offset:3072
 v_mfma_f32_16x16x32_bf16 a[96:99], v[76:79], v[116:119], a[96:99]
 ds_read_b64_tr_b16 v[54:55], v146 offset:2560
 v_mfma_f32_16x16x32_bf16 a[104:107], v[76:79], v[120:123], a[104:107]
 v_mfma_f32_16x16x32_bf16 a[112:115], v[76:79], v[124:127], a[112:115]
 ds_read_b64_tr_b16 v[56:57], v147 offset:512
 v_mfma_f32_16x16x32_bf16 a[120:123], v[76:79], v[128:131], a[120:123]
 buffer_load_dwordx4 v[196:199], v2, s[4:7], s40 offen offset:3072
 v_mfma_f32_16x16x32_bf16 a[68:71], v[80:83], v[100:103], a[68:71]
 s_add_u32 s39, s39, 0x1000
 ds_read_b64_tr_b16 v[58:59], v147 offset:2560
 v_mfma_f32_16x16x32_bf16 a[76:79], v[80:83], v[104:107], a[76:79]
 s_add_u32 s40, s40, 0x1000
 v_mfma_f32_16x16x32_bf16 a[84:87], v[80:83], v[108:111], a[84:87]
 ds_read_b64_tr_b16 v[60:61], v146 offset:768
 v_mfma_f32_16x16x32_bf16 a[92:95], v[80:83], v[112:115], a[92:95]
 buffer_load_dwordx4 v[200:203], v2, s[4:7], s39 offen offset:0
 v_mfma_f32_16x16x32_bf16 a[100:103], v[80:83], v[116:119], a[100:103]
 ds_read_b64_tr_b16 v[62:63], v146 offset:2816
 v_mfma_f32_16x16x32_bf16 a[108:111], v[80:83], v[120:123], a[108:111]
 v_mfma_f32_16x16x32_bf16 a[116:119], v[80:83], v[124:127], a[116:119]
 ds_read_b64_tr_b16 v[64:65], v147 offset:768
 v_mfma_f32_16x16x32_bf16 a[124:127], v[80:83], v[128:131], a[124:127]
 buffer_load_dwordx4 v[204:207], v2, s[4:7], s40 offen offset:0
 v_mfma_f32_16x16x32_bf16 a[128:131], v[84:87], v[100:103], a[128:131]
 s_add_u32 m0, s8, 0x20000
 ds_read_b64_tr_b16 v[66:67], v147 offset:2816
 v_mfma_f32_16x16x32_bf16 a[136:139], v[84:87], v[104:107], a[136:139]
 s_add_u32 s11, s38, 0x180000
 v_mfma_f32_16x16x32_bf16 a[144:147], v[84:87], v[108:111], a[144:147]
 ds_read_b128 v[8:11], v144 offset:2048
 v_mfma_f32_16x16x32_bf16 a[152:155], v[84:87], v[112:115], a[152:155]
 buffer_load_dwordx4 v140, s[20:23], s11 offen offset:0 lds
 v_mfma_f32_16x16x32_bf16 a[160:163], v[84:87], v[116:119], a[160:163]
 ds_read_b128 v[12:15], v144 offset:4096
 v_mfma_f32_16x16x32_bf16 a[168:171], v[84:87], v[120:123], a[168:171]
 v_mfma_f32_16x16x32_bf16 a[176:179], v[84:87], v[124:127], a[176:179]
 ds_read_b128 v[16:19], v144 offset:6144
 v_mfma_f32_16x16x32_bf16 a[184:187], v[84:87], v[128:131], a[184:187]
 buffer_load_dwordx4 v141, s[20:23], s11 offen offset:1024 lds
 v_mfma_f32_16x16x32_bf16 a[132:135], v[88:91], v[100:103], a[132:135]
 ds_read_b128 v[20:23], v144 offset:8192
 v_mfma_f32_16x16x32_bf16 a[140:143], v[88:91], v[104:107], a[140:143]
 v_mfma_f32_16x16x32_bf16 a[148:151], v[88:91], v[108:111], a[148:151]
 ds_read_b128 v[24:27], v144 offset:10240
 v_mfma_f32_16x16x32_bf16 a[156:159], v[88:91], v[112:115], a[156:159]
 buffer_load_dwordx4 v142, s[20:23], s11 offen offset:2048 lds
 v_mfma_f32_16x16x32_bf16 a[164:167], v[88:91], v[116:119], a[164:167]
 ds_read_b128 v[28:31], v144 offset:12288
 v_mfma_f32_16x16x32_bf16 a[172:175], v[88:91], v[120:123], a[172:175]
 v_mfma_f32_16x16x32_bf16 a[180:183], v[88:91], v[124:127], a[180:183]
 ds_read_b128 v[32:35], v144 offset:14336
 v_mfma_f32_16x16x32_bf16 a[188:191], v[88:91], v[128:131], a[188:191]
 buffer_load_dwordx4 v143, s[20:23], s11 offen offset:3072 lds
 v_mfma_f32_16x16x32_bf16 a[192:195], v[92:95], v[100:103], a[192:195]
 v_mfma_f32_16x16x32_bf16 a[200:203], v[92:95], v[104:107], a[200:203]
 v_mfma_f32_16x16x32_bf16 a[208:211], v[92:95], v[108:111], a[208:211]
 buffer_load_dwordx4 v[208:211], v2, s[4:7], s39 offen offset:1024
 v_mfma_f32_16x16x32_bf16 a[216:219], v[92:95], v[112:115], a[216:219]
 v_mfma_f32_16x16x32_bf16 a[224:227], v[92:95], v[116:119], a[224:227]
 v_mfma_f32_16x16x32_bf16 a[232:235], v[92:95], v[120:123], a[232:235]
 v_mfma_f32_16x16x32_bf16 a[240:243], v[92:95], v[124:127], a[240:243]
 buffer_load_dwordx4 v[212:215], v2, s[4:7], s40 offen offset:1024
 v_mfma_f32_16x16x32_bf16 a[248:251], v[92:95], v[128:131], a[248:251]
 s_lshl_b32 s9, s45, 6
 s_lshl_b32 s10, s47, 3
 v_mfma_f32_16x16x32_bf16 a[196:199], v[96:99], v[100:103], a[196:199]
 s_add_u32 s9, s9, s10
 s_lshr_b32 s10, s3, 1
 v_mfma_f32_16x16x32_bf16 a[204:207], v[96:99], v[104:107], a[204:207]
 s_lshl_b32 s10, s10, 2
 s_add_u32 s9, s9, s10
 v_mfma_f32_16x16x32_bf16 a[212:215], v[96:99], v[108:111], a[212:215]
 s_mul_i32 s35, s9, 16384
 s_and_b32 s10, s3, 1
 v_mfma_f32_16x16x32_bf16 a[220:223], v[96:99], v[112:115], a[220:223]
 s_lshl_b32 s68, s10, 10
 s_add_u32 s9, s46, 12
 v_mfma_f32_16x16x32_bf16 a[228:231], v[96:99], v[116:119], a[228:231]
 s_lshl_b32 s10, s10, s9
 s_add_u32 s35, s35, s10
 v_mfma_f32_16x16x32_bf16 a[236:239], v[96:99], v[120:123], a[236:239]
 s_mul_i32 s10, s46, 0x1200000
 s_add_u32 s35, s35, s10
 v_mfma_f32_16x16x32_bf16 a[244:247], v[96:99], v[124:127], a[244:247]
 s_lshl_b32 s32, s45, 7
 s_lshl_b32 s9, s46, 3
 s_add_u32 s9, s9, s47
 s_lshl_b32 s9, s9, 2
 s_add_u32 s32, s32, 0x5300000
 s_add_u32 s34, s32, s9
 s_add_u32 s36, s36, s35
 v_mfma_f32_16x16x32_bf16 a[252:255], v[96:99], v[128:131], a[252:255]
 s_waitcnt vmcnt(28) lgkmcnt(0)
 s_barrier
 v_mfma_f32_16x16x32_bf16 a[0:3], v[4:7], v[36:39], a[0:3]
 ds_read_b128 v[68:71], v145 offset:0
 v_mfma_f32_16x16x32_bf16 a[8:11], v[4:7], v[40:43], a[8:11]
 s_add_u32 s10, s44, 0x8000
 s_cmp_eq_u32 s10, 0x18000
 v_mfma_f32_16x16x32_bf16 a[16:19], v[4:7], v[44:47], a[16:19]
 s_cselect_b32 s10, 0, s10
 ds_read_b64_tr_b16 v[100:101], v146 offset:16384
 v_mfma_f32_16x16x32_bf16 a[24:27], v[4:7], v[48:51], a[24:27]
 s_sub_u32 s69, s10, s44
 s_mov_b32 s44, s10
 v_mfma_f32_16x16x32_bf16 a[32:35], v[4:7], v[52:55], a[32:35]
 s_add_u32 m0, s8, 0x8000
 s_add_u32 s11, s38, 0x80000
 v_mfma_f32_16x16x32_bf16 a[40:43], v[4:7], v[56:59], a[40:43]
 ds_read_b64_tr_b16 v[102:103], v146 offset:18432
 v_mfma_f32_16x16x32_bf16 a[48:51], v[4:7], v[60:63], a[48:51]
 buffer_load_dwordx4 v140, s[20:23], s11 offen offset:0 lds
 v_mfma_f32_16x16x32_bf16 a[56:59], v[4:7], v[64:67], a[56:59]
 ds_read_b64_tr_b16 v[104:105], v147 offset:16384
 v_mfma_f32_16x16x32_bf16 a[4:7], v[8:11], v[36:39], a[4:7]
 ds_read_b64_tr_b16 v[106:107], v147 offset:18432
 v_mfma_f32_16x16x32_bf16 a[12:15], v[8:11], v[40:43], a[12:15]
 buffer_load_dwordx4 v141, s[20:23], s11 offen offset:1024 lds
 v_mfma_f32_16x16x32_bf16 a[20:23], v[8:11], v[44:47], a[20:23]
 ds_read_b64_tr_b16 v[108:109], v146 offset:16640
 v_mfma_f32_16x16x32_bf16 a[28:31], v[8:11], v[48:51], a[28:31]
 v_mfma_f32_16x16x32_bf16 a[36:39], v[8:11], v[52:55], a[36:39]
 ds_read_b64_tr_b16 v[110:111], v146 offset:18688
 v_mfma_f32_16x16x32_bf16 a[44:47], v[8:11], v[56:59], a[44:47]
 buffer_load_dwordx4 v142, s[20:23], s11 offen offset:2048 lds
 v_mfma_f32_16x16x32_bf16 a[52:55], v[8:11], v[60:63], a[52:55]
 ds_read_b64_tr_b16 v[112:113], v147 offset:16640
 v_mfma_f32_16x16x32_bf16 a[60:63], v[8:11], v[64:67], a[60:63]
 v_mfma_f32_16x16x32_bf16 a[64:67], v[12:15], v[36:39], a[64:67]
 ds_read_b64_tr_b16 v[114:115], v147 offset:18688
 v_mfma_f32_16x16x32_bf16 a[72:75], v[12:15], v[40:43], a[72:75]
 buffer_load_dwordx4 v143, s[20:23], s11 offen offset:3072 lds
 v_mfma_f32_16x16x32_bf16 a[80:83], v[12:15], v[44:47], a[80:83]
 ds_read_b64_tr_b16 v[116:117], v146 offset:16896
 v_mfma_f32_16x16x32_bf16 a[88:91], v[12:15], v[48:51], a[88:91]
 v_mfma_f32_16x16x32_bf16 a[96:99], v[12:15], v[52:55], a[96:99]
 ds_read_b64_tr_b16 v[118:119], v146 offset:18944
 v_mfma_f32_16x16x32_bf16 a[104:107], v[12:15], v[56:59], a[104:107]
 buffer_load_dwordx4 v[232:235], v2, s[4:7], s39 offen offset:2048
 v_mfma_f32_16x16x32_bf16 a[112:115], v[12:15], v[60:63], a[112:115]
 ds_read_b64_tr_b16 v[120:121], v147 offset:16896
 v_mfma_f32_16x16x32_bf16 a[120:123], v[12:15], v[64:67], a[120:123]
 v_mfma_f32_16x16x32_bf16 a[68:71], v[16:19], v[36:39], a[68:71]
 ds_read_b64_tr_b16 v[122:123], v147 offset:18944
 v_mfma_f32_16x16x32_bf16 a[76:79], v[16:19], v[40:43], a[76:79]
 buffer_load_dwordx4 v[236:239], v2, s[4:7], s40 offen offset:2048
 v_mfma_f32_16x16x32_bf16 a[84:87], v[16:19], v[44:47], a[84:87]
 ds_read_b64_tr_b16 v[124:125], v146 offset:17152
 v_mfma_f32_16x16x32_bf16 a[92:95], v[16:19], v[48:51], a[92:95]
 v_mfma_f32_16x16x32_bf16 a[100:103], v[16:19], v[52:55], a[100:103]
 ds_read_b64_tr_b16 v[126:127], v146 offset:19200
 v_mfma_f32_16x16x32_bf16 a[108:111], v[16:19], v[56:59], a[108:111]
 buffer_load_dwordx4 v[240:243], v2, s[4:7], s39 offen offset:3072
 v_mfma_f32_16x16x32_bf16 a[116:119], v[16:19], v[60:63], a[116:119]
 ds_read_b64_tr_b16 v[128:129], v147 offset:17152
 v_mfma_f32_16x16x32_bf16 a[124:127], v[16:19], v[64:67], a[124:127]
 v_mfma_f32_16x16x32_bf16 a[128:131], v[20:23], v[36:39], a[128:131]
 ds_read_b64_tr_b16 v[130:131], v147 offset:19200
 v_mfma_f32_16x16x32_bf16 a[136:139], v[20:23], v[40:43], a[136:139]
 buffer_load_dwordx4 v[244:247], v2, s[4:7], s40 offen offset:3072
 v_mfma_f32_16x16x32_bf16 a[144:147], v[20:23], v[44:47], a[144:147]
 ds_read_b128 v[72:75], v145 offset:2048
 s_add_u32 s39, s39, 0x1000
 v_mfma_f32_16x16x32_bf16 a[152:155], v[20:23], v[48:51], a[152:155]
 s_add_u32 s40, s40, 0x1000
 v_mfma_f32_16x16x32_bf16 a[160:163], v[20:23], v[52:55], a[160:163]
 s_add_u32 m0, s8, 0x24000
 ds_read_b128 v[76:79], v145 offset:4096
 v_mfma_f32_16x16x32_bf16 a[168:171], v[20:23], v[56:59], a[168:171]
 s_add_u32 s11, s38, 0x1c0000
 ds_read_b128 v[80:83], v145 offset:6144
 v_mfma_f32_16x16x32_bf16 a[176:179], v[20:23], v[60:63], a[176:179]
 buffer_load_dwordx4 v140, s[20:23], s11 offen offset:0 lds
 v_mfma_f32_16x16x32_bf16 a[184:187], v[20:23], v[64:67], a[184:187]
 v_mfma_f32_16x16x32_bf16 a[132:135], v[24:27], v[36:39], a[132:135]
 ds_read_b128 v[84:87], v145 offset:8192
 v_mfma_f32_16x16x32_bf16 a[140:143], v[24:27], v[40:43], a[140:143]
 ds_read_b128 v[88:91], v145 offset:10240
 v_mfma_f32_16x16x32_bf16 a[148:151], v[24:27], v[44:47], a[148:151]
 buffer_load_dwordx4 v141, s[20:23], s11 offen offset:1024 lds
 v_mfma_f32_16x16x32_bf16 a[156:159], v[24:27], v[48:51], a[156:159]
 v_mfma_f32_16x16x32_bf16 a[164:167], v[24:27], v[52:55], a[164:167]
 ds_read_b128 v[92:95], v145 offset:12288
 v_mfma_f32_16x16x32_bf16 a[172:175], v[24:27], v[56:59], a[172:175]
 ds_read_b128 v[96:99], v145 offset:14336
 v_mfma_f32_16x16x32_bf16 a[180:183], v[24:27], v[60:63], a[180:183]
 buffer_load_dwordx4 v142, s[20:23], s11 offen offset:2048 lds
 v_mfma_f32_16x16x32_bf16 a[188:191], v[24:27], v[64:67], a[188:191]
 v_mfma_f32_16x16x32_bf16 a[192:195], v[28:31], v[36:39], a[192:195]
 v_mfma_f32_16x16x32_bf16 a[200:203], v[28:31], v[40:43], a[200:203]
 v_add_u32 v144, s69, v144
 v_mfma_f32_16x16x32_bf16 a[208:211], v[28:31], v[44:47], a[208:211]
 buffer_load_dwordx4 v143, s[20:23], s11 offen offset:3072 lds
 v_mfma_f32_16x16x32_bf16 a[216:219], v[28:31], v[48:51], a[216:219]
 v_add_u32 v145, s69, v145
 v_mfma_f32_16x16x32_bf16 a[224:227], v[28:31], v[52:55], a[224:227]
 v_xor_b32 v146, 0x8000, v146
 v_mfma_f32_16x16x32_bf16 a[232:235], v[28:31], v[56:59], a[232:235]
 v_xor_b32 v147, 0x8000, v147
 v_mfma_f32_16x16x32_bf16 a[240:243], v[28:31], v[60:63], a[240:243]
 buffer_load_dwordx4 v[248:251], v2, s[4:7], s39 offen offset:0
 v_mfma_f32_16x16x32_bf16 a[248:251], v[28:31], v[64:67], a[248:251]
 v_mfma_f32_16x16x32_bf16 a[196:199], v[32:35], v[36:39], a[196:199]
 v_mfma_f32_16x16x32_bf16 a[204:207], v[32:35], v[40:43], a[204:207]
 v_mfma_f32_16x16x32_bf16 a[212:215], v[32:35], v[44:47], a[212:215]
 buffer_load_dwordx4 v[252:255], v2, s[4:7], s40 offen offset:0
 v_mfma_f32_16x16x32_bf16 a[220:223], v[32:35], v[48:51], a[220:223]
 v_mfma_f32_16x16x32_bf16 a[228:231], v[32:35], v[52:55], a[228:231]
 v_mfma_f32_16x16x32_bf16 a[236:239], v[32:35], v[56:59], a[236:239]
 v_mfma_f32_16x16x32_bf16 a[244:247], v[32:35], v[60:63], a[244:247]
 v_mfma_f32_16x16x32_bf16 a[252:255], v[32:35], v[64:67], a[252:255]
 s_waitcnt lgkmcnt(0)
 s_barrier
 v_mfma_f32_16x16x32_bf16 a[192:195], v[92:95], v[100:103], a[192:195]
 v_mfma_f32_16x16x32_bf16 a[196:199], v[96:99], v[100:103], a[196:199]
 v_subrev_u32 v146, s68, v146
 v_subrev_u32 v147, s68, v147
 v_mfma_f32_16x16x32_bf16 a[200:203], v[92:95], v[104:107], a[200:203]
 v_min_u32 v150, 15, v1
 v_lshlrev_b32 v150, 2, v150
 v_mfma_f32_16x16x32_bf16 a[204:207], v[96:99], v[104:107], a[204:207]
 s_add_u32 m0, s8, 0xc000
 s_add_u32 s11, s38, 0xc0000
 v_mfma_f32_16x16x32_bf16 a[208:211], v[92:95], v[108:111], a[208:211]
 buffer_load_dwordx4 v140, s[20:23], s11 offen offset:0 lds
 v_mfma_f32_16x16x32_bf16 a[212:215], v[96:99], v[108:111], a[212:215]
 v_mfma_f32_16x16x32_bf16 a[216:219], v[92:95], v[112:115], a[216:219]
 v_accvgpr_read_b32 v216, a192
 v_mfma_f32_16x16x32_bf16 a[220:223], v[96:99], v[112:115], a[220:223]
 v_accvgpr_read_b32 v217, a193
 v_accvgpr_read_b32 v218, a194
 v_mfma_f32_16x16x32_bf16 a[224:227], v[92:95], v[116:119], a[224:227]
 v_accvgpr_read_b32 v219, a195
 v_accvgpr_read_b32 v220, a196
 v_mfma_f32_16x16x32_bf16 a[228:231], v[96:99], v[116:119], a[228:231]
 v_accvgpr_read_b32 v221, a197
 v_accvgpr_read_b32 v222, a198
 v_mfma_f32_16x16x32_bf16 a[232:235], v[92:95], v[120:123], a[232:235]
 v_accvgpr_read_b32 v223, a199
 v_cvt_pk_bf16_f32 v224, v216, v217
 v_mfma_f32_16x16x32_bf16 a[236:239], v[96:99], v[120:123], a[236:239]
 v_cvt_pk_bf16_f32 v225, v218, v219
 v_cvt_pk_bf16_f32 v226, v220, v221
 v_mfma_f32_16x16x32_bf16 a[240:243], v[92:95], v[124:127], a[240:243]
 buffer_load_dwordx4 v141, s[20:23], s11 offen offset:1024 lds
 v_mfma_f32_16x16x32_bf16 a[244:247], v[96:99], v[124:127], a[244:247]
 v_cvt_pk_bf16_f32 v227, v222, v223
 s_add_u32 s33, s35, 49152
 v_mfma_f32_16x16x32_bf16 a[248:251], v[92:95], v[128:131], a[248:251]
 buffer_store_dwordx4 v[224:227], v2, s[4:7], s33 offen offset:0 sc1
 v_mfma_f32_16x16x32_bf16 a[252:255], v[96:99], v[128:131], a[252:255]
 v_accvgpr_read_b32 v216, a200
 v_accvgpr_read_b32 v217, a201
 v_mfma_f32_16x16x32_bf16 a[0:3], v[68:71], v[100:103], a[0:3]
 v_accvgpr_read_b32 v218, a202
 v_accvgpr_read_b32 v219, a203
 v_mfma_f32_16x16x32_bf16 a[4:7], v[72:75], v[100:103], a[4:7]
 v_accvgpr_read_b32 v220, a204
 v_accvgpr_read_b32 v221, a205
 v_mfma_f32_16x16x32_bf16 a[8:11], v[68:71], v[104:107], a[8:11]
 v_accvgpr_read_b32 v222, a206
 v_accvgpr_read_b32 v223, a207
 v_mfma_f32_16x16x32_bf16 a[12:15], v[72:75], v[104:107], a[12:15]
 v_cvt_pk_bf16_f32 v228, v216, v217
 v_cvt_pk_bf16_f32 v229, v218, v219
 v_mfma_f32_16x16x32_bf16 a[16:19], v[68:71], v[108:111], a[16:19]
 buffer_load_dwordx4 v142, s[20:23], s11 offen offset:2048 lds
 v_mfma_f32_16x16x32_bf16 a[20:23], v[72:75], v[108:111], a[20:23]
 v_cvt_pk_bf16_f32 v230, v220, v221
 v_cvt_pk_bf16_f32 v231, v222, v223
 v_mfma_f32_16x16x32_bf16 a[24:27], v[68:71], v[112:115], a[24:27]
 buffer_store_dwordx4 v[228:231], v2, s[4:7], s33 offen offset:1024 sc1
 v_mfma_f32_16x16x32_bf16 a[28:31], v[72:75], v[112:115], a[28:31]
 v_accvgpr_read_b32 v216, a208
 v_accvgpr_read_b32 v217, a209
 v_mfma_f32_16x16x32_bf16 a[32:35], v[68:71], v[116:119], a[32:35]
 v_accvgpr_read_b32 v218, a210
 v_accvgpr_read_b32 v219, a211
 v_mfma_f32_16x16x32_bf16 a[36:39], v[72:75], v[116:119], a[36:39]
 v_accvgpr_read_b32 v220, a212
 v_accvgpr_read_b32 v221, a213
 v_mfma_f32_16x16x32_bf16 a[40:43], v[68:71], v[120:123], a[40:43]
 v_accvgpr_read_b32 v222, a214
 v_accvgpr_read_b32 v223, a215
 v_mfma_f32_16x16x32_bf16 a[44:47], v[72:75], v[120:123], a[44:47]
 v_cvt_pk_bf16_f32 v224, v216, v217
 v_cvt_pk_bf16_f32 v225, v218, v219
 v_mfma_f32_16x16x32_bf16 a[48:51], v[68:71], v[124:127], a[48:51]
 buffer_load_dwordx4 v143, s[20:23], s11 offen offset:3072 lds
 v_mfma_f32_16x16x32_bf16 a[52:55], v[72:75], v[124:127], a[52:55]
 v_cvt_pk_bf16_f32 v226, v220, v221
 v_cvt_pk_bf16_f32 v227, v222, v223
 v_mfma_f32_16x16x32_bf16 a[56:59], v[68:71], v[128:131], a[56:59]
 buffer_store_dwordx4 v[224:227], v2, s[4:7], s33 offen offset:2048 sc1
 v_mfma_f32_16x16x32_bf16 a[60:63], v[72:75], v[128:131], a[60:63]
 s_add_u32 m0, s8, 0x10000
 v_accvgpr_read_b32 v216, a216
 v_mfma_f32_16x16x32_bf16 a[64:67], v[76:79], v[100:103], a[64:67]
 v_accvgpr_read_b32 v217, a217
 v_accvgpr_read_b32 v218, a218
 v_mfma_f32_16x16x32_bf16 a[68:71], v[80:83], v[100:103], a[68:71]
 v_accvgpr_read_b32 v219, a219
 s_add_u32 s11, s38, 0x200000
 v_mfma_f32_16x16x32_bf16 a[72:75], v[76:79], v[104:107], a[72:75]
 v_accvgpr_read_b32 v220, a220
 v_accvgpr_read_b32 v221, a221
 v_mfma_f32_16x16x32_bf16 a[76:79], v[80:83], v[104:107], a[76:79]
 v_accvgpr_read_b32 v222, a222
 v_accvgpr_read_b32 v223, a223
 v_mfma_f32_16x16x32_bf16 a[80:83], v[76:79], v[108:111], a[80:83]
 buffer_load_dwordx4 v140, s[20:23], s11 offen offset:0 lds
 v_mfma_f32_16x16x32_bf16 a[84:87], v[80:83], v[108:111], a[84:87]
 v_cvt_pk_bf16_f32 v228, v216, v217
 v_cvt_pk_bf16_f32 v229, v218, v219
 v_mfma_f32_16x16x32_bf16 a[88:91], v[76:79], v[112:115], a[88:91]
 v_cvt_pk_bf16_f32 v230, v220, v221
 v_cvt_pk_bf16_f32 v231, v222, v223
 v_mfma_f32_16x16x32_bf16 a[92:95], v[80:83], v[112:115], a[92:95]
 buffer_store_dwordx4 v[228:231], v2, s[4:7], s33 offen offset:3072 sc1
 v_mfma_f32_16x16x32_bf16 a[96:99], v[76:79], v[116:119], a[96:99]
 v_accvgpr_read_b32 v216, a224
 v_accvgpr_read_b32 v217, a225
 v_mfma_f32_16x16x32_bf16 a[100:103], v[80:83], v[116:119], a[100:103]
 v_accvgpr_read_b32 v218, a226
 v_accvgpr_read_b32 v219, a227
 v_mfma_f32_16x16x32_bf16 a[104:107], v[76:79], v[120:123], a[104:107]
 v_accvgpr_read_b32 v220, a228
 v_accvgpr_read_b32 v221, a229
 v_mfma_f32_16x16x32_bf16 a[108:111], v[80:83], v[120:123], a[108:111]
 v_accvgpr_read_b32 v222, a230
 v_accvgpr_read_b32 v223, a231
 v_mfma_f32_16x16x32_bf16 a[112:115], v[76:79], v[124:127], a[112:115]
 buffer_load_dwordx4 v141, s[20:23], s11 offen offset:1024 lds
 v_mfma_f32_16x16x32_bf16 a[116:119], v[80:83], v[124:127], a[116:119]
 v_cvt_pk_bf16_f32 v224, v216, v217
 v_cvt_pk_bf16_f32 v225, v218, v219
 v_mfma_f32_16x16x32_bf16 a[120:123], v[76:79], v[128:131], a[120:123]
 v_cvt_pk_bf16_f32 v226, v220, v221
 v_cvt_pk_bf16_f32 v227, v222, v223
 v_mfma_f32_16x16x32_bf16 a[124:127], v[80:83], v[128:131], a[124:127]
 s_add_u32 s33, s36, 49152
 v_mfma_f32_16x16x32_bf16 a[128:131], v[84:87], v[100:103], a[128:131]
 buffer_store_dwordx4 v[224:227], v2, s[4:7], s33 offen offset:0 sc1
 v_mfma_f32_16x16x32_bf16 a[132:135], v[88:91], v[100:103], a[132:135]
 v_accvgpr_read_b32 v216, a232
 v_accvgpr_read_b32 v217, a233
 v_mfma_f32_16x16x32_bf16 a[136:139], v[84:87], v[104:107], a[136:139]
 v_accvgpr_read_b32 v218, a234
 v_accvgpr_read_b32 v219, a235
 v_mfma_f32_16x16x32_bf16 a[140:143], v[88:91], v[104:107], a[140:143]
 v_accvgpr_read_b32 v220, a236
 v_accvgpr_read_b32 v221, a237
 v_mfma_f32_16x16x32_bf16 a[144:147], v[84:87], v[108:111], a[144:147]
 v_accvgpr_read_b32 v222, a238
 v_accvgpr_read_b32 v223, a239
 v_mfma_f32_16x16x32_bf16 a[148:151], v[88:91], v[108:111], a[148:151]
 buffer_load_dwordx4 v142, s[20:23], s11 offen offset:2048 lds
 v_mfma_f32_16x16x32_bf16 a[152:155], v[84:87], v[112:115], a[152:155]
 v_cvt_pk_bf16_f32 v228, v216, v217
 v_cvt_pk_bf16_f32 v229, v218, v219
 v_mfma_f32_16x16x32_bf16 a[156:159], v[88:91], v[112:115], a[156:159]
 v_cvt_pk_bf16_f32 v230, v220, v221
 v_cvt_pk_bf16_f32 v231, v222, v223
 v_mfma_f32_16x16x32_bf16 a[160:163], v[84:87], v[116:119], a[160:163]
 buffer_store_dwordx4 v[228:231], v2, s[4:7], s33 offen offset:1024 sc1
 v_mfma_f32_16x16x32_bf16 a[164:167], v[88:91], v[116:119], a[164:167]
 v_accvgpr_read_b32 v216, a240
 v_accvgpr_read_b32 v217, a241
 v_mfma_f32_16x16x32_bf16 a[168:171], v[84:87], v[120:123], a[168:171]
 v_accvgpr_read_b32 v218, a242
 v_accvgpr_read_b32 v219, a243
 v_mfma_f32_16x16x32_bf16 a[172:175], v[88:91], v[120:123], a[172:175]
 v_accvgpr_read_b32 v220, a244
 v_accvgpr_read_b32 v221, a245
 v_mfma_f32_16x16x32_bf16 a[176:179], v[84:87], v[124:127], a[176:179]
 v_accvgpr_read_b32 v222, a246
 v_accvgpr_read_b32 v223, a247
 v_mfma_f32_16x16x32_bf16 a[180:183], v[88:91], v[124:127], a[180:183]
 buffer_load_dwordx4 v143, s[20:23], s11 offen offset:3072 lds
 v_mfma_f32_16x16x32_bf16 a[184:187], v[84:87], v[128:131], a[184:187]
 s_mov_b32 s56, s52
 s_mov_b32 s57, s53
 s_and_b32 s9, s2, 7
 s_lshl_b32 s67, s9, 1
 s_bfe_u32 s9, s2, 0x10003
 s_add_u32 s67, s67, s9
 s_bfe_u32 s68, s2, 0x30004
 s_lshl_b32 s70, s67, 3
 s_add_u32 s70, s70, s68
 s_lshl_b32 s70, s70, 2
 s_add_u32 s70, s70, s3
 s_mul_i32 s9, s67, 1048576
 s_add_u32 s48, s4, s9
 s_addc_u32 s49, s5, 0
 s_add_u32 s52, s48, 0x1200000
 s_addc_u32 s53, s49, 0
 s_mov_b32 s51, 0x20000
 s_mov_b32 s55, 0x20000
 v_add_u32 v154, s8, v2
 s_lshl_b32 s9, s68, 2
 s_sub_u32 s10, 64, s9
 s_add_u32 s11, s9, 4
 s_sub_u32 s62, 15, s68
 s_cmp_gt_u32 s10, 40
 s_cselect_b32 s69, 1, 0
 s_cselect_b32 s63, 40, 0
 s_cselect_b32 s11, s10, s11
 s_cselect_b32 s10, 40, s10
 s_cselect_b32 s9, s62, s68
 s_xor_b32 s66, s69, 1
 s_lshl_b32 s65, s69, 1
 s_bitcmp1_b32 s2, 7
 s_cselect_b32 s64, s10, s11
 s_cselect_b32 s63, 0, s63
 s_cselect_b32 s62, s62, s9
 s_cselect_b32 s66, s66, 1
 s_cselect_b32 s65, s65, s69
 s_cselect_b32 s69, 0, s69
 s_mul_i32 s50, s64, 16384
 s_mov_b32 s54, s50
 s_mul_i32 s60, s63, 16384
 s_mov_b32 s61, s60
 v_mfma_f32_16x16x32_bf16 a[188:191], v[88:91], v[128:131], a[188:191]
 v_cvt_pk_bf16_f32 v224, v216, v217
 v_cvt_pk_bf16_f32 v225, v218, v219
 v_cvt_pk_bf16_f32 v226, v220, v221
 v_cvt_pk_bf16_f32 v227, v222, v223
 buffer_store_dwordx4 v[224:227], v2, s[4:7], s33 offen offset:2048 sc1
 v_accvgpr_read_b32 v216, a248
 v_accvgpr_read_b32 v217, a249
 v_accvgpr_read_b32 v218, a250
 v_accvgpr_read_b32 v219, a251
 v_accvgpr_read_b32 v220, a252
 v_accvgpr_read_b32 v221, a253
 v_accvgpr_read_b32 v222, a254
 v_accvgpr_read_b32 v223, a255
 v_cvt_pk_bf16_f32 v228, v216, v217
 v_cvt_pk_bf16_f32 v229, v218, v219
 v_cvt_pk_bf16_f32 v230, v220, v221
 v_cvt_pk_bf16_f32 v231, v222, v223
 buffer_store_dwordx4 v[228:231], v2, s[4:7], s33 offen offset:3072 sc1
L1_tail:
 s_waitcnt vmcnt(26) lgkmcnt(0)
 s_barrier
 s_add_u32 m0, s8, 0x14000
 s_add_u32 s11, s38, 0x240000
 buffer_load_dwordx4 v140, s[20:23], s11 offen offset:0 lds
 buffer_load_dwordx4 v141, s[20:23], s11 offen offset:1024 lds
 buffer_load_dwordx4 v142, s[20:23], s11 offen offset:2048 lds
 buffer_load_dwordx4 v143, s[20:23], s11 offen offset:3072 lds
 s_load_dwordx2 s[12:13], s[0:1], 56
 s_load_dwordx2 s[14:15], s[0:1], 64
 s_load_dwordx2 s[16:17], s[0:1], 72
 s_getpc_b64 s[24:25]
L_ct3:
 s_sub_u32 s24, s24, L_ct3-L_begin
 s_subb_u32 s25, s25, 0
 s_and_b32 s25, s25, 0xffff
 s_mov_b32 s26, L_last-L_begin
 s_mov_b32 s27, 0x20000
 s_lshr_b32 s28, s2, 3
 s_lshl_b32 s28, s28, 2
 s_add_u32 s28, s28, s3
 s_lshl_b32 s28, s28, 10
 s_waitcnt lgkmcnt(0)
 s_cmp_eq_u32 s3, 1
 s_cselect_b32 s12, s14, s12
 s_cselect_b32 s13, s15, s13
 s_cmp_eq_u32 s3, 2
 s_cselect_b32 s12, s16, s12
 s_cselect_b32 s13, s17, s13
 s_and_b32 s13, s13, 0xffff
 s_mul_i32 s9, s2, 12544
 s_add_u32 s10, s9, 12544
 s_lshr_b32 s11, s2, 7
 s_lshl_b32 s11, s11, 2
 s_add_u32 s11, s11, s3
 s_cmp_lt_u32 s11, 3
 s_cselect_b32 s24, s12, s24
 s_cselect_b32 s25, s13, s25
 s_cselect_b32 s26, s10, s26
 s_cselect_b32 s28, s9, s28
 s_cselect_b32 s29, 1, 64
 s_cselect_b32 s18, -1, 0x1ffff
 s_lshl_b32 s29, s29, 10
 s_mov_b32 s47, 0
 s_lshl_b32 s43, s70, 14
 s_add_u32 s43, s43, 0x2400000
 s_lshr_b32 s30, s70, 2
 s_lshl_b32 s30, s30, 7
 s_lshl_b32 s9, s3, 2
 s_add_u32 s30, s30, s9
 s_add_u32 s30, s30, 0x5300800
 s_cmp_eq_u32 s65, 2
 s_cselect_b32 s41, s43, 0x40000000
 s_cselect_b32 s47, 3, 0
 s_add_u32 s45, s41, 0x1000
 s_add_u32 s46, s41, 0x2000
 s_add_u32 s31, s41, 0x3000
 v_add_u32 v164, 0x10000, v2
 v_and_b32 v158, 15, v1
 v_lshrrev_b32 v152, 4, v1
 v_lshlrev_b32 v159, 2, v152
 v_sub_u32 v158, v158, v159
 s_lshl_b32 s9, s3, 5
 v_add_u32 v160, s9, v158
 v_subrev_u32 v161, 32, v160
 v_subrev_u32 v162, 64, v160
 v_subrev_u32 v163, 96, v160
 v_mov_b32 v165, 0xff800000
 v_mov_b32 v132, 0x3f803f80
 v_mov_b32 v133, 0x3f803f80
 v_mov_b32 v134, 0x3f803f80
 v_mov_b32 v135, 0x3f803f80
 s_mov_b32 s42, 0x4e800000
 v_lshrrev_b32 v156, 5, v1
 v_bfe_u32 v157, v1, 2, 2
 v_lshl_add_u32 v158, v156, 2, v157
 v_mul_u32_u24 v158, 896, v158
 v_bfe_u32 v153, v1, 4, 1
 v_lshl_add_u32 v158, v153, 6, v158
 v_lshlrev_b32 v156, 1, v156
 v_and_b32 v159, 3, v1
 v_xor_b32 v156, v156, v159
 v_lshl_add_u32 v136, v156, 4, v158
 v_add_u32 v137, 6144, v136
 v_add_u32 v138, 12288, v136
 v_add_u32 v139, 18432, v136
 v_lshlrev_b32 v156, 9, v152
 v_lshl_add_u32 v156, v157, 6, v156
 v_lshl_add_u32 v156, v153, 5, v156
 v_lshl_add_u32 v166, v159, 3, v156
 v_xor_b32 v167, 32, v166
 s_and_b32 s57, s57, 0xffff
 s_mov_b32 s58, 0x380000
 s_mov_b32 s59, 0x20000
 s_lshl_b32 s9, s67, 2
 s_add_u32 s9, s9, s3
 s_mul_i32 s44, s9, 57344
 v_add_u32 v156, 0x0, v146
 v_add_u32 v157, 0x0, v147
 ds_read_b64_tr_b16 a[192:193], v156 offset:0
 ds_read_b64_tr_b16 a[194:195], v156 offset:2048
 ds_read_b64_tr_b16 a[196:197], v157 offset:0
 ds_read_b64_tr_b16 a[198:199], v157 offset:2048
 ds_read_b64_tr_b16 a[200:201], v156 offset:256
 ds_read_b64_tr_b16 a[202:203], v156 offset:2304
 ds_read_b64_tr_b16 a[204:205], v157 offset:256
 ds_read_b64_tr_b16 a[206:207], v157 offset:2304
 ds_read_b64_tr_b16 a[208:209], v156 offset:512
 ds_read_b64_tr_b16 a[210:211], v156 offset:2560
 ds_read_b64_tr_b16 a[212:213], v157 offset:512
 ds_read_b64_tr_b16 a[214:215], v157 offset:2560
 ds_read_b64_tr_b16 a[216:217], v156 offset:768
 ds_read_b64_tr_b16 a[218:219], v156 offset:2816
 ds_read_b64_tr_b16 a[220:221], v157 offset:768
 ds_read_b64_tr_b16 a[222:223], v157 offset:2816
 ds_read_b64_tr_b16 a[224:225], v156 offset:1024
 ds_read_b64_tr_b16 a[226:227], v156 offset:3072
 ds_read_b64_tr_b16 a[228:229], v157 offset:1024
 ds_read_b64_tr_b16 a[230:231], v157 offset:3072
 ds_read_b64_tr_b16 a[232:233], v156 offset:1280
 ds_read_b64_tr_b16 a[234:235], v156 offset:3328
 ds_read_b64_tr_b16 a[236:237], v157 offset:1280
 ds_read_b64_tr_b16 a[238:239], v157 offset:3328
 ds_read_b64_tr_b16 a[240:241], v156 offset:1536
 ds_read_b64_tr_b16 a[242:243], v156 offset:3584
 ds_read_b64_tr_b16 a[244:245], v157 offset:1536
 ds_read_b64_tr_b16 a[246:247], v157 offset:3584
 ds_read_b64_tr_b16 a[248:249], v156 offset:1792
 ds_read_b64_tr_b16 a[250:251], v156 offset:3840
 ds_read_b64_tr_b16 a[252:253], v157 offset:1792
 ds_read_b64_tr_b16 a[254:255], v157 offset:3840
 v_accvgpr_read_b32 v216, a152
 v_accvgpr_read_b32 v217, a153
 v_accvgpr_read_b32 v218, a154
 v_accvgpr_read_b32 v219, a155
 v_accvgpr_read_b32 v220, a156
 v_accvgpr_read_b32 v221, a157
 v_accvgpr_read_b32 v222, a158
 v_accvgpr_read_b32 v223, a159
 v_cvt_pk_bf16_f32 v228, v216, v217
 v_cvt_pk_bf16_f32 v229, v218, v219
 v_cvt_pk_bf16_f32 v230, v220, v221
 v_cvt_pk_bf16_f32 v231, v222, v223
 s_add_u32 s33, s35, 32768
 buffer_store_dwordx4 v[228:231], v2, s[4:7], s33 offen offset:3072 sc1
 v_accvgpr_read_b32 v216, a160
 v_accvgpr_read_b32 v217, a161
 v_accvgpr_read_b32 v218, a162
 v_accvgpr_read_b32 v219, a163
 v_accvgpr_read_b32 v220, a164
 v_accvgpr_read_b32 v221, a165
 v_accvgpr_read_b32 v222, a166
 v_accvgpr_read_b32 v223, a167
 v_cvt_pk_bf16_f32 v224, v216, v217
 v_cvt_pk_bf16_f32 v225, v218, v219
 v_cvt_pk_bf16_f32 v226, v220, v221
 v_cvt_pk_bf16_f32 v227, v222, v223
 s_add_u32 s33, s36, 32768
 buffer_store_dwordx4 v[224:227], v2, s[4:7], s33 offen offset:0 sc1
 v_accvgpr_read_b32 v216, a168
 v_accvgpr_read_b32 v217, a169
 v_accvgpr_read_b32 v218, a170
 v_accvgpr_read_b32 v219, a171
 v_accvgpr_read_b32 v220, a172
 v_accvgpr_read_b32 v221, a173
 v_accvgpr_read_b32 v222, a174
 v_accvgpr_read_b32 v223, a175
 v_cvt_pk_bf16_f32 v228, v216, v217
 v_cvt_pk_bf16_f32 v229, v218, v219
 v_cvt_pk_bf16_f32 v230, v220, v221
 v_cvt_pk_bf16_f32 v231, v222, v223
 buffer_store_dwordx4 v[228:231], v2, s[4:7], s33 offen offset:1024 sc1
 v_accvgpr_read_b32 v216, a176
 v_accvgpr_read_b32 v217, a177
 v_accvgpr_read_b32 v218, a178
 v_accvgpr_read_b32 v219, a179
 v_accvgpr_read_b32 v220, a180
 v_accvgpr_read_b32 v221, a181
 v_accvgpr_read_b32 v222, a182
 v_accvgpr_read_b32 v223, a183
 v_cvt_pk_bf16_f32 v224, v216, v217
 v_cvt_pk_bf16_f32 v225, v218, v219
 v_cvt_pk_bf16_f32 v226, v220, v221
 v_cvt_pk_bf16_f32 v227, v222, v223
 buffer_store_dwordx4 v[224:227], v2, s[4:7], s33 offen offset:2048 sc1
 v_accvgpr_read_b32 v216, a184
 v_accvgpr_read_b32 v217, a185
 v_accvgpr_read_b32 v218, a186
 v_accvgpr_read_b32 v219, a187
 v_accvgpr_read_b32 v220, a188
 v_accvgpr_read_b32 v221, a189
 v_accvgpr_read_b32 v222, a190
 v_accvgpr_read_b32 v223, a191
 v_cvt_pk_bf16_f32 v228, v216, v217
 v_cvt_pk_bf16_f32 v229, v218, v219
 v_cvt_pk_bf16_f32 v230, v220, v221
 v_cvt_pk_bf16_f32 v231, v222, v223
 buffer_store_dwordx4 v[228:231], v2, s[4:7], s33 offen offset:3072 sc1
 v_accvgpr_read_b32 v216, a128
 v_accvgpr_read_b32 v217, a129
 v_accvgpr_read_b32 v218, a130
 v_accvgpr_read_b32 v219, a131
 v_accvgpr_read_b32 v220, a132
 v_accvgpr_read_b32 v221, a133
 v_accvgpr_read_b32 v222, a134
 v_accvgpr_read_b32 v223, a135
 v_cvt_pk_bf16_f32 v224, v216, v217
 v_cvt_pk_bf16_f32 v225, v218, v219
 v_cvt_pk_bf16_f32 v226, v220, v221
 v_cvt_pk_bf16_f32 v227, v222, v223
 s_add_u32 s33, s35, 32768
 buffer_store_dwordx4 v[224:227], v2, s[4:7], s33 offen offset:0 sc1
 v_accvgpr_write_b32 a128, 0
 v_accvgpr_write_b32 a129, 0
 v_accvgpr_write_b32 a130, 0
 v_accvgpr_write_b32 a131, 0
 v_accvgpr_read_b32 v216, a136
 v_accvgpr_read_b32 v217, a137
 v_accvgpr_read_b32 v218, a138
 v_accvgpr_read_b32 v219, a139
 v_accvgpr_read_b32 v220, a140
 v_accvgpr_read_b32 v221, a141
 v_accvgpr_read_b32 v222, a142
 v_accvgpr_read_b32 v223, a143
 v_cvt_pk_bf16_f32 v228, v216, v217
 v_cvt_pk_bf16_f32 v229, v218, v219
 v_cvt_pk_bf16_f32 v230, v220, v221
 v_cvt_pk_bf16_f32 v231, v222, v223
 buffer_store_dwordx4 v[228:231], v2, s[4:7], s33 offen offset:1024 sc1
 v_accvgpr_read_b32 v216, a144
 v_accvgpr_read_b32 v217, a145
 v_accvgpr_read_b32 v218, a146
 v_accvgpr_read_b32 v219, a147
 v_accvgpr_read_b32 v220, a148
 v_accvgpr_read_b32 v221, a149
 v_accvgpr_read_b32 v222, a150
 v_accvgpr_read_b32 v223, a151
 v_cvt_pk_bf16_f32 v224, v216, v217
 v_cvt_pk_bf16_f32 v225, v218, v219
 v_cvt_pk_bf16_f32 v226, v220, v221
 v_cvt_pk_bf16_f32 v227, v222, v223
 buffer_store_dwordx4 v[224:227], v2, s[4:7], s33 offen offset:2048 sc1
 s_waitcnt lgkmcnt(0)
 v_mfma_f32_16x16x32_bf16 v[4:7], a[192:195], v[168:171], 0
 v_accvgpr_read_b32 v216, a0
 v_mfma_f32_16x16x32_bf16 v[8:11], a[192:195], v[172:175], 0
 v_add_u32 v158, 0x4000, v146
 v_add_u32 v159, 0x4000, v147
 v_mfma_f32_16x16x32_bf16 v[12:15], a[196:199], v[168:171], 0
 ds_read_b64_tr_b16 a[192:193], v158 offset:0
 v_accvgpr_read_b32 v217, a1
 v_mfma_f32_16x16x32_bf16 v[16:19], a[196:199], v[172:175], 0
 ds_read_b64_tr_b16 a[194:195], v158 offset:2048
 v_accvgpr_read_b32 v218, a2
 v_mfma_f32_16x16x32_bf16 v[20:23], a[200:203], v[168:171], 0
 ds_read_b64_tr_b16 a[196:197], v159 offset:0
 v_accvgpr_read_b32 v219, a3
 v_mfma_f32_16x16x32_bf16 v[24:27], a[200:203], v[172:175], 0
 ds_read_b64_tr_b16 a[198:199], v159 offset:2048
 v_accvgpr_read_b32 v220, a4
 v_mfma_f32_16x16x32_bf16 v[28:31], a[204:207], v[168:171], 0
 ds_read_b64_tr_b16 a[200:201], v158 offset:256
 v_accvgpr_read_b32 v221, a5
 v_mfma_f32_16x16x32_bf16 v[32:35], a[204:207], v[172:175], 0
 ds_read_b64_tr_b16 a[202:203], v158 offset:2304
 v_accvgpr_read_b32 v222, a6
 v_mfma_f32_16x16x32_bf16 v[36:39], a[208:211], v[168:171], 0
 ds_read_b64_tr_b16 a[204:205], v159 offset:256
 v_accvgpr_read_b32 v223, a7
 v_mfma_f32_16x16x32_bf16 v[40:43], a[208:211], v[172:175], 0
 ds_read_b64_tr_b16 a[206:207], v159 offset:2304
 v_cvt_pk_bf16_f32 v224, v216, v217
 v_mfma_f32_16x16x32_bf16 v[44:47], a[212:215], v[168:171], 0
 ds_read_b64_tr_b16 a[208:209], v158 offset:512
 v_cvt_pk_bf16_f32 v225, v218, v219
 v_mfma_f32_16x16x32_bf16 v[48:51], a[212:215], v[172:175], 0
 ds_read_b64_tr_b16 a[210:211], v158 offset:2560
 v_cvt_pk_bf16_f32 v226, v220, v221
 v_mfma_f32_16x16x32_bf16 v[52:55], a[216:219], v[168:171], 0
 ds_read_b64_tr_b16 a[212:213], v159 offset:512
 v_cvt_pk_bf16_f32 v227, v222, v223
 v_mfma_f32_16x16x32_bf16 v[56:59], a[216:219], v[172:175], 0
 ds_read_b64_tr_b16 a[214:215], v159 offset:2560
 s_add_u32 s33, s35, 0
 v_mfma_f32_16x16x32_bf16 v[60:63], a[220:223], v[168:171], 0
 ds_read_b64_tr_b16 a[216:217], v158 offset:768
 v_mfma_f32_16x16x32_bf16 v[64:67], a[220:223], v[172:175], 0
 buffer_store_dwordx4 v[224:227], v2, s[4:7], s33 offen offset:0 sc1
 v_mfma_f32_16x16x32_bf16 v[68:71], a[224:227], v[168:171], 0
 ds_read_b64_tr_b16 a[218:219], v158 offset:2816
 v_accvgpr_read_b32 v216, a8
 v_mfma_f32_16x16x32_bf16 v[72:75], a[224:227], v[172:175], 0
 ds_read_b64_tr_b16 a[220:221], v159 offset:768
 v_accvgpr_read_b32 v217, a9
 v_mfma_f32_16x16x32_bf16 v[76:79], a[228:231], v[168:171], 0
 ds_read_b64_tr_b16 a[222:223], v159 offset:2816
 v_accvgpr_read_b32 v218, a10
 v_mfma_f32_16x16x32_bf16 v[80:83], a[228:231], v[172:175], 0
 ds_read_b64_tr_b16 a[224:225], v158 offset:1024
 v_accvgpr_read_b32 v219, a11
 v_mfma_f32_16x16x32_bf16 v[84:87], a[232:235], v[168:171], 0
 ds_read_b64_tr_b16 a[226:227], v158 offset:3072
 v_accvgpr_read_b32 v220, a12
 v_mfma_f32_16x16x32_bf16 v[88:91], a[232:235], v[172:175], 0
 ds_read_b64_tr_b16 a[228:229], v159 offset:1024
 v_accvgpr_read_b32 v221, a13
 v_mfma_f32_16x16x32_bf16 v[92:95], a[236:239], v[168:171], 0
 ds_read_b64_tr_b16 a[230:231], v159 offset:3072
 v_accvgpr_read_b32 v222, a14
 v_mfma_f32_16x16x32_bf16 v[96:99], a[236:239], v[172:175], 0
 ds_read_b64_tr_b16 a[232:233], v158 offset:1280
 v_accvgpr_read_b32 v223, a15
 v_mfma_f32_16x16x32_bf16 v[100:103], a[240:243], v[168:171], 0
 ds_read_b64_tr_b16 a[234:235], v158 offset:3328
 v_cvt_pk_bf16_f32 v228, v216, v217
 v_mfma_f32_16x16x32_bf16 v[104:107], a[240:243], v[172:175], 0
 ds_read_b64_tr_b16 a[236:237], v159 offset:1280
 v_cvt_pk_bf16_f32 v229, v218, v219
 v_mfma_f32_16x16x32_bf16 v[108:111], a[244:247], v[168:171], 0
 ds_read_b64_tr_b16 a[238:239], v159 offset:3328
 v_cvt_pk_bf16_f32 v230, v220, v221
 v_mfma_f32_16x16x32_bf16 v[112:115], a[244:247], v[172:175], 0
 ds_read_b64_tr_b16 a[240:241], v158 offset:1536
 v_cvt_pk_bf16_f32 v231, v222, v223
 v_mfma_f32_16x16x32_bf16 v[116:119], a[248:251], v[168:171], 0
 ds_read_b64_tr_b16 a[242:243], v158 offset:3584
 v_mfma_f32_16x16x32_bf16 v[120:123], a[248:251], v[172:175], 0
 buffer_store_dwordx4 v[228:231], v2, s[4:7], s33 offen offset:1024 sc1
 v_mfma_f32_16x16x32_bf16 v[124:127], a[252:255], v[168:171], 0
 ds_read_b64_tr_b16 a[244:245], v159 offset:1536
 v_mfma_f32_32x32x16_bf16 a[0:15], a[128:131], a[128:131], 0
 v_mfma_f32_16x16x32_bf16 v[128:131], a[252:255], v[172:175], 0
 ds_read_b64_tr_b16 a[246:247], v159 offset:3584
 v_accvgpr_read_b32 v216, a16
 s_waitcnt lgkmcnt(6)
 v_mfma_f32_16x16x32_bf16 v[4:7], a[192:195], v[176:179], v[4:7]
 ds_read_b64_tr_b16 a[248:249], v158 offset:1792
 v_accvgpr_read_b32 v217, a17
 v_mfma_f32_16x16x32_bf16 v[8:11], a[192:195], v[180:183], v[8:11]
 ds_read_b64_tr_b16 a[250:251], v158 offset:3840
 v_accvgpr_read_b32 v218, a18
 v_mfma_f32_16x16x32_bf16 v[12:15], a[196:199], v[176:179], v[12:15]
 ds_read_b64_tr_b16 a[252:253], v159 offset:1792
 v_accvgpr_read_b32 v219, a19
 v_mfma_f32_16x16x32_bf16 v[16:19], a[196:199], v[180:183], v[16:19]
 ds_read_b64_tr_b16 a[254:255], v159 offset:3840
 v_accvgpr_read_b32 v220, a20
 v_mfma_f32_16x16x32_bf16 v[20:23], a[200:203], v[176:179], v[20:23]
 v_add_u32 v156, 0x8000, v146
 v_add_u32 v157, 0x8000, v147
 v_mfma_f32_16x16x32_bf16 v[24:27], a[200:203], v[180:183], v[24:27]
 ds_read_b64_tr_b16 a[192:193], v156 offset:0
 v_accvgpr_read_b32 v221, a21
 v_mfma_f32_16x16x32_bf16 v[28:31], a[204:207], v[176:179], v[28:31]
 ds_read_b64_tr_b16 a[194:195], v156 offset:2048
 v_accvgpr_read_b32 v222, a22
 v_mfma_f32_16x16x32_bf16 v[32:35], a[204:207], v[180:183], v[32:35]
 ds_read_b64_tr_b16 a[196:197], v157 offset:0
 v_accvgpr_read_b32 v223, a23
 v_mfma_f32_16x16x32_bf16 v[36:39], a[208:211], v[176:179], v[36:39]
 ds_read_b64_tr_b16 a[198:199], v157 offset:2048
 v_cvt_pk_bf16_f32 v224, v216, v217
 v_mfma_f32_16x16x32_bf16 v[40:43], a[208:211], v[180:183], v[40:43]
 ds_read_b64_tr_b16 a[200:201], v156 offset:256
 v_cvt_pk_bf16_f32 v225, v218, v219
 v_mfma_f32_16x16x32_bf16 v[44:47], a[212:215], v[176:179], v[44:47]
 ds_read_b64_tr_b16 a[202:203], v156 offset:2304
 v_cvt_pk_bf16_f32 v226, v220, v221
 v_mfma_f32_16x16x32_bf16 v[48:51], a[212:215], v[180:183], v[48:51]
 ds_read_b64_tr_b16 a[204:205], v157 offset:256
 v_cvt_pk_bf16_f32 v227, v222, v223
 v_mfma_f32_16x16x32_bf16 v[52:55], a[216:219], v[176:179], v[52:55]
 ds_read_b64_tr_b16 a[206:207], v157 offset:2304
 v_mfma_f32_16x16x32_bf16 v[56:59], a[216:219], v[180:183], v[56:59]
 buffer_store_dwordx4 v[224:227], v2, s[4:7], s33 offen offset:2048 sc1
 v_mfma_f32_16x16x32_bf16 v[60:63], a[220:223], v[176:179], v[60:63]
 ds_read_b64_tr_b16 a[208:209], v156 offset:512
 v_accvgpr_read_b32 v216, a24
 v_mfma_f32_16x16x32_bf16 v[64:67], a[220:223], v[180:183], v[64:67]
 ds_read_b64_tr_b16 a[210:211], v156 offset:2560
 v_accvgpr_read_b32 v217, a25
 v_mfma_f32_16x16x32_bf16 v[68:71], a[224:227], v[176:179], v[68:71]
 ds_read_b64_tr_b16 a[212:213], v157 offset:512
 v_accvgpr_read_b32 v218, a26
 v_mfma_f32_16x16x32_bf16 v[72:75], a[224:227], v[180:183], v[72:75]
 ds_read_b64_tr_b16 a[214:215], v157 offset:2560
 v_accvgpr_read_b32 v219, a27
 v_mfma_f32_16x16x32_bf16 v[76:79], a[228:231], v[176:179], v[76:79]
 ds_read_b64_tr_b16 a[216:217], v156 offset:768
 v_accvgpr_read_b32 v220, a28
 v_mfma_f32_16x16x32_bf16 v[80:83], a[228:231], v[180:183], v[80:83]
 ds_read_b64_tr_b16 a[218:219], v156 offset:2816
 v_accvgpr_read_b32 v221, a29
 v_mfma_f32_16x16x32_bf16 v[84:87], a[232:235], v[176:179], v[84:87]
 ds_read_b64_tr_b16 a[220:221], v157 offset:768
 v_accvgpr_read_b32 v222, a30
 v_mfma_f32_16x16x32_bf16 v[88:91], a[232:235], v[180:183], v[88:91]
 ds_read_b64_tr_b16 a[222:223], v157 offset:2816
 v_accvgpr_read_b32 v223, a31
 s_waitcnt lgkmcnt(6)
 v_mfma_f32_16x16x32_bf16 v[92:95], a[236:239], v[176:179], v[92:95]
 ds_read_b64_tr_b16 a[224:225], v156 offset:1024
 v_cvt_pk_bf16_f32 v228, v216, v217
 v_mfma_f32_16x16x32_bf16 v[96:99], a[236:239], v[180:183], v[96:99]
 ds_read_b64_tr_b16 a[226:227], v156 offset:3072
 v_cvt_pk_bf16_f32 v229, v218, v219
 v_mfma_f32_16x16x32_bf16 v[100:103], a[240:243], v[176:179], v[100:103]
 ds_read_b64_tr_b16 a[228:229], v157 offset:1024
 v_cvt_pk_bf16_f32 v230, v220, v221
 v_mfma_f32_16x16x32_bf16 v[104:107], a[240:243], v[180:183], v[104:107]
 ds_read_b64_tr_b16 a[230:231], v157 offset:3072
 v_cvt_pk_bf16_f32 v231, v222, v223
 v_mfma_f32_16x16x32_bf16 v[108:111], a[244:247], v[176:179], v[108:111]
 ds_read_b64_tr_b16 a[232:233], v156 offset:1280
 v_mfma_f32_16x16x32_bf16 v[112:115], a[244:247], v[180:183], v[112:115]
 buffer_store_dwordx4 v[228:231], v2, s[4:7], s33 offen offset:3072 sc1
 v_mfma_f32_16x16x32_bf16 v[116:119], a[248:251], v[176:179], v[116:119]
 ds_read_b64_tr_b16 a[234:235], v156 offset:3328
 v_mfma_f32_32x32x16_bf16 a[16:31], a[128:131], a[128:131], 0
 v_mfma_f32_16x16x32_bf16 v[120:123], a[248:251], v[180:183], v[120:123]
 ds_read_b64_tr_b16 a[236:237], v157 offset:1280
 v_accvgpr_read_b32 v216, a32
 v_mfma_f32_16x16x32_bf16 v[124:127], a[252:255], v[176:179], v[124:127]
 ds_read_b64_tr_b16 a[238:239], v157 offset:3328
 v_accvgpr_read_b32 v217, a33
 v_mfma_f32_16x16x32_bf16 v[128:131], a[252:255], v[180:183], v[128:131]
 s_waitcnt vmcnt(26)
 s_barrier
 v_mfma_f32_16x16x32_bf16 v[4:7], a[192:195], v[184:187], v[4:7]
 ds_read_b64_tr_b16 a[240:241], v156 offset:1536
 v_accvgpr_read_b32 v218, a34
 v_mfma_f32_16x16x32_bf16 v[8:11], a[192:195], v[188:191], v[8:11]
 ds_read_b64_tr_b16 a[242:243], v156 offset:3584
 v_accvgpr_read_b32 v219, a35
 v_mfma_f32_16x16x32_bf16 v[12:15], a[196:199], v[184:187], v[12:15]
 ds_read_b64_tr_b16 a[244:245], v157 offset:1536
 v_accvgpr_read_b32 v220, a36
 v_mfma_f32_16x16x32_bf16 v[16:19], a[196:199], v[188:191], v[16:19]
 ds_read_b64_tr_b16 a[246:247], v157 offset:3584
 v_accvgpr_read_b32 v221, a37
 v_mfma_f32_16x16x32_bf16 v[20:23], a[200:203], v[184:187], v[20:23]
 ds_read_b64_tr_b16 a[248:249], v156 offset:1792
 v_accvgpr_read_b32 v222, a38
 v_mfma_f32_16x16x32_bf16 v[24:27], a[200:203], v[188:191], v[24:27]
 ds_read_b64_tr_b16 a[250:251], v156 offset:3840
 v_accvgpr_read_b32 v223, a39
 v_mfma_f32_16x16x32_bf16 v[28:31], a[204:207], v[184:187], v[28:31]
 ds_read_b64_tr_b16 a[252:253], v157 offset:1792
 v_cvt_pk_bf16_f32 v224, v216, v217
 v_mfma_f32_16x16x32_bf16 v[32:35], a[204:207], v[188:191], v[32:35]
 ds_read_b64_tr_b16 a[254:255], v157 offset:3840
 v_cvt_pk_bf16_f32 v225, v218, v219
 v_mfma_f32_16x16x32_bf16 v[36:39], a[208:211], v[184:187], v[36:39]
 v_add_u32 v158, 0xc000, v146
 v_add_u32 v159, 0xc000, v147
 v_mfma_f32_16x16x32_bf16 v[40:43], a[208:211], v[188:191], v[40:43]
 ds_read_b64_tr_b16 a[192:193], v158 offset:0
 v_cvt_pk_bf16_f32 v226, v220, v221
 ds_read_b64_tr_b16 a[194:195], v158 offset:2048
 s_waitcnt lgkmcnt(6)
 v_mfma_f32_16x16x32_bf16 v[44:47], a[212:215], v[184:187], v[44:47]
 v_cvt_pk_bf16_f32 v227, v222, v223
 ds_read_b64_tr_b16 a[196:197], v159 offset:0
 v_mfma_f32_16x16x32_bf16 v[48:51], a[212:215], v[188:191], v[48:51]
 s_add_u32 s33, s36, 0
 ds_read_b64_tr_b16 a[198:199], v159 offset:2048
 v_mfma_f32_16x16x32_bf16 v[52:55], a[216:219], v[184:187], v[52:55]
 buffer_store_dwordx4 v[224:227], v2, s[4:7], s33 offen offset:0 sc1
 v_mfma_f32_16x16x32_bf16 v[56:59], a[216:219], v[188:191], v[56:59]
 ds_read_b64_tr_b16 a[200:201], v158 offset:256
 v_accvgpr_read_b32 v216, a40
 ds_read_b64_tr_b16 a[202:203], v158 offset:2304
 v_mfma_f32_16x16x32_bf16 v[60:63], a[220:223], v[184:187], v[60:63]
 v_accvgpr_read_b32 v217, a41
 ds_read_b64_tr_b16 a[204:205], v159 offset:256
 v_mfma_f32_16x16x32_bf16 v[64:67], a[220:223], v[188:191], v[64:67]
 v_accvgpr_read_b32 v218, a42
 ds_read_b64_tr_b16 a[206:207], v159 offset:2304
 v_mfma_f32_16x16x32_bf16 v[68:71], a[224:227], v[184:187], v[68:71]
 v_accvgpr_read_b32 v219, a43
 ds_read_b64_tr_b16 a[208:209], v158 offset:512
 v_mfma_f32_16x16x32_bf16 v[72:75], a[224:227], v[188:191], v[72:75]
 v_accvgpr_read_b32 v220, a44
 ds_read_b64_tr_b16 a[210:211], v158 offset:2560
 v_mfma_f32_16x16x32_bf16 v[76:79], a[228:231], v[184:187], v[76:79]
 v_accvgpr_read_b32 v221, a45
 ds_read_b64_tr_b16 a[212:213], v159 offset:512
 v_mfma_f32_16x16x32_bf16 v[80:83], a[228:231], v[188:191], v[80:83]
 v_accvgpr_read_b32 v222, a46
 ds_read_b64_tr_b16 a[214:215], v159 offset:2560
 v_mfma_f32_16x16x32_bf16 v[84:87], a[232:235], v[184:187], v[84:87]
 v_accvgpr_read_b32 v223, a47
 ds_read_b64_tr_b16 a[216:217], v158 offset:768
 v_mfma_f32_16x16x32_bf16 v[88:91], a[232:235], v[188:191], v[88:91]
 v_cvt_pk_bf16_f32 v228, v216, v217
 ds_read_b64_tr_b16 a[218:219], v158 offset:2816
 v_mfma_f32_16x16x32_bf16 v[92:95], a[236:239], v[184:187], v[92:95]
 v_cvt_pk_bf16_f32 v229, v218, v219
 ds_read_b64_tr_b16 a[220:221], v159 offset:768
 v_mfma_f32_16x16x32_bf16 v[96:99], a[236:239], v[188:191], v[96:99]
 v_cvt_pk_bf16_f32 v230, v220, v221
 ds_read_b64_tr_b16 a[222:223], v159 offset:2816
 v_mfma_f32_16x16x32_bf16 v[100:103], a[240:243], v[184:187], v[100:103]
 v_cvt_pk_bf16_f32 v231, v222, v223
 ds_read_b64_tr_b16 a[224:225], v158 offset:1024
 v_mfma_f32_16x16x32_bf16 v[104:107], a[240:243], v[188:191], v[104:107]
 buffer_store_dwordx4 v[228:231], v2, s[4:7], s33 offen offset:1024 sc1
 ds_read_b64_tr_b16 a[226:227], v158 offset:3072
 v_mfma_f32_16x16x32_bf16 v[108:111], a[244:247], v[184:187], v[108:111]
 v_mfma_f32_32x32x16_bf16 a[32:47], a[128:131], a[128:131], 0
 ds_read_b64_tr_b16 a[228:229], v159 offset:1024
 v_mfma_f32_16x16x32_bf16 v[112:115], a[244:247], v[188:191], v[112:115]
 v_accvgpr_read_b32 v216, a48
 ds_read_b64_tr_b16 a[230:231], v159 offset:3072
 s_waitcnt lgkmcnt(7)
 v_mfma_f32_16x16x32_bf16 v[116:119], a[248:251], v[184:187], v[116:119]
 v_accvgpr_read_b32 v217, a49
 ds_read_b64_tr_b16 a[232:233], v158 offset:1280
 v_mfma_f32_16x16x32_bf16 v[120:123], a[248:251], v[188:191], v[120:123]
 v_accvgpr_read_b32 v218, a50
 ds_read_b64_tr_b16 a[234:235], v158 offset:3328
 v_mfma_f32_16x16x32_bf16 v[124:127], a[252:255], v[184:187], v[124:127]
 v_accvgpr_read_b32 v219, a51
 ds_read_b64_tr_b16 a[236:237], v159 offset:1280
 v_mfma_f32_16x16x32_bf16 v[128:131], a[252:255], v[188:191], v[128:131]
 v_accvgpr_read_b32 v220, a52
 ds_read_b64_tr_b16 a[238:239], v159 offset:3328
 v_mfma_f32_16x16x32_bf16 v[4:7], a[192:195], v[192:195], v[4:7]
 v_accvgpr_read_b32 v221, a53
 ds_read_b64_tr_b16 a[240:241], v158 offset:1536
 v_mfma_f32_16x16x32_bf16 v[8:11], a[192:195], v[196:199], v[8:11]
 v_accvgpr_read_b32 v222, a54
 ds_read_b64_tr_b16 a[242:243], v158 offset:3584
 v_mfma_f32_16x16x32_bf16 v[12:15], a[196:199], v[192:195], v[12:15]
 v_accvgpr_read_b32 v223, a55
 ds_read_b64_tr_b16 a[244:245], v159 offset:1536
 v_mfma_f32_16x16x32_bf16 v[16:19], a[196:199], v[196:199], v[16:19]
 v_cvt_pk_bf16_f32 v224, v216, v217
 ds_read_b64_tr_b16 a[246:247], v159 offset:3584
 v_mfma_f32_16x16x32_bf16 v[20:23], a[200:203], v[192:195], v[20:23]
 v_cvt_pk_bf16_f32 v225, v218, v219
 ds_read_b64_tr_b16 a[248:249], v158 offset:1792
 v_mfma_f32_16x16x32_bf16 v[24:27], a[200:203], v[196:199], v[24:27]
 v_cvt_pk_bf16_f32 v226, v220, v221
 ds_read_b64_tr_b16 a[250:251], v158 offset:3840
 v_mfma_f32_16x16x32_bf16 v[28:31], a[204:207], v[192:195], v[28:31]
 v_cvt_pk_bf16_f32 v227, v222, v223
 ds_read_b64_tr_b16 a[252:253], v159 offset:1792
 v_mfma_f32_16x16x32_bf16 v[32:35], a[204:207], v[196:199], v[32:35]
 buffer_store_dwordx4 v[224:227], v2, s[4:7], s33 offen offset:2048 sc1
 ds_read_b64_tr_b16 a[254:255], v159 offset:3840
 v_mfma_f32_16x16x32_bf16 v[36:39], a[208:211], v[192:195], v[36:39]
 v_accvgpr_read_b32 v216, a56
 v_add_u32 v156, 0x18000, v146
 v_mfma_f32_16x16x32_bf16 v[40:43], a[208:211], v[196:199], v[40:43]
 v_add_u32 v157, 0x18000, v147
 ds_read_b64_tr_b16 a[192:193], v156 offset:0
 ds_read_b64_tr_b16 a[194:195], v156 offset:2048
 v_mfma_f32_16x16x32_bf16 v[44:47], a[212:215], v[192:195], v[44:47]
 buffer_load_dwordx4 a[152:155], v2, s[4:7], s39 offen offset:1024
 ds_read_b64_tr_b16 a[196:197], v157 offset:0
 v_mfma_f32_16x16x32_bf16 v[48:51], a[212:215], v[196:199], v[48:51]
 v_accvgpr_read_b32 v217, a57
 v_accvgpr_read_b32 v218, a58
 ds_read_b64_tr_b16 a[198:199], v157 offset:2048
 s_waitcnt lgkmcnt(6)
 v_mfma_f32_16x16x32_bf16 v[52:55], a[216:219], v[192:195], v[52:55]
 v_accvgpr_read_b32 v219, a59
 v_accvgpr_read_b32 v220, a60
 v_mfma_f32_16x16x32_bf16 v[56:59], a[216:219], v[196:199], v[56:59]
 ds_read_b64_tr_b16 a[200:201], v156 offset:256
 v_accvgpr_read_b32 v221, a61
 ds_read_b64_tr_b16 a[202:203], v156 offset:2304
 v_mfma_f32_16x16x32_bf16 v[60:63], a[220:223], v[192:195], v[60:63]
 v_accvgpr_read_b32 v222, a62
 ds_read_b64_tr_b16 a[204:205], v157 offset:256
 v_mfma_f32_16x16x32_bf16 v[64:67], a[220:223], v[196:199], v[64:67]
 v_accvgpr_read_b32 v223, a63
 ds_read_b64_tr_b16 a[206:207], v157 offset:2304
 v_mfma_f32_16x16x32_bf16 v[68:71], a[224:227], v[192:195], v[68:71]
 v_cvt_pk_bf16_f32 v228, v216, v217
 ds_read_b64_tr_b16 a[208:209], v156 offset:512
 v_mfma_f32_16x16x32_bf16 v[72:75], a[224:227], v[196:199], v[72:75]
 v_cvt_pk_bf16_f32 v229, v218, v219
 ds_read_b64_tr_b16 a[210:211], v156 offset:2560
 v_mfma_f32_16x16x32_bf16 v[76:79], a[228:231], v[192:195], v[76:79]
 v_cvt_pk_bf16_f32 v230, v220, v221
 ds_read_b64_tr_b16 a[212:213], v157 offset:512
 v_mfma_f32_16x16x32_bf16 v[80:83], a[228:231], v[196:199], v[80:83]
 v_cvt_pk_bf16_f32 v231, v222, v223
 ds_read_b64_tr_b16 a[214:215], v157 offset:2560
 v_mfma_f32_16x16x32_bf16 v[84:87], a[232:235], v[192:195], v[84:87]
 buffer_store_dwordx4 v[228:231], v2, s[4:7], s33 offen offset:3072 sc1
 v_mfma_f32_16x16x32_bf16 v[88:91], a[232:235], v[196:199], v[88:91]
 ds_read_b64_tr_b16 a[216:217], v156 offset:768
 v_mfma_f32_32x32x16_bf16 a[48:63], a[128:131], a[128:131], 0
 ds_read_b64_tr_b16 a[218:219], v156 offset:2816
 v_mfma_f32_16x16x32_bf16 v[92:95], a[236:239], v[192:195], v[92:95]
 ds_read_b64_tr_b16 a[220:221], v157 offset:768
 v_accvgpr_read_b32 v216, a64
 v_mfma_f32_16x16x32_bf16 v[96:99], a[236:239], v[196:199], v[96:99]
 ds_read_b64_tr_b16 a[222:223], v157 offset:2816
 v_accvgpr_read_b32 v217, a65
 v_mfma_f32_16x16x32_bf16 v[100:103], a[240:243], v[192:195], v[100:103]
 ds_read_b64_tr_b16 a[224:225], v156 offset:1024
 v_accvgpr_read_b32 v218, a66
 v_mfma_f32_16x16x32_bf16 v[104:107], a[240:243], v[196:199], v[104:107]
 ds_read_b64_tr_b16 a[226:227], v156 offset:3072
 v_accvgpr_read_b32 v219, a67
 v_mfma_f32_16x16x32_bf16 v[108:111], a[244:247], v[192:195], v[108:111]
 buffer_load_dwordx4 a[156:159], v2, s[4:7], s40 offen offset:1024
 v_mfma_f32_16x16x32_bf16 v[112:115], a[244:247], v[196:199], v[112:115]
 ds_read_b64_tr_b16 a[228:229], v157 offset:1024
 v_accvgpr_read_b32 v220, a68
 ds_read_b64_tr_b16 a[230:231], v157 offset:3072
 v_mfma_f32_16x16x32_bf16 v[116:119], a[248:251], v[192:195], v[116:119]
 v_accvgpr_read_b32 v221, a69
 ds_read_b64_tr_b16 a[232:233], v156 offset:1280
 v_mfma_f32_16x16x32_bf16 v[120:123], a[248:251], v[196:199], v[120:123]
 v_accvgpr_read_b32 v222, a70
 ds_read_b64_tr_b16 a[234:235], v156 offset:3328
 s_waitcnt lgkmcnt(6)
 v_mfma_f32_16x16x32_bf16 v[124:127], a[252:255], v[192:195], v[124:127]
 v_accvgpr_read_b32 v223, a71
 ds_read_b64_tr_b16 a[236:237], v157 offset:1280
 v_mfma_f32_16x16x32_bf16 v[128:131], a[252:255], v[196:199], v[128:131]
 ds_read_b64_tr_b16 a[238:239], v157 offset:3328
 s_barrier
 v_mfma_f32_16x16x32_bf16 v[4:7], a[192:195], v[200:203], v[4:7]
 v_cvt_pk_bf16_f32 v224, v216, v217
 v_cvt_pk_bf16_f32 v225, v218, v219
 v_mfma_f32_16x16x32_bf16 v[8:11], a[192:195], v[204:207], v[8:11]
 ds_read_b64_tr_b16 a[240:241], v156 offset:1536
 v_cvt_pk_bf16_f32 v226, v220, v221
 ds_read_b64_tr_b16 a[242:243], v156 offset:3584
 v_mfma_f32_16x16x32_bf16 v[12:15], a[196:199], v[200:203], v[12:15]
 v_cvt_pk_bf16_f32 v227, v222, v223
 ds_read_b64_tr_b16 a[244:245], v157 offset:1536
 v_mfma_f32_16x16x32_bf16 v[16:19], a[196:199], v[204:207], v[16:19]
 s_add_u32 s33, s35, 16384
 ds_read_b64_tr_b16 a[246:247], v157 offset:3584
 v_mfma_f32_16x16x32_bf16 v[20:23], a[200:203], v[200:203], v[20:23]
 buffer_store_dwordx4 v[224:227], v2, s[4:7], s33 offen offset:0 sc1
 v_mfma_f32_16x16x32_bf16 v[24:27], a[200:203], v[204:207], v[24:27]
 ds_read_b64_tr_b16 a[248:249], v156 offset:1792
 v_accvgpr_read_b32 v216, a72
 ds_read_b64_tr_b16 a[250:251], v156 offset:3840
 v_mfma_f32_16x16x32_bf16 v[28:31], a[204:207], v[200:203], v[28:31]
 v_accvgpr_read_b32 v217, a73
 ds_read_b64_tr_b16 a[252:253], v157 offset:1792
 v_mfma_f32_16x16x32_bf16 v[32:35], a[204:207], v[204:207], v[32:35]
 v_accvgpr_read_b32 v218, a74
 ds_read_b64_tr_b16 a[254:255], v157 offset:3840
 v_mfma_f32_16x16x32_bf16 v[36:39], a[208:211], v[200:203], v[36:39]
 v_accvgpr_read_b32 v219, a75
 s_add_u32 m0, s8, 0x8000
 v_mfma_f32_16x16x32_bf16 v[40:43], a[208:211], v[204:207], v[40:43]
 v_add_u32 v158, 0x1c000, v146
 v_add_u32 v159, 0x1c000, v147
 ds_read_b64_tr_b16 a[192:193], v158 offset:0
 ds_read_b64_tr_b16 a[194:195], v158 offset:2048
 v_mfma_f32_16x16x32_bf16 v[44:47], a[212:215], v[200:203], v[44:47]
 v_accvgpr_read_b32 v220, a76
 s_add_u32 s11, s38, 0x280000
 ds_read_b64_tr_b16 a[196:197], v159 offset:0
 v_mfma_f32_16x16x32_bf16 v[48:51], a[212:215], v[204:207], v[48:51]
 buffer_load_dwordx4 v140, s[20:23], s11 offen offset:0 lds
 ds_read_b64_tr_b16 a[198:199], v159 offset:2048
 v_mfma_f32_16x16x32_bf16 v[52:55], a[216:219], v[200:203], v[52:55]
 v_accvgpr_read_b32 v221, a77
 v_accvgpr_read_b32 v222, a78
 v_mfma_f32_16x16x32_bf16 v[56:59], a[216:219], v[204:207], v[56:59]
 v_accvgpr_read_b32 v223, a79
 ds_read_b64_tr_b16 a[200:201], v158 offset:256
 ds_read_b64_tr_b16 a[202:203], v158 offset:2304
 v_mfma_f32_16x16x32_bf16 v[60:63], a[220:223], v[200:203], v[60:63]
 v_cvt_pk_bf16_f32 v228, v216, v217
 v_cvt_pk_bf16_f32 v229, v218, v219
 ds_read_b64_tr_b16 a[204:205], v159 offset:256
 v_mfma_f32_16x16x32_bf16 v[64:67], a[220:223], v[204:207], v[64:67]
 buffer_load_dwordx4 v141, s[20:23], s11 offen offset:1024 lds
 ds_read_b64_tr_b16 a[206:207], v159 offset:2304
 s_waitcnt lgkmcnt(6)
 v_mfma_f32_16x16x32_bf16 v[68:71], a[224:227], v[200:203], v[68:71]
 v_cvt_pk_bf16_f32 v230, v220, v221
 v_cvt_pk_bf16_f32 v231, v222, v223
 v_mfma_f32_16x16x32_bf16 v[72:75], a[224:227], v[204:207], v[72:75]
 ds_read_b64_tr_b16 a[208:209], v158 offset:512
 ds_read_b64_tr_b16 a[210:211], v158 offset:2560
 v_mfma_f32_16x16x32_bf16 v[76:79], a[228:231], v[200:203], v[76:79]
 buffer_store_dwordx4 v[228:231], v2, s[4:7], s33 offen offset:1024 sc1
 v_mfma_f32_16x16x32_bf16 v[80:83], a[228:231], v[204:207], v[80:83]
 v_mfma_f32_32x32x16_bf16 a[64:79], a[128:131], a[128:131], 0
 ds_read_b64_tr_b16 a[212:213], v159 offset:512
 ds_read_b64_tr_b16 a[214:215], v159 offset:2560
 v_mfma_f32_16x16x32_bf16 v[84:87], a[232:235], v[200:203], v[84:87]
 v_accvgpr_read_b32 v216, a80
 v_accvgpr_read_b32 v217, a81
 ds_read_b64_tr_b16 a[216:217], v158 offset:768
 v_mfma_f32_16x16x32_bf16 v[88:91], a[232:235], v[204:207], v[88:91]
 buffer_load_dwordx4 v142, s[20:23], s11 offen offset:2048 lds
 ds_read_b64_tr_b16 a[218:219], v158 offset:2816
 v_mfma_f32_16x16x32_bf16 v[92:95], a[236:239], v[200:203], v[92:95]
 v_accvgpr_read_b32 v218, a82
 v_accvgpr_read_b32 v219, a83
 v_mfma_f32_16x16x32_bf16 v[96:99], a[236:239], v[204:207], v[96:99]
 ds_read_b64_tr_b16 a[220:221], v159 offset:768
 v_accvgpr_read_b32 v220, a84
 ds_read_b64_tr_b16 a[222:223], v159 offset:2816
 v_mfma_f32_16x16x32_bf16 v[100:103], a[240:243], v[200:203], v[100:103]
 v_accvgpr_read_b32 v221, a85
 ds_read_b64_tr_b16 a[224:225], v158 offset:1024
 v_mfma_f32_16x16x32_bf16 v[104:107], a[240:243], v[204:207], v[104:107]
 buffer_load_dwordx4 v143, s[20:23], s11 offen offset:3072 lds
 ds_read_b64_tr_b16 a[226:227], v158 offset:3072
 v_mfma_f32_16x16x32_bf16 v[108:111], a[244:247], v[200:203], v[108:111]
 v_accvgpr_read_b32 v222, a86
 v_accvgpr_read_b32 v223, a87
 v_mfma_f32_16x16x32_bf16 v[112:115], a[244:247], v[204:207], v[112:115]
 ds_read_b64_tr_b16 a[228:229], v159 offset:1024
 v_cvt_pk_bf16_f32 v224, v216, v217
 ds_read_b64_tr_b16 a[230:231], v159 offset:3072
 v_mfma_f32_16x16x32_bf16 v[116:119], a[248:251], v[200:203], v[116:119]
 v_cvt_pk_bf16_f32 v225, v218, v219
 ds_read_b64_tr_b16 a[232:233], v158 offset:1280
 v_mfma_f32_16x16x32_bf16 v[120:123], a[248:251], v[204:207], v[120:123]
 v_cvt_pk_bf16_f32 v226, v220, v221
 ds_read_b64_tr_b16 a[234:235], v158 offset:3328
 v_mfma_f32_16x16x32_bf16 v[124:127], a[252:255], v[200:203], v[124:127]
 buffer_load_dwordx4 a[160:163], v2, s[4:7], s39 offen offset:2048
 buffer_load_dwordx4 a[164:167], v2, s[4:7], s40 offen offset:2048
 v_mfma_f32_16x16x32_bf16 v[128:131], a[252:255], v[204:207], v[128:131]
 v_cvt_pk_bf16_f32 v227, v222, v223
 ds_read_b64_tr_b16 a[236:237], v159 offset:1280
 ds_read_b64_tr_b16 a[238:239], v159 offset:3328
 v_mfma_f32_16x16x32_bf16 v[4:7], a[192:195], v[208:211], v[4:7]
 buffer_store_dwordx4 v[224:227], v2, s[4:7], s33 offen offset:2048 sc1
 v_mfma_f32_16x16x32_bf16 v[8:11], a[192:195], v[212:215], v[8:11]
 v_accvgpr_read_b32 v216, a88
 ds_read_b64_tr_b16 a[240:241], v158 offset:1536
 ds_read_b64_tr_b16 a[242:243], v158 offset:3584
 s_waitcnt lgkmcnt(6)
 v_mfma_f32_16x16x32_bf16 v[12:15], a[196:199], v[208:211], v[12:15]
 v_accvgpr_read_b32 v217, a89
 v_accvgpr_read_b32 v218, a90
 v_mfma_f32_16x16x32_bf16 v[16:19], a[196:199], v[212:215], v[16:19]
 ds_read_b64_tr_b16 a[244:245], v159 offset:1536
 v_accvgpr_read_b32 v219, a91
 ds_read_b64_tr_b16 a[246:247], v159 offset:3584
 v_mfma_f32_16x16x32_bf16 v[20:23], a[200:203], v[208:211], v[20:23]
 v_accvgpr_read_b32 v220, a92
 ds_read_b64_tr_b16 a[248:249], v158 offset:1792
 v_mfma_f32_16x16x32_bf16 v[24:27], a[200:203], v[212:215], v[24:27]
 v_accvgpr_read_b32 v221, a93
 ds_read_b64_tr_b16 a[250:251], v158 offset:3840
 v_mfma_f32_16x16x32_bf16 v[28:31], a[204:207], v[208:211], v[28:31]
 v_accvgpr_read_b32 v222, a94
 ds_read_b64_tr_b16 a[252:253], v159 offset:1792
 v_mfma_f32_16x16x32_bf16 v[32:35], a[204:207], v[212:215], v[32:35]
 v_accvgpr_read_b32 v223, a95
 ds_read_b64_tr_b16 a[254:255], v159 offset:3840
 v_mfma_f32_16x16x32_bf16 v[36:39], a[208:211], v[208:211], v[36:39]
 v_cvt_pk_bf16_f32 v228, v216, v217
 s_add_u32 m0, s8, 0xc000
 v_mfma_f32_16x16x32_bf16 v[40:43], a[208:211], v[212:215], v[40:43]
 v_add_u32 v156, 0x20000, v146
 v_add_u32 v157, 0x20000, v147
 ds_read_b64_tr_b16 a[192:193], v156 offset:0
 ds_read_b64_tr_b16 a[194:195], v156 offset:2048
 v_mfma_f32_16x16x32_bf16 v[44:47], a[212:215], v[208:211], v[44:47]
 s_add_u32 s11, s38, 0x2c0000
 v_cvt_pk_bf16_f32 v229, v218, v219
 ds_read_b64_tr_b16 a[196:197], v157 offset:0
 v_mfma_f32_16x16x32_bf16 v[48:51], a[212:215], v[212:215], v[48:51]
 buffer_load_dwordx4 v140, s[20:23], s11 offen offset:0 lds
 ds_read_b64_tr_b16 a[198:199], v157 offset:2048
 v_mfma_f32_16x16x32_bf16 v[52:55], a[216:219], v[208:211], v[52:55]
 v_cvt_pk_bf16_f32 v230, v220, v221
 v_cvt_pk_bf16_f32 v231, v222, v223
 ds_read_b64_tr_b16 a[200:201], v156 offset:256
 v_mfma_f32_16x16x32_bf16 v[56:59], a[216:219], v[212:215], v[56:59]
 buffer_store_dwordx4 v[228:231], v2, s[4:7], s33 offen offset:3072 sc1
 ds_read_b64_tr_b16 a[202:203], v156 offset:2304
 v_mfma_f32_16x16x32_bf16 v[60:63], a[220:223], v[208:211], v[60:63]
 v_mfma_f32_32x32x16_bf16 a[80:95], a[128:131], a[128:131], 0
 v_accvgpr_read_b32 v216, a96
 ds_read_b64_tr_b16 a[204:205], v157 offset:256
 v_mfma_f32_16x16x32_bf16 v[64:67], a[220:223], v[212:215], v[64:67]
 buffer_load_dwordx4 v141, s[20:23], s11 offen offset:1024 lds
 ds_read_b64_tr_b16 a[206:207], v157 offset:2304
 v_mfma_f32_16x16x32_bf16 v[68:71], a[224:227], v[208:211], v[68:71]
 v_accvgpr_read_b32 v217, a97
 v_accvgpr_read_b32 v218, a98
 v_mfma_f32_16x16x32_bf16 v[72:75], a[224:227], v[212:215], v[72:75]
 ds_read_b64_tr_b16 a[208:209], v156 offset:512
 v_accvgpr_read_b32 v219, a99
 ds_read_b64_tr_b16 a[210:211], v156 offset:2560
 v_mfma_f32_16x16x32_bf16 v[76:79], a[228:231], v[208:211], v[76:79]
 v_accvgpr_read_b32 v220, a100
 ds_read_b64_tr_b16 a[212:213], v157 offset:512
 v_mfma_f32_16x16x32_bf16 v[80:83], a[228:231], v[212:215], v[80:83]
 buffer_load_dwordx4 v142, s[20:23], s11 offen offset:2048 lds
 ds_read_b64_tr_b16 a[214:215], v157 offset:2560
 s_waitcnt lgkmcnt(6)
 v_mfma_f32_16x16x32_bf16 v[84:87], a[232:235], v[208:211], v[84:87]
 v_accvgpr_read_b32 v221, a101
 v_accvgpr_read_b32 v222, a102
 v_mfma_f32_16x16x32_bf16 v[88:91], a[232:235], v[212:215], v[88:91]
 ds_read_b64_tr_b16 a[216:217], v156 offset:768
 v_accvgpr_read_b32 v223, a103
 ds_read_b64_tr_b16 a[218:219], v156 offset:2816
 v_mfma_f32_16x16x32_bf16 v[92:95], a[236:239], v[208:211], v[92:95]
 v_cvt_pk_bf16_f32 v224, v216, v217
 ds_read_b64_tr_b16 a[220:221], v157 offset:768
 v_mfma_f32_16x16x32_bf16 v[96:99], a[236:239], v[212:215], v[96:99]
 v_cvt_pk_bf16_f32 v225, v218, v219
 ds_read_b64_tr_b16 a[222:223], v157 offset:2816
 v_mfma_f32_16x16x32_bf16 v[100:103], a[240:243], v[208:211], v[100:103]
 buffer_load_dwordx4 v143, s[20:23], s11 offen offset:3072 lds
 v_mfma_f32_16x16x32_bf16 v[104:107], a[240:243], v[212:215], v[104:107]
 v_cvt_pk_bf16_f32 v226, v220, v221
 ds_read_b64_tr_b16 a[224:225], v156 offset:1024
 ds_read_b64_tr_b16 a[226:227], v156 offset:3072
 v_mfma_f32_16x16x32_bf16 v[108:111], a[244:247], v[208:211], v[108:111]
 v_cvt_pk_bf16_f32 v227, v222, v223
 s_add_u32 s33, s36, 16384
 v_mfma_f32_16x16x32_bf16 v[112:115], a[244:247], v[212:215], v[112:115]
 ds_read_b64_tr_b16 a[228:229], v157 offset:1024
 ds_read_b64_tr_b16 a[230:231], v157 offset:3072
 v_mfma_f32_16x16x32_bf16 v[116:119], a[248:251], v[208:211], v[116:119]
 buffer_store_dwordx4 v[224:227], v2, s[4:7], s33 offen offset:0 sc1
 v_mfma_f32_16x16x32_bf16 v[120:123], a[248:251], v[212:215], v[120:123]
 v_accvgpr_read_b32 v216, a104
 ds_read_b64_tr_b16 a[232:233], v156 offset:1280
 ds_read_b64_tr_b16 a[234:235], v156 offset:3328
 v_mfma_f32_16x16x32_bf16 v[124:127], a[252:255], v[208:211], v[124:127]
 buffer_load_dwordx4 a[168:171], v2, s[4:7], s39 offen offset:3072
 ds_read_b64_tr_b16 a[236:237], v157 offset:1280
 buffer_load_dwordx4 a[172:175], v2, s[4:7], s40 offen offset:3072
 s_add_u32 s39, s39, 0x1000
 s_add_u32 s40, s40, 0x1000
 v_mfma_f32_16x16x32_bf16 v[128:131], a[252:255], v[212:215], v[128:131]
 ds_read_b64_tr_b16 a[238:239], v157 offset:3328
 s_waitcnt vmcnt(41)
 s_barrier
 v_mfma_f32_16x16x32_bf16 v[4:7], a[192:195], v[232:235], v[4:7]
 v_accvgpr_read_b32 v217, a105
 v_accvgpr_read_b32 v218, a106
 ds_read_b64_tr_b16 a[240:241], v156 offset:1536
 v_mfma_f32_16x16x32_bf16 v[8:11], a[192:195], v[236:239], v[8:11]
 v_accvgpr_read_b32 v219, a107
 v_accvgpr_read_b32 v220, a108
 ds_read_b64_tr_b16 a[242:243], v156 offset:3584
 v_mfma_f32_16x16x32_bf16 v[12:15], a[196:199], v[232:235], v[12:15]
 v_accvgpr_read_b32 v221, a109
 v_accvgpr_read_b32 v222, a110
 v_mfma_f32_16x16x32_bf16 v[16:19], a[196:199], v[236:239], v[16:19]
 ds_read_b64_tr_b16 a[244:245], v157 offset:1536
 v_accvgpr_read_b32 v223, a111
 ds_read_b64_tr_b16 a[246:247], v157 offset:3584
 v_mfma_f32_16x16x32_bf16 v[20:23], a[200:203], v[232:235], v[20:23]
 v_cvt_pk_bf16_f32 v228, v216, v217
 ds_read_b64_tr_b16 a[248:249], v156 offset:1792
 v_mfma_f32_16x16x32_bf16 v[24:27], a[200:203], v[236:239], v[24:27]
 v_cvt_pk_bf16_f32 v229, v218, v219
 ds_read_b64_tr_b16 a[250:251], v156 offset:3840
 s_waitcnt lgkmcnt(6)
 v_mfma_f32_16x16x32_bf16 v[28:31], a[204:207], v[232:235], v[28:31]
 v_cvt_pk_bf16_f32 v230, v220, v221
 ds_read_b64_tr_b16 a[252:253], v157 offset:1792
 v_mfma_f32_16x16x32_bf16 v[32:35], a[204:207], v[236:239], v[32:35]
 v_cvt_pk_bf16_f32 v231, v222, v223
 ds_read_b64_tr_b16 a[254:255], v157 offset:3840
 v_mfma_f32_16x16x32_bf16 v[36:39], a[208:211], v[232:235], v[36:39]
 s_add_u32 m0, s8, 0x18000
 v_add_u32 v158, 0x24000, v146
 v_add_u32 v159, 0x24000, v147
 ds_read_b64_tr_b16 a[192:193], v158 offset:0
 v_mfma_f32_16x16x32_bf16 v[40:43], a[208:211], v[236:239], v[40:43]
 buffer_store_dwordx4 v[228:231], v2, s[4:7], s33 offen offset:1024 sc1
 ds_read_b64_tr_b16 a[194:195], v158 offset:2048
 v_mfma_f32_16x16x32_bf16 v[44:47], a[212:215], v[232:235], v[44:47]
 s_add_u32 s11, s38, 0x300000
 v_mfma_f32_32x32x16_bf16 a[96:111], a[128:131], a[128:131], 0
 ds_read_b64_tr_b16 a[196:197], v159 offset:0
 v_mfma_f32_16x16x32_bf16 v[48:51], a[212:215], v[236:239], v[48:51]
 buffer_load_dwordx4 v140, s[20:23], s11 offen offset:0 lds
 ds_read_b64_tr_b16 a[198:199], v159 offset:2048
 v_mfma_f32_16x16x32_bf16 v[52:55], a[216:219], v[232:235], v[52:55]
 v_accvgpr_read_b32 v216, a112
 v_accvgpr_read_b32 v217, a113
 v_mfma_f32_16x16x32_bf16 v[56:59], a[216:219], v[236:239], v[56:59]
 v_accvgpr_read_b32 v218, a114
 ds_read_b64_tr_b16 a[200:201], v158 offset:256
 ds_read_b64_tr_b16 a[202:203], v158 offset:2304
 v_mfma_f32_16x16x32_bf16 v[60:63], a[220:223], v[232:235], v[60:63]
 v_accvgpr_read_b32 v219, a115
 v_accvgpr_read_b32 v220, a116
 ds_read_b64_tr_b16 a[204:205], v159 offset:256
 v_mfma_f32_16x16x32_bf16 v[64:67], a[220:223], v[236:239], v[64:67]
 buffer_load_dwordx4 v141, s[20:23], s11 offen offset:1024 lds
 ds_read_b64_tr_b16 a[206:207], v159 offset:2304
 v_mfma_f32_16x16x32_bf16 v[68:71], a[224:227], v[232:235], v[68:71]
 v_accvgpr_read_b32 v221, a117
 v_accvgpr_read_b32 v222, a118
 v_mfma_f32_16x16x32_bf16 v[72:75], a[224:227], v[236:239], v[72:75]
 ds_read_b64_tr_b16 a[208:209], v158 offset:512
 v_accvgpr_read_b32 v223, a119
 ds_read_b64_tr_b16 a[210:211], v158 offset:2560
 v_mfma_f32_16x16x32_bf16 v[76:79], a[228:231], v[232:235], v[76:79]
 v_cvt_pk_bf16_f32 v224, v216, v217
 ds_read_b64_tr_b16 a[212:213], v159 offset:512
 v_mfma_f32_16x16x32_bf16 v[80:83], a[228:231], v[236:239], v[80:83]
 buffer_load_dwordx4 v142, s[20:23], s11 offen offset:2048 lds
 ds_read_b64_tr_b16 a[214:215], v159 offset:2560
 v_mfma_f32_16x16x32_bf16 v[84:87], a[232:235], v[232:235], v[84:87]
 v_cvt_pk_bf16_f32 v225, v218, v219
 v_cvt_pk_bf16_f32 v226, v220, v221
 v_mfma_f32_16x16x32_bf16 v[88:91], a[232:235], v[236:239], v[88:91]
 ds_read_b64_tr_b16 a[216:217], v158 offset:768
 v_cvt_pk_bf16_f32 v227, v222, v223
 ds_read_b64_tr_b16 a[218:219], v158 offset:2816
 v_mfma_f32_16x16x32_bf16 v[92:95], a[236:239], v[232:235], v[92:95]
 buffer_store_dwordx4 v[224:227], v2, s[4:7], s33 offen offset:2048 sc1
 v_mfma_f32_16x16x32_bf16 v[96:99], a[236:239], v[236:239], v[96:99]
 ds_read_b64_tr_b16 a[220:221], v159 offset:768
 v_accvgpr_read_b32 v216, a120
 ds_read_b64_tr_b16 a[222:223], v159 offset:2816
 s_waitcnt lgkmcnt(6)
 v_mfma_f32_16x16x32_bf16 v[100:103], a[240:243], v[232:235], v[100:103]
 buffer_load_dwordx4 v143, s[20:23], s11 offen offset:3072 lds
 v_mfma_f32_16x16x32_bf16 v[104:107], a[240:243], v[236:239], v[104:107]
 v_accvgpr_read_b32 v217, a121
 ds_read_b64_tr_b16 a[224:225], v158 offset:1024
 ds_read_b64_tr_b16 a[226:227], v158 offset:3072
 v_mfma_f32_16x16x32_bf16 v[108:111], a[244:247], v[232:235], v[108:111]
 v_accvgpr_read_b32 v218, a122
 v_accvgpr_read_b32 v219, a123
 v_mfma_f32_16x16x32_bf16 v[112:115], a[244:247], v[236:239], v[112:115]
 ds_read_b64_tr_b16 a[228:229], v159 offset:1024
 v_accvgpr_read_b32 v220, a124
 ds_read_b64_tr_b16 a[230:231], v159 offset:3072
 v_mfma_f32_16x16x32_bf16 v[116:119], a[248:251], v[232:235], v[116:119]
 v_accvgpr_read_b32 v221, a125
 ds_read_b64_tr_b16 a[232:233], v158 offset:1280
 v_mfma_f32_16x16x32_bf16 v[120:123], a[248:251], v[236:239], v[120:123]
 buffer_load_dwordx4 a[176:179], v2, s[4:7], s39 offen offset:0
 ds_read_b64_tr_b16 a[234:235], v158 offset:3328
 buffer_load_dwordx4 a[180:183], v2, s[4:7], s40 offen offset:0
 v_mfma_f32_16x16x32_bf16 v[124:127], a[252:255], v[232:235], v[124:127]
 v_accvgpr_read_b32 v222, a126
 v_accvgpr_read_b32 v223, a127
 v_mfma_f32_16x16x32_bf16 v[128:131], a[252:255], v[236:239], v[128:131]
 ds_read_b64_tr_b16 a[236:237], v159 offset:1280
 v_cvt_pk_bf16_f32 v228, v216, v217
 ds_read_b64_tr_b16 a[238:239], v159 offset:3328
 v_cvt_pk_bf16_f32 v229, v218, v219
 v_cvt_pk_bf16_f32 v230, v220, v221
 v_cvt_pk_bf16_f32 v231, v222, v223
 buffer_store_dwordx4 v[228:231], v2, s[4:7], s33 offen offset:3072 sc1
 v_mfma_f32_32x32x16_bf16 a[112:127], a[128:131], a[128:131], 0
 v_mfma_f32_16x16x32_bf16 v[4:7], a[192:195], v[240:243], v[4:7]
 ds_read_b64_tr_b16 a[240:241], v158 offset:1536
 v_mfma_f32_16x16x32_bf16 v[8:11], a[192:195], v[244:247], v[8:11]
 ds_read_b64_tr_b16 a[242:243], v158 offset:3584
 s_add_u32 m0, s8, 0x1c000
 v_mfma_f32_16x16x32_bf16 v[12:15], a[196:199], v[240:243], v[12:15]
 ds_read_b64_tr_b16 a[244:245], v159 offset:1536
 s_add_u32 s11, s38, 0x340000
 v_mfma_f32_16x16x32_bf16 v[16:19], a[196:199], v[244:247], v[16:19]
 ds_read_b64_tr_b16 a[246:247], v159 offset:3584
 v_mfma_f32_16x16x32_bf16 v[20:23], a[200:203], v[240:243], v[20:23]
 ds_read_b64_tr_b16 a[248:249], v158 offset:1792
 v_mfma_f32_16x16x32_bf16 v[24:27], a[200:203], v[244:247], v[24:27]
 ds_read_b64_tr_b16 a[250:251], v158 offset:3840
 v_mfma_f32_16x16x32_bf16 v[28:31], a[204:207], v[240:243], v[28:31]
 ds_read_b64_tr_b16 a[252:253], v159 offset:1792
 v_mfma_f32_16x16x32_bf16 v[32:35], a[204:207], v[244:247], v[32:35]
 ds_read_b64_tr_b16 a[254:255], v159 offset:3840
 v_add_u32 v156, 0x10000, v146
 v_mfma_f32_16x16x32_bf16 v[36:39], a[208:211], v[240:243], v[36:39]
 v_add_u32 v157, 0x10000, v147
 ds_read_b64_tr_b16 a[192:193], v156 offset:0
 v_mfma_f32_16x16x32_bf16 v[40:43], a[208:211], v[244:247], v[40:43]
 ds_read_b64_tr_b16 a[194:195], v156 offset:2048
 s_waitcnt lgkmcnt(8)
 v_mfma_f32_16x16x32_bf16 v[44:47], a[212:215], v[240:243], v[44:47]
 buffer_load_dwordx4 v140, s[20:23], s11 offen offset:0 lds
 v_mfma_f32_16x16x32_bf16 v[48:51], a[212:215], v[244:247], v[48:51]
 ds_read_b64_tr_b16 a[196:197], v157 offset:0
 ds_read_b64_tr_b16 a[198:199], v157 offset:2048
 v_mfma_f32_16x16x32_bf16 v[52:55], a[216:219], v[240:243], v[52:55]
 ds_read_b64_tr_b16 a[200:201], v156 offset:256
 v_mfma_f32_16x16x32_bf16 v[56:59], a[216:219], v[244:247], v[56:59]
 ds_read_b64_tr_b16 a[202:203], v156 offset:2304
 v_mfma_f32_16x16x32_bf16 v[60:63], a[220:223], v[240:243], v[60:63]
 buffer_load_dwordx4 v141, s[20:23], s11 offen offset:1024 lds
 v_mfma_f32_16x16x32_bf16 v[64:67], a[220:223], v[244:247], v[64:67]
 ds_read_b64_tr_b16 a[204:205], v157 offset:256
 ds_read_b64_tr_b16 a[206:207], v157 offset:2304
 v_mfma_f32_16x16x32_bf16 v[68:71], a[224:227], v[240:243], v[68:71]
 ds_read_b64_tr_b16 a[208:209], v156 offset:512
 v_mfma_f32_16x16x32_bf16 v[72:75], a[224:227], v[244:247], v[72:75]
 ds_read_b64_tr_b16 a[210:211], v156 offset:2560
 v_mfma_f32_16x16x32_bf16 v[76:79], a[228:231], v[240:243], v[76:79]
 ds_read_b64_tr_b16 a[212:213], v157 offset:512
 ds_read_b64_tr_b16 a[214:215], v157 offset:2560
 v_mfma_f32_16x16x32_bf16 v[80:83], a[228:231], v[244:247], v[80:83]
 buffer_load_dwordx4 v142, s[20:23], s11 offen offset:2048 lds
 v_mfma_f32_16x16x32_bf16 v[84:87], a[232:235], v[240:243], v[84:87]
 ds_read_b64_tr_b16 a[216:217], v156 offset:768
 v_mfma_f32_16x16x32_bf16 v[88:91], a[232:235], v[244:247], v[88:91]
 ds_read_b64_tr_b16 a[218:219], v156 offset:2816
 v_mfma_f32_16x16x32_bf16 v[92:95], a[236:239], v[240:243], v[92:95]
 ds_read_b64_tr_b16 a[220:221], v157 offset:768
 v_mfma_f32_16x16x32_bf16 v[96:99], a[236:239], v[244:247], v[96:99]
 ds_read_b64_tr_b16 a[222:223], v157 offset:2816
 v_mfma_f32_16x16x32_bf16 v[100:103], a[240:243], v[240:243], v[100:103]
 buffer_load_dwordx4 v143, s[20:23], s11 offen offset:3072 lds
 v_mfma_f32_16x16x32_bf16 v[104:107], a[240:243], v[244:247], v[104:107]
 ds_read_b64_tr_b16 a[224:225], v156 offset:1024
 ds_read_b64_tr_b16 a[226:227], v156 offset:3072
 s_waitcnt lgkmcnt(9)
 v_mfma_f32_16x16x32_bf16 v[108:111], a[244:247], v[240:243], v[108:111]
 ds_read_b64_tr_b16 a[228:229], v157 offset:1024
 v_mfma_f32_16x16x32_bf16 v[112:115], a[244:247], v[244:247], v[112:115]
 ds_read_b64_tr_b16 a[230:231], v157 offset:3072
 v_mfma_f32_16x16x32_bf16 v[116:119], a[248:251], v[240:243], v[116:119]
 ds_read_b64_tr_b16 a[232:233], v156 offset:1280
 ds_read_b64_tr_b16 a[234:235], v156 offset:3328
 v_mfma_f32_16x16x32_bf16 v[120:123], a[248:251], v[244:247], v[120:123]
 buffer_load_dwordx4 a[184:187], v2, s[4:7], s39 offen offset:1024
 buffer_load_dwordx4 a[188:191], v2, s[4:7], s40 offen offset:1024
 v_mfma_f32_16x16x32_bf16 v[124:127], a[252:255], v[240:243], v[124:127]
 ds_read_b64_tr_b16 a[236:237], v157 offset:1280
 ds_read_b64_tr_b16 a[238:239], v157 offset:3328
 v_mfma_f32_16x16x32_bf16 v[128:131], a[252:255], v[244:247], v[128:131]
 s_waitcnt vmcnt(6)
 s_barrier
 s_cmp_eq_u32 s71, 0
 s_cbranch_scc1 L1_kvs_slow
 buffer_store_dword v148, v149, s[4:7], s34 offen
L1_kvs_back:
 v_mfma_f32_16x16x32_bf16 v[4:7], a[192:195], v[248:251], v[4:7]
 ds_read_b64_tr_b16 a[240:241], v156 offset:1536
 v_mfma_f32_16x16x32_bf16 v[8:11], a[192:195], v[252:255], v[8:11]
 ds_read_b64_tr_b16 a[242:243], v156 offset:3584
 s_lshl_b32 s11, s8, 1
 v_mfma_f32_16x16x32_bf16 v[12:15], a[196:199], v[248:251], v[12:15]
 ds_read_b64_tr_b16 a[244:245], v157 offset:1536
 s_add_u32 m0, s11, 0x20000
 v_mfma_f32_16x16x32_bf16 v[16:19], a[196:199], v[252:255], v[16:19]
 ds_read_b64_tr_b16 a[246:247], v157 offset:3584
 v_mfma_f32_16x16x32_bf16 v[20:23], a[200:203], v[248:251], v[20:23]
 ds_read_b64_tr_b16 a[248:249], v156 offset:1792
 v_mfma_f32_16x16x32_bf16 v[24:27], a[200:203], v[252:255], v[24:27]
 ds_read_b64_tr_b16 a[250:251], v156 offset:3840
 v_mfma_f32_16x16x32_bf16 v[28:31], a[204:207], v[248:251], v[28:31]
 ds_read_b64_tr_b16 a[252:253], v157 offset:1792
 v_mfma_f32_16x16x32_bf16 v[32:35], a[204:207], v[252:255], v[32:35]
 ds_read_b64_tr_b16 a[254:255], v157 offset:3840
 v_add_u32 v158, 0x14000, v146
 s_waitcnt lgkmcnt(8)
 v_mfma_f32_16x16x32_bf16 v[36:39], a[208:211], v[248:251], v[36:39]
 v_add_u32 v159, 0x14000, v147
 ds_read_b64_tr_b16 a[192:193], v158 offset:0
 v_mfma_f32_16x16x32_bf16 v[40:43], a[208:211], v[252:255], v[40:43]
 ds_read_b64_tr_b16 a[194:195], v158 offset:2048
 v_mfma_f32_16x16x32_bf16 v[44:47], a[212:215], v[248:251], v[44:47]
 buffer_load_dwordx4 v136, s[56:59], s44 offen offset:0 lds
 v_mfma_f32_16x16x32_bf16 v[48:51], a[212:215], v[252:255], v[48:51]
 ds_read_b64_tr_b16 a[196:197], v159 offset:0
 ds_read_b64_tr_b16 a[198:199], v159 offset:2048
 v_mfma_f32_16x16x32_bf16 v[52:55], a[216:219], v[248:251], v[52:55]
 ds_read_b64_tr_b16 a[200:201], v158 offset:256
 ds_read_b64_tr_b16 a[202:203], v158 offset:2304
 v_mfma_f32_16x16x32_bf16 v[56:59], a[216:219], v[252:255], v[56:59]
 buffer_load_dwordx4 v137, s[56:59], s44 offen offset:1024 lds
 v_mfma_f32_16x16x32_bf16 v[60:63], a[220:223], v[248:251], v[60:63]
 ds_read_b64_tr_b16 a[204:205], v159 offset:256
 v_mfma_f32_16x16x32_bf16 v[64:67], a[220:223], v[252:255], v[64:67]
 ds_read_b64_tr_b16 a[206:207], v159 offset:2304
 v_mfma_f32_16x16x32_bf16 v[68:71], a[224:227], v[248:251], v[68:71]
 ds_read_b64_tr_b16 a[208:209], v158 offset:512
 ds_read_b64_tr_b16 a[210:211], v158 offset:2560
 v_mfma_f32_16x16x32_bf16 v[72:75], a[224:227], v[252:255], v[72:75]
 buffer_load_dwordx4 v138, s[56:59], s44 offen offset:2048 lds
 v_mfma_f32_16x16x32_bf16 v[76:79], a[228:231], v[248:251], v[76:79]
 ds_read_b64_tr_b16 a[212:213], v159 offset:512
 v_mfma_f32_16x16x32_bf16 v[80:83], a[228:231], v[252:255], v[80:83]
 ds_read_b64_tr_b16 a[214:215], v159 offset:2560
 v_mfma_f32_16x16x32_bf16 v[84:87], a[232:235], v[248:251], v[84:87]
 buffer_load_dwordx4 v139, s[56:59], s44 offen offset:3072 lds
 v_mfma_f32_16x16x32_bf16 v[88:91], a[232:235], v[252:255], v[88:91]
 ds_read_b64_tr_b16 a[216:217], v158 offset:768
 s_add_u32 s44, s44, 28672
 ds_read_b64_tr_b16 a[218:219], v158 offset:2816
 v_mfma_f32_16x16x32_bf16 v[92:95], a[236:239], v[248:251], v[92:95]
 ds_read_b64_tr_b16 a[220:221], v159 offset:768
 s_add_u32 m0, s11, 0x21000
 v_mfma_f32_16x16x32_bf16 v[96:99], a[236:239], v[252:255], v[96:99]
 ds_read_b64_tr_b16 a[222:223], v159 offset:2816
 s_waitcnt lgkmcnt(8)
 v_mfma_f32_16x16x32_bf16 v[100:103], a[240:243], v[248:251], v[100:103]
 buffer_load_dwordx4 v136, s[56:59], s44 offen offset:0 lds
 v_mfma_f32_16x16x32_bf16 v[104:107], a[240:243], v[252:255], v[104:107]
 ds_read_b64_tr_b16 a[224:225], v158 offset:1024
 ds_read_b64_tr_b16 a[226:227], v158 offset:3072
 v_mfma_f32_16x16x32_bf16 v[108:111], a[244:247], v[248:251], v[108:111]
 ds_read_b64_tr_b16 a[228:229], v159 offset:1024
 ds_read_b64_tr_b16 a[230:231], v159 offset:3072
 v_mfma_f32_16x16x32_bf16 v[112:115], a[244:247], v[252:255], v[112:115]
 buffer_load_dwordx4 v137, s[56:59], s44 offen offset:1024 lds
 v_mfma_f32_16x16x32_bf16 v[116:119], a[248:251], v[248:251], v[116:119]
 ds_read_b64_tr_b16 a[232:233], v158 offset:1280
 v_mfma_f32_16x16x32_bf16 v[120:123], a[248:251], v[252:255], v[120:123]
 ds_read_b64_tr_b16 a[234:235], v158 offset:3328
 v_mfma_f32_16x16x32_bf16 v[124:127], a[252:255], v[248:251], v[124:127]
 ds_read_b64_tr_b16 a[236:237], v159 offset:1280
 ds_read_b64_tr_b16 a[238:239], v159 offset:3328
 v_mfma_f32_16x16x32_bf16 v[128:131], a[252:255], v[252:255], v[128:131]
 buffer_load_dwordx4 v138, s[56:59], s44 offen offset:2048 lds
 buffer_load_dwordx4 v139, s[56:59], s44 offen offset:3072 lds
 s_sub_u32 s44, s44, 28544
 v_mfma_f32_16x16x32_bf16 v[4:7], a[192:195], a[152:155], v[4:7]
 ds_read_b64_tr_b16 a[240:241], v158 offset:1536
 v_mfma_f32_16x16x32_bf16 v[8:11], a[192:195], a[156:159], v[8:11]
 ds_read_b64_tr_b16 a[242:243], v158 offset:3584
 v_mfma_f32_16x16x32_bf16 v[12:15], a[196:199], a[152:155], v[12:15]
 ds_read_b64_tr_b16 a[244:245], v159 offset:1536
 v_mfma_f32_16x16x32_bf16 v[16:19], a[196:199], a[156:159], v[16:19]
 ds_read_b64_tr_b16 a[246:247], v159 offset:3584
 v_mfma_f32_16x16x32_bf16 v[20:23], a[200:203], a[152:155], v[20:23]
 ds_read_b64_tr_b16 a[248:249], v158 offset:1792
 v_mfma_f32_16x16x32_bf16 v[24:27], a[200:203], a[156:159], v[24:27]
 ds_read_b64_tr_b16 a[250:251], v158 offset:3840
 v_mfma_f32_16x16x32_bf16 v[28:31], a[204:207], a[152:155], v[28:31]
 ds_read_b64_tr_b16 a[252:253], v159 offset:1792
 v_mfma_f32_16x16x32_bf16 v[32:35], a[204:207], a[156:159], v[32:35]
 ds_read_b64_tr_b16 a[254:255], v159 offset:3840
 v_add_u32 v156, 0x8000, v146
 s_waitcnt lgkmcnt(8)
 v_mfma_f32_16x16x32_bf16 v[36:39], a[208:211], a[152:155], v[36:39]
 v_add_u32 v157, 0x8000, v147
 ds_read_b64_tr_b16 a[192:193], v156 offset:0
 v_mfma_f32_16x16x32_bf16 v[40:43], a[208:211], a[156:159], v[40:43]
 buffer_load_dword v3, v150, s[4:7], s32 offen sc1
 ds_read_b64_tr_b16 a[194:195], v156 offset:2048
 v_mfma_f32_16x16x32_bf16 v[44:47], a[212:215], a[152:155], v[44:47]
 ds_read_b64_tr_b16 a[196:197], v157 offset:0
 v_mfma_f32_16x16x32_bf16 v[48:51], a[212:215], a[156:159], v[48:51]
 ds_read_b64_tr_b16 a[198:199], v157 offset:2048
 v_mfma_f32_16x16x32_bf16 v[52:55], a[216:219], a[152:155], v[52:55]
 ds_read_b64_tr_b16 a[200:201], v156 offset:256
 v_mfma_f32_16x16x32_bf16 v[56:59], a[216:219], a[156:159], v[56:59]
 ds_read_b64_tr_b16 a[202:203], v156 offset:2304
 v_mfma_f32_16x16x32_bf16 v[60:63], a[220:223], a[152:155], v[60:63]
 ds_read_b64_tr_b16 a[204:205], v157 offset:256
 v_mfma_f32_16x16x32_bf16 v[64:67], a[220:223], a[156:159], v[64:67]
 ds_read_b64_tr_b16 a[206:207], v157 offset:2304
 v_mfma_f32_16x16x32_bf16 v[68:71], a[224:227], a[152:155], v[68:71]
 ds_read_b64_tr_b16 a[208:209], v156 offset:512
 v_mfma_f32_16x16x32_bf16 v[72:75], a[224:227], a[156:159], v[72:75]
 ds_read_b64_tr_b16 a[210:211], v156 offset:2560
 v_mfma_f32_16x16x32_bf16 v[76:79], a[228:231], a[152:155], v[76:79]
 ds_read_b64_tr_b16 a[212:213], v157 offset:512
 v_mfma_f32_16x16x32_bf16 v[80:83], a[228:231], a[156:159], v[80:83]
 ds_read_b64_tr_b16 a[214:215], v157 offset:2560
 v_mfma_f32_16x16x32_bf16 v[84:87], a[232:235], a[152:155], v[84:87]
 ds_read_b64_tr_b16 a[216:217], v156 offset:768
 v_mfma_f32_16x16x32_bf16 v[88:91], a[232:235], a[156:159], v[88:91]
 ds_read_b64_tr_b16 a[218:219], v156 offset:2816
 v_mfma_f32_16x16x32_bf16 v[92:95], a[236:239], a[152:155], v[92:95]
 ds_read_b64_tr_b16 a[220:221], v157 offset:768
 v_mfma_f32_16x16x32_bf16 v[96:99], a[236:239], a[156:159], v[96:99]
 ds_read_b64_tr_b16 a[222:223], v157 offset:2816
 s_waitcnt lgkmcnt(10)
 v_mfma_f32_16x16x32_bf16 v[100:103], a[240:243], a[152:155], v[100:103]
 ds_read_b64_tr_b16 a[224:225], v156 offset:1024
 v_mfma_f32_16x16x32_bf16 v[104:107], a[240:243], a[156:159], v[104:107]
 ds_read_b64_tr_b16 a[226:227], v156 offset:3072
 v_mfma_f32_16x16x32_bf16 v[108:111], a[244:247], a[152:155], v[108:111]
 ds_read_b64_tr_b16 a[228:229], v157 offset:1024
 v_mfma_f32_16x16x32_bf16 v[112:115], a[244:247], a[156:159], v[112:115]
 ds_read_b64_tr_b16 a[230:231], v157 offset:3072
 v_mfma_f32_16x16x32_bf16 v[116:119], a[248:251], a[152:155], v[116:119]
 ds_read_b64_tr_b16 a[232:233], v156 offset:1280
 v_mfma_f32_16x16x32_bf16 v[120:123], a[248:251], a[156:159], v[120:123]
 ds_read_b64_tr_b16 a[234:235], v156 offset:3328
 v_mfma_f32_16x16x32_bf16 v[124:127], a[252:255], a[152:155], v[124:127]
 ds_read_b64_tr_b16 a[236:237], v157 offset:1280
 ds_read_b64_tr_b16 a[238:239], v157 offset:3328
 v_mfma_f32_16x16x32_bf16 v[128:131], a[252:255], a[156:159], v[128:131]
 s_waitcnt vmcnt(12)
 s_barrier
 s_waitcnt vmcnt(0)
 v_cmp_ne_u32 vcc, 1, v3
 s_cbranch_vccnz L1_kvw
L1_kvok:
 s_cmp_eq_u32 s71, 0
 s_cbranch_scc1 L1_kva_acq
L1_kva_acqb:
 v_mfma_f32_16x16x32_bf16 v[4:7], a[192:195], a[160:163], v[4:7]
 ds_read_b64_tr_b16 a[240:241], v156 offset:1536
 v_mfma_f32_16x16x32_bf16 v[8:11], a[192:195], a[164:167], v[8:11]
 ds_read_b64_tr_b16 a[242:243], v156 offset:3584
 s_add_u32 m0, s8, 0x0
 v_mfma_f32_16x16x32_bf16 v[12:15], a[196:199], a[160:163], v[12:15]
 ds_read_b64_tr_b16 a[244:245], v157 offset:1536
 v_mfma_f32_16x16x32_bf16 v[16:19], a[196:199], a[164:167], v[16:19]
 ds_read_b64_tr_b16 a[246:247], v157 offset:3584
 v_mfma_f32_16x16x32_bf16 v[20:23], a[200:203], a[160:163], v[20:23]
 ds_read_b64_tr_b16 a[248:249], v156 offset:1792
 v_mfma_f32_16x16x32_bf16 v[24:27], a[200:203], a[164:167], v[24:27]
 ds_read_b64_tr_b16 a[250:251], v156 offset:3840
 s_waitcnt lgkmcnt(6)
 v_mfma_f32_16x16x32_bf16 v[28:31], a[204:207], a[160:163], v[28:31]
 ds_read_b64_tr_b16 a[252:253], v157 offset:1792
 v_mfma_f32_16x16x32_bf16 v[32:35], a[204:207], a[164:167], v[32:35]
 ds_read_b64_tr_b16 a[254:255], v157 offset:3840
 v_add_u32 v158, 0xc000, v146
 v_mfma_f32_16x16x32_bf16 v[36:39], a[208:211], a[160:163], v[36:39]
 v_add_u32 v159, 0xc000, v147
 ds_read_b64_tr_b16 a[192:193], v158 offset:0
 v_mfma_f32_16x16x32_bf16 v[40:43], a[208:211], a[164:167], v[40:43]
 buffer_load_dwordx4 v154, s[48:51], s60 offen offset:0 lds
 ds_read_b64_tr_b16 a[194:195], v158 offset:2048
 v_mfma_f32_16x16x32_bf16 v[44:47], a[212:215], a[160:163], v[44:47]
 ds_read_b64_tr_b16 a[196:197], v159 offset:0
 v_mfma_f32_16x16x32_bf16 v[48:51], a[212:215], a[164:167], v[48:51]
 ds_read_b64_tr_b16 a[198:199], v159 offset:2048
 v_mfma_f32_16x16x32_bf16 v[52:55], a[216:219], a[160:163], v[52:55]
 ds_read_b64_tr_b16 a[200:201], v158 offset:256
 ds_read_b64_tr_b16 a[202:203], v158 offset:2304
 v_mfma_f32_16x16x32_bf16 v[56:59], a[216:219], a[164:167], v[56:59]
 buffer_load_dwordx4 v154, s[48:51], s60 offen offset:1024 lds
 v_mfma_f32_16x16x32_bf16 v[60:63], a[220:223], a[160:163], v[60:63]
 ds_read_b64_tr_b16 a[204:205], v159 offset:256
 v_mfma_f32_16x16x32_bf16 v[64:67], a[220:223], a[164:167], v[64:67]
 ds_read_b64_tr_b16 a[206:207], v159 offset:2304
 v_mfma_f32_16x16x32_bf16 v[68:71], a[224:227], a[160:163], v[68:71]
 buffer_load_dwordx4 v154, s[48:51], s60 offen offset:2048 lds
 v_mfma_f32_16x16x32_bf16 v[72:75], a[224:227], a[164:167], v[72:75]
 ds_read_b64_tr_b16 a[208:209], v158 offset:512
 ds_read_b64_tr_b16 a[210:211], v158 offset:2560
 v_mfma_f32_16x16x32_bf16 v[76:79], a[228:231], a[160:163], v[76:79]
 ds_read_b64_tr_b16 a[212:213], v159 offset:512
 v_mfma_f32_16x16x32_bf16 v[80:83], a[228:231], a[164:167], v[80:83]
 ds_read_b64_tr_b16 a[214:215], v159 offset:2560
 v_mfma_f32_16x16x32_bf16 v[84:87], a[232:235], a[160:163], v[84:87]
 buffer_load_dwordx4 v154, s[48:51], s60 offen offset:3072 lds
 v_mfma_f32_16x16x32_bf16 v[88:91], a[232:235], a[164:167], v[88:91]
 ds_read_b64_tr_b16 a[216:217], v158 offset:768
 s_add_u32 s60, s60, 16384
 ds_read_b64_tr_b16 a[218:219], v158 offset:2816
 v_mfma_f32_16x16x32_bf16 v[92:95], a[236:239], a[160:163], v[92:95]
 s_add_u32 m0, s8, 0x4000
 ds_read_b64_tr_b16 a[220:221], v159 offset:768
 v_mfma_f32_16x16x32_bf16 v[96:99], a[236:239], a[164:167], v[96:99]
 ds_read_b64_tr_b16 a[222:223], v159 offset:2816
 s_waitcnt lgkmcnt(8)
 v_mfma_f32_16x16x32_bf16 v[100:103], a[240:243], a[160:163], v[100:103]
 buffer_load_dwordx4 v154, s[48:51], s60 offen offset:0 lds
 v_mfma_f32_16x16x32_bf16 v[104:107], a[240:243], a[164:167], v[104:107]
 ds_read_b64_tr_b16 a[224:225], v158 offset:1024
 ds_read_b64_tr_b16 a[226:227], v158 offset:3072
 v_mfma_f32_16x16x32_bf16 v[108:111], a[244:247], a[160:163], v[108:111]
 ds_read_b64_tr_b16 a[228:229], v159 offset:1024
 ds_read_b64_tr_b16 a[230:231], v159 offset:3072
 v_mfma_f32_16x16x32_bf16 v[112:115], a[244:247], a[164:167], v[112:115]
 buffer_load_dwordx4 v154, s[48:51], s60 offen offset:1024 lds
 v_mfma_f32_16x16x32_bf16 v[116:119], a[248:251], a[160:163], v[116:119]
 ds_read_b64_tr_b16 a[232:233], v158 offset:1280
 v_mfma_f32_16x16x32_bf16 v[120:123], a[248:251], a[164:167], v[120:123]
 ds_read_b64_tr_b16 a[234:235], v158 offset:3328
 v_mfma_f32_16x16x32_bf16 v[124:127], a[252:255], a[160:163], v[124:127]
 ds_read_b64_tr_b16 a[236:237], v159 offset:1280
 ds_read_b64_tr_b16 a[238:239], v159 offset:3328
 v_mfma_f32_16x16x32_bf16 v[128:131], a[252:255], a[164:167], v[128:131]
 buffer_load_dwordx4 v154, s[48:51], s60 offen offset:2048 lds
 buffer_load_dwordx4 v154, s[48:51], s60 offen offset:3072 lds
 s_add_u32 s60, s60, 16384
 v_mfma_f32_16x16x32_bf16 v[4:7], a[192:195], a[168:171], v[4:7]
 ds_read_b64_tr_b16 a[240:241], v158 offset:1536
 v_mfma_f32_16x16x32_bf16 v[8:11], a[192:195], a[172:175], v[8:11]
 ds_read_b64_tr_b16 a[242:243], v158 offset:3584
 s_add_u32 m0, s8, 0x10000
 v_mfma_f32_16x16x32_bf16 v[12:15], a[196:199], a[168:171], v[12:15]
 ds_read_b64_tr_b16 a[244:245], v159 offset:1536
 v_mfma_f32_16x16x32_bf16 v[16:19], a[196:199], a[172:175], v[16:19]
 ds_read_b64_tr_b16 a[246:247], v159 offset:3584
 v_mfma_f32_16x16x32_bf16 v[20:23], a[200:203], a[168:171], v[20:23]
 ds_read_b64_tr_b16 a[248:249], v158 offset:1792
 v_mfma_f32_16x16x32_bf16 v[24:27], a[200:203], a[172:175], v[24:27]
 ds_read_b64_tr_b16 a[250:251], v158 offset:3840
 v_mfma_f32_16x16x32_bf16 v[28:31], a[204:207], a[168:171], v[28:31]
 ds_read_b64_tr_b16 a[252:253], v159 offset:1792
 v_mfma_f32_16x16x32_bf16 v[32:35], a[204:207], a[172:175], v[32:35]
 ds_read_b64_tr_b16 a[254:255], v159 offset:3840
 v_add_u32 v156, 0x18000, v146
 s_waitcnt lgkmcnt(8)
 v_mfma_f32_16x16x32_bf16 v[36:39], a[208:211], a[168:171], v[36:39]
 v_add_u32 v157, 0x18000, v147
 ds_read_b64_tr_b16 a[192:193], v156 offset:0
 v_mfma_f32_16x16x32_bf16 v[40:43], a[208:211], a[172:175], v[40:43]
 buffer_load_dwordx4 v154, s[52:55], s61 offen offset:0 lds
 ds_read_b64_tr_b16 a[194:195], v156 offset:2048
 v_mfma_f32_16x16x32_bf16 v[44:47], a[212:215], a[168:171], v[44:47]
 v_add_u32 v158, 0x1c000, v146
 v_add_u32 v159, 0x1c000, v147
 v_mfma_f32_16x16x32_bf16 v[48:51], a[212:215], a[172:175], v[48:51]
 ds_read_b64_tr_b16 a[196:197], v158 offset:0
 ds_read_b64_tr_b16 a[198:199], v158 offset:2048
 v_mfma_f32_16x16x32_bf16 v[52:55], a[216:219], a[168:171], v[52:55]
 ds_read_b64_tr_b16 a[200:201], v157 offset:0
 ds_read_b64_tr_b16 a[202:203], v157 offset:2048
 v_mfma_f32_16x16x32_bf16 v[56:59], a[216:219], a[172:175], v[56:59]
 buffer_load_dwordx4 v154, s[52:55], s61 offen offset:1024 lds
 v_mfma_f32_16x16x32_bf16 v[60:63], a[220:223], a[168:171], v[60:63]
 ds_read_b64_tr_b16 a[204:205], v159 offset:0
 v_mfma_f32_16x16x32_bf16 v[64:67], a[220:223], a[172:175], v[64:67]
 ds_read_b64_tr_b16 a[206:207], v159 offset:2048
 v_mfma_f32_16x16x32_bf16 v[68:71], a[224:227], a[168:171], v[68:71]
 buffer_load_dwordx4 v154, s[52:55], s61 offen offset:2048 lds
 v_mfma_f32_16x16x32_bf16 v[72:75], a[224:227], a[172:175], v[72:75]
 ds_read_b64_tr_b16 a[208:209], v156 offset:256
 ds_read_b64_tr_b16 a[210:211], v156 offset:2304
 v_mfma_f32_16x16x32_bf16 v[76:79], a[228:231], a[168:171], v[76:79]
 ds_read_b64_tr_b16 a[212:213], v158 offset:256
 v_mfma_f32_16x16x32_bf16 v[80:83], a[228:231], a[172:175], v[80:83]
 ds_read_b64_tr_b16 a[214:215], v158 offset:2304
 v_mfma_f32_16x16x32_bf16 v[84:87], a[232:235], a[168:171], v[84:87]
 buffer_load_dwordx4 v154, s[52:55], s61 offen offset:3072 lds
 v_mfma_f32_16x16x32_bf16 v[88:91], a[232:235], a[172:175], v[88:91]
 ds_read_b64_tr_b16 a[216:217], v157 offset:256
 s_add_u32 s61, s61, 16384
 ds_read_b64_tr_b16 a[218:219], v157 offset:2304
 v_mfma_f32_16x16x32_bf16 v[92:95], a[236:239], a[168:171], v[92:95]
 s_add_u32 m0, s8, 0x14000
 ds_read_b64_tr_b16 a[220:221], v159 offset:256
 v_mfma_f32_16x16x32_bf16 v[96:99], a[236:239], a[172:175], v[96:99]
 ds_read_b64_tr_b16 a[222:223], v159 offset:2304
 s_waitcnt lgkmcnt(8)
 v_mfma_f32_16x16x32_bf16 v[100:103], a[240:243], a[168:171], v[100:103]
 buffer_load_dwordx4 v154, s[52:55], s61 offen offset:0 lds
 v_mfma_f32_16x16x32_bf16 v[104:107], a[240:243], a[172:175], v[104:107]
 ds_read_b64_tr_b16 a[224:225], v156 offset:512
 ds_read_b64_tr_b16 a[226:227], v156 offset:2560
 v_mfma_f32_16x16x32_bf16 v[108:111], a[244:247], a[168:171], v[108:111]
 ds_read_b64_tr_b16 a[228:229], v158 offset:512
 ds_read_b64_tr_b16 a[230:231], v158 offset:2560
 v_mfma_f32_16x16x32_bf16 v[112:115], a[244:247], a[172:175], v[112:115]
 buffer_load_dwordx4 v154, s[52:55], s61 offen offset:1024 lds
 v_mfma_f32_16x16x32_bf16 v[116:119], a[248:251], a[168:171], v[116:119]
 ds_read_b64_tr_b16 a[232:233], v157 offset:512
 buffer_load_dwordx4 v154, s[52:55], s61 offen offset:2048 lds
 v_mfma_f32_16x16x32_bf16 v[120:123], a[248:251], a[172:175], v[120:123]
 ds_read_b64_tr_b16 a[234:235], v157 offset:2560
 buffer_load_dwordx4 v154, s[52:55], s61 offen offset:3072 lds
 s_add_u32 s61, s61, 16384
 v_mfma_f32_16x16x32_bf16 v[124:127], a[252:255], a[168:171], v[124:127]
 ds_read_b64_tr_b16 a[236:237], v159 offset:512
 ds_read_b64_tr_b16 a[238:239], v159 offset:2560
 v_mfma_f32_16x16x32_bf16 v[128:131], a[252:255], a[172:175], v[128:131]
 s_barrier
 v_mfma_f32_16x16x32_bf16 v[4:7], a[192:195], a[176:179], v[4:7]
 ds_read_b64_tr_b16 a[240:241], v156 offset:768
 v_mfma_f32_16x16x32_bf16 v[8:11], a[192:195], a[180:183], v[8:11]
 ds_read_b64_tr_b16 a[242:243], v156 offset:2816
 s_add_u32 m0, s8, 0x8000
 v_mfma_f32_16x16x32_bf16 v[4:7], a[196:199], a[184:187], v[4:7]
 ds_read_b64_tr_b16 a[244:245], v158 offset:768
 v_mfma_f32_16x16x32_bf16 v[8:11], a[196:199], a[188:191], v[8:11]
 ds_read_b64_tr_b16 a[246:247], v158 offset:2816
 v_mfma_f32_16x16x32_bf16 v[12:15], a[200:203], a[176:179], v[12:15]
 ds_read_b64_tr_b16 a[248:249], v157 offset:768
 v_mfma_f32_16x16x32_bf16 v[16:19], a[200:203], a[180:183], v[16:19]
 ds_read_b64_tr_b16 a[250:251], v157 offset:2816
 v_mfma_f32_16x16x32_bf16 v[12:15], a[204:207], a[184:187], v[12:15]
 ds_read_b64_tr_b16 a[252:253], v159 offset:768
 v_mfma_f32_16x16x32_bf16 v[16:19], a[204:207], a[188:191], v[16:19]
 ds_read_b64_tr_b16 a[254:255], v159 offset:2816
 s_waitcnt lgkmcnt(8)
 v_mfma_f32_16x16x32_bf16 v[20:23], a[208:211], a[176:179], v[20:23]
 ds_read_b64_tr_b16 a[192:193], v156 offset:1024
 ds_read_b64_tr_b16 a[194:195], v156 offset:3072
 v_mfma_f32_16x16x32_bf16 v[24:27], a[208:211], a[180:183], v[24:27]
 buffer_load_dwordx4 v154, s[48:51], s60 offen offset:0 lds
 v_mfma_f32_16x16x32_bf16 v[20:23], a[212:215], a[184:187], v[20:23]
 ds_read_b64_tr_b16 a[196:197], v158 offset:1024
 v_mfma_f32_16x16x32_bf16 v[24:27], a[212:215], a[188:191], v[24:27]
 ds_read_b64_tr_b16 a[198:199], v158 offset:3072
 v_cvt_pk_bf16_f32 v192, v4, v5
 v_mfma_f32_16x16x32_bf16 v[28:31], a[216:219], a[176:179], v[28:31]
 ds_read_b64_tr_b16 a[200:201], v157 offset:1024
 v_cvt_pk_bf16_f32 v193, v6, v7
 v_mfma_f32_16x16x32_bf16 v[32:35], a[216:219], a[180:183], v[32:35]
 ds_read_b64_tr_b16 a[202:203], v157 offset:3072
 v_cvt_pk_bf16_f32 v194, v12, v13
 v_mfma_f32_16x16x32_bf16 v[28:31], a[220:223], a[184:187], v[28:31]
 ds_read_b64_tr_b16 a[204:205], v159 offset:1024
 v_cvt_pk_bf16_f32 v195, v14, v15
 v_mfma_f32_16x16x32_bf16 v[32:35], a[220:223], a[188:191], v[32:35]
 ds_read_b64_tr_b16 a[206:207], v159 offset:3072
 v_mfma_f32_16x16x32_bf16 v[36:39], a[224:227], a[176:179], v[36:39]
 ds_read_b64_tr_b16 a[208:209], v156 offset:1280
 ds_read_b64_tr_b16 a[210:211], v156 offset:3328
 v_mfma_f32_16x16x32_bf16 v[40:43], a[224:227], a[180:183], v[40:43]
 buffer_load_dwordx4 v154, s[48:51], s60 offen offset:1024 lds
 v_mfma_f32_16x16x32_bf16 v[36:39], a[228:231], a[184:187], v[36:39]
 ds_read_b64_tr_b16 a[212:213], v158 offset:1280
 v_mfma_f32_16x16x32_bf16 v[40:43], a[228:231], a[188:191], v[40:43]
 ds_read_b64_tr_b16 a[214:215], v158 offset:3328
 v_mfma_f32_16x16x32_bf16 v[44:47], a[232:235], a[176:179], v[44:47]
 buffer_store_dwordx4 v[192:195], v2, s[4:7], s41 offen offset:0 sc1
 v_mfma_f32_16x16x32_bf16 v[48:51], a[232:235], a[180:183], v[48:51]
 ds_read_b64_tr_b16 a[216:217], v157 offset:1280
 v_accvgpr_write_b32 a128, v192
 ds_read_b64_tr_b16 a[218:219], v157 offset:3328
 v_mfma_f32_16x16x32_bf16 v[44:47], a[236:239], a[184:187], v[44:47]
 v_accvgpr_write_b32 a129, v193
 v_accvgpr_write_b32 a130, v194
 v_mfma_f32_16x16x32_bf16 v[48:51], a[236:239], a[188:191], v[48:51]
 v_accvgpr_write_b32 a131, v195
 ds_read_b64_tr_b16 a[220:221], v159 offset:1280
 ds_read_b64_tr_b16 a[222:223], v159 offset:3328
 s_waitcnt lgkmcnt(6)
 v_mfma_f32_16x16x32_bf16 v[52:55], a[240:243], a[176:179], v[52:55]
 v_cvt_pk_bf16_f32 v224, v8, v9
 v_cvt_pk_bf16_f32 v225, v10, v11
 ds_read_b64_tr_b16 a[224:225], v156 offset:1536
 v_mfma_f32_16x16x32_bf16 v[56:59], a[240:243], a[180:183], v[56:59]
 v_cvt_pk_bf16_f32 v226, v16, v17
 v_cvt_pk_bf16_f32 v227, v18, v19
 ds_read_b64_tr_b16 a[226:227], v156 offset:3584
 v_mfma_f32_16x16x32_bf16 v[52:55], a[244:247], a[184:187], v[52:55]
 buffer_load_dwordx4 v154, s[48:51], s60 offen offset:2048 lds
 ds_read_b64_tr_b16 a[228:229], v158 offset:1536
 buffer_load_dwordx4 v154, s[48:51], s60 offen offset:3072 lds
 v_mfma_f32_16x16x32_bf16 v[56:59], a[244:247], a[188:191], v[56:59]
 buffer_store_dwordx4 v[224:227], v2, s[4:7], s46 offen offset:0 sc1
 ds_read_b64_tr_b16 a[230:231], v158 offset:3584
 v_mfma_f32_16x16x32_bf16 v[60:63], a[248:251], a[176:179], v[60:63]
 v_accvgpr_write_b32 a160, v224
 v_accvgpr_write_b32 a161, v225
 ds_read_b64_tr_b16 a[232:233], v157 offset:1536
 s_add_u32 s60, s60, 16384
 v_mfma_f32_16x16x32_bf16 v[64:67], a[248:251], a[180:183], v[64:67]
 v_accvgpr_write_b32 a162, v226
 v_accvgpr_write_b32 a163, v227
 ds_read_b64_tr_b16 a[234:235], v157 offset:3584
 v_mfma_f32_16x16x32_bf16 v[60:63], a[252:255], a[184:187], v[60:63]
 v_cvt_pk_bf16_f32 v196, v20, v21
 v_cvt_pk_bf16_f32 v197, v22, v23
 ds_read_b64_tr_b16 a[236:237], v159 offset:1536
 v_mfma_f32_16x16x32_bf16 v[64:67], a[252:255], a[188:191], v[64:67]
 v_cvt_pk_bf16_f32 v198, v28, v29
 v_cvt_pk_bf16_f32 v199, v30, v31
 ds_read_b64_tr_b16 a[238:239], v159 offset:3584
 v_mfma_f32_16x16x32_bf16 v[68:71], a[192:195], a[176:179], v[68:71]
 buffer_store_dwordx4 v[196:199], v2, s[4:7], s41 offen offset:1024 sc1
 ds_read_b64_tr_b16 a[240:241], v156 offset:1792
 v_mfma_f32_16x16x32_bf16 v[72:75], a[192:195], a[180:183], v[72:75]
 v_accvgpr_write_b32 a132, v196
 v_accvgpr_write_b32 a133, v197
 ds_read_b64_tr_b16 a[242:243], v156 offset:3840
 v_mfma_f32_16x16x32_bf16 v[68:71], a[196:199], a[184:187], v[68:71]
 v_accvgpr_write_b32 a134, v198
 v_accvgpr_write_b32 a135, v199
 ds_read_b64_tr_b16 a[244:245], v158 offset:1792
 v_mfma_f32_16x16x32_bf16 v[72:75], a[196:199], a[188:191], v[72:75]
 v_cvt_pk_bf16_f32 v228, v24, v25
 v_cvt_pk_bf16_f32 v229, v26, v27
 ds_read_b64_tr_b16 a[246:247], v158 offset:3840
 v_mfma_f32_16x16x32_bf16 v[76:79], a[200:203], a[176:179], v[76:79]
 v_cvt_pk_bf16_f32 v230, v32, v33
 v_cvt_pk_bf16_f32 v231, v34, v35
 ds_read_b64_tr_b16 a[248:249], v157 offset:1792
 v_mfma_f32_16x16x32_bf16 v[80:83], a[200:203], a[180:183], v[80:83]
 buffer_store_dwordx4 v[228:231], v2, s[4:7], s46 offen offset:1024 sc1
 ds_read_b64_tr_b16 a[250:251], v157 offset:3840
 v_mfma_f32_16x16x32_bf16 v[76:79], a[204:207], a[184:187], v[76:79]
 v_accvgpr_write_b32 a164, v228
 v_accvgpr_write_b32 a165, v229
 ds_read_b64_tr_b16 a[252:253], v159 offset:1792
 v_mfma_f32_16x16x32_bf16 v[80:83], a[204:207], a[188:191], v[80:83]
 v_accvgpr_write_b32 a166, v230
 v_accvgpr_write_b32 a167, v231
 ds_read_b64_tr_b16 a[254:255], v159 offset:3840
 v_mfma_f32_16x16x32_bf16 v[84:87], a[208:211], a[176:179], v[84:87]
 v_cvt_pk_bf16_f32 v200, v36, v37
 v_cvt_pk_bf16_f32 v201, v38, v39
 v_mfma_f32_16x16x32_bf16 v[88:91], a[208:211], a[180:183], v[88:91]
 v_cvt_pk_bf16_f32 v202, v44, v45
 v_cvt_pk_bf16_f32 v203, v46, v47
 s_waitcnt lgkmcnt(4)
 v_mfma_f32_16x16x32_bf16 v[84:87], a[212:215], a[184:187], v[84:87]
 buffer_store_dwordx4 v[200:203], v2, s[4:7], s41 offen offset:2048 sc1
 v_mfma_f32_16x16x32_bf16 v[88:91], a[212:215], a[188:191], v[88:91]
 v_accvgpr_write_b32 a136, v200
 v_accvgpr_write_b32 a137, v201
 v_mfma_f32_16x16x32_bf16 v[92:95], a[216:219], a[176:179], v[92:95]
 v_accvgpr_write_b32 a138, v202
 v_accvgpr_write_b32 a139, v203
 v_mfma_f32_16x16x32_bf16 v[96:99], a[216:219], a[180:183], v[96:99]
 v_cvt_pk_bf16_f32 v232, v40, v41
 v_cvt_pk_bf16_f32 v233, v42, v43
 v_mfma_f32_16x16x32_bf16 v[92:95], a[220:223], a[184:187], v[92:95]
 v_cvt_pk_bf16_f32 v234, v48, v49
 v_cvt_pk_bf16_f32 v235, v50, v51
 v_mfma_f32_16x16x32_bf16 v[96:99], a[220:223], a[188:191], v[96:99]
 buffer_store_dwordx4 v[232:235], v2, s[4:7], s46 offen offset:2048 sc1
 v_mfma_f32_16x16x32_bf16 v[100:103], a[224:227], a[176:179], v[100:103]
 v_accvgpr_write_b32 a168, v232
 v_accvgpr_write_b32 a169, v233
 v_mfma_f32_16x16x32_bf16 v[104:107], a[224:227], a[180:183], v[104:107]
 v_accvgpr_write_b32 a170, v234
 v_accvgpr_write_b32 a171, v235
 v_mfma_f32_16x16x32_bf16 v[100:103], a[228:231], a[184:187], v[100:103]
 v_cvt_pk_bf16_f32 v204, v52, v53
 v_cvt_pk_bf16_f32 v205, v54, v55
 v_mfma_f32_16x16x32_bf16 v[104:107], a[228:231], a[188:191], v[104:107]
 v_cvt_pk_bf16_f32 v206, v60, v61
 v_cvt_pk_bf16_f32 v207, v62, v63
 v_mfma_f32_16x16x32_bf16 v[108:111], a[232:235], a[176:179], v[108:111]
 buffer_store_dwordx4 v[204:207], v2, s[4:7], s41 offen offset:3072 sc1
 v_mfma_f32_16x16x32_bf16 v[112:115], a[232:235], a[180:183], v[112:115]
 v_accvgpr_write_b32 a140, v204
 v_accvgpr_write_b32 a141, v205
 v_mfma_f32_16x16x32_bf16 v[108:111], a[236:239], a[184:187], v[108:111]
 v_accvgpr_write_b32 a142, v206
 v_accvgpr_write_b32 a143, v207
 v_mfma_f32_16x16x32_bf16 v[112:115], a[236:239], a[188:191], v[112:115]
 v_cvt_pk_bf16_f32 v236, v56, v57
 v_cvt_pk_bf16_f32 v237, v58, v59
 v_mfma_f32_16x16x32_bf16 v[116:119], a[240:243], a[176:179], v[116:119]
 v_cvt_pk_bf16_f32 v238, v64, v65
 v_cvt_pk_bf16_f32 v239, v66, v67
 v_mfma_f32_16x16x32_bf16 v[120:123], a[240:243], a[180:183], v[120:123]
 buffer_store_dwordx4 v[236:239], v2, s[4:7], s46 offen offset:3072 sc1
 v_mfma_f32_16x16x32_bf16 v[116:119], a[244:247], a[184:187], v[116:119]
 v_accvgpr_write_b32 a172, v236
 v_accvgpr_write_b32 a173, v237
 v_mfma_f32_16x16x32_bf16 v[120:123], a[244:247], a[188:191], v[120:123]
 v_accvgpr_write_b32 a174, v238
 v_accvgpr_write_b32 a175, v239
 s_waitcnt lgkmcnt(0)
 v_mfma_f32_16x16x32_bf16 v[124:127], a[248:251], a[176:179], v[124:127]
 v_cvt_pk_bf16_f32 v208, v68, v69
 v_cvt_pk_bf16_f32 v209, v70, v71
 v_mfma_f32_16x16x32_bf16 v[128:131], a[248:251], a[180:183], v[128:131]
 v_cvt_pk_bf16_f32 v210, v76, v77
 v_cvt_pk_bf16_f32 v211, v78, v79
 v_mfma_f32_16x16x32_bf16 v[124:127], a[252:255], a[184:187], v[124:127]
 buffer_store_dwordx4 v[208:211], v2, s[4:7], s45 offen offset:0 sc1
 v_mfma_f32_16x16x32_bf16 v[128:131], a[252:255], a[188:191], v[128:131]
 v_accvgpr_write_b32 a144, v208
 v_accvgpr_write_b32 a145, v209
 v_accvgpr_write_b32 a146, v210
 v_accvgpr_write_b32 a147, v211
 v_cvt_pk_bf16_f32 v240, v72, v73
 v_cvt_pk_bf16_f32 v241, v74, v75
 v_cvt_pk_bf16_f32 v242, v80, v81
 v_cvt_pk_bf16_f32 v243, v82, v83
 buffer_store_dwordx4 v[240:243], v2, s[4:7], s31 offen offset:0 sc1
 v_cvt_pk_bf16_f32 v212, v84, v85
 v_cvt_pk_bf16_f32 v213, v86, v87
 v_cvt_pk_bf16_f32 v214, v92, v93
 v_cvt_pk_bf16_f32 v215, v94, v95
 buffer_store_dwordx4 v[212:215], v2, s[4:7], s45 offen offset:1024 sc1
 v_accvgpr_write_b32 a148, v212
 v_accvgpr_write_b32 a149, v213
 v_accvgpr_write_b32 a150, v214
 v_accvgpr_write_b32 a151, v215
 v_cvt_pk_bf16_f32 v244, v88, v89
 v_cvt_pk_bf16_f32 v245, v90, v91
 v_cvt_pk_bf16_f32 v246, v96, v97
 v_cvt_pk_bf16_f32 v247, v98, v99
 buffer_store_dwordx4 v[244:247], v2, s[4:7], s31 offen offset:1024 sc1
 v_cvt_pk_bf16_f32 v216, v100, v101
 v_cvt_pk_bf16_f32 v217, v102, v103
 v_cvt_pk_bf16_f32 v218, v108, v109
 v_cvt_pk_bf16_f32 v219, v110, v111
 buffer_store_dwordx4 v[216:219], v2, s[4:7], s45 offen offset:2048 sc1
 v_accvgpr_write_b32 a152, v216
 v_accvgpr_write_b32 a153, v217
 v_accvgpr_write_b32 a154, v218
 v_accvgpr_write_b32 a155, v219
 v_cvt_pk_bf16_f32 v248, v104, v105
 v_cvt_pk_bf16_f32 v249, v106, v107
 v_cvt_pk_bf16_f32 v250, v112, v113
 v_cvt_pk_bf16_f32 v251, v114, v115
 buffer_store_dwordx4 v[248:251], v2, s[4:7], s31 offen offset:2048 sc1
 s_nop 7
 v_cvt_pk_bf16_f32 v220, v116, v117
 v_cvt_pk_bf16_f32 v221, v118, v119
 v_cvt_pk_bf16_f32 v222, v124, v125
 v_cvt_pk_bf16_f32 v223, v126, v127
 buffer_store_dwordx4 v[220:223], v2, s[4:7], s45 offen offset:3072 sc1
 v_accvgpr_write_b32 a156, v220
 v_accvgpr_write_b32 a157, v221
 v_accvgpr_write_b32 a158, v222
 v_accvgpr_write_b32 a159, v223
 v_cvt_pk_bf16_f32 v252, v120, v121
 v_cvt_pk_bf16_f32 v253, v122, v123
 v_cvt_pk_bf16_f32 v254, v128, v129
 v_cvt_pk_bf16_f32 v255, v130, v131
 buffer_store_dwordx4 v[252:255], v2, s[4:7], s31 offen offset:3072 sc1
 s_mov_b32 s32, s24
 s_mov_b32 s33, s25
 s_mov_b32 s34, s26
 s_mov_b32 s35, s27
 s_mov_b32 s36, s28
 s_mov_b32 s37, s29
 s_mov_b32 s38, s18
 v_accvgpr_write_b32 a176, v240
 v_accvgpr_write_b32 a177, v241
 v_accvgpr_write_b32 a178, v242
 v_accvgpr_write_b32 a179, v243
 v_accvgpr_write_b32 a180, v244
 v_accvgpr_write_b32 a181, v245
 v_accvgpr_write_b32 a182, v246
 v_accvgpr_write_b32 a183, v247
 v_accvgpr_write_b32 a184, v248
 v_accvgpr_write_b32 a185, v249
 v_accvgpr_write_b32 a186, v250
 v_accvgpr_write_b32 a187, v251
 v_accvgpr_write_b32 a188, v252
 v_accvgpr_write_b32 a189, v253
 v_accvgpr_write_b32 a190, v254
 v_accvgpr_write_b32 a191, v255
 s_waitcnt vmcnt(32) lgkmcnt(0)
 s_barrier
 ds_read_b128 a[192:195], v2 offset:0
 ds_read_b128 a[196:199], v2 offset:1024
 ds_read_b128 a[200:203], v2 offset:2048
 ds_read_b128 a[204:207], v2 offset:3072
 ds_read_b128 a[208:211], v2 offset:4096
 ds_read_b128 a[212:215], v2 offset:5120
 ds_read_b128 a[216:219], v2 offset:6144
 ds_read_b128 a[220:223], v2 offset:7168
 ds_read_b128 a[224:227], v2 offset:8192
 ds_read_b128 a[228:231], v2 offset:9216
 ds_read_b128 a[232:235], v2 offset:10240
 ds_read_b128 a[236:239], v2 offset:11264
 ds_read_b128 a[240:243], v2 offset:12288
 ds_read_b128 a[244:247], v2 offset:13312
 ds_read_b128 a[248:251], v2 offset:14336
 ds_read_b128 a[252:255], v2 offset:15360
 s_cmp_eq_u32 s65, 1
 s_cbranch_scc1 L2_qld
 s_waitcnt lgkmcnt(8)
 v_mfma_f32_16x16x32_bf16 v[4:7], a[192:195], a[128:131], 0
 v_mfma_f32_16x16x32_bf16 v[12:15], a[192:195], a[160:163], 0
 v_mfma_f32_16x16x32_bf16 v[4:7], a[196:199], a[132:135], v[4:7]
 s_add_u32 m0, s8, 0xc000
 v_mfma_f32_16x16x32_bf16 v[12:15], a[196:199], a[164:167], v[12:15]
 v_mfma_f32_16x16x32_bf16 v[4:7], a[200:203], a[136:139], v[4:7]
 v_mfma_f32_16x16x32_bf16 v[12:15], a[200:203], a[168:171], v[12:15]
 buffer_load_dwordx4 v154, s[48:51], s60 offen offset:0 lds
 v_mfma_f32_16x16x32_bf16 v[4:7], a[204:207], a[140:143], v[4:7]
 v_mfma_f32_16x16x32_bf16 v[12:15], a[204:207], a[172:175], v[12:15]
 v_mfma_f32_16x16x32_bf16 v[4:7], a[208:211], a[144:147], v[4:7]
 buffer_load_dwordx4 v154, s[48:51], s60 offen offset:1024 lds
 v_mfma_f32_16x16x32_bf16 v[12:15], a[208:211], a[176:179], v[12:15]
 v_mfma_f32_16x16x32_bf16 v[4:7], a[212:215], a[148:151], v[4:7]
 v_mfma_f32_16x16x32_bf16 v[12:15], a[212:215], a[180:183], v[12:15]
 buffer_load_dwordx4 v154, s[48:51], s60 offen offset:2048 lds
 v_mfma_f32_16x16x32_bf16 v[4:7], a[216:219], a[152:155], v[4:7]
 v_mfma_f32_16x16x32_bf16 v[12:15], a[216:219], a[184:187], v[12:15]
 v_mfma_f32_16x16x32_bf16 v[4:7], a[220:223], a[156:159], v[4:7]
 buffer_load_dwordx4 v154, s[48:51], s60 offen offset:3072 lds
 v_mfma_f32_16x16x32_bf16 v[12:15], a[220:223], a[188:191], v[12:15]
 s_waitcnt lgkmcnt(0)
 v_mfma_f32_16x16x32_bf16 v[8:11], a[224:227], a[128:131], 0
 s_add_u32 s60, s60, 16384
 v_mfma_f32_16x16x32_bf16 v[16:19], a[224:227], a[160:163], 0
 v_mfma_f32_16x16x32_bf16 v[8:11], a[228:231], a[132:135], v[8:11]
 v_mfma_f32_16x16x32_bf16 v[16:19], a[228:231], a[164:167], v[16:19]
 s_add_u32 m0, s8, 0x18000
 v_mfma_f32_16x16x32_bf16 v[8:11], a[232:235], a[136:139], v[8:11]
 v_mfma_f32_16x16x32_bf16 v[16:19], a[232:235], a[168:171], v[16:19]
 v_mfma_f32_16x16x32_bf16 v[8:11], a[236:239], a[140:143], v[8:11]
 buffer_load_dwordx4 v154, s[52:55], s61 offen offset:0 lds
 v_mfma_f32_16x16x32_bf16 v[16:19], a[236:239], a[172:175], v[16:19]
 v_mfma_f32_16x16x32_bf16 v[8:11], a[240:243], a[144:147], v[8:11]
 v_mfma_f32_16x16x32_bf16 v[16:19], a[240:243], a[176:179], v[16:19]
 buffer_load_dwordx4 v154, s[52:55], s61 offen offset:1024 lds
 v_mfma_f32_16x16x32_bf16 v[8:11], a[244:247], a[148:151], v[8:11]
 v_mfma_f32_16x16x32_bf16 v[16:19], a[244:247], a[180:183], v[16:19]
 v_mfma_f32_16x16x32_bf16 v[8:11], a[248:251], a[152:155], v[8:11]
 buffer_load_dwordx4 v154, s[52:55], s61 offen offset:2048 lds
 v_mfma_f32_16x16x32_bf16 v[16:19], a[248:251], a[184:187], v[16:19]
 v_mfma_f32_16x16x32_bf16 v[8:11], a[252:255], a[156:159], v[8:11]
 v_mfma_f32_16x16x32_bf16 v[16:19], a[252:255], a[188:191], v[16:19]
 buffer_load_dwordx4 v154, s[52:55], s61 offen offset:3072 lds
 s_add_u32 s61, s61, 16384
 s_waitcnt vmcnt(32)
 s_branch L2_qok
L2_qld:
 s_add_u32 m0, s8, 0xc000
 s_nop 0
 buffer_load_dwordx4 v154, s[48:51], s60 offen offset:0 lds
 buffer_load_dwordx4 v154, s[48:51], s60 offen offset:1024 lds
 buffer_load_dwordx4 v154, s[48:51], s60 offen offset:2048 lds
 buffer_load_dwordx4 v154, s[48:51], s60 offen offset:3072 lds
 s_add_u32 s60, s60, 16384
 s_add_u32 m0, s8, 0x18000
 s_nop 0
 buffer_load_dwordx4 v154, s[52:55], s61 offen offset:0 lds
 buffer_load_dwordx4 v154, s[52:55], s61 offen offset:1024 lds
 buffer_load_dwordx4 v154, s[52:55], s61 offen offset:2048 lds
 buffer_load_dwordx4 v154, s[52:55], s61 offen offset:3072 lds
 s_add_u32 s61, s61, 16384
 v_mov_b32 v117, 0
 s_mov_b32 s31, 0x20000
L2_qx_poll:
 buffer_load_dword v3, v117, s[4:7], s30 offen sc1
 s_waitcnt vmcnt(0)
 v_cmp_ne_u32 vcc, 1, v3
 s_cbranch_vccz L2_qx_done
 s_sleep 2
 s_sub_u32 s31, s31, 1
 s_cbranch_scc0 L2_qx_poll
L2_qx_done:
 s_cmp_eq_u32 s71, 0
 s_cbranch_scc1 L2_qa_acq
L2_qa_acqb:
 buffer_load_dwordx4 a[128:131], v2, s[4:7], s43 offen offset:0
 buffer_load_dwordx4 a[132:135], v2, s[4:7], s43 offen offset:1024
 buffer_load_dwordx4 a[136:139], v2, s[4:7], s43 offen offset:2048
 buffer_load_dwordx4 a[140:143], v2, s[4:7], s43 offen offset:3072
 s_add_u32 s43, s43, 0x1000
 buffer_load_dwordx4 a[144:147], v2, s[4:7], s43 offen offset:0
 buffer_load_dwordx4 a[148:151], v2, s[4:7], s43 offen offset:1024
 buffer_load_dwordx4 a[152:155], v2, s[4:7], s43 offen offset:2048
 buffer_load_dwordx4 a[156:159], v2, s[4:7], s43 offen offset:3072
 s_add_u32 s43, s43, 0x1000
 buffer_load_dwordx4 a[160:163], v2, s[4:7], s43 offen offset:0
 buffer_load_dwordx4 a[164:167], v2, s[4:7], s43 offen offset:1024
 buffer_load_dwordx4 a[168:171], v2, s[4:7], s43 offen offset:2048
 buffer_load_dwordx4 a[172:175], v2, s[4:7], s43 offen offset:3072
 s_add_u32 s43, s43, 0x1000
 buffer_load_dwordx4 a[176:179], v2, s[4:7], s43 offen offset:0
 buffer_load_dwordx4 a[180:183], v2, s[4:7], s43 offen offset:1024
 buffer_load_dwordx4 a[184:187], v2, s[4:7], s43 offen offset:2048
 buffer_load_dwordx4 a[188:191], v2, s[4:7], s43 offen offset:3072
 s_add_u32 s43, s43, 0x1000
 s_add_u32 s30, s30, 16384
 s_waitcnt vmcnt(0) lgkmcnt(0)
 v_mfma_f32_16x16x32_bf16 v[4:7], a[192:195], a[128:131], 0
 v_mfma_f32_16x16x32_bf16 v[12:15], a[192:195], a[160:163], 0
 v_mfma_f32_16x16x32_bf16 v[4:7], a[196:199], a[132:135], v[4:7]
 v_mfma_f32_16x16x32_bf16 v[12:15], a[196:199], a[164:167], v[12:15]
 v_mfma_f32_16x16x32_bf16 v[4:7], a[200:203], a[136:139], v[4:7]
 v_mfma_f32_16x16x32_bf16 v[12:15], a[200:203], a[168:171], v[12:15]
 v_mfma_f32_16x16x32_bf16 v[4:7], a[204:207], a[140:143], v[4:7]
 v_mfma_f32_16x16x32_bf16 v[12:15], a[204:207], a[172:175], v[12:15]
 v_mfma_f32_16x16x32_bf16 v[4:7], a[208:211], a[144:147], v[4:7]
 v_mfma_f32_16x16x32_bf16 v[12:15], a[208:211], a[176:179], v[12:15]
 v_mfma_f32_16x16x32_bf16 v[4:7], a[212:215], a[148:151], v[4:7]
 v_mfma_f32_16x16x32_bf16 v[12:15], a[212:215], a[180:183], v[12:15]
 v_mfma_f32_16x16x32_bf16 v[4:7], a[216:219], a[152:155], v[4:7]
 v_mfma_f32_16x16x32_bf16 v[12:15], a[216:219], a[184:187], v[12:15]
 v_mfma_f32_16x16x32_bf16 v[4:7], a[220:223], a[156:159], v[4:7]
 v_mfma_f32_16x16x32_bf16 v[12:15], a[220:223], a[188:191], v[12:15]
 v_mfma_f32_16x16x32_bf16 v[8:11], a[224:227], a[128:131], 0
 v_mfma_f32_16x16x32_bf16 v[16:19], a[224:227], a[160:163], 0
 v_mfma_f32_16x16x32_bf16 v[8:11], a[228:231], a[132:135], v[8:11]
 v_mfma_f32_16x16x32_bf16 v[16:19], a[228:231], a[164:167], v[16:19]
 v_mfma_f32_16x16x32_bf16 v[8:11], a[232:235], a[136:139], v[8:11]
 v_mfma_f32_16x16x32_bf16 v[16:19], a[232:235], a[168:171], v[16:19]
 v_mfma_f32_16x16x32_bf16 v[8:11], a[236:239], a[140:143], v[8:11]
 v_mfma_f32_16x16x32_bf16 v[16:19], a[236:239], a[172:175], v[16:19]
 v_mfma_f32_16x16x32_bf16 v[8:11], a[240:243], a[144:147], v[8:11]
 v_mfma_f32_16x16x32_bf16 v[16:19], a[240:243], a[176:179], v[16:19]
 v_mfma_f32_16x16x32_bf16 v[8:11], a[244:247], a[148:151], v[8:11]
 v_mfma_f32_16x16x32_bf16 v[16:19], a[244:247], a[180:183], v[16:19]
 v_mfma_f32_16x16x32_bf16 v[8:11], a[248:251], a[152:155], v[8:11]
 v_mfma_f32_16x16x32_bf16 v[16:19], a[248:251], a[184:187], v[16:19]
 v_mfma_f32_16x16x32_bf16 v[8:11], a[252:255], a[156:159], v[8:11]
 v_mfma_f32_16x16x32_bf16 v[16:19], a[252:255], a[188:191], v[16:19]
L2_qok:
 s_barrier
 ds_read_b128 a[192:195], v2 offset:16384
 ds_read_b128 a[196:199], v2 offset:17408
 ds_read_b128 a[200:203], v2 offset:18432
 ds_read_b128 a[204:207], v2 offset:19456
 ds_read_b128 a[208:211], v2 offset:20480
 ds_read_b128 a[212:215], v2 offset:21504
 ds_read_b128 a[216:219], v2 offset:22528
 ds_read_b128 a[220:223], v2 offset:23552
 ds_read_b128 a[224:227], v2 offset:24576
 ds_read_b128 a[228:231], v2 offset:25600
 ds_read_b128 a[232:235], v2 offset:26624
 ds_read_b128 a[236:239], v2 offset:27648
 ds_read_b128 a[240:243], v2 offset:28672
 ds_read_b128 a[244:247], v2 offset:29696
 ds_read_b128 a[248:251], v2 offset:30720
L2_first:
 v_mov_b32 v72, 0
 v_mov_b32 v73, 0
 v_mov_b32 v74, 0
 v_mov_b32 v75, 0
 v_mov_b32 v76, 0
 v_mov_b32 v77, 0
 v_mov_b32 v78, 0
 v_mov_b32 v79, 0
 s_sub_u32 s41, s64, s63
 s_lshr_b32 s41, s41, 2
 s_sub_u32 s41, s41, s66
 s_cmp_eq_u32 s69, 0
 s_cselect_b32 s46, 0x40000000, 0
 s_cmp_eq_u32 s65, 2
 s_cselect_b32 s45, 5, 0
 s_mul_i32 s45, s45, s71
 s_cmp_eq_u32 s47, 2
 s_cselect_b32 s45, 99, s45
 s_cmp_eq_u32 s41, 0
 s_cselect_b32 s9, 0, 0x1000
 v_add_u32 v80, s9, v160
 v_cmp_gt_i32 s[12:13], 0, v80
 v_cmp_gt_i32 s[14:15], 1, v80
 v_cmp_gt_i32 s[16:17], 2, v80
 v_cmp_gt_i32 s[18:19], 3, v80
 v_cmp_gt_i32 s[20:21], 16, v80
 v_cmp_gt_i32 s[22:23], 17, v80
 v_cmp_gt_i32 s[24:25], 18, v80
 v_cmp_gt_i32 s[26:27], 19, v80
 v_cndmask_b32 v4, v4, v165, s[12:13]
 v_cndmask_b32 v5, v5, v165, s[14:15]
 v_cndmask_b32 v6, v6, v165, s[16:17]
 v_cndmask_b32 v7, v7, v165, s[18:19]
 v_cndmask_b32 v8, v8, v165, s[20:21]
 v_cndmask_b32 v9, v9, v165, s[22:23]
 v_cndmask_b32 v10, v10, v165, s[24:25]
 v_cndmask_b32 v11, v11, v165, s[26:27]
 v_cmp_gt_i32 s[12:13], -16, v80
 v_cmp_gt_i32 s[14:15], -15, v80
 v_cmp_gt_i32 s[16:17], -14, v80
 v_cmp_gt_i32 s[18:19], -13, v80
 v_cmp_gt_i32 s[20:21], 0, v80
 v_cmp_gt_i32 s[22:23], 1, v80
 v_cmp_gt_i32 s[24:25], 2, v80
 v_cmp_gt_i32 s[26:27], 3, v80
 v_cndmask_b32 v12, v12, v165, s[12:13]
 v_cndmask_b32 v13, v13, v165, s[14:15]
 v_cndmask_b32 v14, v14, v165, s[16:17]
 v_cndmask_b32 v15, v15, v165, s[18:19]
 v_cndmask_b32 v16, v16, v165, s[20:21]
 v_cndmask_b32 v17, v17, v165, s[22:23]
 v_cndmask_b32 v18, v18, v165, s[24:25]
 v_cndmask_b32 v19, v19, v165, s[26:27]
 v_max3_f32 v118, v4, v5, v6
 v_max3_f32 v118, v118, v7, v8
 v_max3_f32 v118, v118, v9, v10
 v_max_f32 v118, v118, v11
 v_mov_b32 v120, v118
 s_nop 1
 v_permlane16_swap_b32 v118, v120
 v_max_f32 v118, v118, v120
 v_mov_b32 v120, v118
 s_nop 1
 v_permlane32_swap_b32 v118, v120
 v_max_f32 v118, v118, v120
 v_max3_f32 v119, v12, v13, v14
 v_max3_f32 v119, v119, v15, v16
 v_max3_f32 v119, v119, v17, v18
 v_max_f32 v119, v119, v19
 v_mov_b32 v120, v119
 s_nop 1
 v_permlane16_swap_b32 v119, v120
 v_max_f32 v119, v119, v120
 v_mov_b32 v120, v119
 s_nop 1
 v_permlane32_swap_b32 v119, v120
 v_max_f32 v119, v119, v120
 v_sub_f32 v36, 0, v118
 v_sub_f32 v37, 0, v118
 v_sub_f32 v38, 0, v118
 v_sub_f32 v39, 0, v118
 v_sub_f32 v4, v4, v118
 v_sub_f32 v5, v5, v118
 v_sub_f32 v6, v6, v118
 v_sub_f32 v7, v7, v118
 v_sub_f32 v8, v8, v118
 v_sub_f32 v9, v9, v118
 v_sub_f32 v10, v10, v118
 v_sub_f32 v11, v11, v118
 v_sub_f32 v40, 0, v119
 v_sub_f32 v41, 0, v119
 v_sub_f32 v42, 0, v119
 v_sub_f32 v43, 0, v119
 v_sub_f32 v12, v12, v119
 v_sub_f32 v13, v13, v119
 v_sub_f32 v14, v14, v119
 v_sub_f32 v15, v15, v119
 v_sub_f32 v16, v16, v119
 v_sub_f32 v17, v17, v119
 v_sub_f32 v18, v18, v119
 v_sub_f32 v19, v19, v119
 v_exp_f32 v56, v4
 v_exp_f32 v57, v5
 v_exp_f32 v58, v6
 v_exp_f32 v59, v7
 v_cvt_pk_bf16_f32 v44, v56, v57
 v_exp_f32 v60, v8
 v_exp_f32 v61, v9
 v_cvt_pk_bf16_f32 v45, v58, v59
 v_exp_f32 v62, v10
 v_exp_f32 v63, v11
 v_cvt_pk_bf16_f32 v46, v60, v61
 v_cvt_pk_bf16_f32 v47, v62, v63
 s_cmp_eq_u32 s47, 3
 s_cbranch_scc1 L2_pubq
L2_pubqr:
 s_cmp_eq_u32 s41, 0
 s_cbranch_scc1 L2_M_entry
 s_branch L2_U_entry
.p2align 6
L2_U_top:
 v_mfma_f32_16x16x32_bf16 a[0:3], a[192:195], v[48:51], a[0:3]
 s_add_u32 m0, s8, 0x18000
 ds_read_b128 a[252:255], v164 offset:64512
 v_mfma_f32_16x16x32_bf16 a[4:7], a[192:195], v[52:55], a[4:7]
 ds_read_b128 a[192:195], v2 offset:16384
 v_mfma_f32_16x16x32_bf16 a[8:11], a[196:199], v[48:51], a[8:11]
 v_exp_f32 v56, v4
 v_mfma_f32_16x16x32_bf16 a[12:15], a[196:199], v[52:55], a[12:15]
 buffer_load_dwordx4 v154, s[52:55], s61 offen offset:0 lds
 v_mfma_f32_16x16x32_bf16 a[16:19], a[200:203], v[48:51], a[16:19]
 ds_read_b128 a[196:199], v2 offset:17408
 v_mfma_f32_16x16x32_bf16 a[20:23], a[200:203], v[52:55], a[20:23]
 v_exp_f32 v57, v5
 v_mfma_f32_16x16x32_bf16 a[24:27], a[204:207], v[48:51], a[24:27]
 ds_read_b128 a[200:203], v2 offset:18432
 v_mfma_f32_16x16x32_bf16 a[28:31], a[204:207], v[52:55], a[28:31]
 v_exp_f32 v58, v6
 v_mfma_f32_16x16x32_bf16 a[32:35], a[208:211], v[48:51], a[32:35]
 ds_read_b128 a[204:207], v2 offset:19456
 v_mfma_f32_16x16x32_bf16 a[36:39], a[208:211], v[52:55], a[36:39]
 buffer_load_dwordx4 v154, s[52:55], s61 offen offset:1024 lds
 v_mfma_f32_16x16x32_bf16 a[40:43], a[212:215], v[48:51], a[40:43]
 v_exp_f32 v59, v7
 v_mfma_f32_16x16x32_bf16 a[44:47], a[212:215], v[52:55], a[44:47]
 ds_read_b128 a[208:211], v2 offset:20480
 v_cvt_pk_bf16_f32 v44, v56, v57
 v_mfma_f32_16x16x32_bf16 a[48:51], a[216:219], v[48:51], a[48:51]
 ds_read_b128 a[212:215], v2 offset:21504
 v_mfma_f32_16x16x32_bf16 a[52:55], a[216:219], v[52:55], a[52:55]
 ds_read_b128 a[216:219], v2 offset:22528
 v_mfma_f32_16x16x32_bf16 a[56:59], a[220:223], v[48:51], a[56:59]
 v_exp_f32 v60, v8
 v_mfma_f32_16x16x32_bf16 a[60:63], a[220:223], v[52:55], a[60:63]
 ds_read_b128 a[220:223], v2 offset:23552
 s_waitcnt lgkmcnt(8)
 v_mfma_f32_16x16x32_bf16 a[64:67], a[224:227], v[48:51], a[64:67]
 buffer_load_dwordx4 v154, s[52:55], s61 offen offset:2048 lds
 v_mfma_f32_16x16x32_bf16 a[68:71], a[224:227], v[52:55], a[68:71]
 v_exp_f32 v61, v9
 v_mfma_f32_16x16x32_bf16 a[72:75], a[228:231], v[48:51], a[72:75]
 ds_read_b128 a[224:227], v2 offset:24576
 v_cvt_pk_bf16_f32 v45, v58, v59
 v_mfma_f32_16x16x32_bf16 a[76:79], a[228:231], v[52:55], a[76:79]
 ds_read_b128 a[228:231], v2 offset:25600
 v_mfma_f32_16x16x32_bf16 a[80:83], a[232:235], v[48:51], a[80:83]
 v_exp_f32 v62, v10
 v_mfma_f32_16x16x32_bf16 a[84:87], a[232:235], v[52:55], a[84:87]
 ds_read_b128 a[232:235], v2 offset:26624
 v_mfma_f32_16x16x32_bf16 a[88:91], a[236:239], v[48:51], a[88:91]
 buffer_load_dwordx4 v154, s[52:55], s61 offen offset:3072 lds
 v_mfma_f32_16x16x32_bf16 a[92:95], a[236:239], v[52:55], a[92:95]
 v_exp_f32 v63, v11
 v_mfma_f32_16x16x32_bf16 a[96:99], a[240:243], v[48:51], a[96:99]
 ds_read_b128 a[236:239], v2 offset:27648
 s_add_u32 s61, s61, 16384
 v_mfma_f32_16x16x32_bf16 a[100:103], a[240:243], v[52:55], a[100:103]
 v_cvt_pk_bf16_f32 v46, v60, v61
 ds_read_b128 a[240:243], v2 offset:28672
 v_mfma_f32_16x16x32_bf16 a[104:107], a[244:247], v[48:51], a[104:107]
 buffer_load_dwordx4 v[128:131], v2, s[32:35], s36 offen
 v_mfma_f32_16x16x32_bf16 a[108:111], a[244:247], v[52:55], a[108:111]
 v_cvt_pk_bf16_f32 v47, v62, v63
 ds_read_b128 a[244:247], v2 offset:29696
 v_mfma_f32_16x16x32_bf16 a[112:115], a[248:251], v[48:51], a[112:115]
 v_mfma_f32_16x16x32_bf16 a[116:119], a[248:251], v[52:55], a[116:119]
 ds_read_b128 a[248:251], v2 offset:30720
 s_add_u32 s36, s36, s37
 v_mfma_f32_16x16x32_bf16 a[120:123], a[252:255], v[48:51], a[120:123]
 s_and_b32 s36, s36, s38
 v_mfma_f32_16x16x32_bf16 a[124:127], a[252:255], v[52:55], a[124:127]
L2_U_entry:
 s_waitcnt lgkmcnt(7)
 v_mfma_f32_16x16x32_bf16 v[20:23], a[192:195], a[128:131], v[36:39]
 ds_read_b128 a[252:255], v2 offset:31744
 v_mfma_f32_16x16x32_bf16 v[28:31], a[192:195], a[160:163], v[40:43]
 s_add_u32 m0, s8, 0x0
 ds_read_b128 a[192:195], v164 offset:0
 v_mfma_f32_16x16x32_bf16 v[20:23], a[196:199], a[132:135], v[20:23]
 v_exp_f32 v56, v12
 v_mfma_f32_16x16x32_bf16 v[28:31], a[196:199], a[164:167], v[28:31]
 v_exp_f32 v57, v13
 v_mfma_f32_16x16x32_bf16 v[64:67], v[132:135], v[44:47], v[72:75]
 ds_read_b128 a[196:199], v164 offset:1024
 v_mfma_f32_16x16x32_bf16 v[20:23], a[200:203], a[136:139], v[20:23]
 buffer_load_dwordx4 v154, s[48:51], s60 offen offset:0 lds
 v_mfma_f32_16x16x32_bf16 v[28:31], a[200:203], a[168:171], v[28:31]
 v_exp_f32 v58, v14
 v_mfma_f32_16x16x32_bf16 v[20:23], a[204:207], a[140:143], v[20:23]
 v_exp_f32 v59, v15
 v_mfma_f32_16x16x32_bf16 v[28:31], a[204:207], a[172:175], v[28:31]
 ds_read_b128 a[200:203], v164 offset:2048
 v_cvt_pk_bf16_f32 v52, v56, v57
 v_mfma_f32_16x16x32_bf16 v[20:23], a[208:211], a[144:147], v[20:23]
 ds_read_b128 a[204:207], v164 offset:3072
 v_mfma_f32_16x16x32_bf16 v[28:31], a[208:211], a[176:179], v[28:31]
 v_exp_f32 v60, v16
 v_mfma_f32_16x16x32_bf16 v[20:23], a[212:215], a[148:151], v[20:23]
 ds_read_b128 a[208:211], v164 offset:4096
 v_mfma_f32_16x16x32_bf16 v[28:31], a[212:215], a[180:183], v[28:31]
 v_exp_f32 v61, v17
 v_mfma_f32_16x16x32_bf16 v[20:23], a[216:219], a[152:155], v[20:23]
 buffer_load_dwordx4 v154, s[48:51], s60 offen offset:1024 lds
 v_mfma_f32_16x16x32_bf16 v[28:31], a[216:219], a[184:187], v[28:31]
 ds_read_b128 a[212:215], v164 offset:5120
 v_cvt_pk_bf16_f32 v53, v58, v59
 v_mfma_f32_16x16x32_bf16 v[20:23], a[220:223], a[156:159], v[20:23]
 v_exp_f32 v62, v18
 v_mfma_f32_16x16x32_bf16 v[28:31], a[220:223], a[188:191], v[28:31]
 ds_read_b128 a[216:219], v164 offset:6144
 s_waitcnt lgkmcnt(7)
 v_mfma_f32_16x16x32_bf16 v[24:27], a[224:227], a[128:131], v[36:39]
 v_exp_f32 v63, v19
 v_mfma_f32_16x16x32_bf16 v[32:35], a[224:227], a[160:163], v[40:43]
 ds_read_b128 a[220:223], v164 offset:7168
 v_cvt_pk_bf16_f32 v54, v60, v61
 v_mfma_f32_16x16x32_bf16 v[24:27], a[228:231], a[132:135], v[24:27]
 ds_read_b128 a[224:227], v164 offset:8192
 v_cvt_pk_bf16_f32 v55, v62, v63
 v_mfma_f32_16x16x32_bf16 v[32:35], a[228:231], a[164:167], v[32:35]
 buffer_load_dwordx4 v154, s[48:51], s60 offen offset:2048 lds
 v_mfma_f32_16x16x32_bf16 v[24:27], a[232:235], a[136:139], v[24:27]
 ds_read_b128 a[228:231], v164 offset:9216
 v_mfma_f32_16x16x32_bf16 v[32:35], a[232:235], a[168:171], v[32:35]
 ds_read_b128 a[232:235], v164 offset:10240
 v_mfma_f32_16x16x32_bf16 v[68:71], v[132:135], v[52:55], v[76:79]
 v_mfma_f32_16x16x32_bf16 v[24:27], a[236:239], a[140:143], v[24:27]
 v_mfma_f32_16x16x32_bf16 v[32:35], a[236:239], a[172:175], v[32:35]
 ds_read_b128 a[236:239], v164 offset:11264
 v_mfma_f32_16x16x32_bf16 v[24:27], a[240:243], a[144:147], v[24:27]
 buffer_load_dwordx4 v154, s[48:51], s60 offen offset:3072 lds
 v_mfma_f32_16x16x32_bf16 v[32:35], a[240:243], a[176:179], v[32:35]
 ds_read_b128 a[240:243], v164 offset:12288
 v_mfma_f32_16x16x32_bf16 v[24:27], a[244:247], a[148:151], v[24:27]
 v_add_f32 v116, v64, v68
 v_mfma_f32_16x16x32_bf16 v[32:35], a[244:247], a[180:183], v[32:35]
 ds_read_b128 a[244:247], v164 offset:13312
 v_cmp_nge_f32 vcc, s42, v116
 v_mfma_f32_16x16x32_bf16 v[24:27], a[248:251], a[152:155], v[24:27]
 s_add_u32 s60, s60, 16384
 s_cbranch_vccnz L2_rc_U0
L2_rr_U0:
 v_mfma_f32_16x16x32_bf16 v[32:35], a[248:251], a[184:187], v[32:35]
 ds_read_b128 a[248:251], v164 offset:14336
 v_mfma_f32_16x16x32_bf16 v[24:27], a[252:255], a[156:159], v[24:27]
 v_mfma_f32_16x16x32_bf16 v[32:35], a[252:255], a[188:191], v[32:35]
 s_waitcnt vmcnt(13) lgkmcnt(7)
 s_barrier
 v_mfma_f32_16x16x32_bf16 a[0:3], a[192:195], v[44:47], a[0:3]
 s_add_u32 m0, s8, 0x1c000
 ds_read_b128 a[252:255], v164 offset:15360
 v_mfma_f32_16x16x32_bf16 a[4:7], a[192:195], v[52:55], a[4:7]
 ds_read_b128 a[192:195], v2 offset:32768
 v_mfma_f32_16x16x32_bf16 a[8:11], a[196:199], v[44:47], a[8:11]
 v_exp_f32 v56, v20
 v_mfma_f32_16x16x32_bf16 a[12:15], a[196:199], v[52:55], a[12:15]
 buffer_load_dwordx4 v154, s[52:55], s61 offen offset:0 lds
 v_mfma_f32_16x16x32_bf16 a[16:19], a[200:203], v[44:47], a[16:19]
 ds_read_b128 a[196:199], v2 offset:33792
 v_mfma_f32_16x16x32_bf16 a[20:23], a[200:203], v[52:55], a[20:23]
 v_exp_f32 v57, v21
 v_mfma_f32_16x16x32_bf16 a[24:27], a[204:207], v[44:47], a[24:27]
 ds_read_b128 a[200:203], v2 offset:34816
 v_mfma_f32_16x16x32_bf16 a[28:31], a[204:207], v[52:55], a[28:31]
 v_exp_f32 v58, v22
 v_mfma_f32_16x16x32_bf16 a[32:35], a[208:211], v[44:47], a[32:35]
 ds_read_b128 a[204:207], v2 offset:35840
 v_mfma_f32_16x16x32_bf16 a[36:39], a[208:211], v[52:55], a[36:39]
 buffer_load_dwordx4 v154, s[52:55], s61 offen offset:1024 lds
 v_mfma_f32_16x16x32_bf16 a[40:43], a[212:215], v[44:47], a[40:43]
 v_exp_f32 v59, v23
 v_mfma_f32_16x16x32_bf16 a[44:47], a[212:215], v[52:55], a[44:47]
 ds_read_b128 a[208:211], v2 offset:36864
 v_cvt_pk_bf16_f32 v48, v56, v57
 v_mfma_f32_16x16x32_bf16 a[48:51], a[216:219], v[44:47], a[48:51]
 ds_read_b128 a[212:215], v2 offset:37888
 v_mfma_f32_16x16x32_bf16 a[52:55], a[216:219], v[52:55], a[52:55]
 ds_read_b128 a[216:219], v2 offset:38912
 v_mfma_f32_16x16x32_bf16 a[56:59], a[220:223], v[44:47], a[56:59]
 v_exp_f32 v60, v24
 v_mfma_f32_16x16x32_bf16 a[60:63], a[220:223], v[52:55], a[60:63]
 ds_read_b128 a[220:223], v2 offset:39936
 s_waitcnt lgkmcnt(8)
 v_mfma_f32_16x16x32_bf16 a[64:67], a[224:227], v[44:47], a[64:67]
 buffer_load_dwordx4 v154, s[52:55], s61 offen offset:2048 lds
 v_mfma_f32_16x16x32_bf16 a[68:71], a[224:227], v[52:55], a[68:71]
 v_exp_f32 v61, v25
 v_mfma_f32_16x16x32_bf16 a[72:75], a[228:231], v[44:47], a[72:75]
 ds_read_b128 a[224:227], v2 offset:40960
 v_cvt_pk_bf16_f32 v49, v58, v59
 v_mfma_f32_16x16x32_bf16 a[76:79], a[228:231], v[52:55], a[76:79]
 ds_read_b128 a[228:231], v2 offset:41984
 v_mfma_f32_16x16x32_bf16 a[80:83], a[232:235], v[44:47], a[80:83]
 v_exp_f32 v62, v26
 v_mfma_f32_16x16x32_bf16 a[84:87], a[232:235], v[52:55], a[84:87]
 ds_read_b128 a[232:235], v2 offset:43008
 v_mfma_f32_16x16x32_bf16 a[88:91], a[236:239], v[44:47], a[88:91]
 buffer_load_dwordx4 v154, s[52:55], s61 offen offset:3072 lds
 v_mfma_f32_16x16x32_bf16 a[92:95], a[236:239], v[52:55], a[92:95]
 v_exp_f32 v63, v27
 v_mfma_f32_16x16x32_bf16 a[96:99], a[240:243], v[44:47], a[96:99]
 ds_read_b128 a[236:239], v2 offset:44032
 s_add_u32 s61, s61, 16384
 v_mfma_f32_16x16x32_bf16 a[100:103], a[240:243], v[52:55], a[100:103]
 v_cvt_pk_bf16_f32 v50, v60, v61
 ds_read_b128 a[240:243], v2 offset:45056
 v_mfma_f32_16x16x32_bf16 a[104:107], a[244:247], v[44:47], a[104:107]
 buffer_load_dwordx4 v[128:131], v2, s[32:35], s36 offen
 v_mfma_f32_16x16x32_bf16 a[108:111], a[244:247], v[52:55], a[108:111]
 v_cvt_pk_bf16_f32 v51, v62, v63
 ds_read_b128 a[244:247], v2 offset:46080
 v_mfma_f32_16x16x32_bf16 a[112:115], a[248:251], v[44:47], a[112:115]
 v_mfma_f32_16x16x32_bf16 a[116:119], a[248:251], v[52:55], a[116:119]
 ds_read_b128 a[248:251], v2 offset:47104
 s_add_u32 s36, s36, s37
 v_mfma_f32_16x16x32_bf16 a[120:123], a[252:255], v[44:47], a[120:123]
 s_and_b32 s36, s36, s38
 v_mfma_f32_16x16x32_bf16 a[124:127], a[252:255], v[52:55], a[124:127]
 s_waitcnt lgkmcnt(7)
 v_mfma_f32_16x16x32_bf16 v[4:7], a[192:195], a[128:131], v[36:39]
 ds_read_b128 a[252:255], v2 offset:48128
 v_mfma_f32_16x16x32_bf16 v[12:15], a[192:195], a[160:163], v[40:43]
 s_add_u32 m0, s8, 0x4000
 ds_read_b128 a[192:195], v164 offset:16384
 v_mfma_f32_16x16x32_bf16 v[4:7], a[196:199], a[132:135], v[4:7]
 v_exp_f32 v56, v28
 v_mfma_f32_16x16x32_bf16 v[12:15], a[196:199], a[164:167], v[12:15]
 v_exp_f32 v57, v29
 v_mfma_f32_16x16x32_bf16 v[72:75], v[132:135], v[48:51], v[64:67]
 ds_read_b128 a[196:199], v164 offset:17408
 v_mfma_f32_16x16x32_bf16 v[4:7], a[200:203], a[136:139], v[4:7]
 buffer_load_dwordx4 v154, s[48:51], s60 offen offset:0 lds
 v_mfma_f32_16x16x32_bf16 v[12:15], a[200:203], a[168:171], v[12:15]
 v_exp_f32 v58, v30
 v_mfma_f32_16x16x32_bf16 v[4:7], a[204:207], a[140:143], v[4:7]
 v_exp_f32 v59, v31
 v_mfma_f32_16x16x32_bf16 v[12:15], a[204:207], a[172:175], v[12:15]
 ds_read_b128 a[200:203], v164 offset:18432
 v_cvt_pk_bf16_f32 v52, v56, v57
 v_mfma_f32_16x16x32_bf16 v[4:7], a[208:211], a[144:147], v[4:7]
 ds_read_b128 a[204:207], v164 offset:19456
 v_mfma_f32_16x16x32_bf16 v[12:15], a[208:211], a[176:179], v[12:15]
 v_exp_f32 v60, v32
 v_mfma_f32_16x16x32_bf16 v[4:7], a[212:215], a[148:151], v[4:7]
 ds_read_b128 a[208:211], v164 offset:20480
 v_mfma_f32_16x16x32_bf16 v[12:15], a[212:215], a[180:183], v[12:15]
 v_exp_f32 v61, v33
 v_mfma_f32_16x16x32_bf16 v[4:7], a[216:219], a[152:155], v[4:7]
 buffer_load_dwordx4 v154, s[48:51], s60 offen offset:1024 lds
 v_mfma_f32_16x16x32_bf16 v[12:15], a[216:219], a[184:187], v[12:15]
 ds_read_b128 a[212:215], v164 offset:21504
 v_cvt_pk_bf16_f32 v53, v58, v59
 v_mfma_f32_16x16x32_bf16 v[4:7], a[220:223], a[156:159], v[4:7]
 v_exp_f32 v62, v34
 v_mfma_f32_16x16x32_bf16 v[12:15], a[220:223], a[188:191], v[12:15]
 ds_read_b128 a[216:219], v164 offset:22528
 s_waitcnt lgkmcnt(7)
 v_mfma_f32_16x16x32_bf16 v[8:11], a[224:227], a[128:131], v[36:39]
 v_exp_f32 v63, v35
 v_mfma_f32_16x16x32_bf16 v[16:19], a[224:227], a[160:163], v[40:43]
 ds_read_b128 a[220:223], v164 offset:23552
 v_cvt_pk_bf16_f32 v54, v60, v61
 v_mfma_f32_16x16x32_bf16 v[8:11], a[228:231], a[132:135], v[8:11]
 ds_read_b128 a[224:227], v164 offset:24576
 v_cvt_pk_bf16_f32 v55, v62, v63
 v_mfma_f32_16x16x32_bf16 v[16:19], a[228:231], a[164:167], v[16:19]
 buffer_load_dwordx4 v154, s[48:51], s60 offen offset:2048 lds
 v_mfma_f32_16x16x32_bf16 v[8:11], a[232:235], a[136:139], v[8:11]
 ds_read_b128 a[228:231], v164 offset:25600
 v_mfma_f32_16x16x32_bf16 v[16:19], a[232:235], a[168:171], v[16:19]
 ds_read_b128 a[232:235], v164 offset:26624
 v_mfma_f32_16x16x32_bf16 v[76:79], v[132:135], v[52:55], v[68:71]
 v_mfma_f32_16x16x32_bf16 v[8:11], a[236:239], a[140:143], v[8:11]
 v_mfma_f32_16x16x32_bf16 v[16:19], a[236:239], a[172:175], v[16:19]
 ds_read_b128 a[236:239], v164 offset:27648
 v_mfma_f32_16x16x32_bf16 v[8:11], a[240:243], a[144:147], v[8:11]
 buffer_load_dwordx4 v154, s[48:51], s60 offen offset:3072 lds
 v_mfma_f32_16x16x32_bf16 v[16:19], a[240:243], a[176:179], v[16:19]
 ds_read_b128 a[240:243], v164 offset:28672
 v_mfma_f32_16x16x32_bf16 v[8:11], a[244:247], a[148:151], v[8:11]
 v_add_f32 v116, v72, v76
 v_mfma_f32_16x16x32_bf16 v[16:19], a[244:247], a[180:183], v[16:19]
 ds_read_b128 a[244:247], v164 offset:29696
 v_cmp_nge_f32 vcc, s42, v116
 v_mfma_f32_16x16x32_bf16 v[8:11], a[248:251], a[152:155], v[8:11]
 s_add_u32 s60, s60, 16384
 s_cbranch_vccnz L2_rc_U1
L2_rr_U1:
 v_mfma_f32_16x16x32_bf16 v[16:19], a[248:251], a[184:187], v[16:19]
 ds_read_b128 a[248:251], v164 offset:30720
 v_mfma_f32_16x16x32_bf16 v[8:11], a[252:255], a[156:159], v[8:11]
 v_mfma_f32_16x16x32_bf16 v[16:19], a[252:255], a[188:191], v[16:19]
 s_waitcnt vmcnt(13) lgkmcnt(7)
 s_barrier
 v_mfma_f32_16x16x32_bf16 a[0:3], a[192:195], v[48:51], a[0:3]
 s_add_u32 m0, s8, 0x10000
 ds_read_b128 a[252:255], v164 offset:31744
 v_mfma_f32_16x16x32_bf16 a[4:7], a[192:195], v[52:55], a[4:7]
 ds_read_b128 a[192:195], v2 offset:49152
 v_mfma_f32_16x16x32_bf16 a[8:11], a[196:199], v[48:51], a[8:11]
 v_exp_f32 v56, v4
 v_mfma_f32_16x16x32_bf16 a[12:15], a[196:199], v[52:55], a[12:15]
 buffer_load_dwordx4 v154, s[52:55], s61 offen offset:0 lds
 v_mfma_f32_16x16x32_bf16 a[16:19], a[200:203], v[48:51], a[16:19]
 ds_read_b128 a[196:199], v2 offset:50176
 v_mfma_f32_16x16x32_bf16 a[20:23], a[200:203], v[52:55], a[20:23]
 v_exp_f32 v57, v5
 v_mfma_f32_16x16x32_bf16 a[24:27], a[204:207], v[48:51], a[24:27]
 ds_read_b128 a[200:203], v2 offset:51200
 v_mfma_f32_16x16x32_bf16 a[28:31], a[204:207], v[52:55], a[28:31]
 v_exp_f32 v58, v6
 v_mfma_f32_16x16x32_bf16 a[32:35], a[208:211], v[48:51], a[32:35]
 ds_read_b128 a[204:207], v2 offset:52224
 v_mfma_f32_16x16x32_bf16 a[36:39], a[208:211], v[52:55], a[36:39]
 buffer_load_dwordx4 v154, s[52:55], s61 offen offset:1024 lds
 v_mfma_f32_16x16x32_bf16 a[40:43], a[212:215], v[48:51], a[40:43]
 v_exp_f32 v59, v7
 v_mfma_f32_16x16x32_bf16 a[44:47], a[212:215], v[52:55], a[44:47]
 ds_read_b128 a[208:211], v2 offset:53248
 v_cvt_pk_bf16_f32 v44, v56, v57
 v_mfma_f32_16x16x32_bf16 a[48:51], a[216:219], v[48:51], a[48:51]
 ds_read_b128 a[212:215], v2 offset:54272
 v_mfma_f32_16x16x32_bf16 a[52:55], a[216:219], v[52:55], a[52:55]
 ds_read_b128 a[216:219], v2 offset:55296
 v_mfma_f32_16x16x32_bf16 a[56:59], a[220:223], v[48:51], a[56:59]
 v_exp_f32 v60, v8
 v_mfma_f32_16x16x32_bf16 a[60:63], a[220:223], v[52:55], a[60:63]
 ds_read_b128 a[220:223], v2 offset:56320
 s_waitcnt lgkmcnt(8)
 v_mfma_f32_16x16x32_bf16 a[64:67], a[224:227], v[48:51], a[64:67]
 buffer_load_dwordx4 v154, s[52:55], s61 offen offset:2048 lds
 v_mfma_f32_16x16x32_bf16 a[68:71], a[224:227], v[52:55], a[68:71]
 v_exp_f32 v61, v9
 v_mfma_f32_16x16x32_bf16 a[72:75], a[228:231], v[48:51], a[72:75]
 ds_read_b128 a[224:227], v2 offset:57344
 v_cvt_pk_bf16_f32 v45, v58, v59
 v_mfma_f32_16x16x32_bf16 a[76:79], a[228:231], v[52:55], a[76:79]
 ds_read_b128 a[228:231], v2 offset:58368
 v_mfma_f32_16x16x32_bf16 a[80:83], a[232:235], v[48:51], a[80:83]
 v_exp_f32 v62, v10
 v_mfma_f32_16x16x32_bf16 a[84:87], a[232:235], v[52:55], a[84:87]
 ds_read_b128 a[232:235], v2 offset:59392
 v_mfma_f32_16x16x32_bf16 a[88:91], a[236:239], v[48:51], a[88:91]
 buffer_load_dwordx4 v154, s[52:55], s61 offen offset:3072 lds
 v_mfma_f32_16x16x32_bf16 a[92:95], a[236:239], v[52:55], a[92:95]
 v_exp_f32 v63, v11
 v_mfma_f32_16x16x32_bf16 a[96:99], a[240:243], v[48:51], a[96:99]
 ds_read_b128 a[236:239], v2 offset:60416
 s_add_u32 s61, s61, 16384
 v_mfma_f32_16x16x32_bf16 a[100:103], a[240:243], v[52:55], a[100:103]
 v_cvt_pk_bf16_f32 v46, v60, v61
 ds_read_b128 a[240:243], v2 offset:61440
 v_mfma_f32_16x16x32_bf16 a[104:107], a[244:247], v[48:51], a[104:107]
 buffer_load_dwordx4 v[128:131], v2, s[32:35], s36 offen
 v_mfma_f32_16x16x32_bf16 a[108:111], a[244:247], v[52:55], a[108:111]
 v_cvt_pk_bf16_f32 v47, v62, v63
 ds_read_b128 a[244:247], v2 offset:62464
 v_mfma_f32_16x16x32_bf16 a[112:115], a[248:251], v[48:51], a[112:115]
 v_mfma_f32_16x16x32_bf16 a[116:119], a[248:251], v[52:55], a[116:119]
 ds_read_b128 a[248:251], v2 offset:63488
 s_add_u32 s36, s36, s37
 v_mfma_f32_16x16x32_bf16 a[120:123], a[252:255], v[48:51], a[120:123]
 s_and_b32 s36, s36, s38
 v_mfma_f32_16x16x32_bf16 a[124:127], a[252:255], v[52:55], a[124:127]
 s_waitcnt lgkmcnt(7)
 v_mfma_f32_16x16x32_bf16 v[20:23], a[192:195], a[128:131], v[36:39]
 ds_read_b128 a[252:255], v2 offset:64512
 v_mfma_f32_16x16x32_bf16 v[28:31], a[192:195], a[160:163], v[40:43]
 s_add_u32 m0, s8, 0x8000
 ds_read_b128 a[192:195], v164 offset:32768
 v_mfma_f32_16x16x32_bf16 v[20:23], a[196:199], a[132:135], v[20:23]
 v_exp_f32 v56, v12
 v_mfma_f32_16x16x32_bf16 v[28:31], a[196:199], a[164:167], v[28:31]
 v_exp_f32 v57, v13
 v_mfma_f32_16x16x32_bf16 v[64:67], v[132:135], v[44:47], v[72:75]
 ds_read_b128 a[196:199], v164 offset:33792
 v_mfma_f32_16x16x32_bf16 v[20:23], a[200:203], a[136:139], v[20:23]
 buffer_load_dwordx4 v154, s[48:51], s60 offen offset:0 lds
 v_mfma_f32_16x16x32_bf16 v[28:31], a[200:203], a[168:171], v[28:31]
 v_exp_f32 v58, v14
 v_mfma_f32_16x16x32_bf16 v[20:23], a[204:207], a[140:143], v[20:23]
 v_exp_f32 v59, v15
 v_mfma_f32_16x16x32_bf16 v[28:31], a[204:207], a[172:175], v[28:31]
 ds_read_b128 a[200:203], v164 offset:34816
 v_cvt_pk_bf16_f32 v52, v56, v57
 v_mfma_f32_16x16x32_bf16 v[20:23], a[208:211], a[144:147], v[20:23]
 ds_read_b128 a[204:207], v164 offset:35840
 v_mfma_f32_16x16x32_bf16 v[28:31], a[208:211], a[176:179], v[28:31]
 v_exp_f32 v60, v16
 v_mfma_f32_16x16x32_bf16 v[20:23], a[212:215], a[148:151], v[20:23]
 ds_read_b128 a[208:211], v164 offset:36864
 v_mfma_f32_16x16x32_bf16 v[28:31], a[212:215], a[180:183], v[28:31]
 v_exp_f32 v61, v17
 v_mfma_f32_16x16x32_bf16 v[20:23], a[216:219], a[152:155], v[20:23]
 buffer_load_dwordx4 v154, s[48:51], s60 offen offset:1024 lds
 v_mfma_f32_16x16x32_bf16 v[28:31], a[216:219], a[184:187], v[28:31]
 ds_read_b128 a[212:215], v164 offset:37888
 v_cvt_pk_bf16_f32 v53, v58, v59
 v_mfma_f32_16x16x32_bf16 v[20:23], a[220:223], a[156:159], v[20:23]
 v_exp_f32 v62, v18
 v_mfma_f32_16x16x32_bf16 v[28:31], a[220:223], a[188:191], v[28:31]
 ds_read_b128 a[216:219], v164 offset:38912
 s_waitcnt lgkmcnt(7)
 v_mfma_f32_16x16x32_bf16 v[24:27], a[224:227], a[128:131], v[36:39]
 v_exp_f32 v63, v19
 v_mfma_f32_16x16x32_bf16 v[32:35], a[224:227], a[160:163], v[40:43]
 ds_read_b128 a[220:223], v164 offset:39936
 v_cvt_pk_bf16_f32 v54, v60, v61
 v_mfma_f32_16x16x32_bf16 v[24:27], a[228:231], a[132:135], v[24:27]
 ds_read_b128 a[224:227], v164 offset:40960
 v_cvt_pk_bf16_f32 v55, v62, v63
 v_mfma_f32_16x16x32_bf16 v[32:35], a[228:231], a[164:167], v[32:35]
 buffer_load_dwordx4 v154, s[48:51], s60 offen offset:2048 lds
 v_mfma_f32_16x16x32_bf16 v[24:27], a[232:235], a[136:139], v[24:27]
 ds_read_b128 a[228:231], v164 offset:41984
 v_mfma_f32_16x16x32_bf16 v[32:35], a[232:235], a[168:171], v[32:35]
 ds_read_b128 a[232:235], v164 offset:43008
 v_mfma_f32_16x16x32_bf16 v[68:71], v[132:135], v[52:55], v[76:79]
 v_mfma_f32_16x16x32_bf16 v[24:27], a[236:239], a[140:143], v[24:27]
 v_mfma_f32_16x16x32_bf16 v[32:35], a[236:239], a[172:175], v[32:35]
 ds_read_b128 a[236:239], v164 offset:44032
 v_mfma_f32_16x16x32_bf16 v[24:27], a[240:243], a[144:147], v[24:27]
 buffer_load_dwordx4 v154, s[48:51], s60 offen offset:3072 lds
 v_mfma_f32_16x16x32_bf16 v[32:35], a[240:243], a[176:179], v[32:35]
 ds_read_b128 a[240:243], v164 offset:45056
 v_mfma_f32_16x16x32_bf16 v[24:27], a[244:247], a[148:151], v[24:27]
 v_add_f32 v116, v64, v68
 v_mfma_f32_16x16x32_bf16 v[32:35], a[244:247], a[180:183], v[32:35]
 ds_read_b128 a[244:247], v164 offset:46080
 v_cmp_nge_f32 vcc, s42, v116
 v_mfma_f32_16x16x32_bf16 v[24:27], a[248:251], a[152:155], v[24:27]
 s_add_u32 s60, s60, 16384
 s_cbranch_vccnz L2_rc_U2
L2_rr_U2:
 v_mfma_f32_16x16x32_bf16 v[32:35], a[248:251], a[184:187], v[32:35]
 ds_read_b128 a[248:251], v164 offset:47104
 v_mfma_f32_16x16x32_bf16 v[24:27], a[252:255], a[156:159], v[24:27]
 v_mfma_f32_16x16x32_bf16 v[32:35], a[252:255], a[188:191], v[32:35]
 s_waitcnt vmcnt(13) lgkmcnt(7)
 s_barrier
 v_mfma_f32_16x16x32_bf16 a[0:3], a[192:195], v[44:47], a[0:3]
 s_add_u32 m0, s8, 0x14000
 ds_read_b128 a[252:255], v164 offset:48128
 v_mfma_f32_16x16x32_bf16 a[4:7], a[192:195], v[52:55], a[4:7]
 ds_read_b128 a[192:195], v2 offset:0
 v_mfma_f32_16x16x32_bf16 a[8:11], a[196:199], v[44:47], a[8:11]
 v_exp_f32 v56, v20
 v_mfma_f32_16x16x32_bf16 a[12:15], a[196:199], v[52:55], a[12:15]
 buffer_load_dwordx4 v154, s[52:55], s61 offen offset:0 lds
 v_mfma_f32_16x16x32_bf16 a[16:19], a[200:203], v[44:47], a[16:19]
 ds_read_b128 a[196:199], v2 offset:1024
 v_mfma_f32_16x16x32_bf16 a[20:23], a[200:203], v[52:55], a[20:23]
 v_exp_f32 v57, v21
 v_mfma_f32_16x16x32_bf16 a[24:27], a[204:207], v[44:47], a[24:27]
 ds_read_b128 a[200:203], v2 offset:2048
 v_mfma_f32_16x16x32_bf16 a[28:31], a[204:207], v[52:55], a[28:31]
 v_exp_f32 v58, v22
 v_mfma_f32_16x16x32_bf16 a[32:35], a[208:211], v[44:47], a[32:35]
 ds_read_b128 a[204:207], v2 offset:3072
 v_mfma_f32_16x16x32_bf16 a[36:39], a[208:211], v[52:55], a[36:39]
 buffer_load_dwordx4 v154, s[52:55], s61 offen offset:1024 lds
 v_mfma_f32_16x16x32_bf16 a[40:43], a[212:215], v[44:47], a[40:43]
 v_exp_f32 v59, v23
 v_mfma_f32_16x16x32_bf16 a[44:47], a[212:215], v[52:55], a[44:47]
 ds_read_b128 a[208:211], v2 offset:4096
 v_cvt_pk_bf16_f32 v48, v56, v57
 v_mfma_f32_16x16x32_bf16 a[48:51], a[216:219], v[44:47], a[48:51]
 ds_read_b128 a[212:215], v2 offset:5120
 v_mfma_f32_16x16x32_bf16 a[52:55], a[216:219], v[52:55], a[52:55]
 ds_read_b128 a[216:219], v2 offset:6144
 v_mfma_f32_16x16x32_bf16 a[56:59], a[220:223], v[44:47], a[56:59]
 v_exp_f32 v60, v24
 v_mfma_f32_16x16x32_bf16 a[60:63], a[220:223], v[52:55], a[60:63]
 ds_read_b128 a[220:223], v2 offset:7168
 s_waitcnt lgkmcnt(8)
 v_mfma_f32_16x16x32_bf16 a[64:67], a[224:227], v[44:47], a[64:67]
 buffer_load_dwordx4 v154, s[52:55], s61 offen offset:2048 lds
 v_mfma_f32_16x16x32_bf16 a[68:71], a[224:227], v[52:55], a[68:71]
 v_exp_f32 v61, v25
 v_mfma_f32_16x16x32_bf16 a[72:75], a[228:231], v[44:47], a[72:75]
 ds_read_b128 a[224:227], v2 offset:8192
 v_cvt_pk_bf16_f32 v49, v58, v59
 v_mfma_f32_16x16x32_bf16 a[76:79], a[228:231], v[52:55], a[76:79]
 ds_read_b128 a[228:231], v2 offset:9216
 v_mfma_f32_16x16x32_bf16 a[80:83], a[232:235], v[44:47], a[80:83]
 v_exp_f32 v62, v26
 v_mfma_f32_16x16x32_bf16 a[84:87], a[232:235], v[52:55], a[84:87]
 ds_read_b128 a[232:235], v2 offset:10240
 v_mfma_f32_16x16x32_bf16 a[88:91], a[236:239], v[44:47], a[88:91]
 buffer_load_dwordx4 v154, s[52:55], s61 offen offset:3072 lds
 v_mfma_f32_16x16x32_bf16 a[92:95], a[236:239], v[52:55], a[92:95]
 v_exp_f32 v63, v27
 v_mfma_f32_16x16x32_bf16 a[96:99], a[240:243], v[44:47], a[96:99]
 ds_read_b128 a[236:239], v2 offset:11264
 s_add_u32 s61, s61, 16384
 v_mfma_f32_16x16x32_bf16 a[100:103], a[240:243], v[52:55], a[100:103]
 v_cvt_pk_bf16_f32 v50, v60, v61
 ds_read_b128 a[240:243], v2 offset:12288
 v_mfma_f32_16x16x32_bf16 a[104:107], a[244:247], v[44:47], a[104:107]
 buffer_load_dwordx4 v[128:131], v2, s[32:35], s36 offen
 v_mfma_f32_16x16x32_bf16 a[108:111], a[244:247], v[52:55], a[108:111]
 v_cvt_pk_bf16_f32 v51, v62, v63
 ds_read_b128 a[244:247], v2 offset:13312
 v_mfma_f32_16x16x32_bf16 a[112:115], a[248:251], v[44:47], a[112:115]
 v_mfma_f32_16x16x32_bf16 a[116:119], a[248:251], v[52:55], a[116:119]
 ds_read_b128 a[248:251], v2 offset:14336
 s_add_u32 s36, s36, s37
 v_mfma_f32_16x16x32_bf16 a[120:123], a[252:255], v[44:47], a[120:123]
 s_and_b32 s36, s36, s38
 v_mfma_f32_16x16x32_bf16 a[124:127], a[252:255], v[52:55], a[124:127]
 s_waitcnt lgkmcnt(7)
 v_mfma_f32_16x16x32_bf16 v[4:7], a[192:195], a[128:131], v[36:39]
 ds_read_b128 a[252:255], v2 offset:15360
 v_mfma_f32_16x16x32_bf16 v[12:15], a[192:195], a[160:163], v[40:43]
 s_add_u32 m0, s8, 0xc000
 ds_read_b128 a[192:195], v164 offset:49152
 v_mfma_f32_16x16x32_bf16 v[4:7], a[196:199], a[132:135], v[4:7]
 v_exp_f32 v56, v28
 v_mfma_f32_16x16x32_bf16 v[12:15], a[196:199], a[164:167], v[12:15]
 v_exp_f32 v57, v29
 v_mfma_f32_16x16x32_bf16 v[72:75], v[132:135], v[48:51], v[64:67]
 ds_read_b128 a[196:199], v164 offset:50176
 v_mfma_f32_16x16x32_bf16 v[4:7], a[200:203], a[136:139], v[4:7]
 buffer_load_dwordx4 v154, s[48:51], s60 offen offset:0 lds
 v_mfma_f32_16x16x32_bf16 v[12:15], a[200:203], a[168:171], v[12:15]
 v_exp_f32 v58, v30
 v_mfma_f32_16x16x32_bf16 v[4:7], a[204:207], a[140:143], v[4:7]
 v_exp_f32 v59, v31
 v_mfma_f32_16x16x32_bf16 v[12:15], a[204:207], a[172:175], v[12:15]
 ds_read_b128 a[200:203], v164 offset:51200
 v_cvt_pk_bf16_f32 v52, v56, v57
 v_mfma_f32_16x16x32_bf16 v[4:7], a[208:211], a[144:147], v[4:7]
 ds_read_b128 a[204:207], v164 offset:52224
 v_mfma_f32_16x16x32_bf16 v[12:15], a[208:211], a[176:179], v[12:15]
 v_exp_f32 v60, v32
 v_mfma_f32_16x16x32_bf16 v[4:7], a[212:215], a[148:151], v[4:7]
 ds_read_b128 a[208:211], v164 offset:53248
 v_mfma_f32_16x16x32_bf16 v[12:15], a[212:215], a[180:183], v[12:15]
 v_exp_f32 v61, v33
 v_mfma_f32_16x16x32_bf16 v[4:7], a[216:219], a[152:155], v[4:7]
 buffer_load_dwordx4 v154, s[48:51], s60 offen offset:1024 lds
 v_mfma_f32_16x16x32_bf16 v[12:15], a[216:219], a[184:187], v[12:15]
 ds_read_b128 a[212:215], v164 offset:54272
 v_cvt_pk_bf16_f32 v53, v58, v59
 v_mfma_f32_16x16x32_bf16 v[4:7], a[220:223], a[156:159], v[4:7]
 v_exp_f32 v62, v34
 v_mfma_f32_16x16x32_bf16 v[12:15], a[220:223], a[188:191], v[12:15]
 ds_read_b128 a[216:219], v164 offset:55296
 s_waitcnt lgkmcnt(7)
 v_mfma_f32_16x16x32_bf16 v[8:11], a[224:227], a[128:131], v[36:39]
 v_exp_f32 v63, v35
 v_mfma_f32_16x16x32_bf16 v[16:19], a[224:227], a[160:163], v[40:43]
 ds_read_b128 a[220:223], v164 offset:56320
 v_cvt_pk_bf16_f32 v54, v60, v61
 v_mfma_f32_16x16x32_bf16 v[8:11], a[228:231], a[132:135], v[8:11]
 ds_read_b128 a[224:227], v164 offset:57344
 v_cvt_pk_bf16_f32 v55, v62, v63
 v_mfma_f32_16x16x32_bf16 v[16:19], a[228:231], a[164:167], v[16:19]
 buffer_load_dwordx4 v154, s[48:51], s60 offen offset:2048 lds
 v_mfma_f32_16x16x32_bf16 v[8:11], a[232:235], a[136:139], v[8:11]
 ds_read_b128 a[228:231], v164 offset:58368
 v_mfma_f32_16x16x32_bf16 v[16:19], a[232:235], a[168:171], v[16:19]
 ds_read_b128 a[232:235], v164 offset:59392
 v_mfma_f32_16x16x32_bf16 v[76:79], v[132:135], v[52:55], v[68:71]
 v_mfma_f32_16x16x32_bf16 v[8:11], a[236:239], a[140:143], v[8:11]
 v_mfma_f32_16x16x32_bf16 v[16:19], a[236:239], a[172:175], v[16:19]
 ds_read_b128 a[236:239], v164 offset:60416
 v_mfma_f32_16x16x32_bf16 v[8:11], a[240:243], a[144:147], v[8:11]
 buffer_load_dwordx4 v154, s[48:51], s60 offen offset:3072 lds
 v_mfma_f32_16x16x32_bf16 v[16:19], a[240:243], a[176:179], v[16:19]
 ds_read_b128 a[240:243], v164 offset:61440
 v_mfma_f32_16x16x32_bf16 v[8:11], a[244:247], a[148:151], v[8:11]
 v_add_f32 v116, v72, v76
 v_mfma_f32_16x16x32_bf16 v[16:19], a[244:247], a[180:183], v[16:19]
 ds_read_b128 a[244:247], v164 offset:62464
 v_cmp_nge_f32 vcc, s42, v116
 v_mfma_f32_16x16x32_bf16 v[8:11], a[248:251], a[152:155], v[8:11]
 s_add_u32 s60, s60, 16384
 s_cbranch_vccnz L2_rc_U3
L2_rr_U3:
 v_mfma_f32_16x16x32_bf16 v[16:19], a[248:251], a[184:187], v[16:19]
 ds_read_b128 a[248:251], v164 offset:63488
 v_mfma_f32_16x16x32_bf16 v[8:11], a[252:255], a[156:159], v[8:11]
 v_mfma_f32_16x16x32_bf16 v[16:19], a[252:255], a[188:191], v[16:19]
 s_waitcnt vmcnt(13) lgkmcnt(7)
 s_barrier
 s_sub_u32 s41, s41, 1
 s_cmp_gt_u32 s41, s45
 s_cbranch_scc1 L2_U_top
 s_cmp_eq_u32 s47, 2
 s_cbranch_scc0 L2_nopub
 v_mov_b32 v126, 1
 v_mov_b32 v127, 0
 s_mov_b32 s47, 0
 s_cmp_eq_u32 s71, 0
 s_cbranch_scc1 L2_ps_slow
 buffer_store_dword v126, v127, s[4:7], s30 offen
L2_ps_back:
 s_mov_b32 s45, 0
 s_cmp_lg_u32 s41, 0
 s_cbranch_scc1 L2_U_top
L2_nopub:
 s_cmp_eq_u32 s41, 0
 s_cbranch_scc1 L2_U_exit
 s_cmp_eq_u32 s41, 5
 s_cbranch_scc1 L2_ev2
 v_cmp_ne_u32 vcc, 1, v3
 s_cbranch_vccnz L2_ev2
 s_lshl_b32 s10, s70, 10
 s_add_u32 s10, s10, 0x5200000
 buffer_load_dwordx4 v[92:95], v2, s[4:7], s10 offen
 s_lshl_b32 s10, s70, 14
 s_add_u32 s10, s10, 0x4a00000
 buffer_load_dwordx4 v[192:195], v2, s[4:7], s10 offen offset:0
 buffer_load_dwordx4 v[196:199], v2, s[4:7], s10 offen offset:1024
 buffer_load_dwordx4 v[200:203], v2, s[4:7], s10 offen offset:2048
 buffer_load_dwordx4 v[204:207], v2, s[4:7], s10 offen offset:3072
 s_add_u32 s10, s10, 0x1000
 buffer_load_dwordx4 v[208:211], v2, s[4:7], s10 offen offset:0
 buffer_load_dwordx4 v[212:215], v2, s[4:7], s10 offen offset:1024
 buffer_load_dwordx4 v[216:219], v2, s[4:7], s10 offen offset:2048
 buffer_load_dwordx4 v[220:223], v2, s[4:7], s10 offen offset:3072
 s_add_u32 s10, s10, 0x1000
 buffer_load_dwordx4 v[224:227], v2, s[4:7], s10 offen offset:0
 buffer_load_dwordx4 v[228:231], v2, s[4:7], s10 offen offset:1024
 buffer_load_dwordx4 v[232:235], v2, s[4:7], s10 offen offset:2048
 buffer_load_dwordx4 v[236:239], v2, s[4:7], s10 offen offset:3072
 s_add_u32 s10, s10, 0x1000
 buffer_load_dwordx4 v[240:243], v2, s[4:7], s10 offen offset:0
 buffer_load_dwordx4 v[244:247], v2, s[4:7], s10 offen offset:1024
 buffer_load_dwordx4 v[248:251], v2, s[4:7], s10 offen offset:2048
 buffer_load_dwordx4 v[252:255], v2, s[4:7], s10 offen offset:3072
 s_mov_b32 s47, 1
 s_mov_b32 s45, 0
 s_branch L2_U_top
L2_ev2:
 v_mov_b32 v117, 0
 s_nop 0
 buffer_load_dword v3, v117, s[4:7], s30 offen sc1
 s_branch L2_U_top
L2_U_exit:
 s_cmp_lg_u32 s45, 0
 s_cbranch_scc1 L2_ev3
L2_ev3r:
 s_cmp_eq_u32 s66, 0
 s_cbranch_scc1 L2_fin
 v_mfma_f32_16x16x32_bf16 a[0:3], a[192:195], v[48:51], a[0:3]
 s_add_u32 m0, s8, 0x18000
 ds_read_b128 a[252:255], v164 offset:64512
 v_mfma_f32_16x16x32_bf16 a[4:7], a[192:195], v[52:55], a[4:7]
 ds_read_b128 a[192:195], v2 offset:16384
 v_cmp_gt_i32 s[12:13], 0, v160
 v_mfma_f32_16x16x32_bf16 a[8:11], a[196:199], v[48:51], a[8:11]
 buffer_load_dwordx4 v154, s[52:55], s61 offen offset:0 lds
 v_mfma_f32_16x16x32_bf16 a[12:15], a[196:199], v[52:55], a[12:15]
 v_cmp_gt_i32 s[14:15], 1, v160
 ds_read_b128 a[196:199], v2 offset:17408
 v_mfma_f32_16x16x32_bf16 a[16:19], a[200:203], v[48:51], a[16:19]
 v_cmp_gt_i32 s[16:17], 2, v160
 v_cmp_gt_i32 s[18:19], 3, v160
 v_mfma_f32_16x16x32_bf16 a[20:23], a[200:203], v[52:55], a[20:23]
 ds_read_b128 a[200:203], v2 offset:18432
 v_cmp_gt_i32 s[20:21], 16, v160
 v_mfma_f32_16x16x32_bf16 a[24:27], a[204:207], v[48:51], a[24:27]
 v_cmp_gt_i32 s[22:23], 17, v160
 v_mfma_f32_16x16x32_bf16 a[28:31], a[204:207], v[52:55], a[28:31]
 ds_read_b128 a[204:207], v2 offset:19456
 v_cmp_gt_i32 s[24:25], 18, v160
 v_mfma_f32_16x16x32_bf16 a[32:35], a[208:211], v[48:51], a[32:35]
 v_cmp_gt_i32 s[26:27], 19, v160
 v_mfma_f32_16x16x32_bf16 a[36:39], a[208:211], v[52:55], a[36:39]
 buffer_load_dwordx4 v154, s[52:55], s61 offen offset:1024 lds
 v_mfma_f32_16x16x32_bf16 a[40:43], a[212:215], v[48:51], a[40:43]
 ds_read_b128 a[208:211], v2 offset:20480
 v_cndmask_b32 v4, v4, v165, s[12:13]
 v_mfma_f32_16x16x32_bf16 a[44:47], a[212:215], v[52:55], a[44:47]
 v_cndmask_b32 v5, v5, v165, s[14:15]
 ds_read_b128 a[212:215], v2 offset:21504
 v_mfma_f32_16x16x32_bf16 a[48:51], a[216:219], v[48:51], a[48:51]
 v_cndmask_b32 v6, v6, v165, s[16:17]
 v_cndmask_b32 v7, v7, v165, s[18:19]
 v_mfma_f32_16x16x32_bf16 a[52:55], a[216:219], v[52:55], a[52:55]
 ds_read_b128 a[216:219], v2 offset:22528
 v_cndmask_b32 v8, v8, v165, s[20:21]
 v_mfma_f32_16x16x32_bf16 a[56:59], a[220:223], v[48:51], a[56:59]
 v_cndmask_b32 v9, v9, v165, s[22:23]
 v_cndmask_b32 v10, v10, v165, s[24:25]
 v_mfma_f32_16x16x32_bf16 a[60:63], a[220:223], v[52:55], a[60:63]
 ds_read_b128 a[220:223], v2 offset:23552
 s_waitcnt lgkmcnt(8)
 v_mfma_f32_16x16x32_bf16 a[64:67], a[224:227], v[48:51], a[64:67]
 buffer_load_dwordx4 v154, s[52:55], s61 offen offset:2048 lds
 v_mfma_f32_16x16x32_bf16 a[68:71], a[224:227], v[52:55], a[68:71]
 v_cndmask_b32 v11, v11, v165, s[26:27]
 ds_read_b128 a[224:227], v2 offset:24576
 v_mfma_f32_16x16x32_bf16 a[72:75], a[228:231], v[48:51], a[72:75]
 v_exp_f32 v56, v4
 v_mfma_f32_16x16x32_bf16 a[76:79], a[228:231], v[52:55], a[76:79]
 v_exp_f32 v57, v5
 v_mfma_f32_16x16x32_bf16 a[80:83], a[232:235], v[48:51], a[80:83]
 ds_read_b128 a[228:231], v2 offset:25600
 v_mfma_f32_16x16x32_bf16 a[84:87], a[232:235], v[52:55], a[84:87]
 v_exp_f32 v58, v6
 v_mfma_f32_16x16x32_bf16 a[88:91], a[236:239], v[48:51], a[88:91]
 v_exp_f32 v59, v7
 v_mfma_f32_16x16x32_bf16 a[92:95], a[236:239], v[52:55], a[92:95]
 ds_read_b128 a[232:235], v2 offset:26624
 v_cvt_pk_bf16_f32 v44, v56, v57
 v_mfma_f32_16x16x32_bf16 a[96:99], a[240:243], v[48:51], a[96:99]
 buffer_load_dwordx4 v154, s[52:55], s61 offen offset:3072 lds
 ds_read_b128 a[236:239], v2 offset:27648
 v_mfma_f32_16x16x32_bf16 a[100:103], a[240:243], v[52:55], a[100:103]
 v_exp_f32 v60, v8
 v_mfma_f32_16x16x32_bf16 a[104:107], a[244:247], v[48:51], a[104:107]
 s_add_u32 s61, s61, 16384
 ds_read_b128 a[240:243], v2 offset:28672
 v_mfma_f32_16x16x32_bf16 a[108:111], a[244:247], v[52:55], a[108:111]
 v_exp_f32 v61, v9
 v_mfma_f32_16x16x32_bf16 a[112:115], a[248:251], v[48:51], a[112:115]
 v_cvt_pk_bf16_f32 v45, v58, v59
 ds_read_b128 a[244:247], v2 offset:29696
 v_mfma_f32_16x16x32_bf16 a[116:119], a[248:251], v[52:55], a[116:119]
 v_exp_f32 v62, v10
 ds_read_b128 a[248:251], v2 offset:30720
 v_mfma_f32_16x16x32_bf16 a[120:123], a[252:255], v[48:51], a[120:123]
 v_exp_f32 v63, v11
 v_mfma_f32_16x16x32_bf16 a[124:127], a[252:255], v[52:55], a[124:127]
 v_cvt_pk_bf16_f32 v46, v60, v61
 v_cvt_pk_bf16_f32 v47, v62, v63
L2_M_entry:
 s_waitcnt lgkmcnt(7)
 v_mfma_f32_16x16x32_bf16 v[20:23], a[192:195], a[128:131], v[36:39]
 ds_read_b128 a[252:255], v2 offset:31744
 v_cmp_gt_i32 s[12:13], -16, v160
 v_mfma_f32_16x16x32_bf16 v[28:31], a[192:195], a[160:163], v[40:43]
 s_add_u32 m0, s8, 0x0
 s_mov_b32 s60, s46
 v_mfma_f32_16x16x32_bf16 v[20:23], a[196:199], a[132:135], v[20:23]
 ds_read_b128 a[192:195], v164 offset:0
 v_cmp_gt_i32 s[14:15], -15, v160
 v_mfma_f32_16x16x32_bf16 v[28:31], a[196:199], a[164:167], v[28:31]
 v_cmp_gt_i32 s[16:17], -14, v160
 ds_read_b128 a[196:199], v164 offset:1024
 v_mfma_f32_16x16x32_bf16 v[64:67], v[132:135], v[44:47], v[72:75]
 buffer_load_dwordx4 v154, s[48:51], s60 offen offset:0 lds
 v_mfma_f32_16x16x32_bf16 v[20:23], a[200:203], a[136:139], v[20:23]
 v_cmp_gt_i32 s[18:19], -13, v160
 v_cmp_gt_i32 s[20:21], 0, v160
 v_mfma_f32_16x16x32_bf16 v[28:31], a[200:203], a[168:171], v[28:31]
 v_cmp_gt_i32 s[22:23], 1, v160
 v_cmp_gt_i32 s[24:25], 2, v160
 v_mfma_f32_16x16x32_bf16 v[20:23], a[204:207], a[140:143], v[20:23]
 ds_read_b128 a[200:203], v164 offset:2048
 v_cmp_gt_i32 s[26:27], 3, v160
 v_mfma_f32_16x16x32_bf16 v[28:31], a[204:207], a[172:175], v[28:31]
 v_cndmask_b32 v12, v12, v165, s[12:13]
 ds_read_b128 a[204:207], v164 offset:3072
 v_mfma_f32_16x16x32_bf16 v[20:23], a[208:211], a[144:147], v[20:23]
 v_cndmask_b32 v13, v13, v165, s[14:15]
 v_cndmask_b32 v14, v14, v165, s[16:17]
 v_mfma_f32_16x16x32_bf16 v[28:31], a[208:211], a[176:179], v[28:31]
 ds_read_b128 a[208:211], v164 offset:4096
 v_cndmask_b32 v15, v15, v165, s[18:19]
 v_mfma_f32_16x16x32_bf16 v[20:23], a[212:215], a[148:151], v[20:23]
 v_cndmask_b32 v16, v16, v165, s[20:21]
 v_cndmask_b32 v17, v17, v165, s[22:23]
 v_mfma_f32_16x16x32_bf16 v[28:31], a[212:215], a[180:183], v[28:31]
 buffer_load_dwordx4 v154, s[48:51], s60 offen offset:1024 lds
 v_mfma_f32_16x16x32_bf16 v[20:23], a[216:219], a[152:155], v[20:23]
 ds_read_b128 a[212:215], v164 offset:5120
 v_cndmask_b32 v18, v18, v165, s[24:25]
 v_mfma_f32_16x16x32_bf16 v[28:31], a[216:219], a[184:187], v[28:31]
 v_cndmask_b32 v19, v19, v165, s[26:27]
 ds_read_b128 a[216:219], v164 offset:6144
 v_mfma_f32_16x16x32_bf16 v[20:23], a[220:223], a[156:159], v[20:23]
 v_exp_f32 v56, v12
 v_mfma_f32_16x16x32_bf16 v[28:31], a[220:223], a[188:191], v[28:31]
 ds_read_b128 a[220:223], v164 offset:7168
 s_waitcnt lgkmcnt(8)
 v_mfma_f32_16x16x32_bf16 v[24:27], a[224:227], a[128:131], v[36:39]
 v_exp_f32 v57, v13
 v_mfma_f32_16x16x32_bf16 v[32:35], a[224:227], a[160:163], v[40:43]
 v_exp_f32 v58, v14
 v_mfma_f32_16x16x32_bf16 v[24:27], a[228:231], a[132:135], v[24:27]
 v_exp_f32 v59, v15
 v_mfma_f32_16x16x32_bf16 v[32:35], a[228:231], a[164:167], v[32:35]
 v_cvt_pk_bf16_f32 v52, v56, v57
 ds_read_b128 a[224:227], v164 offset:8192
 v_mfma_f32_16x16x32_bf16 v[24:27], a[232:235], a[136:139], v[24:27]
 v_exp_f32 v60, v16
 ds_read_b128 a[228:231], v164 offset:9216
 v_mfma_f32_16x16x32_bf16 v[32:35], a[232:235], a[168:171], v[32:35]
 buffer_load_dwordx4 v154, s[48:51], s60 offen offset:2048 lds
 v_mfma_f32_16x16x32_bf16 v[24:27], a[236:239], a[140:143], v[24:27]
 v_exp_f32 v61, v17
 v_mfma_f32_16x16x32_bf16 v[32:35], a[236:239], a[172:175], v[32:35]
 v_cvt_pk_bf16_f32 v53, v58, v59
 ds_read_b128 a[232:235], v164 offset:10240
 v_mfma_f32_16x16x32_bf16 v[24:27], a[240:243], a[144:147], v[24:27]
 v_exp_f32 v62, v18
 v_exp_f32 v63, v19
 v_cvt_pk_bf16_f32 v54, v60, v61
 v_cvt_pk_bf16_f32 v55, v62, v63
 v_mfma_f32_16x16x32_bf16 v[32:35], a[240:243], a[176:179], v[32:35]
 ds_read_b128 a[236:239], v164 offset:11264
 v_mfma_f32_16x16x32_bf16 v[68:71], v[132:135], v[52:55], v[76:79]
 ds_read_b128 a[240:243], v164 offset:12288
 v_mfma_f32_16x16x32_bf16 v[24:27], a[244:247], a[148:151], v[24:27]
 buffer_load_dwordx4 v154, s[48:51], s60 offen offset:3072 lds
 v_mfma_f32_16x16x32_bf16 v[32:35], a[244:247], a[180:183], v[32:35]
 ds_read_b128 a[244:247], v164 offset:13312
 v_mfma_f32_16x16x32_bf16 v[24:27], a[248:251], a[152:155], v[24:27]
 s_add_u32 s60, s60, 16384
 v_mfma_f32_16x16x32_bf16 v[32:35], a[248:251], a[184:187], v[32:35]
 ds_read_b128 a[248:251], v164 offset:14336
 v_mfma_f32_16x16x32_bf16 v[24:27], a[252:255], a[156:159], v[24:27]
 v_add_f32 v116, v64, v68
 v_cmp_nge_f32 vcc, s42, v116
 v_mfma_f32_16x16x32_bf16 v[32:35], a[252:255], a[188:191], v[32:35]
 s_cbranch_vccnz L2_rc_M0
L2_rr_M0:
 s_waitcnt vmcnt(12) lgkmcnt(7)
 s_barrier
 v_mfma_f32_16x16x32_bf16 a[0:3], a[192:195], v[44:47], a[0:3]
 s_add_u32 m0, s8, 0x1c000
 ds_read_b128 a[252:255], v164 offset:15360
 v_mfma_f32_16x16x32_bf16 a[4:7], a[192:195], v[52:55], a[4:7]
 ds_read_b128 a[192:195], v2 offset:32768
 v_cmp_gt_i32 s[12:13], 0, v161
 v_mfma_f32_16x16x32_bf16 a[8:11], a[196:199], v[44:47], a[8:11]
 buffer_load_dwordx4 v154, s[52:55], s61 offen offset:0 lds
 v_mfma_f32_16x16x32_bf16 a[12:15], a[196:199], v[52:55], a[12:15]
 v_cmp_gt_i32 s[14:15], 1, v161
 ds_read_b128 a[196:199], v2 offset:33792
 v_mfma_f32_16x16x32_bf16 a[16:19], a[200:203], v[44:47], a[16:19]
 v_cmp_gt_i32 s[16:17], 2, v161
 v_cmp_gt_i32 s[18:19], 3, v161
 v_mfma_f32_16x16x32_bf16 a[20:23], a[200:203], v[52:55], a[20:23]
 ds_read_b128 a[200:203], v2 offset:34816
 v_cmp_gt_i32 s[20:21], 16, v161
 v_mfma_f32_16x16x32_bf16 a[24:27], a[204:207], v[44:47], a[24:27]
 v_cmp_gt_i32 s[22:23], 17, v161
 v_mfma_f32_16x16x32_bf16 a[28:31], a[204:207], v[52:55], a[28:31]
 ds_read_b128 a[204:207], v2 offset:35840
 v_cmp_gt_i32 s[24:25], 18, v161
 v_mfma_f32_16x16x32_bf16 a[32:35], a[208:211], v[44:47], a[32:35]
 v_cmp_gt_i32 s[26:27], 19, v161
 v_mfma_f32_16x16x32_bf16 a[36:39], a[208:211], v[52:55], a[36:39]
 buffer_load_dwordx4 v154, s[52:55], s61 offen offset:1024 lds
 v_mfma_f32_16x16x32_bf16 a[40:43], a[212:215], v[44:47], a[40:43]
 ds_read_b128 a[208:211], v2 offset:36864
 v_cndmask_b32 v20, v20, v165, s[12:13]
 v_mfma_f32_16x16x32_bf16 a[44:47], a[212:215], v[52:55], a[44:47]
 v_cndmask_b32 v21, v21, v165, s[14:15]
 ds_read_b128 a[212:215], v2 offset:37888
 v_mfma_f32_16x16x32_bf16 a[48:51], a[216:219], v[44:47], a[48:51]
 v_cndmask_b32 v22, v22, v165, s[16:17]
 v_cndmask_b32 v23, v23, v165, s[18:19]
 v_mfma_f32_16x16x32_bf16 a[52:55], a[216:219], v[52:55], a[52:55]
 ds_read_b128 a[216:219], v2 offset:38912
 v_cndmask_b32 v24, v24, v165, s[20:21]
 v_mfma_f32_16x16x32_bf16 a[56:59], a[220:223], v[44:47], a[56:59]
 v_cndmask_b32 v25, v25, v165, s[22:23]
 v_cndmask_b32 v26, v26, v165, s[24:25]
 v_mfma_f32_16x16x32_bf16 a[60:63], a[220:223], v[52:55], a[60:63]
 ds_read_b128 a[220:223], v2 offset:39936
 s_waitcnt lgkmcnt(8)
 v_mfma_f32_16x16x32_bf16 a[64:67], a[224:227], v[44:47], a[64:67]
 buffer_load_dwordx4 v154, s[52:55], s61 offen offset:2048 lds
 v_mfma_f32_16x16x32_bf16 a[68:71], a[224:227], v[52:55], a[68:71]
 v_cndmask_b32 v27, v27, v165, s[26:27]
 ds_read_b128 a[224:227], v2 offset:40960
 v_mfma_f32_16x16x32_bf16 a[72:75], a[228:231], v[44:47], a[72:75]
 v_exp_f32 v56, v20
 v_mfma_f32_16x16x32_bf16 a[76:79], a[228:231], v[52:55], a[76:79]
 v_exp_f32 v57, v21
 v_mfma_f32_16x16x32_bf16 a[80:83], a[232:235], v[44:47], a[80:83]
 ds_read_b128 a[228:231], v2 offset:41984
 v_mfma_f32_16x16x32_bf16 a[84:87], a[232:235], v[52:55], a[84:87]
 v_exp_f32 v58, v22
 v_mfma_f32_16x16x32_bf16 a[88:91], a[236:239], v[44:47], a[88:91]
 v_exp_f32 v59, v23
 v_mfma_f32_16x16x32_bf16 a[92:95], a[236:239], v[52:55], a[92:95]
 ds_read_b128 a[232:235], v2 offset:43008
 v_cvt_pk_bf16_f32 v48, v56, v57
 v_mfma_f32_16x16x32_bf16 a[96:99], a[240:243], v[44:47], a[96:99]
 buffer_load_dwordx4 v154, s[52:55], s61 offen offset:3072 lds
 ds_read_b128 a[236:239], v2 offset:44032
 v_mfma_f32_16x16x32_bf16 a[100:103], a[240:243], v[52:55], a[100:103]
 v_exp_f32 v60, v24
 v_mfma_f32_16x16x32_bf16 a[104:107], a[244:247], v[44:47], a[104:107]
 s_add_u32 s61, s61, 16384
 ds_read_b128 a[240:243], v2 offset:45056
 v_mfma_f32_16x16x32_bf16 a[108:111], a[244:247], v[52:55], a[108:111]
 v_exp_f32 v61, v25
 v_mfma_f32_16x16x32_bf16 a[112:115], a[248:251], v[44:47], a[112:115]
 v_cvt_pk_bf16_f32 v49, v58, v59
 ds_read_b128 a[244:247], v2 offset:46080
 v_mfma_f32_16x16x32_bf16 a[116:119], a[248:251], v[52:55], a[116:119]
 v_exp_f32 v62, v26
 ds_read_b128 a[248:251], v2 offset:47104
 v_mfma_f32_16x16x32_bf16 a[120:123], a[252:255], v[44:47], a[120:123]
 v_exp_f32 v63, v27
 v_mfma_f32_16x16x32_bf16 a[124:127], a[252:255], v[52:55], a[124:127]
 v_cvt_pk_bf16_f32 v50, v60, v61
 v_cvt_pk_bf16_f32 v51, v62, v63
 s_waitcnt lgkmcnt(7)
 v_mfma_f32_16x16x32_bf16 v[4:7], a[192:195], a[128:131], v[36:39]
 ds_read_b128 a[252:255], v2 offset:48128
 v_cmp_gt_i32 s[12:13], -16, v161
 v_mfma_f32_16x16x32_bf16 v[12:15], a[192:195], a[160:163], v[40:43]
 s_add_u32 m0, s8, 0x4000
 ds_read_b128 a[192:195], v164 offset:16384
 v_mfma_f32_16x16x32_bf16 v[4:7], a[196:199], a[132:135], v[4:7]
 v_cmp_gt_i32 s[14:15], -15, v161
 v_mfma_f32_16x16x32_bf16 v[12:15], a[196:199], a[164:167], v[12:15]
 v_cmp_gt_i32 s[16:17], -14, v161
 ds_read_b128 a[196:199], v164 offset:17408
 v_mfma_f32_16x16x32_bf16 v[72:75], v[132:135], v[48:51], v[64:67]
 buffer_load_dwordx4 v154, s[48:51], s60 offen offset:0 lds
 v_mfma_f32_16x16x32_bf16 v[4:7], a[200:203], a[136:139], v[4:7]
 v_cmp_gt_i32 s[18:19], -13, v161
 v_cmp_gt_i32 s[20:21], 0, v161
 v_mfma_f32_16x16x32_bf16 v[12:15], a[200:203], a[168:171], v[12:15]
 v_cmp_gt_i32 s[22:23], 1, v161
 v_cmp_gt_i32 s[24:25], 2, v161
 v_mfma_f32_16x16x32_bf16 v[4:7], a[204:207], a[140:143], v[4:7]
 ds_read_b128 a[200:203], v164 offset:18432
 v_cmp_gt_i32 s[26:27], 3, v161
 v_mfma_f32_16x16x32_bf16 v[12:15], a[204:207], a[172:175], v[12:15]
 v_cndmask_b32 v28, v28, v165, s[12:13]
 ds_read_b128 a[204:207], v164 offset:19456
 v_mfma_f32_16x16x32_bf16 v[4:7], a[208:211], a[144:147], v[4:7]
 v_cndmask_b32 v29, v29, v165, s[14:15]
 v_cndmask_b32 v30, v30, v165, s[16:17]
 v_mfma_f32_16x16x32_bf16 v[12:15], a[208:211], a[176:179], v[12:15]
 ds_read_b128 a[208:211], v164 offset:20480
 v_cndmask_b32 v31, v31, v165, s[18:19]
 v_mfma_f32_16x16x32_bf16 v[4:7], a[212:215], a[148:151], v[4:7]
 v_cndmask_b32 v32, v32, v165, s[20:21]
 v_cndmask_b32 v33, v33, v165, s[22:23]
 v_mfma_f32_16x16x32_bf16 v[12:15], a[212:215], a[180:183], v[12:15]
 buffer_load_dwordx4 v154, s[48:51], s60 offen offset:1024 lds
 v_mfma_f32_16x16x32_bf16 v[4:7], a[216:219], a[152:155], v[4:7]
 ds_read_b128 a[212:215], v164 offset:21504
 v_cndmask_b32 v34, v34, v165, s[24:25]
 v_mfma_f32_16x16x32_bf16 v[12:15], a[216:219], a[184:187], v[12:15]
 v_cndmask_b32 v35, v35, v165, s[26:27]
 ds_read_b128 a[216:219], v164 offset:22528
 v_mfma_f32_16x16x32_bf16 v[4:7], a[220:223], a[156:159], v[4:7]
 v_exp_f32 v56, v28
 v_mfma_f32_16x16x32_bf16 v[12:15], a[220:223], a[188:191], v[12:15]
 ds_read_b128 a[220:223], v164 offset:23552
 s_waitcnt lgkmcnt(8)
 v_mfma_f32_16x16x32_bf16 v[8:11], a[224:227], a[128:131], v[36:39]
 v_exp_f32 v57, v29
 v_mfma_f32_16x16x32_bf16 v[16:19], a[224:227], a[160:163], v[40:43]
 v_exp_f32 v58, v30
 v_mfma_f32_16x16x32_bf16 v[8:11], a[228:231], a[132:135], v[8:11]
 v_exp_f32 v59, v31
 v_mfma_f32_16x16x32_bf16 v[16:19], a[228:231], a[164:167], v[16:19]
 v_cvt_pk_bf16_f32 v52, v56, v57
 ds_read_b128 a[224:227], v164 offset:24576
 v_mfma_f32_16x16x32_bf16 v[8:11], a[232:235], a[136:139], v[8:11]
 v_exp_f32 v60, v32
 ds_read_b128 a[228:231], v164 offset:25600
 v_mfma_f32_16x16x32_bf16 v[16:19], a[232:235], a[168:171], v[16:19]
 buffer_load_dwordx4 v154, s[48:51], s60 offen offset:2048 lds
 v_mfma_f32_16x16x32_bf16 v[8:11], a[236:239], a[140:143], v[8:11]
 v_exp_f32 v61, v33
 v_mfma_f32_16x16x32_bf16 v[16:19], a[236:239], a[172:175], v[16:19]
 v_cvt_pk_bf16_f32 v53, v58, v59
 ds_read_b128 a[232:235], v164 offset:26624
 v_mfma_f32_16x16x32_bf16 v[8:11], a[240:243], a[144:147], v[8:11]
 v_exp_f32 v62, v34
 v_exp_f32 v63, v35
 v_cvt_pk_bf16_f32 v54, v60, v61
 v_cvt_pk_bf16_f32 v55, v62, v63
 v_mfma_f32_16x16x32_bf16 v[16:19], a[240:243], a[176:179], v[16:19]
 ds_read_b128 a[236:239], v164 offset:27648
 v_mfma_f32_16x16x32_bf16 v[76:79], v[132:135], v[52:55], v[68:71]
 ds_read_b128 a[240:243], v164 offset:28672
 v_mfma_f32_16x16x32_bf16 v[8:11], a[244:247], a[148:151], v[8:11]
 buffer_load_dwordx4 v154, s[48:51], s60 offen offset:3072 lds
 v_mfma_f32_16x16x32_bf16 v[16:19], a[244:247], a[180:183], v[16:19]
 ds_read_b128 a[244:247], v164 offset:29696
 v_mfma_f32_16x16x32_bf16 v[8:11], a[248:251], a[152:155], v[8:11]
 s_add_u32 s60, s60, 16384
 v_mfma_f32_16x16x32_bf16 v[16:19], a[248:251], a[184:187], v[16:19]
 ds_read_b128 a[248:251], v164 offset:30720
 v_mfma_f32_16x16x32_bf16 v[8:11], a[252:255], a[156:159], v[8:11]
 v_add_f32 v116, v72, v76
 v_cmp_nge_f32 vcc, s42, v116
 v_mfma_f32_16x16x32_bf16 v[16:19], a[252:255], a[188:191], v[16:19]
 s_cbranch_vccnz L2_rc_M1
L2_rr_M1:
 s_waitcnt vmcnt(12) lgkmcnt(7)
 s_barrier
 s_cmp_eq_u32 s47, 2
 s_cbranch_scc1 L2_pub2
L2_pub2r:
 v_mfma_f32_16x16x32_bf16 a[0:3], a[192:195], v[48:51], a[0:3]
 s_add_u32 m0, s8, 0x10000
 s_mov_b32 s61, s46
 v_mfma_f32_16x16x32_bf16 a[4:7], a[192:195], v[52:55], a[4:7]
 ds_read_b128 a[252:255], v164 offset:31744
 v_cmp_gt_i32 s[12:13], 0, v162
 v_mfma_f32_16x16x32_bf16 a[8:11], a[196:199], v[48:51], a[8:11]
 ds_read_b128 a[192:195], v2 offset:49152
 v_cmp_gt_i32 s[14:15], 1, v162
 v_mfma_f32_16x16x32_bf16 a[12:15], a[196:199], v[52:55], a[12:15]
 buffer_load_dwordx4 v154, s[52:55], s61 offen offset:0 lds
 v_mfma_f32_16x16x32_bf16 a[16:19], a[200:203], v[48:51], a[16:19]
 ds_read_b128 a[196:199], v2 offset:50176
 v_cmp_gt_i32 s[16:17], 2, v162
 v_mfma_f32_16x16x32_bf16 a[20:23], a[200:203], v[52:55], a[20:23]
 v_cmp_gt_i32 s[18:19], 3, v162
 ds_read_b128 a[200:203], v2 offset:51200
 v_mfma_f32_16x16x32_bf16 a[24:27], a[204:207], v[48:51], a[24:27]
 v_cmp_gt_i32 s[20:21], 16, v162
 v_cmp_gt_i32 s[22:23], 17, v162
 v_mfma_f32_16x16x32_bf16 a[28:31], a[204:207], v[52:55], a[28:31]
 ds_read_b128 a[204:207], v2 offset:52224
 v_cmp_gt_i32 s[24:25], 18, v162
 v_mfma_f32_16x16x32_bf16 a[32:35], a[208:211], v[48:51], a[32:35]
 v_cmp_gt_i32 s[26:27], 19, v162
 v_mfma_f32_16x16x32_bf16 a[36:39], a[208:211], v[52:55], a[36:39]
 buffer_load_dwordx4 v154, s[52:55], s61 offen offset:1024 lds
 v_mfma_f32_16x16x32_bf16 a[40:43], a[212:215], v[48:51], a[40:43]
 ds_read_b128 a[208:211], v2 offset:53248
 v_cndmask_b32 v4, v4, v165, s[12:13]
 v_mfma_f32_16x16x32_bf16 a[44:47], a[212:215], v[52:55], a[44:47]
 v_cndmask_b32 v5, v5, v165, s[14:15]
 ds_read_b128 a[212:215], v2 offset:54272
 v_mfma_f32_16x16x32_bf16 a[48:51], a[216:219], v[48:51], a[48:51]
 v_cndmask_b32 v6, v6, v165, s[16:17]
 v_cndmask_b32 v7, v7, v165, s[18:19]
 v_mfma_f32_16x16x32_bf16 a[52:55], a[216:219], v[52:55], a[52:55]
 ds_read_b128 a[216:219], v2 offset:55296
 v_cndmask_b32 v8, v8, v165, s[20:21]
 v_mfma_f32_16x16x32_bf16 a[56:59], a[220:223], v[48:51], a[56:59]
 v_cndmask_b32 v9, v9, v165, s[22:23]
 v_cndmask_b32 v10, v10, v165, s[24:25]
 v_mfma_f32_16x16x32_bf16 a[60:63], a[220:223], v[52:55], a[60:63]
 ds_read_b128 a[220:223], v2 offset:56320
 s_waitcnt lgkmcnt(8)
 v_mfma_f32_16x16x32_bf16 a[64:67], a[224:227], v[48:51], a[64:67]
 buffer_load_dwordx4 v154, s[52:55], s61 offen offset:2048 lds
 v_mfma_f32_16x16x32_bf16 a[68:71], a[224:227], v[52:55], a[68:71]
 v_cndmask_b32 v11, v11, v165, s[26:27]
 ds_read_b128 a[224:227], v2 offset:57344
 v_mfma_f32_16x16x32_bf16 a[72:75], a[228:231], v[48:51], a[72:75]
 v_exp_f32 v56, v4
 v_mfma_f32_16x16x32_bf16 a[76:79], a[228:231], v[52:55], a[76:79]
 v_exp_f32 v57, v5
 v_mfma_f32_16x16x32_bf16 a[80:83], a[232:235], v[48:51], a[80:83]
 ds_read_b128 a[228:231], v2 offset:58368
 v_mfma_f32_16x16x32_bf16 a[84:87], a[232:235], v[52:55], a[84:87]
 v_exp_f32 v58, v6
 v_mfma_f32_16x16x32_bf16 a[88:91], a[236:239], v[48:51], a[88:91]
 v_exp_f32 v59, v7
 v_mfma_f32_16x16x32_bf16 a[92:95], a[236:239], v[52:55], a[92:95]
 ds_read_b128 a[232:235], v2 offset:59392
 v_cvt_pk_bf16_f32 v44, v56, v57
 v_mfma_f32_16x16x32_bf16 a[96:99], a[240:243], v[48:51], a[96:99]
 buffer_load_dwordx4 v154, s[52:55], s61 offen offset:3072 lds
 ds_read_b128 a[236:239], v2 offset:60416
 v_mfma_f32_16x16x32_bf16 a[100:103], a[240:243], v[52:55], a[100:103]
 v_exp_f32 v60, v8
 v_mfma_f32_16x16x32_bf16 a[104:107], a[244:247], v[48:51], a[104:107]
 s_add_u32 s61, s61, 16384
 ds_read_b128 a[240:243], v2 offset:61440
 v_mfma_f32_16x16x32_bf16 a[108:111], a[244:247], v[52:55], a[108:111]
 v_exp_f32 v61, v9
 v_mfma_f32_16x16x32_bf16 a[112:115], a[248:251], v[48:51], a[112:115]
 v_cvt_pk_bf16_f32 v45, v58, v59
 ds_read_b128 a[244:247], v2 offset:62464
 v_mfma_f32_16x16x32_bf16 a[116:119], a[248:251], v[52:55], a[116:119]
 v_exp_f32 v62, v10
 ds_read_b128 a[248:251], v2 offset:63488
 v_mfma_f32_16x16x32_bf16 a[120:123], a[252:255], v[48:51], a[120:123]
 v_exp_f32 v63, v11
 v_mfma_f32_16x16x32_bf16 a[124:127], a[252:255], v[52:55], a[124:127]
 v_cvt_pk_bf16_f32 v46, v60, v61
 v_cvt_pk_bf16_f32 v47, v62, v63
 s_waitcnt lgkmcnt(7)
 v_mfma_f32_16x16x32_bf16 v[20:23], a[192:195], a[128:131], v[36:39]
 ds_read_b128 a[252:255], v2 offset:64512
 v_cmp_gt_i32 s[12:13], -16, v162
 v_mfma_f32_16x16x32_bf16 v[28:31], a[192:195], a[160:163], v[40:43]
 s_add_u32 m0, s8, 0x8000
 ds_read_b128 a[192:195], v164 offset:32768
 v_mfma_f32_16x16x32_bf16 v[20:23], a[196:199], a[132:135], v[20:23]
 v_cmp_gt_i32 s[14:15], -15, v162
 v_mfma_f32_16x16x32_bf16 v[28:31], a[196:199], a[164:167], v[28:31]
 v_cmp_gt_i32 s[16:17], -14, v162
 ds_read_b128 a[196:199], v164 offset:33792
 v_mfma_f32_16x16x32_bf16 v[64:67], v[132:135], v[44:47], v[72:75]
 buffer_load_dwordx4 v154, s[48:51], s60 offen offset:0 lds
 v_mfma_f32_16x16x32_bf16 v[20:23], a[200:203], a[136:139], v[20:23]
 v_cmp_gt_i32 s[18:19], -13, v162
 v_cmp_gt_i32 s[20:21], 0, v162
 v_mfma_f32_16x16x32_bf16 v[28:31], a[200:203], a[168:171], v[28:31]
 v_cmp_gt_i32 s[22:23], 1, v162
 v_cmp_gt_i32 s[24:25], 2, v162
 v_mfma_f32_16x16x32_bf16 v[20:23], a[204:207], a[140:143], v[20:23]
 ds_read_b128 a[200:203], v164 offset:34816
 v_cmp_gt_i32 s[26:27], 3, v162
 v_mfma_f32_16x16x32_bf16 v[28:31], a[204:207], a[172:175], v[28:31]
 v_cndmask_b32 v12, v12, v165, s[12:13]
 ds_read_b128 a[204:207], v164 offset:35840
 v_mfma_f32_16x16x32_bf16 v[20:23], a[208:211], a[144:147], v[20:23]
 v_cndmask_b32 v13, v13, v165, s[14:15]
 v_cndmask_b32 v14, v14, v165, s[16:17]
 v_mfma_f32_16x16x32_bf16 v[28:31], a[208:211], a[176:179], v[28:31]
 ds_read_b128 a[208:211], v164 offset:36864
 v_cndmask_b32 v15, v15, v165, s[18:19]
 v_mfma_f32_16x16x32_bf16 v[20:23], a[212:215], a[148:151], v[20:23]
 v_cndmask_b32 v16, v16, v165, s[20:21]
 v_cndmask_b32 v17, v17, v165, s[22:23]
 v_mfma_f32_16x16x32_bf16 v[28:31], a[212:215], a[180:183], v[28:31]
 buffer_load_dwordx4 v154, s[48:51], s60 offen offset:1024 lds
 v_mfma_f32_16x16x32_bf16 v[20:23], a[216:219], a[152:155], v[20:23]
 ds_read_b128 a[212:215], v164 offset:37888
 v_cndmask_b32 v18, v18, v165, s[24:25]
 v_mfma_f32_16x16x32_bf16 v[28:31], a[216:219], a[184:187], v[28:31]
 v_cndmask_b32 v19, v19, v165, s[26:27]
 ds_read_b128 a[216:219], v164 offset:38912
 v_mfma_f32_16x16x32_bf16 v[20:23], a[220:223], a[156:159], v[20:23]
 v_exp_f32 v56, v12
 v_mfma_f32_16x16x32_bf16 v[28:31], a[220:223], a[188:191], v[28:31]
 ds_read_b128 a[220:223], v164 offset:39936
 s_waitcnt lgkmcnt(8)
 v_mfma_f32_16x16x32_bf16 v[24:27], a[224:227], a[128:131], v[36:39]
 v_exp_f32 v57, v13
 v_mfma_f32_16x16x32_bf16 v[32:35], a[224:227], a[160:163], v[40:43]
 v_exp_f32 v58, v14
 v_mfma_f32_16x16x32_bf16 v[24:27], a[228:231], a[132:135], v[24:27]
 v_exp_f32 v59, v15
 v_mfma_f32_16x16x32_bf16 v[32:35], a[228:231], a[164:167], v[32:35]
 v_cvt_pk_bf16_f32 v52, v56, v57
 ds_read_b128 a[224:227], v164 offset:40960
 v_mfma_f32_16x16x32_bf16 v[24:27], a[232:235], a[136:139], v[24:27]
 v_exp_f32 v60, v16
 ds_read_b128 a[228:231], v164 offset:41984
 v_mfma_f32_16x16x32_bf16 v[32:35], a[232:235], a[168:171], v[32:35]
 buffer_load_dwordx4 v154, s[48:51], s60 offen offset:2048 lds
 v_mfma_f32_16x16x32_bf16 v[24:27], a[236:239], a[140:143], v[24:27]
 v_exp_f32 v61, v17
 v_mfma_f32_16x16x32_bf16 v[32:35], a[236:239], a[172:175], v[32:35]
 v_cvt_pk_bf16_f32 v53, v58, v59
 ds_read_b128 a[232:235], v164 offset:43008
 v_mfma_f32_16x16x32_bf16 v[24:27], a[240:243], a[144:147], v[24:27]
 v_exp_f32 v62, v18
 v_exp_f32 v63, v19
 v_cvt_pk_bf16_f32 v54, v60, v61
 v_cvt_pk_bf16_f32 v55, v62, v63
 v_mfma_f32_16x16x32_bf16 v[32:35], a[240:243], a[176:179], v[32:35]
 ds_read_b128 a[236:239], v164 offset:44032
 v_mfma_f32_16x16x32_bf16 v[68:71], v[132:135], v[52:55], v[76:79]
 ds_read_b128 a[240:243], v164 offset:45056
 v_mfma_f32_16x16x32_bf16 v[24:27], a[244:247], a[148:151], v[24:27]
 buffer_load_dwordx4 v154, s[48:51], s60 offen offset:3072 lds
 v_mfma_f32_16x16x32_bf16 v[32:35], a[244:247], a[180:183], v[32:35]
 ds_read_b128 a[244:247], v164 offset:46080
 v_mfma_f32_16x16x32_bf16 v[24:27], a[248:251], a[152:155], v[24:27]
 s_add_u32 s60, s60, 16384
 v_mfma_f32_16x16x32_bf16 v[32:35], a[248:251], a[184:187], v[32:35]
 ds_read_b128 a[248:251], v164 offset:47104
 v_mfma_f32_16x16x32_bf16 v[24:27], a[252:255], a[156:159], v[24:27]
 v_add_f32 v116, v64, v68
 v_cmp_nge_f32 vcc, s42, v116
 v_mfma_f32_16x16x32_bf16 v[32:35], a[252:255], a[188:191], v[32:35]
 s_cbranch_vccnz L2_rc_M2
L2_rr_M2:
 s_waitcnt vmcnt(12) lgkmcnt(7)
 s_barrier
 v_mfma_f32_16x16x32_bf16 a[0:3], a[192:195], v[44:47], a[0:3]
 s_add_u32 m0, s8, 0x14000
 ds_read_b128 a[252:255], v164 offset:48128
 v_mfma_f32_16x16x32_bf16 a[4:7], a[192:195], v[52:55], a[4:7]
 ds_read_b128 a[192:195], v2 offset:0
 v_cmp_gt_i32 s[12:13], 0, v163
 v_mfma_f32_16x16x32_bf16 a[8:11], a[196:199], v[44:47], a[8:11]
 buffer_load_dwordx4 v154, s[52:55], s61 offen offset:0 lds
 v_mfma_f32_16x16x32_bf16 a[12:15], a[196:199], v[52:55], a[12:15]
 v_cmp_gt_i32 s[14:15], 1, v163
 ds_read_b128 a[196:199], v2 offset:1024
 v_mfma_f32_16x16x32_bf16 a[16:19], a[200:203], v[44:47], a[16:19]
 v_cmp_gt_i32 s[16:17], 2, v163
 v_cmp_gt_i32 s[18:19], 3, v163
 v_mfma_f32_16x16x32_bf16 a[20:23], a[200:203], v[52:55], a[20:23]
 ds_read_b128 a[200:203], v2 offset:2048
 v_cmp_gt_i32 s[20:21], 16, v163
 v_mfma_f32_16x16x32_bf16 a[24:27], a[204:207], v[44:47], a[24:27]
 v_cmp_gt_i32 s[22:23], 17, v163
 v_mfma_f32_16x16x32_bf16 a[28:31], a[204:207], v[52:55], a[28:31]
 ds_read_b128 a[204:207], v2 offset:3072
 v_cmp_gt_i32 s[24:25], 18, v163
 v_mfma_f32_16x16x32_bf16 a[32:35], a[208:211], v[44:47], a[32:35]
 v_cmp_gt_i32 s[26:27], 19, v163
 v_mfma_f32_16x16x32_bf16 a[36:39], a[208:211], v[52:55], a[36:39]
 buffer_load_dwordx4 v154, s[52:55], s61 offen offset:1024 lds
 v_mfma_f32_16x16x32_bf16 a[40:43], a[212:215], v[44:47], a[40:43]
 ds_read_b128 a[208:211], v2 offset:4096
 v_cndmask_b32 v20, v20, v165, s[12:13]
 v_mfma_f32_16x16x32_bf16 a[44:47], a[212:215], v[52:55], a[44:47]
 v_cndmask_b32 v21, v21, v165, s[14:15]
 ds_read_b128 a[212:215], v2 offset:5120
 v_mfma_f32_16x16x32_bf16 a[48:51], a[216:219], v[44:47], a[48:51]
 v_cndmask_b32 v22, v22, v165, s[16:17]
 v_cndmask_b32 v23, v23, v165, s[18:19]
 v_mfma_f32_16x16x32_bf16 a[52:55], a[216:219], v[52:55], a[52:55]
 ds_read_b128 a[216:219], v2 offset:6144
 v_cndmask_b32 v24, v24, v165, s[20:21]
 v_mfma_f32_16x16x32_bf16 a[56:59], a[220:223], v[44:47], a[56:59]
 v_cndmask_b32 v25, v25, v165, s[22:23]
 v_cndmask_b32 v26, v26, v165, s[24:25]
 v_mfma_f32_16x16x32_bf16 a[60:63], a[220:223], v[52:55], a[60:63]
 ds_read_b128 a[220:223], v2 offset:7168
 s_waitcnt lgkmcnt(8)
 v_mfma_f32_16x16x32_bf16 a[64:67], a[224:227], v[44:47], a[64:67]
 buffer_load_dwordx4 v154, s[52:55], s61 offen offset:2048 lds
 v_mfma_f32_16x16x32_bf16 a[68:71], a[224:227], v[52:55], a[68:71]
 v_cndmask_b32 v27, v27, v165, s[26:27]
 ds_read_b128 a[224:227], v2 offset:8192
 v_mfma_f32_16x16x32_bf16 a[72:75], a[228:231], v[44:47], a[72:75]
 v_exp_f32 v56, v20
 v_mfma_f32_16x16x32_bf16 a[76:79], a[228:231], v[52:55], a[76:79]
 v_exp_f32 v57, v21
 v_mfma_f32_16x16x32_bf16 a[80:83], a[232:235], v[44:47], a[80:83]
 ds_read_b128 a[228:231], v2 offset:9216
 v_mfma_f32_16x16x32_bf16 a[84:87], a[232:235], v[52:55], a[84:87]
 v_exp_f32 v58, v22
 v_mfma_f32_16x16x32_bf16 a[88:91], a[236:239], v[44:47], a[88:91]
 v_exp_f32 v59, v23
 v_mfma_f32_16x16x32_bf16 a[92:95], a[236:239], v[52:55], a[92:95]
 ds_read_b128 a[232:235], v2 offset:10240
 v_cvt_pk_bf16_f32 v48, v56, v57
 v_mfma_f32_16x16x32_bf16 a[96:99], a[240:243], v[44:47], a[96:99]
 buffer_load_dwordx4 v154, s[52:55], s61 offen offset:3072 lds
 ds_read_b128 a[236:239], v2 offset:11264
 v_mfma_f32_16x16x32_bf16 a[100:103], a[240:243], v[52:55], a[100:103]
 v_exp_f32 v60, v24
 v_mfma_f32_16x16x32_bf16 a[104:107], a[244:247], v[44:47], a[104:107]
 s_add_u32 s61, s61, 16384
 ds_read_b128 a[240:243], v2 offset:12288
 v_mfma_f32_16x16x32_bf16 a[108:111], a[244:247], v[52:55], a[108:111]
 v_exp_f32 v61, v25
 v_mfma_f32_16x16x32_bf16 a[112:115], a[248:251], v[44:47], a[112:115]
 v_cvt_pk_bf16_f32 v49, v58, v59
 ds_read_b128 a[244:247], v2 offset:13312
 v_mfma_f32_16x16x32_bf16 a[116:119], a[248:251], v[52:55], a[116:119]
 v_exp_f32 v62, v26
 ds_read_b128 a[248:251], v2 offset:14336
 v_mfma_f32_16x16x32_bf16 a[120:123], a[252:255], v[44:47], a[120:123]
 v_exp_f32 v63, v27
 v_mfma_f32_16x16x32_bf16 a[124:127], a[252:255], v[52:55], a[124:127]
 v_cvt_pk_bf16_f32 v50, v60, v61
 v_cvt_pk_bf16_f32 v51, v62, v63
 s_waitcnt lgkmcnt(7)
 v_mfma_f32_16x16x32_bf16 v[4:7], a[192:195], v[192:195], 0
 ds_read_b128 a[252:255], v2 offset:15360
 v_cmp_gt_i32 s[12:13], -16, v163
 v_mfma_f32_16x16x32_bf16 v[12:15], a[192:195], v[224:227], 0
 s_add_u32 m0, s8, 0xc000
 ds_read_b128 a[192:195], v164 offset:49152
 v_mfma_f32_16x16x32_bf16 v[4:7], a[196:199], v[196:199], v[4:7]
 v_cmp_gt_i32 s[14:15], -15, v163
 v_mfma_f32_16x16x32_bf16 v[12:15], a[196:199], v[228:231], v[12:15]
 v_cmp_gt_i32 s[16:17], -14, v163
 ds_read_b128 a[196:199], v164 offset:50176
 v_mfma_f32_16x16x32_bf16 v[72:75], v[132:135], v[48:51], v[64:67]
 buffer_load_dwordx4 v154, s[48:51], s60 offen offset:0 lds
 v_mfma_f32_16x16x32_bf16 v[4:7], a[200:203], v[200:203], v[4:7]
 v_cmp_gt_i32 s[18:19], -13, v163
 v_cmp_gt_i32 s[20:21], 0, v163
 v_mfma_f32_16x16x32_bf16 v[12:15], a[200:203], v[232:235], v[12:15]
 v_cmp_gt_i32 s[22:23], 1, v163
 v_cmp_gt_i32 s[24:25], 2, v163
 v_mfma_f32_16x16x32_bf16 v[4:7], a[204:207], v[204:207], v[4:7]
 ds_read_b128 a[200:203], v164 offset:51200
 v_cmp_gt_i32 s[26:27], 3, v163
 v_mfma_f32_16x16x32_bf16 v[12:15], a[204:207], v[236:239], v[12:15]
 v_cndmask_b32 v28, v28, v165, s[12:13]
 ds_read_b128 a[204:207], v164 offset:52224
 v_mfma_f32_16x16x32_bf16 v[4:7], a[208:211], v[208:211], v[4:7]
 v_cndmask_b32 v29, v29, v165, s[14:15]
 v_cndmask_b32 v30, v30, v165, s[16:17]
 v_mfma_f32_16x16x32_bf16 v[12:15], a[208:211], v[240:243], v[12:15]
 ds_read_b128 a[208:211], v164 offset:53248
 v_cndmask_b32 v31, v31, v165, s[18:19]
 v_mfma_f32_16x16x32_bf16 v[4:7], a[212:215], v[212:215], v[4:7]
 v_cndmask_b32 v32, v32, v165, s[20:21]
 v_cndmask_b32 v33, v33, v165, s[22:23]
 v_mfma_f32_16x16x32_bf16 v[12:15], a[212:215], v[244:247], v[12:15]
 buffer_load_dwordx4 v154, s[48:51], s60 offen offset:1024 lds
 v_mfma_f32_16x16x32_bf16 v[4:7], a[216:219], v[216:219], v[4:7]
 ds_read_b128 a[212:215], v164 offset:54272
 v_cndmask_b32 v34, v34, v165, s[24:25]
 v_mfma_f32_16x16x32_bf16 v[12:15], a[216:219], v[248:251], v[12:15]
 v_cndmask_b32 v35, v35, v165, s[26:27]
 ds_read_b128 a[216:219], v164 offset:55296
 v_mfma_f32_16x16x32_bf16 v[4:7], a[220:223], v[220:223], v[4:7]
 v_exp_f32 v56, v28
 v_mfma_f32_16x16x32_bf16 v[12:15], a[220:223], v[252:255], v[12:15]
 ds_read_b128 a[220:223], v164 offset:56320
 s_waitcnt lgkmcnt(8)
 v_mfma_f32_16x16x32_bf16 v[8:11], a[224:227], v[192:195], 0
 v_exp_f32 v57, v29
 v_mfma_f32_16x16x32_bf16 v[16:19], a[224:227], v[224:227], 0
 v_exp_f32 v58, v30
 v_mfma_f32_16x16x32_bf16 v[8:11], a[228:231], v[196:199], v[8:11]
 v_exp_f32 v59, v31
 v_mfma_f32_16x16x32_bf16 v[16:19], a[228:231], v[228:231], v[16:19]
 v_cvt_pk_bf16_f32 v52, v56, v57
 ds_read_b128 a[224:227], v164 offset:57344
 v_mfma_f32_16x16x32_bf16 v[8:11], a[232:235], v[200:203], v[8:11]
 v_exp_f32 v60, v32
 ds_read_b128 a[228:231], v164 offset:58368
 v_mfma_f32_16x16x32_bf16 v[16:19], a[232:235], v[232:235], v[16:19]
 buffer_load_dwordx4 v154, s[48:51], s60 offen offset:2048 lds
 v_mfma_f32_16x16x32_bf16 v[8:11], a[236:239], v[204:207], v[8:11]
 v_exp_f32 v61, v33
 v_mfma_f32_16x16x32_bf16 v[16:19], a[236:239], v[236:239], v[16:19]
 v_cvt_pk_bf16_f32 v53, v58, v59
 ds_read_b128 a[232:235], v164 offset:59392
 v_mfma_f32_16x16x32_bf16 v[8:11], a[240:243], v[208:211], v[8:11]
 v_exp_f32 v62, v34
 v_exp_f32 v63, v35
 v_cvt_pk_bf16_f32 v54, v60, v61
 v_cvt_pk_bf16_f32 v55, v62, v63
 v_mfma_f32_16x16x32_bf16 v[16:19], a[240:243], v[240:243], v[16:19]
 ds_read_b128 a[236:239], v164 offset:60416
 v_mfma_f32_16x16x32_bf16 v[76:79], v[132:135], v[52:55], v[68:71]
 ds_read_b128 a[240:243], v164 offset:61440
 v_mfma_f32_16x16x32_bf16 v[8:11], a[244:247], v[212:215], v[8:11]
 buffer_load_dwordx4 v154, s[48:51], s60 offen offset:3072 lds
 v_mfma_f32_16x16x32_bf16 v[16:19], a[244:247], v[244:247], v[16:19]
 ds_read_b128 a[244:247], v164 offset:62464
 v_mfma_f32_16x16x32_bf16 v[8:11], a[248:251], v[216:219], v[8:11]
 s_add_u32 s60, s60, 16384
 v_mfma_f32_16x16x32_bf16 v[16:19], a[248:251], v[248:251], v[16:19]
 ds_read_b128 a[248:251], v164 offset:63488
 v_mfma_f32_16x16x32_bf16 v[8:11], a[252:255], v[220:223], v[8:11]
 v_add_f32 v116, v72, v76
 v_cmp_nge_f32 vcc, s42, v116
 v_mfma_f32_16x16x32_bf16 v[16:19], a[252:255], v[252:255], v[16:19]
 s_cbranch_vccnz L2_rc_M3
L2_rr_M3:
 s_waitcnt vmcnt(12) lgkmcnt(7)
 s_barrier
 s_cmp_eq_u32 s69, 0
 s_cbranch_scc1 L2_fin
 v_mfma_f32_16x16x32_bf16 a[0:3], a[192:195], v[48:51], a[0:3]
 s_add_u32 m0, s8, 0x18000
 ds_read_b128 a[252:255], v164 offset:64512
 v_mfma_f32_16x16x32_bf16 a[4:7], a[192:195], v[52:55], a[4:7]
 ds_read_b128 a[192:195], v2 offset:16384
 v_mfma_f32_16x16x32_bf16 a[8:11], a[196:199], v[48:51], a[8:11]
 buffer_load_dwordx4 v154, s[52:55], s61 offen offset:0 lds
 v_mfma_f32_16x16x32_bf16 a[12:15], a[196:199], v[52:55], a[12:15]
 ds_read_b128 a[196:199], v2 offset:17408
 v_mfma_f32_16x16x32_bf16 a[16:19], a[200:203], v[48:51], a[16:19]
 v_mfma_f32_16x16x32_bf16 a[20:23], a[200:203], v[52:55], a[20:23]
 ds_read_b128 a[200:203], v2 offset:18432
 v_mfma_f32_16x16x32_bf16 a[24:27], a[204:207], v[48:51], a[24:27]
 v_mfma_f32_16x16x32_bf16 a[28:31], a[204:207], v[52:55], a[28:31]
 ds_read_b128 a[204:207], v2 offset:19456
 v_mfma_f32_16x16x32_bf16 a[32:35], a[208:211], v[48:51], a[32:35]
 buffer_load_dwordx4 v154, s[52:55], s61 offen offset:1024 lds
 v_mfma_f32_16x16x32_bf16 a[36:39], a[208:211], v[52:55], a[36:39]
 ds_read_b128 a[208:211], v2 offset:20480
 v_mfma_f32_16x16x32_bf16 a[40:43], a[212:215], v[48:51], a[40:43]
 v_mfma_f32_16x16x32_bf16 a[44:47], a[212:215], v[52:55], a[44:47]
 ds_read_b128 a[212:215], v2 offset:21504
 v_mfma_f32_16x16x32_bf16 a[48:51], a[216:219], v[48:51], a[48:51]
 v_mfma_f32_16x16x32_bf16 a[52:55], a[216:219], v[52:55], a[52:55]
 ds_read_b128 a[216:219], v2 offset:22528
 v_mfma_f32_16x16x32_bf16 a[56:59], a[220:223], v[48:51], a[56:59]
 buffer_load_dwordx4 v154, s[52:55], s61 offen offset:2048 lds
 v_mfma_f32_16x16x32_bf16 a[60:63], a[220:223], v[52:55], a[60:63]
 ds_read_b128 a[220:223], v2 offset:23552
 s_waitcnt lgkmcnt(8)
 v_mfma_f32_16x16x32_bf16 a[64:67], a[224:227], v[48:51], a[64:67]
 v_mfma_f32_16x16x32_bf16 a[68:71], a[224:227], v[52:55], a[68:71]
 ds_read_b128 a[224:227], v2 offset:24576
 v_mfma_f32_16x16x32_bf16 a[72:75], a[228:231], v[48:51], a[72:75]
 v_mfma_f32_16x16x32_bf16 a[76:79], a[228:231], v[52:55], a[76:79]
 ds_read_b128 a[228:231], v2 offset:25600
 v_mfma_f32_16x16x32_bf16 a[80:83], a[232:235], v[48:51], a[80:83]
 v_mfma_f32_16x16x32_bf16 a[84:87], a[232:235], v[52:55], a[84:87]
 ds_read_b128 a[232:235], v2 offset:26624
 v_mfma_f32_16x16x32_bf16 a[88:91], a[236:239], v[48:51], a[88:91]
 buffer_load_dwordx4 v154, s[52:55], s61 offen offset:3072 lds
 v_mfma_f32_16x16x32_bf16 a[92:95], a[236:239], v[52:55], a[92:95]
 ds_read_b128 a[236:239], v2 offset:27648
 s_add_u32 s61, s61, 16384
 v_mfma_f32_16x16x32_bf16 a[96:99], a[240:243], v[48:51], a[96:99]
 v_mfma_f32_16x16x32_bf16 a[100:103], a[240:243], v[52:55], a[100:103]
 ds_read_b128 a[240:243], v2 offset:28672
 v_mfma_f32_16x16x32_bf16 a[104:107], a[244:247], v[48:51], a[104:107]
 v_mfma_f32_16x16x32_bf16 a[108:111], a[244:247], v[52:55], a[108:111]
 ds_read_b128 a[244:247], v2 offset:29696
 v_mfma_f32_16x16x32_bf16 a[112:115], a[248:251], v[48:51], a[112:115]
 v_mfma_f32_16x16x32_bf16 a[116:119], a[248:251], v[52:55], a[116:119]
 ds_read_b128 a[248:251], v2 offset:30720
 v_mfma_f32_16x16x32_bf16 a[120:123], a[252:255], v[48:51], a[120:123]
 v_mfma_f32_16x16x32_bf16 a[124:127], a[252:255], v[52:55], a[124:127]
 v_rcp_f32 v84, v72
 v_rcp_f32 v86, v76
 s_nop 0
 v_mov_b32 v85, v84
 v_mov_b32 v87, v86
 s_lshl_b32 s43, s70, 14
 s_add_u32 s43, s43, 0x4a00000
 v_mov_b32 v92, v36
 v_mov_b32 v93, v40
 v_mov_b32 v94, v72
 v_mov_b32 v95, v76
 s_lshl_b32 s10, s70, 10
 s_add_u32 s10, s10, 0x5200000
 buffer_store_dwordx4 v[92:95], v2, s[4:7], s10 offen sc1
 v_accvgpr_read_b32 v168, a0
 v_accvgpr_read_b32 v169, a1
 v_accvgpr_read_b32 v170, a2
 v_accvgpr_read_b32 v171, a3
 v_accvgpr_read_b32 v172, a8
 v_accvgpr_read_b32 v173, a9
 v_accvgpr_read_b32 v174, a10
 v_accvgpr_read_b32 v175, a11
 v_pk_mul_f32 v[168:169], v[168:169], v[84:85]
 v_pk_mul_f32 v[170:171], v[170:171], v[84:85]
 v_pk_mul_f32 v[172:173], v[172:173], v[84:85]
 v_pk_mul_f32 v[174:175], v[174:175], v[84:85]
 v_cvt_pk_bf16_f32 v100, v168, v169
 v_cvt_pk_bf16_f32 v101, v170, v171
 v_cvt_pk_bf16_f32 v102, v172, v173
 v_cvt_pk_bf16_f32 v103, v174, v175
 buffer_store_dwordx4 v[100:103], v2, s[4:7], s43 offen offset:0 sc1
 v_accvgpr_read_b32 v176, a16
 v_accvgpr_read_b32 v177, a17
 v_accvgpr_read_b32 v178, a18
 v_accvgpr_read_b32 v179, a19
 v_accvgpr_read_b32 v180, a24
 v_accvgpr_read_b32 v181, a25
 v_accvgpr_read_b32 v182, a26
 v_accvgpr_read_b32 v183, a27
 v_pk_mul_f32 v[176:177], v[176:177], v[84:85]
 v_pk_mul_f32 v[178:179], v[178:179], v[84:85]
 v_pk_mul_f32 v[180:181], v[180:181], v[84:85]
 v_pk_mul_f32 v[182:183], v[182:183], v[84:85]
 v_cvt_pk_bf16_f32 v104, v176, v177
 v_cvt_pk_bf16_f32 v105, v178, v179
 v_cvt_pk_bf16_f32 v106, v180, v181
 v_cvt_pk_bf16_f32 v107, v182, v183
 buffer_store_dwordx4 v[104:107], v2, s[4:7], s43 offen offset:1024 sc1
 v_accvgpr_read_b32 v168, a32
 v_accvgpr_read_b32 v169, a33
 v_accvgpr_read_b32 v170, a34
 v_accvgpr_read_b32 v171, a35
 v_accvgpr_read_b32 v172, a40
 v_accvgpr_read_b32 v173, a41
 v_accvgpr_read_b32 v174, a42
 v_accvgpr_read_b32 v175, a43
 v_pk_mul_f32 v[168:169], v[168:169], v[84:85]
 v_pk_mul_f32 v[170:171], v[170:171], v[84:85]
 v_pk_mul_f32 v[172:173], v[172:173], v[84:85]
 v_pk_mul_f32 v[174:175], v[174:175], v[84:85]
 v_cvt_pk_bf16_f32 v108, v168, v169
 v_cvt_pk_bf16_f32 v109, v170, v171
 v_cvt_pk_bf16_f32 v110, v172, v173
 v_cvt_pk_bf16_f32 v111, v174, v175
 buffer_store_dwordx4 v[108:111], v2, s[4:7], s43 offen offset:2048 sc1
 v_accvgpr_read_b32 v176, a48
 v_accvgpr_read_b32 v177, a49
 v_accvgpr_read_b32 v178, a50
 v_accvgpr_read_b32 v179, a51
 v_accvgpr_read_b32 v180, a56
 v_accvgpr_read_b32 v181, a57
 v_accvgpr_read_b32 v182, a58
 v_accvgpr_read_b32 v183, a59
 v_pk_mul_f32 v[176:177], v[176:177], v[84:85]
 v_pk_mul_f32 v[178:179], v[178:179], v[84:85]
 v_pk_mul_f32 v[180:181], v[180:181], v[84:85]
 v_pk_mul_f32 v[182:183], v[182:183], v[84:85]
 v_cvt_pk_bf16_f32 v112, v176, v177
 v_cvt_pk_bf16_f32 v113, v178, v179
 v_cvt_pk_bf16_f32 v114, v180, v181
 v_cvt_pk_bf16_f32 v115, v182, v183
 buffer_store_dwordx4 v[112:115], v2, s[4:7], s43 offen offset:3072 sc1
 s_add_u32 s43, s43, 0x1000
 v_accvgpr_read_b32 v168, a64
 v_accvgpr_read_b32 v169, a65
 v_accvgpr_read_b32 v170, a66
 v_accvgpr_read_b32 v171, a67
 v_accvgpr_read_b32 v172, a72
 v_accvgpr_read_b32 v173, a73
 v_accvgpr_read_b32 v174, a74
 v_accvgpr_read_b32 v175, a75
 v_pk_mul_f32 v[168:169], v[168:169], v[84:85]
 v_pk_mul_f32 v[170:171], v[170:171], v[84:85]
 v_pk_mul_f32 v[172:173], v[172:173], v[84:85]
 v_pk_mul_f32 v[174:175], v[174:175], v[84:85]
 v_cvt_pk_bf16_f32 v100, v168, v169
 v_cvt_pk_bf16_f32 v101, v170, v171
 v_cvt_pk_bf16_f32 v102, v172, v173
 v_cvt_pk_bf16_f32 v103, v174, v175
 buffer_store_dwordx4 v[100:103], v2, s[4:7], s43 offen offset:0 sc1
 v_accvgpr_read_b32 v176, a80
 v_accvgpr_read_b32 v177, a81
 v_accvgpr_read_b32 v178, a82
 v_accvgpr_read_b32 v179, a83
 v_accvgpr_read_b32 v180, a88
 v_accvgpr_read_b32 v181, a89
 v_accvgpr_read_b32 v182, a90
 v_accvgpr_read_b32 v183, a91
 v_pk_mul_f32 v[176:177], v[176:177], v[84:85]
 v_pk_mul_f32 v[178:179], v[178:179], v[84:85]
 v_pk_mul_f32 v[180:181], v[180:181], v[84:85]
 v_pk_mul_f32 v[182:183], v[182:183], v[84:85]
 v_cvt_pk_bf16_f32 v104, v176, v177
 v_cvt_pk_bf16_f32 v105, v178, v179
 v_cvt_pk_bf16_f32 v106, v180, v181
 v_cvt_pk_bf16_f32 v107, v182, v183
 buffer_store_dwordx4 v[104:107], v2, s[4:7], s43 offen offset:1024 sc1
 v_accvgpr_read_b32 v168, a96
 v_accvgpr_read_b32 v169, a97
 v_accvgpr_read_b32 v170, a98
 v_accvgpr_read_b32 v171, a99
 v_accvgpr_read_b32 v172, a104
 v_accvgpr_read_b32 v173, a105
 v_accvgpr_read_b32 v174, a106
 v_accvgpr_read_b32 v175, a107
 v_pk_mul_f32 v[168:169], v[168:169], v[84:85]
 v_pk_mul_f32 v[170:171], v[170:171], v[84:85]
 v_pk_mul_f32 v[172:173], v[172:173], v[84:85]
 v_pk_mul_f32 v[174:175], v[174:175], v[84:85]
 v_cvt_pk_bf16_f32 v108, v168, v169
 v_cvt_pk_bf16_f32 v109, v170, v171
 v_cvt_pk_bf16_f32 v110, v172, v173
 v_cvt_pk_bf16_f32 v111, v174, v175
 buffer_store_dwordx4 v[108:111], v2, s[4:7], s43 offen offset:2048 sc1
 v_accvgpr_read_b32 v176, a112
 v_accvgpr_read_b32 v177, a113
 v_accvgpr_read_b32 v178, a114
 v_accvgpr_read_b32 v179, a115
 v_accvgpr_read_b32 v180, a120
 v_accvgpr_read_b32 v181, a121
 v_accvgpr_read_b32 v182, a122
 v_accvgpr_read_b32 v183, a123
 v_pk_mul_f32 v[176:177], v[176:177], v[84:85]
 v_pk_mul_f32 v[178:179], v[178:179], v[84:85]
 v_pk_mul_f32 v[180:181], v[180:181], v[84:85]
 v_pk_mul_f32 v[182:183], v[182:183], v[84:85]
 v_cvt_pk_bf16_f32 v112, v176, v177
 v_cvt_pk_bf16_f32 v113, v178, v179
 v_cvt_pk_bf16_f32 v114, v180, v181
 v_cvt_pk_bf16_f32 v115, v182, v183
 buffer_store_dwordx4 v[112:115], v2, s[4:7], s43 offen offset:3072 sc1
 s_add_u32 s43, s43, 0x1000
 v_accvgpr_read_b32 v168, a4
 v_accvgpr_read_b32 v169, a5
 v_accvgpr_read_b32 v170, a6
 v_accvgpr_read_b32 v171, a7
 v_accvgpr_read_b32 v172, a12
 v_accvgpr_read_b32 v173, a13
 v_accvgpr_read_b32 v174, a14
 v_accvgpr_read_b32 v175, a15
 v_pk_mul_f32 v[168:169], v[168:169], v[86:87]
 v_pk_mul_f32 v[170:171], v[170:171], v[86:87]
 v_pk_mul_f32 v[172:173], v[172:173], v[86:87]
 v_pk_mul_f32 v[174:175], v[174:175], v[86:87]
 v_cvt_pk_bf16_f32 v100, v168, v169
 v_cvt_pk_bf16_f32 v101, v170, v171
 v_cvt_pk_bf16_f32 v102, v172, v173
 v_cvt_pk_bf16_f32 v103, v174, v175
 buffer_store_dwordx4 v[100:103], v2, s[4:7], s43 offen offset:0 sc1
 v_accvgpr_read_b32 v176, a20
 v_accvgpr_read_b32 v177, a21
 v_accvgpr_read_b32 v178, a22
 v_accvgpr_read_b32 v179, a23
 v_accvgpr_read_b32 v180, a28
 v_accvgpr_read_b32 v181, a29
 v_accvgpr_read_b32 v182, a30
 v_accvgpr_read_b32 v183, a31
 v_pk_mul_f32 v[176:177], v[176:177], v[86:87]
 v_pk_mul_f32 v[178:179], v[178:179], v[86:87]
 v_pk_mul_f32 v[180:181], v[180:181], v[86:87]
 v_pk_mul_f32 v[182:183], v[182:183], v[86:87]
 v_cvt_pk_bf16_f32 v104, v176, v177
 v_cvt_pk_bf16_f32 v105, v178, v179
 v_cvt_pk_bf16_f32 v106, v180, v181
 v_cvt_pk_bf16_f32 v107, v182, v183
 buffer_store_dwordx4 v[104:107], v2, s[4:7], s43 offen offset:1024 sc1
 v_accvgpr_read_b32 v168, a36
 v_accvgpr_read_b32 v169, a37
 v_accvgpr_read_b32 v170, a38
 v_accvgpr_read_b32 v171, a39
 v_accvgpr_read_b32 v172, a44
 v_accvgpr_read_b32 v173, a45
 v_accvgpr_read_b32 v174, a46
 v_accvgpr_read_b32 v175, a47
 v_pk_mul_f32 v[168:169], v[168:169], v[86:87]
 v_pk_mul_f32 v[170:171], v[170:171], v[86:87]
 v_pk_mul_f32 v[172:173], v[172:173], v[86:87]
 v_pk_mul_f32 v[174:175], v[174:175], v[86:87]
 v_cvt_pk_bf16_f32 v108, v168, v169
 v_cvt_pk_bf16_f32 v109, v170, v171
 v_cvt_pk_bf16_f32 v110, v172, v173
 v_cvt_pk_bf16_f32 v111, v174, v175
 buffer_store_dwordx4 v[108:111], v2, s[4:7], s43 offen offset:2048 sc1
 v_accvgpr_read_b32 v176, a52
 v_accvgpr_read_b32 v177, a53
 v_accvgpr_read_b32 v178, a54
 v_accvgpr_read_b32 v179, a55
 v_accvgpr_read_b32 v180, a60
 v_accvgpr_read_b32 v181, a61
 v_accvgpr_read_b32 v182, a62
 v_accvgpr_read_b32 v183, a63
 v_pk_mul_f32 v[176:177], v[176:177], v[86:87]
 v_pk_mul_f32 v[178:179], v[178:179], v[86:87]
 v_pk_mul_f32 v[180:181], v[180:181], v[86:87]
 v_pk_mul_f32 v[182:183], v[182:183], v[86:87]
 v_cvt_pk_bf16_f32 v112, v176, v177
 v_cvt_pk_bf16_f32 v113, v178, v179
 v_cvt_pk_bf16_f32 v114, v180, v181
 v_cvt_pk_bf16_f32 v115, v182, v183
 buffer_store_dwordx4 v[112:115], v2, s[4:7], s43 offen offset:3072 sc1
 s_add_u32 s43, s43, 0x1000
 v_accvgpr_read_b32 v168, a68
 v_accvgpr_read_b32 v169, a69
 v_accvgpr_read_b32 v170, a70
 v_accvgpr_read_b32 v171, a71
 v_accvgpr_read_b32 v172, a76
 v_accvgpr_read_b32 v173, a77
 v_accvgpr_read_b32 v174, a78
 v_accvgpr_read_b32 v175, a79
 v_pk_mul_f32 v[168:169], v[168:169], v[86:87]
 v_pk_mul_f32 v[170:171], v[170:171], v[86:87]
 v_pk_mul_f32 v[172:173], v[172:173], v[86:87]
 v_pk_mul_f32 v[174:175], v[174:175], v[86:87]
 v_cvt_pk_bf16_f32 v100, v168, v169
 v_cvt_pk_bf16_f32 v101, v170, v171
 v_cvt_pk_bf16_f32 v102, v172, v173
 v_cvt_pk_bf16_f32 v103, v174, v175
 buffer_store_dwordx4 v[100:103], v2, s[4:7], s43 offen offset:0 sc1
 v_accvgpr_read_b32 v176, a84
 v_accvgpr_read_b32 v177, a85
 v_accvgpr_read_b32 v178, a86
 v_accvgpr_read_b32 v179, a87
 v_accvgpr_read_b32 v180, a92
 v_accvgpr_read_b32 v181, a93
 v_accvgpr_read_b32 v182, a94
 v_accvgpr_read_b32 v183, a95
 v_pk_mul_f32 v[176:177], v[176:177], v[86:87]
 v_pk_mul_f32 v[178:179], v[178:179], v[86:87]
 v_pk_mul_f32 v[180:181], v[180:181], v[86:87]
 v_pk_mul_f32 v[182:183], v[182:183], v[86:87]
 v_cvt_pk_bf16_f32 v104, v176, v177
 v_cvt_pk_bf16_f32 v105, v178, v179
 v_cvt_pk_bf16_f32 v106, v180, v181
 v_cvt_pk_bf16_f32 v107, v182, v183
 buffer_store_dwordx4 v[104:107], v2, s[4:7], s43 offen offset:1024 sc1
 v_accvgpr_read_b32 v168, a100
 v_accvgpr_read_b32 v169, a101
 v_accvgpr_read_b32 v170, a102
 v_accvgpr_read_b32 v171, a103
 v_accvgpr_read_b32 v172, a108
 v_accvgpr_read_b32 v173, a109
 v_accvgpr_read_b32 v174, a110
 v_accvgpr_read_b32 v175, a111
 v_pk_mul_f32 v[168:169], v[168:169], v[86:87]
 v_pk_mul_f32 v[170:171], v[170:171], v[86:87]
 v_pk_mul_f32 v[172:173], v[172:173], v[86:87]
 v_pk_mul_f32 v[174:175], v[174:175], v[86:87]
 v_cvt_pk_bf16_f32 v108, v168, v169
 v_cvt_pk_bf16_f32 v109, v170, v171
 v_cvt_pk_bf16_f32 v110, v172, v173
 v_cvt_pk_bf16_f32 v111, v174, v175
 buffer_store_dwordx4 v[108:111], v2, s[4:7], s43 offen offset:2048 sc1
 v_accvgpr_read_b32 v176, a116
 v_accvgpr_read_b32 v177, a117
 v_accvgpr_read_b32 v178, a118
 v_accvgpr_read_b32 v179, a119
 v_accvgpr_read_b32 v180, a124
 v_accvgpr_read_b32 v181, a125
 v_accvgpr_read_b32 v182, a126
 v_accvgpr_read_b32 v183, a127
 v_pk_mul_f32 v[176:177], v[176:177], v[86:87]
 v_pk_mul_f32 v[178:179], v[178:179], v[86:87]
 v_pk_mul_f32 v[180:181], v[180:181], v[86:87]
 v_pk_mul_f32 v[182:183], v[182:183], v[86:87]
 v_cvt_pk_bf16_f32 v112, v176, v177
 v_cvt_pk_bf16_f32 v113, v178, v179
 v_cvt_pk_bf16_f32 v114, v180, v181
 v_cvt_pk_bf16_f32 v115, v182, v183
 buffer_store_dwordx4 v[112:115], v2, s[4:7], s43 offen offset:3072 sc1
 s_add_u32 s43, s43, 0x1000
 v_accvgpr_write_b32 a0, 0
 v_accvgpr_write_b32 a1, 0
 v_accvgpr_write_b32 a2, 0
 v_accvgpr_write_b32 a3, 0
 v_accvgpr_write_b32 a4, 0
 v_accvgpr_write_b32 a5, 0
 v_accvgpr_write_b32 a6, 0
 v_accvgpr_write_b32 a7, 0
 v_accvgpr_write_b32 a8, 0
 v_accvgpr_write_b32 a9, 0
 v_accvgpr_write_b32 a10, 0
 v_accvgpr_write_b32 a11, 0
 v_accvgpr_write_b32 a12, 0
 v_accvgpr_write_b32 a13, 0
 v_accvgpr_write_b32 a14, 0
 v_accvgpr_write_b32 a15, 0
 v_accvgpr_write_b32 a16, 0
 v_accvgpr_write_b32 a17, 0
 v_accvgpr_write_b32 a18, 0
 v_accvgpr_write_b32 a19, 0
 v_accvgpr_write_b32 a20, 0
 v_accvgpr_write_b32 a21, 0
 v_accvgpr_write_b32 a22, 0
 v_accvgpr_write_b32 a23, 0
 v_accvgpr_write_b32 a24, 0
 v_accvgpr_write_b32 a25, 0
 v_accvgpr_write_b32 a26, 0
 v_accvgpr_write_b32 a27, 0
 v_accvgpr_write_b32 a28, 0
 v_accvgpr_write_b32 a29, 0
 v_accvgpr_write_b32 a30, 0
 v_accvgpr_write_b32 a31, 0
 v_accvgpr_write_b32 a32, 0
 v_accvgpr_write_b32 a33, 0
 v_accvgpr_write_b32 a34, 0
 v_accvgpr_write_b32 a35, 0
 v_accvgpr_write_b32 a36, 0
 v_accvgpr_write_b32 a37, 0
 v_accvgpr_write_b32 a38, 0
 v_accvgpr_write_b32 a39, 0
 v_accvgpr_write_b32 a40, 0
 v_accvgpr_write_b32 a41, 0
 v_accvgpr_write_b32 a42, 0
 v_accvgpr_write_b32 a43, 0
 v_accvgpr_write_b32 a44, 0
 v_accvgpr_write_b32 a45, 0
 v_accvgpr_write_b32 a46, 0
 v_accvgpr_write_b32 a47, 0
 v_accvgpr_write_b32 a48, 0
 v_accvgpr_write_b32 a49, 0
 v_accvgpr_write_b32 a50, 0
 v_accvgpr_write_b32 a51, 0
 v_accvgpr_write_b32 a52, 0
 v_accvgpr_write_b32 a53, 0
 v_accvgpr_write_b32 a54, 0
 v_accvgpr_write_b32 a55, 0
 v_accvgpr_write_b32 a56, 0
 v_accvgpr_write_b32 a57, 0
 v_accvgpr_write_b32 a58, 0
 v_accvgpr_write_b32 a59, 0
 v_accvgpr_write_b32 a60, 0
 v_accvgpr_write_b32 a61, 0
 v_accvgpr_write_b32 a62, 0
 v_accvgpr_write_b32 a63, 0
 v_accvgpr_write_b32 a64, 0
 v_accvgpr_write_b32 a65, 0
 v_accvgpr_write_b32 a66, 0
 v_accvgpr_write_b32 a67, 0
 v_accvgpr_write_b32 a68, 0
 v_accvgpr_write_b32 a69, 0
 v_accvgpr_write_b32 a70, 0
 v_accvgpr_write_b32 a71, 0
 v_accvgpr_write_b32 a72, 0
 v_accvgpr_write_b32 a73, 0
 v_accvgpr_write_b32 a74, 0
 v_accvgpr_write_b32 a75, 0
 v_accvgpr_write_b32 a76, 0
 v_accvgpr_write_b32 a77, 0
 v_accvgpr_write_b32 a78, 0
 v_accvgpr_write_b32 a79, 0
 v_accvgpr_write_b32 a80, 0
 v_accvgpr_write_b32 a81, 0
 v_accvgpr_write_b32 a82, 0
 v_accvgpr_write_b32 a83, 0
 v_accvgpr_write_b32 a84, 0
 v_accvgpr_write_b32 a85, 0
 v_accvgpr_write_b32 a86, 0
 v_accvgpr_write_b32 a87, 0
 v_accvgpr_write_b32 a88, 0
 v_accvgpr_write_b32 a89, 0
 v_accvgpr_write_b32 a90, 0
 v_accvgpr_write_b32 a91, 0
 v_accvgpr_write_b32 a92, 0
 v_accvgpr_write_b32 a93, 0
 v_accvgpr_write_b32 a94, 0
 v_accvgpr_write_b32 a95, 0
 v_accvgpr_write_b32 a96, 0
 v_accvgpr_write_b32 a97, 0
 v_accvgpr_write_b32 a98, 0
 v_accvgpr_write_b32 a99, 0
 v_accvgpr_write_b32 a100, 0
 v_accvgpr_write_b32 a101, 0
 v_accvgpr_write_b32 a102, 0
 v_accvgpr_write_b32 a103, 0
 v_accvgpr_write_b32 a104, 0
 v_accvgpr_write_b32 a105, 0
 v_accvgpr_write_b32 a106, 0
 v_accvgpr_write_b32 a107, 0
 v_accvgpr_write_b32 a108, 0
 v_accvgpr_write_b32 a109, 0
 v_accvgpr_write_b32 a110, 0
 v_accvgpr_write_b32 a111, 0
 v_accvgpr_write_b32 a112, 0
 v_accvgpr_write_b32 a113, 0
 v_accvgpr_write_b32 a114, 0
 v_accvgpr_write_b32 a115, 0
 v_accvgpr_write_b32 a116, 0
 v_accvgpr_write_b32 a117, 0
 v_accvgpr_write_b32 a118, 0
 v_accvgpr_write_b32 a119, 0
 v_accvgpr_write_b32 a120, 0
 v_accvgpr_write_b32 a121, 0
 v_accvgpr_write_b32 a122, 0
 v_accvgpr_write_b32 a123, 0
 v_accvgpr_write_b32 a124, 0
 v_accvgpr_write_b32 a125, 0
 v_accvgpr_write_b32 a126, 0
 v_accvgpr_write_b32 a127, 0
 v_accvgpr_write_b32 a128, v192
 v_accvgpr_write_b32 a129, v193
 v_accvgpr_write_b32 a130, v194
 v_accvgpr_write_b32 a131, v195
 v_accvgpr_write_b32 a132, v196
 v_accvgpr_write_b32 a133, v197
 v_accvgpr_write_b32 a134, v198
 v_accvgpr_write_b32 a135, v199
 v_accvgpr_write_b32 a136, v200
 v_accvgpr_write_b32 a137, v201
 v_accvgpr_write_b32 a138, v202
 v_accvgpr_write_b32 a139, v203
 v_accvgpr_write_b32 a140, v204
 v_accvgpr_write_b32 a141, v205
 v_accvgpr_write_b32 a142, v206
 v_accvgpr_write_b32 a143, v207
 v_accvgpr_write_b32 a144, v208
 v_accvgpr_write_b32 a145, v209
 v_accvgpr_write_b32 a146, v210
 v_accvgpr_write_b32 a147, v211
 v_accvgpr_write_b32 a148, v212
 v_accvgpr_write_b32 a149, v213
 v_accvgpr_write_b32 a150, v214
 v_accvgpr_write_b32 a151, v215
 v_accvgpr_write_b32 a152, v216
 v_accvgpr_write_b32 a153, v217
 v_accvgpr_write_b32 a154, v218
 v_accvgpr_write_b32 a155, v219
 v_accvgpr_write_b32 a156, v220
 v_accvgpr_write_b32 a157, v221
 v_accvgpr_write_b32 a158, v222
 v_accvgpr_write_b32 a159, v223
 v_accvgpr_write_b32 a160, v224
 v_accvgpr_write_b32 a161, v225
 v_accvgpr_write_b32 a162, v226
 v_accvgpr_write_b32 a163, v227
 v_accvgpr_write_b32 a164, v228
 v_accvgpr_write_b32 a165, v229
 v_accvgpr_write_b32 a166, v230
 v_accvgpr_write_b32 a167, v231
 v_accvgpr_write_b32 a168, v232
 v_accvgpr_write_b32 a169, v233
 v_accvgpr_write_b32 a170, v234
 v_accvgpr_write_b32 a171, v235
 v_accvgpr_write_b32 a172, v236
 v_accvgpr_write_b32 a173, v237
 v_accvgpr_write_b32 a174, v238
 v_accvgpr_write_b32 a175, v239
 v_accvgpr_write_b32 a176, v240
 v_accvgpr_write_b32 a177, v241
 v_accvgpr_write_b32 a178, v242
 v_accvgpr_write_b32 a179, v243
 v_accvgpr_write_b32 a180, v244
 v_accvgpr_write_b32 a181, v245
 v_accvgpr_write_b32 a182, v246
 v_accvgpr_write_b32 a183, v247
 v_accvgpr_write_b32 a184, v248
 v_accvgpr_write_b32 a185, v249
 v_accvgpr_write_b32 a186, v250
 v_accvgpr_write_b32 a187, v251
 v_accvgpr_write_b32 a188, v252
 v_accvgpr_write_b32 a189, v253
 v_accvgpr_write_b32 a190, v254
 v_accvgpr_write_b32 a191, v255
 s_mov_b32 s62, s68
 s_mov_b32 s63, 0
 s_lshl_b32 s64, s68, 2
 s_add_u32 s64, s64, 4
 s_mov_b32 s65, 0
 s_mov_b32 s69, 0
 s_mov_b32 s47, 2
 s_branch L2_first
L2_rc_U0:
 s_mov_b32 s9, 1.0
 s_call_b64 s[28:29], L2_rare0
 s_branch L2_rr_U0
L2_rc_U1:
 s_mov_b32 s9, 1.0
 s_call_b64 s[28:29], L2_rare1
 s_branch L2_rr_U1
L2_rc_U2:
 s_mov_b32 s9, 1.0
 s_call_b64 s[28:29], L2_rare0
 s_branch L2_rr_U2
L2_rc_U3:
 s_mov_b32 s9, 1.0
 s_call_b64 s[28:29], L2_rare1
 s_branch L2_rr_U3
L2_rc_M0:
 s_mov_b32 s9, 1.0
 s_call_b64 s[28:29], L2_rare0
 s_branch L2_rr_M0
L2_rc_M1:
 s_mov_b32 s9, 1.0
 s_call_b64 s[28:29], L2_rare1
 s_branch L2_rr_M1
L2_rc_M2:
 s_mov_b32 s9, 1.0
 s_call_b64 s[28:29], L2_rare0
 s_branch L2_rr_M2
L2_rc_M3:
 s_mov_b32 s9, 0
 s_call_b64 s[28:29], L2_rare1
 s_branch L2_rr_M3
L2_rare0:
 s_nop 7
 s_nop 7
 v_max3_f32 v118, v4, v5, v6
 v_max3_f32 v118, v118, v7, v8
 v_max3_f32 v118, v118, v9, v10
 v_max_f32 v118, v118, v11
 v_mov_b32 v122, v118
 s_nop 1
 v_permlane16_swap_b32 v118, v122
 v_max_f32 v118, v118, v122
 v_mov_b32 v122, v118
 s_nop 1
 v_permlane32_swap_b32 v118, v122
 v_max_f32 v118, v118, v122
 v_log_f32 v122, v72
 s_nop 0
 v_max_f32 v118, v118, v122
 v_exp_f32 v119, -v118
 v_sub_f32 v36, v36, v118
 v_sub_f32 v37, v37, v118
 v_sub_f32 v38, v38, v118
 v_sub_f32 v39, v39, v118
 v_mul_f32 v72, v72, v119
 v_mul_f32 v73, v73, v119
 v_mul_f32 v74, v74, v119
 v_mul_f32 v75, v75, v119
 v_sub_f32 v4, v4, v118
 v_sub_f32 v5, v5, v118
 v_sub_f32 v6, v6, v118
 v_sub_f32 v7, v7, v118
 v_sub_f32 v8, v8, v118
 v_sub_f32 v9, v9, v118
 v_sub_f32 v10, v10, v118
 v_sub_f32 v11, v11, v118
 v_mul_f32 v122, s9, v118
 v_sub_f32 v20, v20, v122
 v_sub_f32 v21, v21, v122
 v_sub_f32 v22, v22, v122
 v_sub_f32 v23, v23, v122
 v_sub_f32 v24, v24, v122
 v_sub_f32 v25, v25, v122
 v_sub_f32 v26, v26, v122
 v_sub_f32 v27, v27, v122
 v_exp_f32 v56, v4
 v_exp_f32 v57, v5
 v_exp_f32 v58, v6
 v_exp_f32 v59, v7
 v_cvt_pk_bf16_f32 v44, v56, v57
 v_exp_f32 v60, v8
 v_exp_f32 v61, v9
 v_cvt_pk_bf16_f32 v45, v58, v59
 v_exp_f32 v62, v10
 v_exp_f32 v63, v11
 v_cvt_pk_bf16_f32 v46, v60, v61
 v_cvt_pk_bf16_f32 v47, v62, v63
 v_max3_f32 v120, v12, v13, v14
 v_max3_f32 v120, v120, v15, v16
 v_max3_f32 v120, v120, v17, v18
 v_max_f32 v120, v120, v19
 v_mov_b32 v122, v120
 s_nop 1
 v_permlane16_swap_b32 v120, v122
 v_max_f32 v120, v120, v122
 v_mov_b32 v122, v120
 s_nop 1
 v_permlane32_swap_b32 v120, v122
 v_max_f32 v120, v120, v122
 v_log_f32 v122, v76
 s_nop 0
 v_max_f32 v120, v120, v122
 v_exp_f32 v121, -v120
 v_sub_f32 v40, v40, v120
 v_sub_f32 v41, v41, v120
 v_sub_f32 v42, v42, v120
 v_sub_f32 v43, v43, v120
 v_mul_f32 v76, v76, v121
 v_mul_f32 v77, v77, v121
 v_mul_f32 v78, v78, v121
 v_mul_f32 v79, v79, v121
 v_sub_f32 v12, v12, v120
 v_sub_f32 v13, v13, v120
 v_sub_f32 v14, v14, v120
 v_sub_f32 v15, v15, v120
 v_sub_f32 v16, v16, v120
 v_sub_f32 v17, v17, v120
 v_sub_f32 v18, v18, v120
 v_sub_f32 v19, v19, v120
 v_mul_f32 v122, s9, v120
 v_sub_f32 v28, v28, v122
 v_sub_f32 v29, v29, v122
 v_sub_f32 v30, v30, v122
 v_sub_f32 v31, v31, v122
 v_sub_f32 v32, v32, v122
 v_sub_f32 v33, v33, v122
 v_sub_f32 v34, v34, v122
 v_sub_f32 v35, v35, v122
 v_exp_f32 v56, v12
 v_exp_f32 v57, v13
 v_exp_f32 v58, v14
 v_exp_f32 v59, v15
 v_cvt_pk_bf16_f32 v52, v56, v57
 v_exp_f32 v60, v16
 v_exp_f32 v61, v17
 v_cvt_pk_bf16_f32 v53, v58, v59
 v_exp_f32 v62, v18
 v_exp_f32 v63, v19
 v_cvt_pk_bf16_f32 v54, v60, v61
 v_cvt_pk_bf16_f32 v55, v62, v63
 v_accvgpr_read_b32 v168, a0
 v_accvgpr_read_b32 v169, a1
 v_accvgpr_read_b32 v170, a2
 v_accvgpr_read_b32 v171, a3
 v_accvgpr_read_b32 v172, a4
 v_accvgpr_read_b32 v173, a5
 v_accvgpr_read_b32 v174, a6
 v_accvgpr_read_b32 v175, a7
 v_mul_f32 v168, v168, v119
 v_mul_f32 v169, v169, v119
 v_mul_f32 v170, v170, v119
 v_mul_f32 v171, v171, v119
 v_mul_f32 v172, v172, v121
 v_mul_f32 v173, v173, v121
 v_mul_f32 v174, v174, v121
 v_mul_f32 v175, v175, v121
 v_accvgpr_write_b32 a0, v168
 v_accvgpr_write_b32 a1, v169
 v_accvgpr_write_b32 a2, v170
 v_accvgpr_write_b32 a3, v171
 v_accvgpr_write_b32 a4, v172
 v_accvgpr_write_b32 a5, v173
 v_accvgpr_write_b32 a6, v174
 v_accvgpr_write_b32 a7, v175
 v_accvgpr_read_b32 v168, a8
 v_accvgpr_read_b32 v169, a9
 v_accvgpr_read_b32 v170, a10
 v_accvgpr_read_b32 v171, a11
 v_accvgpr_read_b32 v172, a12
 v_accvgpr_read_b32 v173, a13
 v_accvgpr_read_b32 v174, a14
 v_accvgpr_read_b32 v175, a15
 v_mul_f32 v168, v168, v119
 v_mul_f32 v169, v169, v119
 v_mul_f32 v170, v170, v119
 v_mul_f32 v171, v171, v119
 v_mul_f32 v172, v172, v121
 v_mul_f32 v173, v173, v121
 v_mul_f32 v174, v174, v121
 v_mul_f32 v175, v175, v121
 v_accvgpr_write_b32 a8, v168
 v_accvgpr_write_b32 a9, v169
 v_accvgpr_write_b32 a10, v170
 v_accvgpr_write_b32 a11, v171
 v_accvgpr_write_b32 a12, v172
 v_accvgpr_write_b32 a13, v173
 v_accvgpr_write_b32 a14, v174
 v_accvgpr_write_b32 a15, v175
 v_accvgpr_read_b32 v168, a16
 v_accvgpr_read_b32 v169, a17
 v_accvgpr_read_b32 v170, a18
 v_accvgpr_read_b32 v171, a19
 v_accvgpr_read_b32 v172, a20
 v_accvgpr_read_b32 v173, a21
 v_accvgpr_read_b32 v174, a22
 v_accvgpr_read_b32 v175, a23
 v_mul_f32 v168, v168, v119
 v_mul_f32 v169, v169, v119
 v_mul_f32 v170, v170, v119
 v_mul_f32 v171, v171, v119
 v_mul_f32 v172, v172, v121
 v_mul_f32 v173, v173, v121
 v_mul_f32 v174, v174, v121
 v_mul_f32 v175, v175, v121
 v_accvgpr_write_b32 a16, v168
 v_accvgpr_write_b32 a17, v169
 v_accvgpr_write_b32 a18, v170
 v_accvgpr_write_b32 a19, v171
 v_accvgpr_write_b32 a20, v172
 v_accvgpr_write_b32 a21, v173
 v_accvgpr_write_b32 a22, v174
 v_accvgpr_write_b32 a23, v175
 v_accvgpr_read_b32 v168, a24
 v_accvgpr_read_b32 v169, a25
 v_accvgpr_read_b32 v170, a26
 v_accvgpr_read_b32 v171, a27
 v_accvgpr_read_b32 v172, a28
 v_accvgpr_read_b32 v173, a29
 v_accvgpr_read_b32 v174, a30
 v_accvgpr_read_b32 v175, a31
 v_mul_f32 v168, v168, v119
 v_mul_f32 v169, v169, v119
 v_mul_f32 v170, v170, v119
 v_mul_f32 v171, v171, v119
 v_mul_f32 v172, v172, v121
 v_mul_f32 v173, v173, v121
 v_mul_f32 v174, v174, v121
 v_mul_f32 v175, v175, v121
 v_accvgpr_write_b32 a24, v168
 v_accvgpr_write_b32 a25, v169
 v_accvgpr_write_b32 a26, v170
 v_accvgpr_write_b32 a27, v171
 v_accvgpr_write_b32 a28, v172
 v_accvgpr_write_b32 a29, v173
 v_accvgpr_write_b32 a30, v174
 v_accvgpr_write_b32 a31, v175
 v_accvgpr_read_b32 v168, a32
 v_accvgpr_read_b32 v169, a33
 v_accvgpr_read_b32 v170, a34
 v_accvgpr_read_b32 v171, a35
 v_accvgpr_read_b32 v172, a36
 v_accvgpr_read_b32 v173, a37
 v_accvgpr_read_b32 v174, a38
 v_accvgpr_read_b32 v175, a39
 v_mul_f32 v168, v168, v119
 v_mul_f32 v169, v169, v119
 v_mul_f32 v170, v170, v119
 v_mul_f32 v171, v171, v119
 v_mul_f32 v172, v172, v121
 v_mul_f32 v173, v173, v121
 v_mul_f32 v174, v174, v121
 v_mul_f32 v175, v175, v121
 v_accvgpr_write_b32 a32, v168
 v_accvgpr_write_b32 a33, v169
 v_accvgpr_write_b32 a34, v170
 v_accvgpr_write_b32 a35, v171
 v_accvgpr_write_b32 a36, v172
 v_accvgpr_write_b32 a37, v173
 v_accvgpr_write_b32 a38, v174
 v_accvgpr_write_b32 a39, v175
 v_accvgpr_read_b32 v168, a40
 v_accvgpr_read_b32 v169, a41
 v_accvgpr_read_b32 v170, a42
 v_accvgpr_read_b32 v171, a43
 v_accvgpr_read_b32 v172, a44
 v_accvgpr_read_b32 v173, a45
 v_accvgpr_read_b32 v174, a46
 v_accvgpr_read_b32 v175, a47
 v_mul_f32 v168, v168, v119
 v_mul_f32 v169, v169, v119
 v_mul_f32 v170, v170, v119
 v_mul_f32 v171, v171, v119
 v_mul_f32 v172, v172, v121
 v_mul_f32 v173, v173, v121
 v_mul_f32 v174, v174, v121
 v_mul_f32 v175, v175, v121
 v_accvgpr_write_b32 a40, v168
 v_accvgpr_write_b32 a41, v169
 v_accvgpr_write_b32 a42, v170
 v_accvgpr_write_b32 a43, v171
 v_accvgpr_write_b32 a44, v172
 v_accvgpr_write_b32 a45, v173
 v_accvgpr_write_b32 a46, v174
 v_accvgpr_write_b32 a47, v175
 v_accvgpr_read_b32 v168, a48
 v_accvgpr_read_b32 v169, a49
 v_accvgpr_read_b32 v170, a50
 v_accvgpr_read_b32 v171, a51
 v_accvgpr_read_b32 v172, a52
 v_accvgpr_read_b32 v173, a53
 v_accvgpr_read_b32 v174, a54
 v_accvgpr_read_b32 v175, a55
 v_mul_f32 v168, v168, v119
 v_mul_f32 v169, v169, v119
 v_mul_f32 v170, v170, v119
 v_mul_f32 v171, v171, v119
 v_mul_f32 v172, v172, v121
 v_mul_f32 v173, v173, v121
 v_mul_f32 v174, v174, v121
 v_mul_f32 v175, v175, v121
 v_accvgpr_write_b32 a48, v168
 v_accvgpr_write_b32 a49, v169
 v_accvgpr_write_b32 a50, v170
 v_accvgpr_write_b32 a51, v171
 v_accvgpr_write_b32 a52, v172
 v_accvgpr_write_b32 a53, v173
 v_accvgpr_write_b32 a54, v174
 v_accvgpr_write_b32 a55, v175
 v_accvgpr_read_b32 v168, a56
 v_accvgpr_read_b32 v169, a57
 v_accvgpr_read_b32 v170, a58
 v_accvgpr_read_b32 v171, a59
 v_accvgpr_read_b32 v172, a60
 v_accvgpr_read_b32 v173, a61
 v_accvgpr_read_b32 v174, a62
 v_accvgpr_read_b32 v175, a63
 v_mul_f32 v168, v168, v119
 v_mul_f32 v169, v169, v119
 v_mul_f32 v170, v170, v119
 v_mul_f32 v171, v171, v119
 v_mul_f32 v172, v172, v121
 v_mul_f32 v173, v173, v121
 v_mul_f32 v174, v174, v121
 v_mul_f32 v175, v175, v121
 v_accvgpr_write_b32 a56, v168
 v_accvgpr_write_b32 a57, v169
 v_accvgpr_write_b32 a58, v170
 v_accvgpr_write_b32 a59, v171
 v_accvgpr_write_b32 a60, v172
 v_accvgpr_write_b32 a61, v173
 v_accvgpr_write_b32 a62, v174
 v_accvgpr_write_b32 a63, v175
 v_accvgpr_read_b32 v168, a64
 v_accvgpr_read_b32 v169, a65
 v_accvgpr_read_b32 v170, a66
 v_accvgpr_read_b32 v171, a67
 v_accvgpr_read_b32 v172, a68
 v_accvgpr_read_b32 v173, a69
 v_accvgpr_read_b32 v174, a70
 v_accvgpr_read_b32 v175, a71
 v_mul_f32 v168, v168, v119
 v_mul_f32 v169, v169, v119
 v_mul_f32 v170, v170, v119
 v_mul_f32 v171, v171, v119
 v_mul_f32 v172, v172, v121
 v_mul_f32 v173, v173, v121
 v_mul_f32 v174, v174, v121
 v_mul_f32 v175, v175, v121
 v_accvgpr_write_b32 a64, v168
 v_accvgpr_write_b32 a65, v169
 v_accvgpr_write_b32 a66, v170
 v_accvgpr_write_b32 a67, v171
 v_accvgpr_write_b32 a68, v172
 v_accvgpr_write_b32 a69, v173
 v_accvgpr_write_b32 a70, v174
 v_accvgpr_write_b32 a71, v175
 v_accvgpr_read_b32 v168, a72
 v_accvgpr_read_b32 v169, a73
 v_accvgpr_read_b32 v170, a74
 v_accvgpr_read_b32 v171, a75
 v_accvgpr_read_b32 v172, a76
 v_accvgpr_read_b32 v173, a77
 v_accvgpr_read_b32 v174, a78
 v_accvgpr_read_b32 v175, a79
 v_mul_f32 v168, v168, v119
 v_mul_f32 v169, v169, v119
 v_mul_f32 v170, v170, v119
 v_mul_f32 v171, v171, v119
 v_mul_f32 v172, v172, v121
 v_mul_f32 v173, v173, v121
 v_mul_f32 v174, v174, v121
 v_mul_f32 v175, v175, v121
 v_accvgpr_write_b32 a72, v168
 v_accvgpr_write_b32 a73, v169
 v_accvgpr_write_b32 a74, v170
 v_accvgpr_write_b32 a75, v171
 v_accvgpr_write_b32 a76, v172
 v_accvgpr_write_b32 a77, v173
 v_accvgpr_write_b32 a78, v174
 v_accvgpr_write_b32 a79, v175
 v_accvgpr_read_b32 v168, a80
 v_accvgpr_read_b32 v169, a81
 v_accvgpr_read_b32 v170, a82
 v_accvgpr_read_b32 v171, a83
 v_accvgpr_read_b32 v172, a84
 v_accvgpr_read_b32 v173, a85
 v_accvgpr_read_b32 v174, a86
 v_accvgpr_read_b32 v175, a87
 v_mul_f32 v168, v168, v119
 v_mul_f32 v169, v169, v119
 v_mul_f32 v170, v170, v119
 v_mul_f32 v171, v171, v119
 v_mul_f32 v172, v172, v121
 v_mul_f32 v173, v173, v121
 v_mul_f32 v174, v174, v121
 v_mul_f32 v175, v175, v121
 v_accvgpr_write_b32 a80, v168
 v_accvgpr_write_b32 a81, v169
 v_accvgpr_write_b32 a82, v170
 v_accvgpr_write_b32 a83, v171
 v_accvgpr_write_b32 a84, v172
 v_accvgpr_write_b32 a85, v173
 v_accvgpr_write_b32 a86, v174
 v_accvgpr_write_b32 a87, v175
 v_accvgpr_read_b32 v168, a88
 v_accvgpr_read_b32 v169, a89
 v_accvgpr_read_b32 v170, a90
 v_accvgpr_read_b32 v171, a91
 v_accvgpr_read_b32 v172, a92
 v_accvgpr_read_b32 v173, a93
 v_accvgpr_read_b32 v174, a94
 v_accvgpr_read_b32 v175, a95
 v_mul_f32 v168, v168, v119
 v_mul_f32 v169, v169, v119
 v_mul_f32 v170, v170, v119
 v_mul_f32 v171, v171, v119
 v_mul_f32 v172, v172, v121
 v_mul_f32 v173, v173, v121
 v_mul_f32 v174, v174, v121
 v_mul_f32 v175, v175, v121
 v_accvgpr_write_b32 a88, v168
 v_accvgpr_write_b32 a89, v169
 v_accvgpr_write_b32 a90, v170
 v_accvgpr_write_b32 a91, v171
 v_accvgpr_write_b32 a92, v172
 v_accvgpr_write_b32 a93, v173
 v_accvgpr_write_b32 a94, v174
 v_accvgpr_write_b32 a95, v175
 v_accvgpr_read_b32 v168, a96
 v_accvgpr_read_b32 v169, a97
 v_accvgpr_read_b32 v170, a98
 v_accvgpr_read_b32 v171, a99
 v_accvgpr_read_b32 v172, a100
 v_accvgpr_read_b32 v173, a101
 v_accvgpr_read_b32 v174, a102
 v_accvgpr_read_b32 v175, a103
 v_mul_f32 v168, v168, v119
 v_mul_f32 v169, v169, v119
 v_mul_f32 v170, v170, v119
 v_mul_f32 v171, v171, v119
 v_mul_f32 v172, v172, v121
 v_mul_f32 v173, v173, v121
 v_mul_f32 v174, v174, v121
 v_mul_f32 v175, v175, v121
 v_accvgpr_write_b32 a96, v168
 v_accvgpr_write_b32 a97, v169
 v_accvgpr_write_b32 a98, v170
 v_accvgpr_write_b32 a99, v171
 v_accvgpr_write_b32 a100, v172
 v_accvgpr_write_b32 a101, v173
 v_accvgpr_write_b32 a102, v174
 v_accvgpr_write_b32 a103, v175
 v_accvgpr_read_b32 v168, a104
 v_accvgpr_read_b32 v169, a105
 v_accvgpr_read_b32 v170, a106
 v_accvgpr_read_b32 v171, a107
 v_accvgpr_read_b32 v172, a108
 v_accvgpr_read_b32 v173, a109
 v_accvgpr_read_b32 v174, a110
 v_accvgpr_read_b32 v175, a111
 v_mul_f32 v168, v168, v119
 v_mul_f32 v169, v169, v119
 v_mul_f32 v170, v170, v119
 v_mul_f32 v171, v171, v119
 v_mul_f32 v172, v172, v121
 v_mul_f32 v173, v173, v121
 v_mul_f32 v174, v174, v121
 v_mul_f32 v175, v175, v121
 v_accvgpr_write_b32 a104, v168
 v_accvgpr_write_b32 a105, v169
 v_accvgpr_write_b32 a106, v170
 v_accvgpr_write_b32 a107, v171
 v_accvgpr_write_b32 a108, v172
 v_accvgpr_write_b32 a109, v173
 v_accvgpr_write_b32 a110, v174
 v_accvgpr_write_b32 a111, v175
 v_accvgpr_read_b32 v168, a112
 v_accvgpr_read_b32 v169, a113
 v_accvgpr_read_b32 v170, a114
 v_accvgpr_read_b32 v171, a115
 v_accvgpr_read_b32 v172, a116
 v_accvgpr_read_b32 v173, a117
 v_accvgpr_read_b32 v174, a118
 v_accvgpr_read_b32 v175, a119
 v_mul_f32 v168, v168, v119
 v_mul_f32 v169, v169, v119
 v_mul_f32 v170, v170, v119
 v_mul_f32 v171, v171, v119
 v_mul_f32 v172, v172, v121
 v_mul_f32 v173, v173, v121
 v_mul_f32 v174, v174, v121
 v_mul_f32 v175, v175, v121
 v_accvgpr_write_b32 a112, v168
 v_accvgpr_write_b32 a113, v169
 v_accvgpr_write_b32 a114, v170
 v_accvgpr_write_b32 a115, v171
 v_accvgpr_write_b32 a116, v172
 v_accvgpr_write_b32 a117, v173
 v_accvgpr_write_b32 a118, v174
 v_accvgpr_write_b32 a119, v175
 v_accvgpr_read_b32 v168, a120
 v_accvgpr_read_b32 v169, a121
 v_accvgpr_read_b32 v170, a122
 v_accvgpr_read_b32 v171, a123
 v_accvgpr_read_b32 v172, a124
 v_accvgpr_read_b32 v173, a125
 v_accvgpr_read_b32 v174, a126
 v_accvgpr_read_b32 v175, a127
 v_mul_f32 v168, v168, v119
 v_mul_f32 v169, v169, v119
 v_mul_f32 v170, v170, v119
 v_mul_f32 v171, v171, v119
 v_mul_f32 v172, v172, v121
 v_mul_f32 v173, v173, v121
 v_mul_f32 v174, v174, v121
 v_mul_f32 v175, v175, v121
 v_accvgpr_write_b32 a120, v168
 v_accvgpr_write_b32 a121, v169
 v_accvgpr_write_b32 a122, v170
 v_accvgpr_write_b32 a123, v171
 v_accvgpr_write_b32 a124, v172
 v_accvgpr_write_b32 a125, v173
 v_accvgpr_write_b32 a126, v174
 v_accvgpr_write_b32 a127, v175
 s_nop 1
 v_mfma_f32_16x16x32_bf16 v[64:67], v[132:135], v[44:47], v[72:75]
 v_mfma_f32_16x16x32_bf16 v[68:71], v[132:135], v[52:55], v[76:79]
 s_nop 7
 s_setpc_b64 s[28:29]
L2_rare1:
 s_nop 7
 s_nop 7
 v_max3_f32 v118, v20, v21, v22
 v_max3_f32 v118, v118, v23, v24
 v_max3_f32 v118, v118, v25, v26
 v_max_f32 v118, v118, v27
 v_mov_b32 v122, v118
 s_nop 1
 v_permlane16_swap_b32 v118, v122
 v_max_f32 v118, v118, v122
 v_mov_b32 v122, v118
 s_nop 1
 v_permlane32_swap_b32 v118, v122
 v_max_f32 v118, v118, v122
 v_log_f32 v122, v64
 s_nop 0
 v_max_f32 v118, v118, v122
 v_exp_f32 v119, -v118
 v_sub_f32 v36, v36, v118
 v_sub_f32 v37, v37, v118
 v_sub_f32 v38, v38, v118
 v_sub_f32 v39, v39, v118
 v_mul_f32 v64, v64, v119
 v_mul_f32 v65, v65, v119
 v_mul_f32 v66, v66, v119
 v_mul_f32 v67, v67, v119
 v_sub_f32 v20, v20, v118
 v_sub_f32 v21, v21, v118
 v_sub_f32 v22, v22, v118
 v_sub_f32 v23, v23, v118
 v_sub_f32 v24, v24, v118
 v_sub_f32 v25, v25, v118
 v_sub_f32 v26, v26, v118
 v_sub_f32 v27, v27, v118
 v_mul_f32 v122, s9, v118
 v_sub_f32 v4, v4, v122
 v_sub_f32 v5, v5, v122
 v_sub_f32 v6, v6, v122
 v_sub_f32 v7, v7, v122
 v_sub_f32 v8, v8, v122
 v_sub_f32 v9, v9, v122
 v_sub_f32 v10, v10, v122
 v_sub_f32 v11, v11, v122
 v_exp_f32 v56, v20
 v_exp_f32 v57, v21
 v_exp_f32 v58, v22
 v_exp_f32 v59, v23
 v_cvt_pk_bf16_f32 v48, v56, v57
 v_exp_f32 v60, v24
 v_exp_f32 v61, v25
 v_cvt_pk_bf16_f32 v49, v58, v59
 v_exp_f32 v62, v26
 v_exp_f32 v63, v27
 v_cvt_pk_bf16_f32 v50, v60, v61
 v_cvt_pk_bf16_f32 v51, v62, v63
 v_max3_f32 v120, v28, v29, v30
 v_max3_f32 v120, v120, v31, v32
 v_max3_f32 v120, v120, v33, v34
 v_max_f32 v120, v120, v35
 v_mov_b32 v122, v120
 s_nop 1
 v_permlane16_swap_b32 v120, v122
 v_max_f32 v120, v120, v122
 v_mov_b32 v122, v120
 s_nop 1
 v_permlane32_swap_b32 v120, v122
 v_max_f32 v120, v120, v122
 v_log_f32 v122, v68
 s_nop 0
 v_max_f32 v120, v120, v122
 v_exp_f32 v121, -v120
 v_sub_f32 v40, v40, v120
 v_sub_f32 v41, v41, v120
 v_sub_f32 v42, v42, v120
 v_sub_f32 v43, v43, v120
 v_mul_f32 v68, v68, v121
 v_mul_f32 v69, v69, v121
 v_mul_f32 v70, v70, v121
 v_mul_f32 v71, v71, v121
 v_sub_f32 v28, v28, v120
 v_sub_f32 v29, v29, v120
 v_sub_f32 v30, v30, v120
 v_sub_f32 v31, v31, v120
 v_sub_f32 v32, v32, v120
 v_sub_f32 v33, v33, v120
 v_sub_f32 v34, v34, v120
 v_sub_f32 v35, v35, v120
 v_mul_f32 v122, s9, v120
 v_sub_f32 v12, v12, v122
 v_sub_f32 v13, v13, v122
 v_sub_f32 v14, v14, v122
 v_sub_f32 v15, v15, v122
 v_sub_f32 v16, v16, v122
 v_sub_f32 v17, v17, v122
 v_sub_f32 v18, v18, v122
 v_sub_f32 v19, v19, v122
 v_exp_f32 v56, v28
 v_exp_f32 v57, v29
 v_exp_f32 v58, v30
 v_exp_f32 v59, v31
 v_cvt_pk_bf16_f32 v52, v56, v57
 v_exp_f32 v60, v32
 v_exp_f32 v61, v33
 v_cvt_pk_bf16_f32 v53, v58, v59
 v_exp_f32 v62, v34
 v_exp_f32 v63, v35
 v_cvt_pk_bf16_f32 v54, v60, v61
 v_cvt_pk_bf16_f32 v55, v62, v63
 v_accvgpr_read_b32 v168, a0
 v_accvgpr_read_b32 v169, a1
 v_accvgpr_read_b32 v170, a2
 v_accvgpr_read_b32 v171, a3
 v_accvgpr_read_b32 v172, a4
 v_accvgpr_read_b32 v173, a5
 v_accvgpr_read_b32 v174, a6
 v_accvgpr_read_b32 v175, a7
 v_mul_f32 v168, v168, v119
 v_mul_f32 v169, v169, v119
 v_mul_f32 v170, v170, v119
 v_mul_f32 v171, v171, v119
 v_mul_f32 v172, v172, v121
 v_mul_f32 v173, v173, v121
 v_mul_f32 v174, v174, v121
 v_mul_f32 v175, v175, v121
 v_accvgpr_write_b32 a0, v168
 v_accvgpr_write_b32 a1, v169
 v_accvgpr_write_b32 a2, v170
 v_accvgpr_write_b32 a3, v171
 v_accvgpr_write_b32 a4, v172
 v_accvgpr_write_b32 a5, v173
 v_accvgpr_write_b32 a6, v174
 v_accvgpr_write_b32 a7, v175
 v_accvgpr_read_b32 v168, a8
 v_accvgpr_read_b32 v169, a9
 v_accvgpr_read_b32 v170, a10
 v_accvgpr_read_b32 v171, a11
 v_accvgpr_read_b32 v172, a12
 v_accvgpr_read_b32 v173, a13
 v_accvgpr_read_b32 v174, a14
 v_accvgpr_read_b32 v175, a15
 v_mul_f32 v168, v168, v119
 v_mul_f32 v169, v169, v119
 v_mul_f32 v170, v170, v119
 v_mul_f32 v171, v171, v119
 v_mul_f32 v172, v172, v121
 v_mul_f32 v173, v173, v121
 v_mul_f32 v174, v174, v121
 v_mul_f32 v175, v175, v121
 v_accvgpr_write_b32 a8, v168
 v_accvgpr_write_b32 a9, v169
 v_accvgpr_write_b32 a10, v170
 v_accvgpr_write_b32 a11, v171
 v_accvgpr_write_b32 a12, v172
 v_accvgpr_write_b32 a13, v173
 v_accvgpr_write_b32 a14, v174
 v_accvgpr_write_b32 a15, v175
 v_accvgpr_read_b32 v168, a16
 v_accvgpr_read_b32 v169, a17
 v_accvgpr_read_b32 v170, a18
 v_accvgpr_read_b32 v171, a19
 v_accvgpr_read_b32 v172, a20
 v_accvgpr_read_b32 v173, a21
 v_accvgpr_read_b32 v174, a22
 v_accvgpr_read_b32 v175, a23
 v_mul_f32 v168, v168, v119
 v_mul_f32 v169, v169, v119
 v_mul_f32 v170, v170, v119
 v_mul_f32 v171, v171, v119
 v_mul_f32 v172, v172, v121
 v_mul_f32 v173, v173, v121
 v_mul_f32 v174, v174, v121
 v_mul_f32 v175, v175, v121
 v_accvgpr_write_b32 a16, v168
 v_accvgpr_write_b32 a17, v169
 v_accvgpr_write_b32 a18, v170
 v_accvgpr_write_b32 a19, v171
 v_accvgpr_write_b32 a20, v172
 v_accvgpr_write_b32 a21, v173
 v_accvgpr_write_b32 a22, v174
 v_accvgpr_write_b32 a23, v175
 v_accvgpr_read_b32 v168, a24
 v_accvgpr_read_b32 v169, a25
 v_accvgpr_read_b32 v170, a26
 v_accvgpr_read_b32 v171, a27
 v_accvgpr_read_b32 v172, a28
 v_accvgpr_read_b32 v173, a29
 v_accvgpr_read_b32 v174, a30
 v_accvgpr_read_b32 v175, a31
 v_mul_f32 v168, v168, v119
 v_mul_f32 v169, v169, v119
 v_mul_f32 v170, v170, v119
 v_mul_f32 v171, v171, v119
 v_mul_f32 v172, v172, v121
 v_mul_f32 v173, v173, v121
 v_mul_f32 v174, v174, v121
 v_mul_f32 v175, v175, v121
 v_accvgpr_write_b32 a24, v168
 v_accvgpr_write_b32 a25, v169
 v_accvgpr_write_b32 a26, v170
 v_accvgpr_write_b32 a27, v171
 v_accvgpr_write_b32 a28, v172
 v_accvgpr_write_b32 a29, v173
 v_accvgpr_write_b32 a30, v174
 v_accvgpr_write_b32 a31, v175
 v_accvgpr_read_b32 v168, a32
 v_accvgpr_read_b32 v169, a33
 v_accvgpr_read_b32 v170, a34
 v_accvgpr_read_b32 v171, a35
 v_accvgpr_read_b32 v172, a36
 v_accvgpr_read_b32 v173, a37
 v_accvgpr_read_b32 v174, a38
 v_accvgpr_read_b32 v175, a39
 v_mul_f32 v168, v168, v119
 v_mul_f32 v169, v169, v119
 v_mul_f32 v170, v170, v119
 v_mul_f32 v171, v171, v119
 v_mul_f32 v172, v172, v121
 v_mul_f32 v173, v173, v121
 v_mul_f32 v174, v174, v121
 v_mul_f32 v175, v175, v121
 v_accvgpr_write_b32 a32, v168
 v_accvgpr_write_b32 a33, v169
 v_accvgpr_write_b32 a34, v170
 v_accvgpr_write_b32 a35, v171
 v_accvgpr_write_b32 a36, v172
 v_accvgpr_write_b32 a37, v173
 v_accvgpr_write_b32 a38, v174
 v_accvgpr_write_b32 a39, v175
 v_accvgpr_read_b32 v168, a40
 v_accvgpr_read_b32 v169, a41
 v_accvgpr_read_b32 v170, a42
 v_accvgpr_read_b32 v171, a43
 v_accvgpr_read_b32 v172, a44
 v_accvgpr_read_b32 v173, a45
 v_accvgpr_read_b32 v174, a46
 v_accvgpr_read_b32 v175, a47
 v_mul_f32 v168, v168, v119
 v_mul_f32 v169, v169, v119
 v_mul_f32 v170, v170, v119
 v_mul_f32 v171, v171, v119
 v_mul_f32 v172, v172, v121
 v_mul_f32 v173, v173, v121
 v_mul_f32 v174, v174, v121
 v_mul_f32 v175, v175, v121
 v_accvgpr_write_b32 a40, v168
 v_accvgpr_write_b32 a41, v169
 v_accvgpr_write_b32 a42, v170
 v_accvgpr_write_b32 a43, v171
 v_accvgpr_write_b32 a44, v172
 v_accvgpr_write_b32 a45, v173
 v_accvgpr_write_b32 a46, v174
 v_accvgpr_write_b32 a47, v175
 v_accvgpr_read_b32 v168, a48
 v_accvgpr_read_b32 v169, a49
 v_accvgpr_read_b32 v170, a50
 v_accvgpr_read_b32 v171, a51
 v_accvgpr_read_b32 v172, a52
 v_accvgpr_read_b32 v173, a53
 v_accvgpr_read_b32 v174, a54
 v_accvgpr_read_b32 v175, a55
 v_mul_f32 v168, v168, v119
 v_mul_f32 v169, v169, v119
 v_mul_f32 v170, v170, v119
 v_mul_f32 v171, v171, v119
 v_mul_f32 v172, v172, v121
 v_mul_f32 v173, v173, v121
 v_mul_f32 v174, v174, v121
 v_mul_f32 v175, v175, v121
 v_accvgpr_write_b32 a48, v168
 v_accvgpr_write_b32 a49, v169
 v_accvgpr_write_b32 a50, v170
 v_accvgpr_write_b32 a51, v171
 v_accvgpr_write_b32 a52, v172
 v_accvgpr_write_b32 a53, v173
 v_accvgpr_write_b32 a54, v174
 v_accvgpr_write_b32 a55, v175
 v_accvgpr_read_b32 v168, a56
 v_accvgpr_read_b32 v169, a57
 v_accvgpr_read_b32 v170, a58
 v_accvgpr_read_b32 v171, a59
 v_accvgpr_read_b32 v172, a60
 v_accvgpr_read_b32 v173, a61
 v_accvgpr_read_b32 v174, a62
 v_accvgpr_read_b32 v175, a63
 v_mul_f32 v168, v168, v119
 v_mul_f32 v169, v169, v119
 v_mul_f32 v170, v170, v119
 v_mul_f32 v171, v171, v119
 v_mul_f32 v172, v172, v121
 v_mul_f32 v173, v173, v121
 v_mul_f32 v174, v174, v121
 v_mul_f32 v175, v175, v121
 v_accvgpr_write_b32 a56, v168
 v_accvgpr_write_b32 a57, v169
 v_accvgpr_write_b32 a58, v170
 v_accvgpr_write_b32 a59, v171
 v_accvgpr_write_b32 a60, v172
 v_accvgpr_write_b32 a61, v173
 v_accvgpr_write_b32 a62, v174
 v_accvgpr_write_b32 a63, v175
 v_accvgpr_read_b32 v168, a64
 v_accvgpr_read_b32 v169, a65
 v_accvgpr_read_b32 v170, a66
 v_accvgpr_read_b32 v171, a67
 v_accvgpr_read_b32 v172, a68
 v_accvgpr_read_b32 v173, a69
 v_accvgpr_read_b32 v174, a70
 v_accvgpr_read_b32 v175, a71
 v_mul_f32 v168, v168, v119
 v_mul_f32 v169, v169, v119
 v_mul_f32 v170, v170, v119
 v_mul_f32 v171, v171, v119
 v_mul_f32 v172, v172, v121
 v_mul_f32 v173, v173, v121
 v_mul_f32 v174, v174, v121
 v_mul_f32 v175, v175, v121
 v_accvgpr_write_b32 a64, v168
 v_accvgpr_write_b32 a65, v169
 v_accvgpr_write_b32 a66, v170
 v_accvgpr_write_b32 a67, v171
 v_accvgpr_write_b32 a68, v172
 v_accvgpr_write_b32 a69, v173
 v_accvgpr_write_b32 a70, v174
 v_accvgpr_write_b32 a71, v175
 v_accvgpr_read_b32 v168, a72
 v_accvgpr_read_b32 v169, a73
 v_accvgpr_read_b32 v170, a74
 v_accvgpr_read_b32 v171, a75
 v_accvgpr_read_b32 v172, a76
 v_accvgpr_read_b32 v173, a77
 v_accvgpr_read_b32 v174, a78
 v_accvgpr_read_b32 v175, a79
 v_mul_f32 v168, v168, v119
 v_mul_f32 v169, v169, v119
 v_mul_f32 v170, v170, v119
 v_mul_f32 v171, v171, v119
 v_mul_f32 v172, v172, v121
 v_mul_f32 v173, v173, v121
 v_mul_f32 v174, v174, v121
 v_mul_f32 v175, v175, v121
 v_accvgpr_write_b32 a72, v168
 v_accvgpr_write_b32 a73, v169
 v_accvgpr_write_b32 a74, v170
 v_accvgpr_write_b32 a75, v171
 v_accvgpr_write_b32 a76, v172
 v_accvgpr_write_b32 a77, v173
 v_accvgpr_write_b32 a78, v174
 v_accvgpr_write_b32 a79, v175
 v_accvgpr_read_b32 v168, a80
 v_accvgpr_read_b32 v169, a81
 v_accvgpr_read_b32 v170, a82
 v_accvgpr_read_b32 v171, a83
 v_accvgpr_read_b32 v172, a84
 v_accvgpr_read_b32 v173, a85
 v_accvgpr_read_b32 v174, a86
 v_accvgpr_read_b32 v175, a87
 v_mul_f32 v168, v168, v119
 v_mul_f32 v169, v169, v119
 v_mul_f32 v170, v170, v119
 v_mul_f32 v171, v171, v119
 v_mul_f32 v172, v172, v121
 v_mul_f32 v173, v173, v121
 v_mul_f32 v174, v174, v121
 v_mul_f32 v175, v175, v121
 v_accvgpr_write_b32 a80, v168
 v_accvgpr_write_b32 a81, v169
 v_accvgpr_write_b32 a82, v170
 v_accvgpr_write_b32 a83, v171
 v_accvgpr_write_b32 a84, v172
 v_accvgpr_write_b32 a85, v173
 v_accvgpr_write_b32 a86, v174
 v_accvgpr_write_b32 a87, v175
 v_accvgpr_read_b32 v168, a88
 v_accvgpr_read_b32 v169, a89
 v_accvgpr_read_b32 v170, a90
 v_accvgpr_read_b32 v171, a91
 v_accvgpr_read_b32 v172, a92
 v_accvgpr_read_b32 v173, a93
 v_accvgpr_read_b32 v174, a94
 v_accvgpr_read_b32 v175, a95
 v_mul_f32 v168, v168, v119
 v_mul_f32 v169, v169, v119
 v_mul_f32 v170, v170, v119
 v_mul_f32 v171, v171, v119
 v_mul_f32 v172, v172, v121
 v_mul_f32 v173, v173, v121
 v_mul_f32 v174, v174, v121
 v_mul_f32 v175, v175, v121
 v_accvgpr_write_b32 a88, v168
 v_accvgpr_write_b32 a89, v169
 v_accvgpr_write_b32 a90, v170
 v_accvgpr_write_b32 a91, v171
 v_accvgpr_write_b32 a92, v172
 v_accvgpr_write_b32 a93, v173
 v_accvgpr_write_b32 a94, v174
 v_accvgpr_write_b32 a95, v175
 v_accvgpr_read_b32 v168, a96
 v_accvgpr_read_b32 v169, a97
 v_accvgpr_read_b32 v170, a98
 v_accvgpr_read_b32 v171, a99
 v_accvgpr_read_b32 v172, a100
 v_accvgpr_read_b32 v173, a101
 v_accvgpr_read_b32 v174, a102
 v_accvgpr_read_b32 v175, a103
 v_mul_f32 v168, v168, v119
 v_mul_f32 v169, v169, v119
 v_mul_f32 v170, v170, v119
 v_mul_f32 v171, v171, v119
 v_mul_f32 v172, v172, v121
 v_mul_f32 v173, v173, v121
 v_mul_f32 v174, v174, v121
 v_mul_f32 v175, v175, v121
 v_accvgpr_write_b32 a96, v168
 v_accvgpr_write_b32 a97, v169
 v_accvgpr_write_b32 a98, v170
 v_accvgpr_write_b32 a99, v171
 v_accvgpr_write_b32 a100, v172
 v_accvgpr_write_b32 a101, v173
 v_accvgpr_write_b32 a102, v174
 v_accvgpr_write_b32 a103, v175
 v_accvgpr_read_b32 v168, a104
 v_accvgpr_read_b32 v169, a105
 v_accvgpr_read_b32 v170, a106
 v_accvgpr_read_b32 v171, a107
 v_accvgpr_read_b32 v172, a108
 v_accvgpr_read_b32 v173, a109
 v_accvgpr_read_b32 v174, a110
 v_accvgpr_read_b32 v175, a111
 v_mul_f32 v168, v168, v119
 v_mul_f32 v169, v169, v119
 v_mul_f32 v170, v170, v119
 v_mul_f32 v171, v171, v119
 v_mul_f32 v172, v172, v121
 v_mul_f32 v173, v173, v121
 v_mul_f32 v174, v174, v121
 v_mul_f32 v175, v175, v121
 v_accvgpr_write_b32 a104, v168
 v_accvgpr_write_b32 a105, v169
 v_accvgpr_write_b32 a106, v170
 v_accvgpr_write_b32 a107, v171
 v_accvgpr_write_b32 a108, v172
 v_accvgpr_write_b32 a109, v173
 v_accvgpr_write_b32 a110, v174
 v_accvgpr_write_b32 a111, v175
 v_accvgpr_read_b32 v168, a112
 v_accvgpr_read_b32 v169, a113
 v_accvgpr_read_b32 v170, a114
 v_accvgpr_read_b32 v171, a115
 v_accvgpr_read_b32 v172, a116
 v_accvgpr_read_b32 v173, a117
 v_accvgpr_read_b32 v174, a118
 v_accvgpr_read_b32 v175, a119
 v_mul_f32 v168, v168, v119
 v_mul_f32 v169, v169, v119
 v_mul_f32 v170, v170, v119
 v_mul_f32 v171, v171, v119
 v_mul_f32 v172, v172, v121
 v_mul_f32 v173, v173, v121
 v_mul_f32 v174, v174, v121
 v_mul_f32 v175, v175, v121
 v_accvgpr_write_b32 a112, v168
 v_accvgpr_write_b32 a113, v169
 v_accvgpr_write_b32 a114, v170
 v_accvgpr_write_b32 a115, v171
 v_accvgpr_write_b32 a116, v172
 v_accvgpr_write_b32 a117, v173
 v_accvgpr_write_b32 a118, v174
 v_accvgpr_write_b32 a119, v175
 v_accvgpr_read_b32 v168, a120
 v_accvgpr_read_b32 v169, a121
 v_accvgpr_read_b32 v170, a122
 v_accvgpr_read_b32 v171, a123
 v_accvgpr_read_b32 v172, a124
 v_accvgpr_read_b32 v173, a125
 v_accvgpr_read_b32 v174, a126
 v_accvgpr_read_b32 v175, a127
 v_mul_f32 v168, v168, v119
 v_mul_f32 v169, v169, v119
 v_mul_f32 v170, v170, v119
 v_mul_f32 v171, v171, v119
 v_mul_f32 v172, v172, v121
 v_mul_f32 v173, v173, v121
 v_mul_f32 v174, v174, v121
 v_mul_f32 v175, v175, v121
 v_accvgpr_write_b32 a120, v168
 v_accvgpr_write_b32 a121, v169
 v_accvgpr_write_b32 a122, v170
 v_accvgpr_write_b32 a123, v171
 v_accvgpr_write_b32 a124, v172
 v_accvgpr_write_b32 a125, v173
 v_accvgpr_write_b32 a126, v174
 v_accvgpr_write_b32 a127, v175
 s_nop 1
 v_mfma_f32_16x16x32_bf16 v[72:75], v[132:135], v[48:51], v[64:67]
 v_mfma_f32_16x16x32_bf16 v[76:79], v[132:135], v[52:55], v[68:71]
 s_nop 7
 s_setpc_b64 s[28:29]
L2_fin:
 v_mfma_f32_16x16x32_bf16 a[0:3], a[192:195], v[48:51], a[0:3]
 ds_read_b128 a[252:255], v164 offset:64512
 v_mfma_f32_16x16x32_bf16 a[4:7], a[192:195], v[52:55], a[4:7]
 s_lshl_b32 s11, s8, 1
 v_mfma_f32_16x16x32_bf16 a[8:11], a[196:199], v[48:51], a[8:11]
 v_mfma_f32_16x16x32_bf16 a[12:15], a[196:199], v[52:55], a[12:15]
 s_add_u32 m0, s11, 0x0
 v_mfma_f32_16x16x32_bf16 a[16:19], a[200:203], v[48:51], a[16:19]
 v_mfma_f32_16x16x32_bf16 a[20:23], a[200:203], v[52:55], a[20:23]
 s_nop 0
 v_mfma_f32_16x16x32_bf16 a[24:27], a[204:207], v[48:51], a[24:27]
 v_mfma_f32_16x16x32_bf16 a[28:31], a[204:207], v[52:55], a[28:31]
 buffer_load_dwordx4 v136, s[56:59], s44 offen offset:0 lds
 v_mfma_f32_16x16x32_bf16 a[32:35], a[208:211], v[48:51], a[32:35]
 v_mfma_f32_16x16x32_bf16 a[36:39], a[208:211], v[52:55], a[36:39]
 buffer_load_dwordx4 v137, s[56:59], s44 offen offset:1024 lds
 v_mfma_f32_16x16x32_bf16 a[40:43], a[212:215], v[48:51], a[40:43]
 v_mfma_f32_16x16x32_bf16 a[44:47], a[212:215], v[52:55], a[44:47]
 buffer_load_dwordx4 v138, s[56:59], s44 offen offset:2048 lds
 v_mfma_f32_16x16x32_bf16 a[48:51], a[216:219], v[48:51], a[48:51]
 v_mfma_f32_16x16x32_bf16 a[52:55], a[216:219], v[52:55], a[52:55]
 buffer_load_dwordx4 v139, s[56:59], s44 offen offset:3072 lds
 v_mfma_f32_16x16x32_bf16 a[56:59], a[220:223], v[48:51], a[56:59]
 v_mfma_f32_16x16x32_bf16 a[60:63], a[220:223], v[52:55], a[60:63]
 s_add_u32 s44, s44, 28672
 s_waitcnt lgkmcnt(0)
 v_mfma_f32_16x16x32_bf16 a[64:67], a[224:227], v[48:51], a[64:67]
 v_mfma_f32_16x16x32_bf16 a[68:71], a[224:227], v[52:55], a[68:71]
 s_add_u32 m0, s11, 0x1000
 v_mfma_f32_16x16x32_bf16 a[72:75], a[228:231], v[48:51], a[72:75]
 v_mfma_f32_16x16x32_bf16 a[76:79], a[228:231], v[52:55], a[76:79]
 s_nop 0
 v_mfma_f32_16x16x32_bf16 a[80:83], a[232:235], v[48:51], a[80:83]
 v_mfma_f32_16x16x32_bf16 a[84:87], a[232:235], v[52:55], a[84:87]
 buffer_load_dwordx4 v136, s[56:59], s44 offen offset:0 lds
 v_mfma_f32_16x16x32_bf16 a[88:91], a[236:239], v[48:51], a[88:91]
 v_mfma_f32_16x16x32_bf16 a[92:95], a[236:239], v[52:55], a[92:95]
 buffer_load_dwordx4 v137, s[56:59], s44 offen offset:1024 lds
 v_mfma_f32_16x16x32_bf16 a[96:99], a[240:243], v[48:51], a[96:99]
 v_mfma_f32_16x16x32_bf16 a[100:103], a[240:243], v[52:55], a[100:103]
 buffer_load_dwordx4 v138, s[56:59], s44 offen offset:2048 lds
 v_mfma_f32_16x16x32_bf16 a[104:107], a[244:247], v[48:51], a[104:107]
 v_mfma_f32_16x16x32_bf16 a[108:111], a[244:247], v[52:55], a[108:111]
 buffer_load_dwordx4 v139, s[56:59], s44 offen offset:3072 lds
 v_mfma_f32_16x16x32_bf16 a[112:115], a[248:251], v[48:51], a[112:115]
 v_mfma_f32_16x16x32_bf16 a[116:119], a[248:251], v[52:55], a[116:119]
 s_sub_u32 s44, s44, 28544
 v_mfma_f32_16x16x32_bf16 a[120:123], a[252:255], v[48:51], a[120:123]
 v_mfma_f32_16x16x32_bf16 a[124:127], a[252:255], v[52:55], a[124:127]
 s_waitcnt vmcnt(8)
 s_barrier
 s_cmp_eq_u32 s65, 2
 s_cbranch_scc1 L2_merge
 v_rcp_f32 v84, v72
 v_rcp_f32 v86, v76
 s_nop 0
 v_mov_b32 v85, v84
 v_mov_b32 v87, v86
 v_accvgpr_read_b32 v168, a0
 s_lshl_b32 s11, s8, 1
 v_accvgpr_read_b32 v169, a1
 s_add_u32 m0, s11, 0x8000
 v_accvgpr_read_b32 v170, a2
 buffer_load_dwordx4 v136, s[56:59], s44 offen offset:0 lds
 v_accvgpr_read_b32 v171, a3
 s_getpc_b64 s[12:13]
 v_accvgpr_read_b32 v172, a8
L_ct6:
 v_accvgpr_read_b32 v173, a9
 s_sub_u32 s12, s12, L_ct6-L_begin
 v_accvgpr_read_b32 v174, a10
 s_subb_u32 s13, s13, 0
 v_accvgpr_read_b32 v175, a11
 s_and_b32 s13, s13, 0xffff
 v_pk_mul_f32 v[168:169], v[168:169], v[84:85]
 buffer_load_dwordx4 v137, s[56:59], s44 offen offset:1024 lds
 v_pk_mul_f32 v[170:171], v[170:171], v[84:85]
 s_mov_b32 s14, L_last-L_begin
 v_pk_mul_f32 v[172:173], v[172:173], v[84:85]
 s_mov_b32 s15, 0x20000
 v_pk_mul_f32 v[174:175], v[174:175], v[84:85]
 s_lshr_b32 s9, s2, 3
 v_cvt_pk_bf16_f32 v192, v168, v169
 s_lshl_b32 s9, s9, 2
 v_cvt_pk_bf16_f32 v193, v170, v171
 s_add_u32 s9, s9, s3
 v_cvt_pk_bf16_f32 v194, v172, v173
 buffer_load_dwordx4 v138, s[56:59], s44 offen offset:2048 lds
 v_cvt_pk_bf16_f32 v195, v174, v175
 s_lshl_b32 s9, s9, 10
 v_accvgpr_read_b32 v176, a16
 buffer_load_dwordx4 a[128:131], v2, s[12:15], s9 offen
 v_accvgpr_read_b32 v177, a17
 s_load_dwordx2 s[48:49], s[0:1], 56
 v_accvgpr_read_b32 v178, a18
 s_load_dwordx2 s[52:53], s[0:1], 64
 v_accvgpr_read_b32 v179, a19
 s_and_b32 s64, s2, 7
 v_accvgpr_read_b32 v180, a24
 buffer_load_dwordx4 v139, s[56:59], s44 offen offset:3072 lds
 v_accvgpr_read_b32 v181, a25
 s_lshr_b32 s65, s2, 7
 v_accvgpr_read_b32 v182, a26
 s_lshl_b32 s65, s65, 3
 v_accvgpr_read_b32 v183, a27
 s_add_u32 s64, s64, s65
 v_pk_mul_f32 v[176:177], v[176:177], v[84:85]
 s_bfe_u32 s65, s2, 0x40003
 v_pk_mul_f32 v[178:179], v[178:179], v[84:85]
 v_lshrrev_b32 v186, 4, v1
 v_pk_mul_f32 v[180:181], v[180:181], v[84:85]
 s_add_u32 s44, s44, 28672
 v_pk_mul_f32 v[182:183], v[182:183], v[84:85]
 s_add_u32 m0, s11, 0x9000
 v_cvt_pk_bf16_f32 v196, v176, v177
 buffer_load_dwordx4 v136, s[56:59], s44 offen offset:0 lds
 v_cvt_pk_bf16_f32 v197, v178, v179
 v_bfe_u32 v184, v1, 2, 2
 v_cvt_pk_bf16_f32 v198, v180, v181
 s_lshl_b32 s9, s3, 3
 v_cvt_pk_bf16_f32 v199, v182, v183
 v_add_u32 v185, s9, v184
 v_accvgpr_read_b32 v168, a32
 v_mul_u32_u24 v185, 3584, v185
 v_accvgpr_read_b32 v169, a33
 v_lshl_add_u32 v185, v186, 6, v185
 v_accvgpr_read_b32 v170, a34
 buffer_load_dwordx4 v137, s[56:59], s44 offen offset:1024 lds
 v_accvgpr_read_b32 v171, a35
 v_and_b32 v187, 3, v1
 v_accvgpr_read_b32 v172, a40
 v_lshl_add_u32 v185, v187, 4, v185
 v_accvgpr_read_b32 v173, a41
 v_xor_b32 v188, 32, v185
 v_accvgpr_read_b32 v174, a42
 v_add_u32 v140, 0x1000, v185
 v_accvgpr_read_b32 v175, a43
 v_add_u32 v141, 0xc00, v185
 v_pk_mul_f32 v[168:169], v[168:169], v[84:85]
 buffer_load_dwordx4 v138, s[56:59], s44 offen offset:2048 lds
 v_pk_mul_f32 v[170:171], v[170:171], v[84:85]
 v_add_u32 v142, 0x4000, v188
 v_pk_mul_f32 v[172:173], v[172:173], v[84:85]
 v_add_u32 v143, 0x3c00, v188
 v_pk_mul_f32 v[174:175], v[174:175], v[84:85]
 v_lshlrev_b32 v185, 11, v186
 v_cvt_pk_bf16_f32 v200, v168, v169
 v_lshl_add_u32 v185, v184, 6, v185
 v_cvt_pk_bf16_f32 v201, v170, v171
 v_bfe_u32 v184, v1, 4, 1
 v_cvt_pk_bf16_f32 v202, v172, v173
 buffer_load_dwordx4 v139, s[56:59], s44 offen offset:3072 lds
 v_cvt_pk_bf16_f32 v203, v174, v175
 v_lshl_add_u32 v185, v184, 5, v185
 v_accvgpr_read_b32 v176, a48
 v_lshl_add_u32 v144, v187, 3, v185
 v_accvgpr_read_b32 v177, a49
 v_xor_b32 v145, 32, v144
 v_accvgpr_read_b32 v178, a50
 s_waitcnt lgkmcnt(0)
 v_accvgpr_read_b32 v179, a51
 s_sub_u32 s48, s48, 4096
 v_accvgpr_read_b32 v180, a56
 s_subb_u32 s49, s49, 0
 v_accvgpr_read_b32 v181, a57
 s_sub_u32 s44, s44, 28544
 v_accvgpr_read_b32 v182, a58
 s_lshl_b32 s11, s8, 1
 v_accvgpr_read_b32 v183, a59
 s_add_u32 m0, s11, 0x10000
 v_pk_mul_f32 v[176:177], v[176:177], v[84:85]
 buffer_load_dwordx4 v136, s[56:59], s44 offen offset:0 lds
 v_pk_mul_f32 v[178:179], v[178:179], v[84:85]
 s_and_b32 s49, s49, 0xffff
 v_pk_mul_f32 v[180:181], v[180:181], v[84:85]
 s_mov_b32 s50, 0x189000
 v_pk_mul_f32 v[182:183], v[182:183], v[84:85]
 s_mov_b32 s51, 0x20000
 v_cvt_pk_bf16_f32 v204, v176, v177
 s_sub_u32 s52, s52, 4096
 v_cvt_pk_bf16_f32 v205, v178, v179
 s_subb_u32 s53, s53, 0
 v_cvt_pk_bf16_f32 v206, v180, v181
 buffer_load_dwordx4 v137, s[56:59], s44 offen offset:1024 lds
 v_cvt_pk_bf16_f32 v207, v182, v183
 s_and_b32 s53, s53, 0xffff
 v_accvgpr_read_b32 v168, a64
 s_mov_b32 s54, 0x189000
 v_accvgpr_read_b32 v169, a65
 s_mov_b32 s55, 0x20000
 v_accvgpr_read_b32 v170, a66
 s_min_u32 s9, s65, 13
 v_accvgpr_read_b32 v171, a67
 s_lshl_b32 s66, s9, 8
 v_accvgpr_read_b32 v172, a72
 buffer_load_dwordx4 v138, s[56:59], s44 offen offset:2048 lds
 v_accvgpr_read_b32 v173, a73
 s_and_b32 s32, s2, 7
 v_accvgpr_read_b32 v174, a74
 s_lshr_b32 s33, s2, 7
 v_accvgpr_read_b32 v175, a75
 s_lshl_b32 s33, s33, 3
 v_pk_mul_f32 v[168:169], v[168:169], v[84:85]
 s_add_u32 s32, s32, s33
 v_pk_mul_f32 v[170:171], v[170:171], v[84:85]
 s_bfe_u32 s33, s2, 0x40003
 v_pk_mul_f32 v[172:173], v[172:173], v[84:85]
 buffer_load_dwordx4 v139, s[56:59], s44 offen offset:3072 lds
 v_pk_mul_f32 v[174:175], v[174:175], v[84:85]
 v_and_b32 v184, 7, v1
 v_cvt_pk_bf16_f32 v208, v168, v169
 v_bfe_u32 v185, v1, 3, 2
 v_cvt_pk_bf16_f32 v209, v170, v171
 v_lshrrev_b32 v186, 5, v1
 v_cvt_pk_bf16_f32 v210, v172, v173
 v_lshlrev_b32 v190, 4, v184
 v_cvt_pk_bf16_f32 v211, v174, v175
 v_lshl_add_u32 v190, v185, 8, v190
 v_accvgpr_read_b32 v176, a80
 s_add_u32 s44, s44, 28672
 v_accvgpr_read_b32 v177, a81
 s_add_u32 m0, s11, 0x11000
 v_accvgpr_read_b32 v178, a82
 buffer_load_dwordx4 v136, s[56:59], s44 offen offset:0 lds
 v_accvgpr_read_b32 v179, a83
 v_mul_u32_u24 v187, 14336, v186
 v_accvgpr_read_b32 v180, a88
 v_add_u32 v190, v190, v187
 v_accvgpr_read_b32 v181, a89
 s_lshl_b32 s24, s32, 3
 v_accvgpr_read_b32 v182, a90
 s_lshr_b32 s25, s33, 1
 v_accvgpr_read_b32 v183, a91
 s_add_u32 s24, s24, s25
 v_pk_mul_f32 v[176:177], v[176:177], v[84:85]
 buffer_load_dwordx4 v137, s[56:59], s44 offen offset:1024 lds
 v_pk_mul_f32 v[178:179], v[178:179], v[84:85]
 s_and_b32 s25, s33, 1
 v_pk_mul_f32 v[180:181], v[180:181], v[84:85]
 s_lshl_b32 s25, s25, 7
 v_pk_mul_f32 v[182:183], v[182:183], v[84:85]
 s_lshl_b32 s26, s3, 11
 v_cvt_pk_bf16_f32 v212, v176, v177
 s_add_u32 s25, s25, s26
 v_cvt_pk_bf16_f32 v213, v178, v179
 s_mul_i32 s36, s24, 14336
 v_cvt_pk_bf16_f32 v214, v180, v181
 buffer_load_dwordx4 v138, s[56:59], s44 offen offset:2048 lds
 v_cvt_pk_bf16_f32 v215, v182, v183
 s_add_u32 s36, s36, s25
 v_accvgpr_read_b32 v168, a96
 s_add_u32 s36, s36, 0x5e00000
 v_accvgpr_read_b32 v169, a97
 s_mul_i32 s34, s24, 229376
 v_accvgpr_read_b32 v170, a98
 s_add_u32 s34, s34, s25
 v_accvgpr_read_b32 v171, a99
 s_add_u32 s34, s34, 0x2c00000
 v_accvgpr_read_b32 v172, a104
 buffer_load_dwordx4 v139, s[56:59], s44 offen offset:3072 lds
 v_accvgpr_read_b32 v173, a105
 s_add_u32 s26, s3, 1
 v_accvgpr_read_b32 v174, a106
 s_lshr_b32 s26, s26, 2
 v_accvgpr_read_b32 v175, a107
 s_lshl_b32 s26, s26, 30
 v_pk_mul_f32 v[168:169], v[168:169], v[84:85]
 s_add_u32 s39, s34, s26
 v_pk_mul_f32 v[170:171], v[170:171], v[84:85]
 s_add_u32 s39, s39, 0x2000
 v_pk_mul_f32 v[172:173], v[172:173], v[84:85]
 s_sub_u32 s44, s44, 28544
 v_pk_mul_f32 v[174:175], v[174:175], v[84:85]
 s_lshl_b32 s11, s8, 1
 v_cvt_pk_bf16_f32 v216, v168, v169
 s_add_u32 m0, s11, 0x18000
 v_cvt_pk_bf16_f32 v217, v170, v171
 buffer_load_dwordx4 v136, s[56:59], s44 offen offset:0 lds
 v_cvt_pk_bf16_f32 v218, v172, v173
 s_lshl_b32 s37, s32, 11
 v_cvt_pk_bf16_f32 v219, v174, v175
 s_add_u32 s37, s37, 0x530a000
 v_accvgpr_read_b32 v176, a112
 s_add_u32 s26, s2, 1
 v_accvgpr_read_b32 v177, a113
 s_lshl_b32 s26, s26, 1
 v_accvgpr_read_b32 v178, a114
 v_add_u32 v146, s26, v1
 v_accvgpr_read_b32 v179, a115
 buffer_load_dwordx4 v137, s[56:59], s44 offen offset:1024 lds
 v_accvgpr_read_b32 v180, a120
 v_and_b32 v146, 15, v146
 v_accvgpr_read_b32 v181, a121
 v_lshlrev_b32 v146, 7, v146
 v_accvgpr_read_b32 v182, a122
 s_mov_b32 s46, -1
 v_accvgpr_read_b32 v183, a123
 v_add_u32 v96, 0x20000, v166
 v_pk_mul_f32 v[176:177], v[176:177], v[84:85]
 v_add_u32 v97, 0x20000, v167
 v_pk_mul_f32 v[178:179], v[178:179], v[84:85]
 buffer_load_dwordx4 v138, s[56:59], s44 offen offset:2048 lds
 v_pk_mul_f32 v[180:181], v[180:181], v[84:85]
 ds_read_b64_tr_b16 a[192:193], v96 offset:0
 v_pk_mul_f32 v[182:183], v[182:183], v[84:85]
 ds_read_b64_tr_b16 a[194:195], v96 offset:2048
 v_cvt_pk_bf16_f32 v220, v176, v177
 ds_read_b64_tr_b16 a[196:197], v97 offset:0
 v_cvt_pk_bf16_f32 v221, v178, v179
 ds_read_b64_tr_b16 a[198:199], v97 offset:2048
 v_cvt_pk_bf16_f32 v222, v180, v181
 ds_read_b64_tr_b16 a[200:201], v96 offset:256
 v_cvt_pk_bf16_f32 v223, v182, v183
 buffer_load_dwordx4 v139, s[56:59], s44 offen offset:3072 lds
 v_accvgpr_read_b32 v168, a4
 ds_read_b64_tr_b16 a[202:203], v96 offset:2304
 v_accvgpr_read_b32 v169, a5
 ds_read_b64_tr_b16 a[204:205], v97 offset:256
 v_accvgpr_read_b32 v170, a6
 ds_read_b64_tr_b16 a[206:207], v97 offset:2304
 v_accvgpr_read_b32 v171, a7
 ds_read_b64_tr_b16 a[208:209], v96 offset:4096
 v_accvgpr_read_b32 v172, a12
 ds_read_b64_tr_b16 a[210:211], v96 offset:6144
 v_accvgpr_read_b32 v173, a13
 s_add_u32 s44, s44, 28672
 v_accvgpr_read_b32 v174, a14
 s_add_u32 m0, s11, 0x19000
 v_accvgpr_read_b32 v175, a15
 buffer_load_dwordx4 v136, s[56:59], s44 offen offset:0 lds
 v_pk_mul_f32 v[168:169], v[168:169], v[86:87]
 ds_read_b64_tr_b16 a[212:213], v97 offset:4096
 v_pk_mul_f32 v[170:171], v[170:171], v[86:87]
 ds_read_b64_tr_b16 a[214:215], v97 offset:6144
 v_pk_mul_f32 v[172:173], v[172:173], v[86:87]
 ds_read_b64_tr_b16 a[216:217], v96 offset:4352
 v_pk_mul_f32 v[174:175], v[174:175], v[86:87]
 ds_read_b64_tr_b16 a[218:219], v96 offset:6400
 v_cvt_pk_bf16_f32 v224, v168, v169
 ds_read_b64_tr_b16 a[220:221], v97 offset:4352
 v_cvt_pk_bf16_f32 v225, v170, v171
 buffer_load_dwordx4 v137, s[56:59], s44 offen offset:1024 lds
 v_cvt_pk_bf16_f32 v226, v172, v173
 ds_read_b64_tr_b16 a[222:223], v97 offset:6400
 v_cvt_pk_bf16_f32 v227, v174, v175
 ds_read_b64_tr_b16 a[224:225], v96 offset:8192
 v_accvgpr_read_b32 v176, a20
 ds_read_b64_tr_b16 a[226:227], v96 offset:10240
 v_accvgpr_read_b32 v177, a21
 ds_read_b64_tr_b16 a[228:229], v97 offset:8192
 v_accvgpr_read_b32 v178, a22
 ds_read_b64_tr_b16 a[230:231], v97 offset:10240
 v_accvgpr_read_b32 v179, a23
 buffer_load_dwordx4 v138, s[56:59], s44 offen offset:2048 lds
 v_accvgpr_read_b32 v180, a28
 ds_read_b64_tr_b16 a[232:233], v96 offset:8448
 v_accvgpr_read_b32 v181, a29
 ds_read_b64_tr_b16 a[234:235], v96 offset:10496
 v_accvgpr_read_b32 v182, a30
 ds_read_b64_tr_b16 a[236:237], v97 offset:8448
 v_accvgpr_read_b32 v183, a31
 ds_read_b64_tr_b16 a[238:239], v97 offset:10496
 v_pk_mul_f32 v[176:177], v[176:177], v[86:87]
 ds_read_b64_tr_b16 a[240:241], v96 offset:12288
 v_pk_mul_f32 v[178:179], v[178:179], v[86:87]
 buffer_load_dwordx4 v139, s[56:59], s44 offen offset:3072 lds
 v_pk_mul_f32 v[180:181], v[180:181], v[86:87]
 ds_read_b64_tr_b16 a[242:243], v96 offset:14336
 v_pk_mul_f32 v[182:183], v[182:183], v[86:87]
 ds_read_b64_tr_b16 a[244:245], v97 offset:12288
 v_cvt_pk_bf16_f32 v228, v176, v177
 ds_read_b64_tr_b16 a[246:247], v97 offset:14336
 v_cvt_pk_bf16_f32 v229, v178, v179
 ds_read_b64_tr_b16 a[248:249], v96 offset:12544
 v_cvt_pk_bf16_f32 v230, v180, v181
 ds_read_b64_tr_b16 a[250:251], v96 offset:14592
 v_cvt_pk_bf16_f32 v231, v182, v183
 s_sub_u32 s44, s44, 28544
 v_accvgpr_read_b32 v168, a36
 ds_read_b64_tr_b16 a[252:253], v97 offset:12544
 v_accvgpr_read_b32 v169, a37
 ds_read_b64_tr_b16 a[254:255], v97 offset:14592
 v_accvgpr_read_b32 v170, a38
 v_accvgpr_read_b32 v171, a39
 v_accvgpr_read_b32 v172, a44
 v_accvgpr_read_b32 v173, a45
 v_accvgpr_read_b32 v174, a46
 v_accvgpr_read_b32 v175, a47
 v_pk_mul_f32 v[168:169], v[168:169], v[86:87]
 v_pk_mul_f32 v[170:171], v[170:171], v[86:87]
 v_pk_mul_f32 v[172:173], v[172:173], v[86:87]
 v_pk_mul_f32 v[174:175], v[174:175], v[86:87]
 v_cvt_pk_bf16_f32 v232, v168, v169
 v_cvt_pk_bf16_f32 v233, v170, v171
 v_cvt_pk_bf16_f32 v234, v172, v173
 v_cvt_pk_bf16_f32 v235, v174, v175
 v_accvgpr_read_b32 v176, a52
 v_accvgpr_read_b32 v177, a53
 v_accvgpr_read_b32 v178, a54
 v_accvgpr_read_b32 v179, a55
 v_accvgpr_read_b32 v180, a60
 v_accvgpr_read_b32 v181, a61
 v_accvgpr_read_b32 v182, a62
 v_accvgpr_read_b32 v183, a63
 v_pk_mul_f32 v[176:177], v[176:177], v[86:87]
 v_pk_mul_f32 v[178:179], v[178:179], v[86:87]
 v_pk_mul_f32 v[180:181], v[180:181], v[86:87]
 v_pk_mul_f32 v[182:183], v[182:183], v[86:87]
 v_cvt_pk_bf16_f32 v236, v176, v177
 v_cvt_pk_bf16_f32 v237, v178, v179
 v_cvt_pk_bf16_f32 v238, v180, v181
 v_cvt_pk_bf16_f32 v239, v182, v183
 v_accvgpr_read_b32 v168, a68
 v_accvgpr_read_b32 v169, a69
 v_accvgpr_read_b32 v170, a70
 v_accvgpr_read_b32 v171, a71
 v_accvgpr_read_b32 v172, a76
 v_accvgpr_read_b32 v173, a77
 v_accvgpr_read_b32 v174, a78
 v_accvgpr_read_b32 v175, a79
 v_pk_mul_f32 v[168:169], v[168:169], v[86:87]
 v_pk_mul_f32 v[170:171], v[170:171], v[86:87]
 v_pk_mul_f32 v[172:173], v[172:173], v[86:87]
 v_pk_mul_f32 v[174:175], v[174:175], v[86:87]
 v_cvt_pk_bf16_f32 v240, v168, v169
 v_cvt_pk_bf16_f32 v241, v170, v171
 v_cvt_pk_bf16_f32 v242, v172, v173
 v_cvt_pk_bf16_f32 v243, v174, v175
 v_accvgpr_read_b32 v176, a84
 v_accvgpr_read_b32 v177, a85
 v_accvgpr_read_b32 v178, a86
 v_accvgpr_read_b32 v179, a87
 v_accvgpr_read_b32 v180, a92
 v_accvgpr_read_b32 v181, a93
 v_accvgpr_read_b32 v182, a94
 v_accvgpr_read_b32 v183, a95
 v_pk_mul_f32 v[176:177], v[176:177], v[86:87]
 v_pk_mul_f32 v[178:179], v[178:179], v[86:87]
 v_pk_mul_f32 v[180:181], v[180:181], v[86:87]
 v_pk_mul_f32 v[182:183], v[182:183], v[86:87]
 v_cvt_pk_bf16_f32 v244, v176, v177
 v_cvt_pk_bf16_f32 v245, v178, v179
 v_cvt_pk_bf16_f32 v246, v180, v181
 v_cvt_pk_bf16_f32 v247, v182, v183
 v_accvgpr_read_b32 v168, a100
 v_accvgpr_read_b32 v169, a101
 v_accvgpr_read_b32 v170, a102
 v_accvgpr_read_b32 v171, a103
 v_accvgpr_read_b32 v172, a108
 v_accvgpr_read_b32 v173, a109
 v_accvgpr_read_b32 v174, a110
 v_accvgpr_read_b32 v175, a111
 v_pk_mul_f32 v[168:169], v[168:169], v[86:87]
 v_pk_mul_f32 v[170:171], v[170:171], v[86:87]
 v_pk_mul_f32 v[172:173], v[172:173], v[86:87]
 v_pk_mul_f32 v[174:175], v[174:175], v[86:87]
 v_cvt_pk_bf16_f32 v248, v168, v169
 v_cvt_pk_bf16_f32 v249, v170, v171
 v_cvt_pk_bf16_f32 v250, v172, v173
 v_cvt_pk_bf16_f32 v251, v174, v175
 v_accvgpr_read_b32 v176, a116
 v_accvgpr_read_b32 v177, a117
 v_accvgpr_read_b32 v178, a118
 v_accvgpr_read_b32 v179, a119
 v_accvgpr_read_b32 v180, a124
 v_accvgpr_read_b32 v181, a125
 v_accvgpr_read_b32 v182, a126
 v_accvgpr_read_b32 v183, a127
 v_pk_mul_f32 v[176:177], v[176:177], v[86:87]
 v_pk_mul_f32 v[178:179], v[178:179], v[86:87]
 v_pk_mul_f32 v[180:181], v[180:181], v[86:87]
 v_pk_mul_f32 v[182:183], v[182:183], v[86:87]
 v_cvt_pk_bf16_f32 v252, v176, v177
 v_cvt_pk_bf16_f32 v253, v178, v179
 v_cvt_pk_bf16_f32 v254, v180, v181
 v_cvt_pk_bf16_f32 v255, v182, v183
 s_branch L2_oproj
L2_merge:
 s_cmp_eq_u32 s47, 1
 s_cbranch_scc1 L2_have
 v_mov_b32 v117, 0
 s_mov_b32 s31, 0x20000
L2_pt_poll:
 buffer_load_dword v3, v117, s[4:7], s30 offen sc1
 s_waitcnt vmcnt(0)
 v_cmp_ne_u32 vcc, 1, v3
 s_cbranch_vccz L2_pt_done
 s_sleep 2
 s_sub_u32 s31, s31, 1
 s_cbranch_scc0 L2_pt_poll
L2_pt_done:
 s_cmp_eq_u32 s71, 0
 s_cbranch_scc1 L2_pa_acq
L2_pa_acqb:
 s_lshl_b32 s10, s70, 10
 s_add_u32 s10, s10, 0x5200000
 buffer_load_dwordx4 v[92:95], v2, s[4:7], s10 offen
 s_lshl_b32 s10, s70, 14
 s_add_u32 s10, s10, 0x4a00000
 buffer_load_dwordx4 v[192:195], v2, s[4:7], s10 offen offset:0
 buffer_load_dwordx4 v[196:199], v2, s[4:7], s10 offen offset:1024
 buffer_load_dwordx4 v[200:203], v2, s[4:7], s10 offen offset:2048
 buffer_load_dwordx4 v[204:207], v2, s[4:7], s10 offen offset:3072
 s_add_u32 s10, s10, 0x1000
 buffer_load_dwordx4 v[208:211], v2, s[4:7], s10 offen offset:0
 buffer_load_dwordx4 v[212:215], v2, s[4:7], s10 offen offset:1024
 buffer_load_dwordx4 v[216:219], v2, s[4:7], s10 offen offset:2048
 buffer_load_dwordx4 v[220:223], v2, s[4:7], s10 offen offset:3072
 s_add_u32 s10, s10, 0x1000
 buffer_load_dwordx4 v[224:227], v2, s[4:7], s10 offen offset:0
 buffer_load_dwordx4 v[228:231], v2, s[4:7], s10 offen offset:1024
 buffer_load_dwordx4 v[232:235], v2, s[4:7], s10 offen offset:2048
 buffer_load_dwordx4 v[236:239], v2, s[4:7], s10 offen offset:3072
 s_add_u32 s10, s10, 0x1000
 buffer_load_dwordx4 v[240:243], v2, s[4:7], s10 offen offset:0
 buffer_load_dwordx4 v[244:247], v2, s[4:7], s10 offen offset:1024
 buffer_load_dwordx4 v[248:251], v2, s[4:7], s10 offen offset:2048
 buffer_load_dwordx4 v[252:255], v2, s[4:7], s10 offen offset:3072
 s_waitcnt vmcnt(0)
L2_have:
 v_min_f32 v118, v36, v92
 v_sub_f32 v119, v118, v36
 v_sub_f32 v120, v118, v92
 v_exp_f32 v119, v119
 v_exp_f32 v120, v120
 s_nop 0
 v_mul_f32 v120, v120, v94
 v_fma_f32 v118, v119, v72, v120
 v_rcp_f32 v118, v118
 s_nop 0
 v_mul_f32 v84, v119, v118
 v_mul_f32 v88, v120, v118
 v_mul_f32 v85, v119, v118
 v_mul_f32 v89, v120, v118
 v_min_f32 v118, v40, v93
 v_sub_f32 v119, v118, v40
 v_sub_f32 v120, v118, v93
 v_exp_f32 v119, v119
 v_exp_f32 v120, v120
 s_nop 0
 v_mul_f32 v120, v120, v95
 v_fma_f32 v118, v119, v76, v120
 v_rcp_f32 v118, v118
 s_nop 0
 v_mul_f32 v86, v119, v118
 v_mul_f32 v90, v120, v118
 v_mul_f32 v87, v119, v118
 v_mul_f32 v91, v120, v118
 v_accvgpr_read_b32 v168, a0
 v_accvgpr_read_b32 v169, a1
 s_lshl_b32 s11, s8, 1
 v_accvgpr_read_b32 v170, a2
 v_accvgpr_read_b32 v171, a3
 s_add_u32 m0, s11, 0x8000
 v_accvgpr_read_b32 v172, a8
 v_accvgpr_read_b32 v173, a9
 buffer_load_dwordx4 v136, s[56:59], s44 offen offset:0 lds
 v_accvgpr_read_b32 v174, a10
 v_accvgpr_read_b32 v175, a11
 s_getpc_b64 s[12:13]
 v_pk_mul_f32 v[168:169], v[168:169], v[84:85]
 v_pk_mul_f32 v[170:171], v[170:171], v[84:85]
L_ct7:
 v_pk_mul_f32 v[172:173], v[172:173], v[84:85]
 v_pk_mul_f32 v[174:175], v[174:175], v[84:85]
 s_sub_u32 s12, s12, L_ct7-L_begin
 v_lshlrev_b32 v122, 16, v192
 v_and_b32 v123, 0xffff0000, v192
 s_subb_u32 s13, s13, 0
 v_pk_fma_f32 v[168:169], v[122:123], v[88:89], v[168:169]
 v_lshlrev_b32 v124, 16, v193
 s_and_b32 s13, s13, 0xffff
 v_and_b32 v125, 0xffff0000, v193
 v_pk_fma_f32 v[170:171], v[124:125], v[88:89], v[170:171]
 buffer_load_dwordx4 v137, s[56:59], s44 offen offset:1024 lds
 v_lshlrev_b32 v122, 16, v194
 v_and_b32 v123, 0xffff0000, v194
 s_mov_b32 s14, L_last-L_begin
 v_pk_fma_f32 v[172:173], v[122:123], v[88:89], v[172:173]
 v_lshlrev_b32 v124, 16, v195
 s_mov_b32 s15, 0x20000
 v_and_b32 v125, 0xffff0000, v195
 v_pk_fma_f32 v[174:175], v[124:125], v[88:89], v[174:175]
 s_lshr_b32 s9, s2, 3
 v_cvt_pk_bf16_f32 v192, v168, v169
 v_cvt_pk_bf16_f32 v193, v170, v171
 s_lshl_b32 s9, s9, 2
 v_cvt_pk_bf16_f32 v194, v172, v173
 v_cvt_pk_bf16_f32 v195, v174, v175
 s_add_u32 s9, s9, s3
 v_accvgpr_read_b32 v176, a16
 v_accvgpr_read_b32 v177, a17
 buffer_load_dwordx4 v138, s[56:59], s44 offen offset:2048 lds
 v_accvgpr_read_b32 v178, a18
 v_accvgpr_read_b32 v179, a19
 s_lshl_b32 s9, s9, 10
 v_accvgpr_read_b32 v180, a24
 v_accvgpr_read_b32 v181, a25
 buffer_load_dwordx4 a[128:131], v2, s[12:15], s9 offen
 v_accvgpr_read_b32 v182, a26
 v_accvgpr_read_b32 v183, a27
 s_load_dwordx2 s[48:49], s[0:1], 56
 v_pk_mul_f32 v[176:177], v[176:177], v[84:85]
 v_pk_mul_f32 v[178:179], v[178:179], v[84:85]
 s_load_dwordx2 s[52:53], s[0:1], 64
 v_pk_mul_f32 v[180:181], v[180:181], v[84:85]
 v_pk_mul_f32 v[182:183], v[182:183], v[84:85]
 s_and_b32 s64, s2, 7
 v_lshlrev_b32 v122, 16, v196
 v_and_b32 v123, 0xffff0000, v196
 buffer_load_dwordx4 v139, s[56:59], s44 offen offset:3072 lds
 v_pk_fma_f32 v[176:177], v[122:123], v[88:89], v[176:177]
 v_lshlrev_b32 v124, 16, v197
 s_lshr_b32 s65, s2, 7
 v_and_b32 v125, 0xffff0000, v197
 v_pk_fma_f32 v[178:179], v[124:125], v[88:89], v[178:179]
 s_lshl_b32 s65, s65, 3
 v_lshlrev_b32 v122, 16, v198
 v_and_b32 v123, 0xffff0000, v198
 s_add_u32 s64, s64, s65
 v_pk_fma_f32 v[180:181], v[122:123], v[88:89], v[180:181]
 v_lshlrev_b32 v124, 16, v199
 s_bfe_u32 s65, s2, 0x40003
 v_and_b32 v125, 0xffff0000, v199
 v_pk_fma_f32 v[182:183], v[124:125], v[88:89], v[182:183]
 v_lshrrev_b32 v186, 4, v1
 v_cvt_pk_bf16_f32 v196, v176, v177
 v_cvt_pk_bf16_f32 v197, v178, v179
 s_add_u32 s44, s44, 28672
 v_cvt_pk_bf16_f32 v198, v180, v181
 v_cvt_pk_bf16_f32 v199, v182, v183
 s_add_u32 m0, s11, 0x9000
 v_accvgpr_read_b32 v168, a32
 v_accvgpr_read_b32 v169, a33
 buffer_load_dwordx4 v136, s[56:59], s44 offen offset:0 lds
 v_accvgpr_read_b32 v170, a34
 v_accvgpr_read_b32 v171, a35
 v_bfe_u32 v184, v1, 2, 2
 v_accvgpr_read_b32 v172, a40
 v_accvgpr_read_b32 v173, a41
 s_lshl_b32 s9, s3, 3
 v_accvgpr_read_b32 v174, a42
 v_accvgpr_read_b32 v175, a43
 v_add_u32 v185, s9, v184
 v_pk_mul_f32 v[168:169], v[168:169], v[84:85]
 v_pk_mul_f32 v[170:171], v[170:171], v[84:85]
 v_mul_u32_u24 v185, 3584, v185
 v_pk_mul_f32 v[172:173], v[172:173], v[84:85]
 v_pk_mul_f32 v[174:175], v[174:175], v[84:85]
 v_lshl_add_u32 v185, v186, 6, v185
 v_lshlrev_b32 v122, 16, v200
 v_and_b32 v123, 0xffff0000, v200
 buffer_load_dwordx4 v137, s[56:59], s44 offen offset:1024 lds
 v_pk_fma_f32 v[168:169], v[122:123], v[88:89], v[168:169]
 v_lshlrev_b32 v124, 16, v201
 v_and_b32 v187, 3, v1
 v_and_b32 v125, 0xffff0000, v201
 v_pk_fma_f32 v[170:171], v[124:125], v[88:89], v[170:171]
 v_lshl_add_u32 v185, v187, 4, v185
 v_lshlrev_b32 v122, 16, v202
 v_and_b32 v123, 0xffff0000, v202
 v_xor_b32 v188, 32, v185
 v_pk_fma_f32 v[172:173], v[122:123], v[88:89], v[172:173]
 v_lshlrev_b32 v124, 16, v203
 v_add_u32 v140, 0x1000, v185
 v_and_b32 v125, 0xffff0000, v203
 v_pk_fma_f32 v[174:175], v[124:125], v[88:89], v[174:175]
 v_add_u32 v141, 0xc00, v185
 v_cvt_pk_bf16_f32 v200, v168, v169
 v_cvt_pk_bf16_f32 v201, v170, v171
 buffer_load_dwordx4 v138, s[56:59], s44 offen offset:2048 lds
 v_cvt_pk_bf16_f32 v202, v172, v173
 v_cvt_pk_bf16_f32 v203, v174, v175
 v_add_u32 v142, 0x4000, v188
 v_accvgpr_read_b32 v176, a48
 v_accvgpr_read_b32 v177, a49
 v_add_u32 v143, 0x3c00, v188
 v_accvgpr_read_b32 v178, a50
 v_accvgpr_read_b32 v179, a51
 v_lshlrev_b32 v185, 11, v186
 v_accvgpr_read_b32 v180, a56
 v_accvgpr_read_b32 v181, a57
 v_lshl_add_u32 v185, v184, 6, v185
 v_accvgpr_read_b32 v182, a58
 v_accvgpr_read_b32 v183, a59
 v_bfe_u32 v184, v1, 4, 1
 v_pk_mul_f32 v[176:177], v[176:177], v[84:85]
 v_pk_mul_f32 v[178:179], v[178:179], v[84:85]
 buffer_load_dwordx4 v139, s[56:59], s44 offen offset:3072 lds
 v_pk_mul_f32 v[180:181], v[180:181], v[84:85]
 v_pk_mul_f32 v[182:183], v[182:183], v[84:85]
 v_lshl_add_u32 v185, v184, 5, v185
 v_lshlrev_b32 v122, 16, v204
 v_and_b32 v123, 0xffff0000, v204
 v_lshl_add_u32 v144, v187, 3, v185
 v_pk_fma_f32 v[176:177], v[122:123], v[88:89], v[176:177]
 v_lshlrev_b32 v124, 16, v205
 v_xor_b32 v145, 32, v144
 v_and_b32 v125, 0xffff0000, v205
 v_pk_fma_f32 v[178:179], v[124:125], v[88:89], v[178:179]
 s_waitcnt lgkmcnt(0)
 v_lshlrev_b32 v122, 16, v206
 v_and_b32 v123, 0xffff0000, v206
 s_sub_u32 s48, s48, 4096
 v_pk_fma_f32 v[180:181], v[122:123], v[88:89], v[180:181]
 v_lshlrev_b32 v124, 16, v207
 s_subb_u32 s49, s49, 0
 v_and_b32 v125, 0xffff0000, v207
 v_pk_fma_f32 v[182:183], v[124:125], v[88:89], v[182:183]
 s_sub_u32 s44, s44, 28544
 v_cvt_pk_bf16_f32 v204, v176, v177
 v_cvt_pk_bf16_f32 v205, v178, v179
 s_lshl_b32 s11, s8, 1
 v_cvt_pk_bf16_f32 v206, v180, v181
 v_cvt_pk_bf16_f32 v207, v182, v183
 s_add_u32 m0, s11, 0x10000
 v_accvgpr_read_b32 v168, a64
 v_accvgpr_read_b32 v169, a65
 buffer_load_dwordx4 v136, s[56:59], s44 offen offset:0 lds
 v_accvgpr_read_b32 v170, a66
 v_accvgpr_read_b32 v171, a67
 s_and_b32 s49, s49, 0xffff
 v_accvgpr_read_b32 v172, a72
 v_accvgpr_read_b32 v173, a73
 s_mov_b32 s50, 0x189000
 v_accvgpr_read_b32 v174, a74
 v_accvgpr_read_b32 v175, a75
 s_mov_b32 s51, 0x20000
 v_pk_mul_f32 v[168:169], v[168:169], v[84:85]
 v_pk_mul_f32 v[170:171], v[170:171], v[84:85]
 s_sub_u32 s52, s52, 4096
 v_pk_mul_f32 v[172:173], v[172:173], v[84:85]
 v_pk_mul_f32 v[174:175], v[174:175], v[84:85]
 s_subb_u32 s53, s53, 0
 v_lshlrev_b32 v122, 16, v208
 v_and_b32 v123, 0xffff0000, v208
 buffer_load_dwordx4 v137, s[56:59], s44 offen offset:1024 lds
 v_pk_fma_f32 v[168:169], v[122:123], v[88:89], v[168:169]
 v_lshlrev_b32 v124, 16, v209
 s_and_b32 s53, s53, 0xffff
 v_and_b32 v125, 0xffff0000, v209
 v_pk_fma_f32 v[170:171], v[124:125], v[88:89], v[170:171]
 s_mov_b32 s54, 0x189000
 v_lshlrev_b32 v122, 16, v210
 v_and_b32 v123, 0xffff0000, v210
 s_mov_b32 s55, 0x20000
 v_pk_fma_f32 v[172:173], v[122:123], v[88:89], v[172:173]
 v_lshlrev_b32 v124, 16, v211
 s_min_u32 s9, s65, 13
 v_and_b32 v125, 0xffff0000, v211
 v_pk_fma_f32 v[174:175], v[124:125], v[88:89], v[174:175]
 s_lshl_b32 s66, s9, 8
 v_cvt_pk_bf16_f32 v208, v168, v169
 v_cvt_pk_bf16_f32 v209, v170, v171
 buffer_load_dwordx4 v138, s[56:59], s44 offen offset:2048 lds
 v_cvt_pk_bf16_f32 v210, v172, v173
 v_cvt_pk_bf16_f32 v211, v174, v175
 s_and_b32 s32, s2, 7
 v_accvgpr_read_b32 v176, a80
 v_accvgpr_read_b32 v177, a81
 s_lshr_b32 s33, s2, 7
 v_accvgpr_read_b32 v178, a82
 v_accvgpr_read_b32 v179, a83
 s_lshl_b32 s33, s33, 3
 v_accvgpr_read_b32 v180, a88
 v_accvgpr_read_b32 v181, a89
 s_add_u32 s32, s32, s33
 v_accvgpr_read_b32 v182, a90
 v_accvgpr_read_b32 v183, a91
 s_bfe_u32 s33, s2, 0x40003
 v_pk_mul_f32 v[176:177], v[176:177], v[84:85]
 v_pk_mul_f32 v[178:179], v[178:179], v[84:85]
 buffer_load_dwordx4 v139, s[56:59], s44 offen offset:3072 lds
 v_pk_mul_f32 v[180:181], v[180:181], v[84:85]
 v_pk_mul_f32 v[182:183], v[182:183], v[84:85]
 v_and_b32 v184, 7, v1
 v_lshlrev_b32 v122, 16, v212
 v_and_b32 v123, 0xffff0000, v212
 v_bfe_u32 v185, v1, 3, 2
 v_pk_fma_f32 v[176:177], v[122:123], v[88:89], v[176:177]
 v_lshlrev_b32 v124, 16, v213
 v_lshrrev_b32 v186, 5, v1
 v_and_b32 v125, 0xffff0000, v213
 v_pk_fma_f32 v[178:179], v[124:125], v[88:89], v[178:179]
 v_lshlrev_b32 v190, 4, v184
 v_lshlrev_b32 v122, 16, v214
 v_and_b32 v123, 0xffff0000, v214
 v_lshl_add_u32 v190, v185, 8, v190
 v_pk_fma_f32 v[180:181], v[122:123], v[88:89], v[180:181]
 v_lshlrev_b32 v124, 16, v215
 s_add_u32 s44, s44, 28672
 v_and_b32 v125, 0xffff0000, v215
 v_pk_fma_f32 v[182:183], v[124:125], v[88:89], v[182:183]
 s_add_u32 m0, s11, 0x11000
 v_cvt_pk_bf16_f32 v212, v176, v177
 v_cvt_pk_bf16_f32 v213, v178, v179
 buffer_load_dwordx4 v136, s[56:59], s44 offen offset:0 lds
 v_cvt_pk_bf16_f32 v214, v180, v181
 v_cvt_pk_bf16_f32 v215, v182, v183
 v_mul_u32_u24 v187, 14336, v186
 v_accvgpr_read_b32 v168, a96
 v_accvgpr_read_b32 v169, a97
 v_add_u32 v190, v190, v187
 v_accvgpr_read_b32 v170, a98
 v_accvgpr_read_b32 v171, a99
 s_lshl_b32 s24, s32, 3
 v_accvgpr_read_b32 v172, a104
 v_accvgpr_read_b32 v173, a105
 s_lshr_b32 s25, s33, 1
 v_accvgpr_read_b32 v174, a106
 v_accvgpr_read_b32 v175, a107
 s_add_u32 s24, s24, s25
 v_pk_mul_f32 v[168:169], v[168:169], v[84:85]
 v_pk_mul_f32 v[170:171], v[170:171], v[84:85]
 buffer_load_dwordx4 v137, s[56:59], s44 offen offset:1024 lds
 v_pk_mul_f32 v[172:173], v[172:173], v[84:85]
 v_pk_mul_f32 v[174:175], v[174:175], v[84:85]
 s_and_b32 s25, s33, 1
 v_lshlrev_b32 v122, 16, v216
 v_and_b32 v123, 0xffff0000, v216
 s_lshl_b32 s25, s25, 7
 v_pk_fma_f32 v[168:169], v[122:123], v[88:89], v[168:169]
 v_lshlrev_b32 v124, 16, v217
 s_lshl_b32 s26, s3, 11
 v_and_b32 v125, 0xffff0000, v217
 v_pk_fma_f32 v[170:171], v[124:125], v[88:89], v[170:171]
 s_add_u32 s25, s25, s26
 v_lshlrev_b32 v122, 16, v218
 v_and_b32 v123, 0xffff0000, v218
 s_mul_i32 s36, s24, 14336
 v_pk_fma_f32 v[172:173], v[122:123], v[88:89], v[172:173]
 v_lshlrev_b32 v124, 16, v219
 buffer_load_dwordx4 v138, s[56:59], s44 offen offset:2048 lds
 v_and_b32 v125, 0xffff0000, v219
 v_pk_fma_f32 v[174:175], v[124:125], v[88:89], v[174:175]
 s_add_u32 s36, s36, s25
 v_cvt_pk_bf16_f32 v216, v168, v169
 v_cvt_pk_bf16_f32 v217, v170, v171
 s_add_u32 s36, s36, 0x5e00000
 v_cvt_pk_bf16_f32 v218, v172, v173
 v_cvt_pk_bf16_f32 v219, v174, v175
 s_mul_i32 s34, s24, 229376
 v_accvgpr_read_b32 v176, a112
 v_accvgpr_read_b32 v177, a113
 s_add_u32 s34, s34, s25
 v_accvgpr_read_b32 v178, a114
 v_accvgpr_read_b32 v179, a115
 s_add_u32 s34, s34, 0x2c00000
 v_accvgpr_read_b32 v180, a120
 v_accvgpr_read_b32 v181, a121
 buffer_load_dwordx4 v139, s[56:59], s44 offen offset:3072 lds
 v_accvgpr_read_b32 v182, a122
 v_accvgpr_read_b32 v183, a123
 s_add_u32 s26, s3, 1
 v_pk_mul_f32 v[176:177], v[176:177], v[84:85]
 v_pk_mul_f32 v[178:179], v[178:179], v[84:85]
 s_lshr_b32 s26, s26, 2
 v_pk_mul_f32 v[180:181], v[180:181], v[84:85]
 v_pk_mul_f32 v[182:183], v[182:183], v[84:85]
 s_lshl_b32 s26, s26, 30
 v_lshlrev_b32 v122, 16, v220
 v_and_b32 v123, 0xffff0000, v220
 s_add_u32 s39, s34, s26
 v_pk_fma_f32 v[176:177], v[122:123], v[88:89], v[176:177]
 v_lshlrev_b32 v124, 16, v221
 s_add_u32 s39, s39, 0x2000
 v_and_b32 v125, 0xffff0000, v221
 v_pk_fma_f32 v[178:179], v[124:125], v[88:89], v[178:179]
 s_sub_u32 s44, s44, 28544
 v_lshlrev_b32 v122, 16, v222
 v_and_b32 v123, 0xffff0000, v222
 s_lshl_b32 s11, s8, 1
 v_pk_fma_f32 v[180:181], v[122:123], v[88:89], v[180:181]
 v_lshlrev_b32 v124, 16, v223
 s_add_u32 m0, s11, 0x18000
 v_and_b32 v125, 0xffff0000, v223
 v_pk_fma_f32 v[182:183], v[124:125], v[88:89], v[182:183]
 buffer_load_dwordx4 v136, s[56:59], s44 offen offset:0 lds
 v_cvt_pk_bf16_f32 v220, v176, v177
 v_cvt_pk_bf16_f32 v221, v178, v179
 s_lshl_b32 s37, s32, 11
 v_cvt_pk_bf16_f32 v222, v180, v181
 v_cvt_pk_bf16_f32 v223, v182, v183
 s_add_u32 s37, s37, 0x530a000
 v_accvgpr_read_b32 v168, a4
 v_accvgpr_read_b32 v169, a5
 s_add_u32 s26, s2, 1
 v_accvgpr_read_b32 v170, a6
 v_accvgpr_read_b32 v171, a7
 s_lshl_b32 s26, s26, 1
 v_accvgpr_read_b32 v172, a12
 v_accvgpr_read_b32 v173, a13
 v_add_u32 v146, s26, v1
 v_accvgpr_read_b32 v174, a14
 v_accvgpr_read_b32 v175, a15
 buffer_load_dwordx4 v137, s[56:59], s44 offen offset:1024 lds
 v_pk_mul_f32 v[168:169], v[168:169], v[86:87]
 v_pk_mul_f32 v[170:171], v[170:171], v[86:87]
 v_and_b32 v146, 15, v146
 v_pk_mul_f32 v[172:173], v[172:173], v[86:87]
 v_pk_mul_f32 v[174:175], v[174:175], v[86:87]
 v_lshlrev_b32 v146, 7, v146
 v_lshlrev_b32 v122, 16, v224
 v_and_b32 v123, 0xffff0000, v224
 s_mov_b32 s46, -1
 v_pk_fma_f32 v[168:169], v[122:123], v[90:91], v[168:169]
 v_lshlrev_b32 v124, 16, v225
 v_add_u32 v96, 0x20000, v166
 v_and_b32 v125, 0xffff0000, v225
 v_pk_fma_f32 v[170:171], v[124:125], v[90:91], v[170:171]
 v_add_u32 v97, 0x20000, v167
 v_lshlrev_b32 v122, 16, v226
 v_and_b32 v123, 0xffff0000, v226
 buffer_load_dwordx4 v138, s[56:59], s44 offen offset:2048 lds
 v_pk_fma_f32 v[172:173], v[122:123], v[90:91], v[172:173]
 v_lshlrev_b32 v124, 16, v227
 ds_read_b64_tr_b16 a[192:193], v96 offset:0
 v_and_b32 v125, 0xffff0000, v227
 v_pk_fma_f32 v[174:175], v[124:125], v[90:91], v[174:175]
 ds_read_b64_tr_b16 a[194:195], v96 offset:2048
 v_cvt_pk_bf16_f32 v224, v168, v169
 v_cvt_pk_bf16_f32 v225, v170, v171
 ds_read_b64_tr_b16 a[196:197], v97 offset:0
 v_cvt_pk_bf16_f32 v226, v172, v173
 v_cvt_pk_bf16_f32 v227, v174, v175
 ds_read_b64_tr_b16 a[198:199], v97 offset:2048
 v_accvgpr_read_b32 v176, a20
 v_accvgpr_read_b32 v177, a21
 ds_read_b64_tr_b16 a[200:201], v96 offset:256
 v_accvgpr_read_b32 v178, a22
 v_accvgpr_read_b32 v179, a23
 buffer_load_dwordx4 v139, s[56:59], s44 offen offset:3072 lds
 v_accvgpr_read_b32 v180, a28
 v_accvgpr_read_b32 v181, a29
 ds_read_b64_tr_b16 a[202:203], v96 offset:2304
 v_accvgpr_read_b32 v182, a30
 v_accvgpr_read_b32 v183, a31
 ds_read_b64_tr_b16 a[204:205], v97 offset:256
 v_pk_mul_f32 v[176:177], v[176:177], v[86:87]
 v_pk_mul_f32 v[178:179], v[178:179], v[86:87]
 ds_read_b64_tr_b16 a[206:207], v97 offset:2304
 v_pk_mul_f32 v[180:181], v[180:181], v[86:87]
 v_pk_mul_f32 v[182:183], v[182:183], v[86:87]
 ds_read_b64_tr_b16 a[208:209], v96 offset:4096
 v_lshlrev_b32 v122, 16, v228
 v_and_b32 v123, 0xffff0000, v228
 ds_read_b64_tr_b16 a[210:211], v96 offset:6144
 v_pk_fma_f32 v[176:177], v[122:123], v[90:91], v[176:177]
 v_lshlrev_b32 v124, 16, v229
 s_add_u32 s44, s44, 28672
 v_and_b32 v125, 0xffff0000, v229
 v_pk_fma_f32 v[178:179], v[124:125], v[90:91], v[178:179]
 s_add_u32 m0, s11, 0x19000
 v_lshlrev_b32 v122, 16, v230
 v_and_b32 v123, 0xffff0000, v230
 buffer_load_dwordx4 v136, s[56:59], s44 offen offset:0 lds
 v_pk_fma_f32 v[180:181], v[122:123], v[90:91], v[180:181]
 v_lshlrev_b32 v124, 16, v231
 ds_read_b64_tr_b16 a[212:213], v97 offset:4096
 v_and_b32 v125, 0xffff0000, v231
 v_pk_fma_f32 v[182:183], v[124:125], v[90:91], v[182:183]
 ds_read_b64_tr_b16 a[214:215], v97 offset:6144
 v_cvt_pk_bf16_f32 v228, v176, v177
 v_cvt_pk_bf16_f32 v229, v178, v179
 ds_read_b64_tr_b16 a[216:217], v96 offset:4352
 v_cvt_pk_bf16_f32 v230, v180, v181
 v_cvt_pk_bf16_f32 v231, v182, v183
 ds_read_b64_tr_b16 a[218:219], v96 offset:6400
 v_accvgpr_read_b32 v168, a36
 v_accvgpr_read_b32 v169, a37
 ds_read_b64_tr_b16 a[220:221], v97 offset:4352
 v_accvgpr_read_b32 v170, a38
 v_accvgpr_read_b32 v171, a39
 buffer_load_dwordx4 v137, s[56:59], s44 offen offset:1024 lds
 v_accvgpr_read_b32 v172, a44
 v_accvgpr_read_b32 v173, a45
 ds_read_b64_tr_b16 a[222:223], v97 offset:6400
 v_accvgpr_read_b32 v174, a46
 v_accvgpr_read_b32 v175, a47
 ds_read_b64_tr_b16 a[224:225], v96 offset:8192
 v_pk_mul_f32 v[168:169], v[168:169], v[86:87]
 v_pk_mul_f32 v[170:171], v[170:171], v[86:87]
 ds_read_b64_tr_b16 a[226:227], v96 offset:10240
 v_pk_mul_f32 v[172:173], v[172:173], v[86:87]
 v_pk_mul_f32 v[174:175], v[174:175], v[86:87]
 ds_read_b64_tr_b16 a[228:229], v97 offset:8192
 v_lshlrev_b32 v122, 16, v232
 v_and_b32 v123, 0xffff0000, v232
 ds_read_b64_tr_b16 a[230:231], v97 offset:10240
 v_pk_fma_f32 v[168:169], v[122:123], v[90:91], v[168:169]
 v_lshlrev_b32 v124, 16, v233
 buffer_load_dwordx4 v138, s[56:59], s44 offen offset:2048 lds
 v_and_b32 v125, 0xffff0000, v233
 v_pk_fma_f32 v[170:171], v[124:125], v[90:91], v[170:171]
 ds_read_b64_tr_b16 a[232:233], v96 offset:8448
 v_lshlrev_b32 v122, 16, v234
 v_and_b32 v123, 0xffff0000, v234
 ds_read_b64_tr_b16 a[234:235], v96 offset:10496
 v_pk_fma_f32 v[172:173], v[122:123], v[90:91], v[172:173]
 v_lshlrev_b32 v124, 16, v235
 ds_read_b64_tr_b16 a[236:237], v97 offset:8448
 v_and_b32 v125, 0xffff0000, v235
 v_pk_fma_f32 v[174:175], v[124:125], v[90:91], v[174:175]
 ds_read_b64_tr_b16 a[238:239], v97 offset:10496
 v_cvt_pk_bf16_f32 v232, v168, v169
 v_cvt_pk_bf16_f32 v233, v170, v171
 ds_read_b64_tr_b16 a[240:241], v96 offset:12288
 v_cvt_pk_bf16_f32 v234, v172, v173
 v_cvt_pk_bf16_f32 v235, v174, v175
 buffer_load_dwordx4 v139, s[56:59], s44 offen offset:3072 lds
 v_accvgpr_read_b32 v176, a52
 v_accvgpr_read_b32 v177, a53
 ds_read_b64_tr_b16 a[242:243], v96 offset:14336
 v_accvgpr_read_b32 v178, a54
 v_accvgpr_read_b32 v179, a55
 ds_read_b64_tr_b16 a[244:245], v97 offset:12288
 v_accvgpr_read_b32 v180, a60
 v_accvgpr_read_b32 v181, a61
 ds_read_b64_tr_b16 a[246:247], v97 offset:14336
 v_accvgpr_read_b32 v182, a62
 v_accvgpr_read_b32 v183, a63
 ds_read_b64_tr_b16 a[248:249], v96 offset:12544
 v_pk_mul_f32 v[176:177], v[176:177], v[86:87]
 v_pk_mul_f32 v[178:179], v[178:179], v[86:87]
 ds_read_b64_tr_b16 a[250:251], v96 offset:14592
 v_pk_mul_f32 v[180:181], v[180:181], v[86:87]
 v_pk_mul_f32 v[182:183], v[182:183], v[86:87]
 s_sub_u32 s44, s44, 28544
 v_lshlrev_b32 v122, 16, v236
 v_and_b32 v123, 0xffff0000, v236
 ds_read_b64_tr_b16 a[252:253], v97 offset:12544
 v_pk_fma_f32 v[176:177], v[122:123], v[90:91], v[176:177]
 v_lshlrev_b32 v124, 16, v237
 ds_read_b64_tr_b16 a[254:255], v97 offset:14592
 v_and_b32 v125, 0xffff0000, v237
 v_pk_fma_f32 v[178:179], v[124:125], v[90:91], v[178:179]
 v_lshlrev_b32 v122, 16, v238
 v_and_b32 v123, 0xffff0000, v238
 v_pk_fma_f32 v[180:181], v[122:123], v[90:91], v[180:181]
 v_lshlrev_b32 v124, 16, v239
 v_and_b32 v125, 0xffff0000, v239
 v_pk_fma_f32 v[182:183], v[124:125], v[90:91], v[182:183]
 v_cvt_pk_bf16_f32 v236, v176, v177
 v_cvt_pk_bf16_f32 v237, v178, v179
 v_cvt_pk_bf16_f32 v238, v180, v181
 v_cvt_pk_bf16_f32 v239, v182, v183
 v_accvgpr_read_b32 v168, a68
 v_accvgpr_read_b32 v169, a69
 v_accvgpr_read_b32 v170, a70
 v_accvgpr_read_b32 v171, a71
 v_accvgpr_read_b32 v172, a76
 v_accvgpr_read_b32 v173, a77
 v_accvgpr_read_b32 v174, a78
 v_accvgpr_read_b32 v175, a79
 v_pk_mul_f32 v[168:169], v[168:169], v[86:87]
 v_pk_mul_f32 v[170:171], v[170:171], v[86:87]
 v_pk_mul_f32 v[172:173], v[172:173], v[86:87]
 v_pk_mul_f32 v[174:175], v[174:175], v[86:87]
 v_lshlrev_b32 v122, 16, v240
 v_and_b32 v123, 0xffff0000, v240
 v_pk_fma_f32 v[168:169], v[122:123], v[90:91], v[168:169]
 v_lshlrev_b32 v124, 16, v241
 v_and_b32 v125, 0xffff0000, v241
 v_pk_fma_f32 v[170:171], v[124:125], v[90:91], v[170:171]
 v_lshlrev_b32 v122, 16, v242
 v_and_b32 v123, 0xffff0000, v242
 v_pk_fma_f32 v[172:173], v[122:123], v[90:91], v[172:173]
 v_lshlrev_b32 v124, 16, v243
 v_and_b32 v125, 0xffff0000, v243
 v_pk_fma_f32 v[174:175], v[124:125], v[90:91], v[174:175]
 v_cvt_pk_bf16_f32 v240, v168, v169
 v_cvt_pk_bf16_f32 v241, v170, v171
 v_cvt_pk_bf16_f32 v242, v172, v173
 v_cvt_pk_bf16_f32 v243, v174, v175
 v_accvgpr_read_b32 v176, a84
 v_accvgpr_read_b32 v177, a85
 v_accvgpr_read_b32 v178, a86
 v_accvgpr_read_b32 v179, a87
 v_accvgpr_read_b32 v180, a92
 v_accvgpr_read_b32 v181, a93
 v_accvgpr_read_b32 v182, a94
 v_accvgpr_read_b32 v183, a95
 v_pk_mul_f32 v[176:177], v[176:177], v[86:87]
 v_pk_mul_f32 v[178:179], v[178:179], v[86:87]
 v_pk_mul_f32 v[180:181], v[180:181], v[86:87]
 v_pk_mul_f32 v[182:183], v[182:183], v[86:87]
 v_lshlrev_b32 v122, 16, v244
 v_and_b32 v123, 0xffff0000, v244
 v_pk_fma_f32 v[176:177], v[122:123], v[90:91], v[176:177]
 v_lshlrev_b32 v124, 16, v245
 v_and_b32 v125, 0xffff0000, v245
 v_pk_fma_f32 v[178:179], v[124:125], v[90:91], v[178:179]
 v_lshlrev_b32 v122, 16, v246
 v_and_b32 v123, 0xffff0000, v246
 v_pk_fma_f32 v[180:181], v[122:123], v[90:91], v[180:181]
 v_lshlrev_b32 v124, 16, v247
 v_and_b32 v125, 0xffff0000, v247
 v_pk_fma_f32 v[182:183], v[124:125], v[90:91], v[182:183]
 v_cvt_pk_bf16_f32 v244, v176, v177
 v_cvt_pk_bf16_f32 v245, v178, v179
 v_cvt_pk_bf16_f32 v246, v180, v181
 v_cvt_pk_bf16_f32 v247, v182, v183
 v_accvgpr_read_b32 v168, a100
 v_accvgpr_read_b32 v169, a101
 v_accvgpr_read_b32 v170, a102
 v_accvgpr_read_b32 v171, a103
 v_accvgpr_read_b32 v172, a108
 v_accvgpr_read_b32 v173, a109
 v_accvgpr_read_b32 v174, a110
 v_accvgpr_read_b32 v175, a111
 v_pk_mul_f32 v[168:169], v[168:169], v[86:87]
 v_pk_mul_f32 v[170:171], v[170:171], v[86:87]
 v_pk_mul_f32 v[172:173], v[172:173], v[86:87]
 v_pk_mul_f32 v[174:175], v[174:175], v[86:87]
 v_lshlrev_b32 v122, 16, v248
 v_and_b32 v123, 0xffff0000, v248
 v_pk_fma_f32 v[168:169], v[122:123], v[90:91], v[168:169]
 v_lshlrev_b32 v124, 16, v249
 v_and_b32 v125, 0xffff0000, v249
 v_pk_fma_f32 v[170:171], v[124:125], v[90:91], v[170:171]
 v_lshlrev_b32 v122, 16, v250
 v_and_b32 v123, 0xffff0000, v250
 v_pk_fma_f32 v[172:173], v[122:123], v[90:91], v[172:173]
 v_lshlrev_b32 v124, 16, v251
 v_and_b32 v125, 0xffff0000, v251
 v_pk_fma_f32 v[174:175], v[124:125], v[90:91], v[174:175]
 v_cvt_pk_bf16_f32 v248, v168, v169
 v_cvt_pk_bf16_f32 v249, v170, v171
 v_cvt_pk_bf16_f32 v250, v172, v173
 v_cvt_pk_bf16_f32 v251, v174, v175
 v_accvgpr_read_b32 v176, a116
 v_accvgpr_read_b32 v177, a117
 v_accvgpr_read_b32 v178, a118
 v_accvgpr_read_b32 v179, a119
 v_accvgpr_read_b32 v180, a124
 v_accvgpr_read_b32 v181, a125
 v_accvgpr_read_b32 v182, a126
 v_accvgpr_read_b32 v183, a127
 v_pk_mul_f32 v[176:177], v[176:177], v[86:87]
 v_pk_mul_f32 v[178:179], v[178:179], v[86:87]
 v_pk_mul_f32 v[180:181], v[180:181], v[86:87]
 v_pk_mul_f32 v[182:183], v[182:183], v[86:87]
 v_lshlrev_b32 v122, 16, v252
 v_and_b32 v123, 0xffff0000, v252
 v_pk_fma_f32 v[176:177], v[122:123], v[90:91], v[176:177]
 v_lshlrev_b32 v124, 16, v253
 v_and_b32 v125, 0xffff0000, v253
 v_pk_fma_f32 v[178:179], v[124:125], v[90:91], v[178:179]
 v_lshlrev_b32 v122, 16, v254
 v_and_b32 v123, 0xffff0000, v254
 v_pk_fma_f32 v[180:181], v[122:123], v[90:91], v[180:181]
 v_lshlrev_b32 v124, 16, v255
 v_and_b32 v125, 0xffff0000, v255
 v_pk_fma_f32 v[182:183], v[124:125], v[90:91], v[182:183]
 v_cvt_pk_bf16_f32 v252, v176, v177
 v_cvt_pk_bf16_f32 v253, v178, v179
 v_cvt_pk_bf16_f32 v254, v180, v181
 v_cvt_pk_bf16_f32 v255, v182, v183
L2_oproj:
 s_lshl_b32 s9, s62, 2
 s_add_u32 s9, s9, s3
 s_lshl_b32 s9, s9, 5
 s_add_u32 s9, s9, s67
 s_mul_i32 s43, s9, 14336
 s_add_u32 s43, s43, 0x2c00000
 s_add_u32 s10, s43, 229376
 s_lshl_b32 s30, s62, 4
 s_add_u32 s30, s30, s67
 s_lshl_b32 s30, s30, 7
 s_add_u32 s30, s30, 0x530a000
 s_waitcnt lgkmcnt(0)
 v_mfma_f32_16x16x32_bf16 v[4:7], a[192:195], v[192:195], 0
 v_mfma_f32_16x16x32_bf16 v[8:11], a[192:195], v[224:227], 0
 ds_read_b64_tr_b16 a[192:193], v96 offset:16384
 v_mfma_f32_16x16x32_bf16 v[12:15], a[196:199], v[192:195], 0
 ds_read_b64_tr_b16 a[194:195], v96 offset:18432
 v_mfma_f32_16x16x32_bf16 v[16:19], a[196:199], v[224:227], 0
 ds_read_b64_tr_b16 a[196:197], v97 offset:16384
 v_mfma_f32_16x16x32_bf16 v[20:23], a[200:203], v[192:195], 0
 ds_read_b64_tr_b16 a[198:199], v97 offset:18432
 v_mfma_f32_16x16x32_bf16 v[24:27], a[200:203], v[224:227], 0
 ds_read_b64_tr_b16 a[200:201], v96 offset:16640
 v_mfma_f32_16x16x32_bf16 v[28:31], a[204:207], v[192:195], 0
 ds_read_b64_tr_b16 a[202:203], v96 offset:18688
 v_mfma_f32_16x16x32_bf16 v[32:35], a[204:207], v[224:227], 0
 ds_read_b64_tr_b16 a[204:205], v97 offset:16640
 v_mfma_f32_16x16x32_bf16 v[4:7], a[208:211], v[196:199], v[4:7]
 ds_read_b64_tr_b16 a[206:207], v97 offset:18688
 v_mfma_f32_16x16x32_bf16 v[8:11], a[208:211], v[228:231], v[8:11]
 ds_read_b64_tr_b16 a[208:209], v96 offset:20480
 v_mfma_f32_16x16x32_bf16 v[12:15], a[212:215], v[196:199], v[12:15]
 ds_read_b64_tr_b16 a[210:211], v96 offset:22528
 v_mfma_f32_16x16x32_bf16 v[16:19], a[212:215], v[228:231], v[16:19]
 ds_read_b64_tr_b16 a[212:213], v97 offset:20480
 v_mfma_f32_16x16x32_bf16 v[20:23], a[216:219], v[196:199], v[20:23]
 ds_read_b64_tr_b16 a[214:215], v97 offset:22528
 v_mfma_f32_16x16x32_bf16 v[24:27], a[216:219], v[228:231], v[24:27]
 ds_read_b64_tr_b16 a[216:217], v96 offset:20736
 v_mfma_f32_16x16x32_bf16 v[28:31], a[220:223], v[196:199], v[28:31]
 ds_read_b64_tr_b16 a[218:219], v96 offset:22784
 v_mfma_f32_16x16x32_bf16 v[32:35], a[220:223], v[228:231], v[32:35]
 ds_read_b64_tr_b16 a[220:221], v97 offset:20736
 v_mfma_f32_16x16x32_bf16 v[4:7], a[224:227], v[200:203], v[4:7]
 ds_read_b64_tr_b16 a[222:223], v97 offset:22784
 v_mfma_f32_16x16x32_bf16 v[8:11], a[224:227], v[232:235], v[8:11]
 ds_read_b64_tr_b16 a[224:225], v96 offset:24576
 v_mfma_f32_16x16x32_bf16 v[12:15], a[228:231], v[200:203], v[12:15]
 ds_read_b64_tr_b16 a[226:227], v96 offset:26624
 v_mfma_f32_16x16x32_bf16 v[16:19], a[228:231], v[232:235], v[16:19]
 ds_read_b64_tr_b16 a[228:229], v97 offset:24576
 v_mfma_f32_16x16x32_bf16 v[20:23], a[232:235], v[200:203], v[20:23]
 ds_read_b64_tr_b16 a[230:231], v97 offset:26624
 v_mfma_f32_16x16x32_bf16 v[24:27], a[232:235], v[232:235], v[24:27]
 ds_read_b64_tr_b16 a[232:233], v96 offset:24832
 v_mfma_f32_16x16x32_bf16 v[28:31], a[236:239], v[200:203], v[28:31]
 ds_read_b64_tr_b16 a[234:235], v96 offset:26880
 v_mfma_f32_16x16x32_bf16 v[32:35], a[236:239], v[232:235], v[32:35]
 ds_read_b64_tr_b16 a[236:237], v97 offset:24832
 v_mfma_f32_16x16x32_bf16 v[4:7], a[240:243], v[204:207], v[4:7]
 ds_read_b64_tr_b16 a[238:239], v97 offset:26880
 v_mfma_f32_16x16x32_bf16 v[8:11], a[240:243], v[236:239], v[8:11]
 ds_read_b64_tr_b16 a[240:241], v96 offset:28672
 v_mfma_f32_16x16x32_bf16 v[12:15], a[244:247], v[204:207], v[12:15]
 ds_read_b64_tr_b16 a[242:243], v96 offset:30720
 v_mfma_f32_16x16x32_bf16 v[16:19], a[244:247], v[236:239], v[16:19]
 ds_read_b64_tr_b16 a[244:245], v97 offset:28672
 v_mfma_f32_16x16x32_bf16 v[20:23], a[248:251], v[204:207], v[20:23]
 ds_read_b64_tr_b16 a[246:247], v97 offset:30720
 v_mfma_f32_16x16x32_bf16 v[24:27], a[248:251], v[236:239], v[24:27]
 ds_read_b64_tr_b16 a[248:249], v96 offset:28928
 v_mfma_f32_16x16x32_bf16 v[28:31], a[252:255], v[204:207], v[28:31]
 ds_read_b64_tr_b16 a[250:251], v96 offset:30976
 v_mfma_f32_16x16x32_bf16 v[32:35], a[252:255], v[236:239], v[32:35]
 s_waitcnt vmcnt(25)
 s_barrier
 s_waitcnt lgkmcnt(9)
 v_mfma_f32_16x16x32_bf16 v[4:7], a[192:195], v[208:211], v[4:7]
 ds_read_b64_tr_b16 a[252:253], v97 offset:28928
 v_mfma_f32_16x16x32_bf16 v[8:11], a[192:195], v[240:243], v[8:11]
 ds_read_b64_tr_b16 a[254:255], v97 offset:30976
 v_add_u32 v96, 0x0, v166
 v_mfma_f32_16x16x32_bf16 v[12:15], a[196:199], v[208:211], v[12:15]
 v_add_u32 v97, 0x0, v167
 ds_read_b64_tr_b16 a[192:193], v96 offset:0
 v_mfma_f32_16x16x32_bf16 v[16:19], a[196:199], v[240:243], v[16:19]
 ds_read_b64_tr_b16 a[194:195], v96 offset:2048
 v_mfma_f32_16x16x32_bf16 v[20:23], a[200:203], v[208:211], v[20:23]
 ds_read_b64_tr_b16 a[196:197], v97 offset:0
 v_mfma_f32_16x16x32_bf16 v[24:27], a[200:203], v[240:243], v[24:27]
 ds_read_b64_tr_b16 a[198:199], v97 offset:2048
 v_mfma_f32_16x16x32_bf16 v[28:31], a[204:207], v[208:211], v[28:31]
 ds_read_b64_tr_b16 a[200:201], v96 offset:256
 v_mfma_f32_16x16x32_bf16 v[32:35], a[204:207], v[240:243], v[32:35]
 ds_read_b64_tr_b16 a[202:203], v96 offset:2304
 v_mfma_f32_16x16x32_bf16 v[4:7], a[208:211], v[212:215], v[4:7]
 ds_read_b64_tr_b16 a[204:205], v97 offset:256
 v_mfma_f32_16x16x32_bf16 v[8:11], a[208:211], v[244:247], v[8:11]
 ds_read_b64_tr_b16 a[206:207], v97 offset:2304
 v_mfma_f32_16x16x32_bf16 v[12:15], a[212:215], v[212:215], v[12:15]
 ds_read_b64_tr_b16 a[208:209], v96 offset:4096
 v_mfma_f32_16x16x32_bf16 v[16:19], a[212:215], v[244:247], v[16:19]
 ds_read_b64_tr_b16 a[210:211], v96 offset:6144
 v_mfma_f32_16x16x32_bf16 v[20:23], a[216:219], v[212:215], v[20:23]
 ds_read_b64_tr_b16 a[212:213], v97 offset:4096
 v_mfma_f32_16x16x32_bf16 v[24:27], a[216:219], v[244:247], v[24:27]
 ds_read_b64_tr_b16 a[214:215], v97 offset:6144
 v_mfma_f32_16x16x32_bf16 v[28:31], a[220:223], v[212:215], v[28:31]
 ds_read_b64_tr_b16 a[216:217], v96 offset:4352
 v_mfma_f32_16x16x32_bf16 v[32:35], a[220:223], v[244:247], v[32:35]
 ds_read_b64_tr_b16 a[218:219], v96 offset:6400
 v_mfma_f32_16x16x32_bf16 v[4:7], a[224:227], v[216:219], v[4:7]
 ds_read_b64_tr_b16 a[220:221], v97 offset:4352
 v_mfma_f32_16x16x32_bf16 v[8:11], a[224:227], v[248:251], v[8:11]
 ds_read_b64_tr_b16 a[222:223], v97 offset:6400
 v_mfma_f32_16x16x32_bf16 v[12:15], a[228:231], v[216:219], v[12:15]
 ds_read_b64_tr_b16 a[224:225], v96 offset:8192
 v_mfma_f32_16x16x32_bf16 v[16:19], a[228:231], v[248:251], v[16:19]
 ds_read_b64_tr_b16 a[226:227], v96 offset:10240
 s_waitcnt lgkmcnt(10)
 v_mfma_f32_16x16x32_bf16 v[20:23], a[232:235], v[216:219], v[20:23]
 ds_read_b64_tr_b16 a[228:229], v97 offset:8192
 v_mfma_f32_16x16x32_bf16 v[24:27], a[232:235], v[248:251], v[24:27]
 ds_read_b64_tr_b16 a[230:231], v97 offset:10240
 v_mfma_f32_16x16x32_bf16 v[28:31], a[236:239], v[216:219], v[28:31]
 ds_read_b64_tr_b16 a[232:233], v96 offset:8448
 v_mfma_f32_16x16x32_bf16 v[32:35], a[236:239], v[248:251], v[32:35]
 ds_read_b64_tr_b16 a[234:235], v96 offset:10496
 v_mfma_f32_16x16x32_bf16 v[4:7], a[240:243], v[220:223], v[4:7]
 ds_read_b64_tr_b16 a[236:237], v97 offset:8448
 v_mfma_f32_16x16x32_bf16 v[8:11], a[240:243], v[252:255], v[8:11]
 ds_read_b64_tr_b16 a[238:239], v97 offset:10496
 v_mfma_f32_16x16x32_bf16 v[12:15], a[244:247], v[220:223], v[12:15]
 ds_read_b64_tr_b16 a[240:241], v96 offset:12288
 v_mfma_f32_16x16x32_bf16 v[16:19], a[244:247], v[252:255], v[16:19]
 ds_read_b64_tr_b16 a[242:243], v96 offset:14336
 v_mfma_f32_16x16x32_bf16 v[20:23], a[248:251], v[220:223], v[20:23]
 ds_read_b64_tr_b16 a[244:245], v97 offset:12288
 v_mfma_f32_16x16x32_bf16 v[24:27], a[248:251], v[252:255], v[24:27]
 ds_read_b64_tr_b16 a[246:247], v97 offset:14336
 v_mfma_f32_16x16x32_bf16 v[28:31], a[252:255], v[220:223], v[28:31]
 ds_read_b64_tr_b16 a[248:249], v96 offset:12544
 v_mfma_f32_16x16x32_bf16 v[32:35], a[252:255], v[252:255], v[32:35]
 ds_read_b64_tr_b16 a[250:251], v96 offset:14592
 v_mfma_f32_16x16x32_bf16 v[36:39], a[192:195], v[192:195], 0
 ds_read_b64_tr_b16 a[252:253], v97 offset:12544
 v_mfma_f32_16x16x32_bf16 v[40:43], a[192:195], v[224:227], 0
 ds_read_b64_tr_b16 a[254:255], v97 offset:14592
 v_mfma_f32_16x16x32_bf16 v[44:47], a[196:199], v[192:195], 0
 ds_read_b64_tr_b16 a[192:193], v96 offset:16384
 v_mfma_f32_16x16x32_bf16 v[48:51], a[196:199], v[224:227], 0
 ds_read_b64_tr_b16 a[194:195], v96 offset:18432
 v_mfma_f32_16x16x32_bf16 v[52:55], a[200:203], v[192:195], 0
 ds_read_b64_tr_b16 a[196:197], v97 offset:16384
 v_mfma_f32_16x16x32_bf16 v[56:59], a[200:203], v[224:227], 0
 ds_read_b64_tr_b16 a[198:199], v97 offset:18432
 v_cvt_pk_bf16_f32 v100, v4, v5
 v_mfma_f32_16x16x32_bf16 v[60:63], a[204:207], v[192:195], 0
 ds_read_b64_tr_b16 a[200:201], v96 offset:16640
 v_mfma_f32_16x16x32_bf16 v[64:67], a[204:207], v[224:227], 0
 ds_read_b64_tr_b16 a[202:203], v96 offset:18688
 s_waitcnt lgkmcnt(9)
 v_mfma_f32_16x16x32_bf16 v[36:39], a[208:211], v[196:199], v[36:39]
 ds_read_b64_tr_b16 a[204:205], v97 offset:16640
 v_cvt_pk_bf16_f32 v101, v6, v7
 v_mfma_f32_16x16x32_bf16 v[40:43], a[208:211], v[228:231], v[40:43]
 ds_read_b64_tr_b16 a[206:207], v97 offset:18688
 v_mfma_f32_16x16x32_bf16 v[44:47], a[212:215], v[196:199], v[44:47]
 ds_read_b64_tr_b16 a[208:209], v96 offset:20480
 v_cvt_pk_bf16_f32 v102, v12, v13
 v_mfma_f32_16x16x32_bf16 v[48:51], a[212:215], v[228:231], v[48:51]
 ds_read_b64_tr_b16 a[210:211], v96 offset:22528
 v_mfma_f32_16x16x32_bf16 v[52:55], a[216:219], v[196:199], v[52:55]
 ds_read_b64_tr_b16 a[212:213], v97 offset:20480
 v_mfma_f32_16x16x32_bf16 v[56:59], a[216:219], v[228:231], v[56:59]
 ds_read_b64_tr_b16 a[214:215], v97 offset:22528
 v_cvt_pk_bf16_f32 v103, v14, v15
 v_mfma_f32_16x16x32_bf16 v[60:63], a[220:223], v[196:199], v[60:63]
 ds_read_b64_tr_b16 a[216:217], v96 offset:20736
 v_mfma_f32_16x16x32_bf16 v[64:67], a[220:223], v[228:231], v[64:67]
 ds_read_b64_tr_b16 a[218:219], v96 offset:22784
 v_mfma_f32_16x16x32_bf16 v[36:39], a[224:227], v[200:203], v[36:39]
 ds_read_b64_tr_b16 a[220:221], v97 offset:20736
 v_mfma_f32_16x16x32_bf16 v[40:43], a[224:227], v[232:235], v[40:43]
 buffer_store_dwordx4 v[100:103], v2, s[4:7], s43 offen offset:0 sc1
 v_mfma_f32_16x16x32_bf16 v[44:47], a[228:231], v[200:203], v[44:47]
 ds_read_b64_tr_b16 a[222:223], v97 offset:22784
 v_cvt_pk_bf16_f32 v104, v20, v21
 v_mfma_f32_16x16x32_bf16 v[48:51], a[228:231], v[232:235], v[48:51]
 ds_read_b64_tr_b16 a[224:225], v96 offset:24576
 v_mfma_f32_16x16x32_bf16 v[52:55], a[232:235], v[200:203], v[52:55]
 ds_read_b64_tr_b16 a[226:227], v96 offset:26624
 v_mfma_f32_16x16x32_bf16 v[56:59], a[232:235], v[232:235], v[56:59]
 ds_read_b64_tr_b16 a[228:229], v97 offset:24576
 v_cvt_pk_bf16_f32 v105, v22, v23
 v_mfma_f32_16x16x32_bf16 v[60:63], a[236:239], v[200:203], v[60:63]
 ds_read_b64_tr_b16 a[230:231], v97 offset:26624
 v_mfma_f32_16x16x32_bf16 v[64:67], a[236:239], v[232:235], v[64:67]
 ds_read_b64_tr_b16 a[232:233], v96 offset:24832
 v_mfma_f32_16x16x32_bf16 v[36:39], a[240:243], v[204:207], v[36:39]
 ds_read_b64_tr_b16 a[234:235], v96 offset:26880
 v_cvt_pk_bf16_f32 v106, v28, v29
 v_mfma_f32_16x16x32_bf16 v[40:43], a[240:243], v[236:239], v[40:43]
 ds_read_b64_tr_b16 a[236:237], v97 offset:24832
 v_mfma_f32_16x16x32_bf16 v[44:47], a[244:247], v[204:207], v[44:47]
 ds_read_b64_tr_b16 a[238:239], v97 offset:26880
 v_mfma_f32_16x16x32_bf16 v[48:51], a[244:247], v[236:239], v[48:51]
 ds_read_b64_tr_b16 a[240:241], v96 offset:28672
 v_cvt_pk_bf16_f32 v107, v30, v31
 s_waitcnt lgkmcnt(8)
 v_mfma_f32_16x16x32_bf16 v[52:55], a[248:251], v[204:207], v[52:55]
 ds_read_b64_tr_b16 a[242:243], v96 offset:30720
 v_mfma_f32_16x16x32_bf16 v[56:59], a[248:251], v[236:239], v[56:59]
 ds_read_b64_tr_b16 a[244:245], v97 offset:28672
 v_mfma_f32_16x16x32_bf16 v[60:63], a[252:255], v[204:207], v[60:63]
 ds_read_b64_tr_b16 a[246:247], v97 offset:30720
 v_mfma_f32_16x16x32_bf16 v[64:67], a[252:255], v[236:239], v[64:67]
 s_waitcnt vmcnt(17)
 s_barrier
 v_mfma_f32_16x16x32_bf16 v[36:39], a[192:195], v[208:211], v[36:39]
 ds_read_b64_tr_b16 a[248:249], v96 offset:28928
 s_lshl_b32 s11, s8, 1
 v_mfma_f32_16x16x32_bf16 v[40:43], a[192:195], v[240:243], v[40:43]
 buffer_store_dwordx4 v[104:107], v2, s[4:7], s43 offen offset:1024 sc1
 v_mfma_f32_16x16x32_bf16 v[44:47], a[196:199], v[208:211], v[44:47]
 ds_read_b64_tr_b16 a[250:251], v96 offset:30976
 v_cvt_pk_bf16_f32 v108, v8, v9
 v_mfma_f32_16x16x32_bf16 v[48:51], a[196:199], v[240:243], v[48:51]
 ds_read_b64_tr_b16 a[252:253], v97 offset:28928
 s_add_u32 m0, s11, 0x20000
 v_mfma_f32_16x16x32_bf16 v[52:55], a[200:203], v[208:211], v[52:55]
 ds_read_b64_tr_b16 a[254:255], v97 offset:30976
 v_add_u32 v96, 0x8000, v166
 v_add_u32 v97, 0x8000, v167
 v_mfma_f32_16x16x32_bf16 v[56:59], a[200:203], v[240:243], v[56:59]
 ds_read_b64_tr_b16 a[192:193], v96 offset:0
 v_cvt_pk_bf16_f32 v109, v10, v11
 v_mfma_f32_16x16x32_bf16 v[60:63], a[204:207], v[208:211], v[60:63]
 ds_read_b64_tr_b16 a[194:195], v96 offset:2048
 v_cvt_pk_bf16_f32 v110, v16, v17
 v_mfma_f32_16x16x32_bf16 v[64:67], a[204:207], v[240:243], v[64:67]
 buffer_load_dwordx4 v136, s[56:59], s44 offen offset:0 lds
 v_mfma_f32_16x16x32_bf16 v[36:39], a[208:211], v[212:215], v[36:39]
 ds_read_b64_tr_b16 a[196:197], v97 offset:0
 v_cvt_pk_bf16_f32 v111, v18, v19
 v_mfma_f32_16x16x32_bf16 v[40:43], a[208:211], v[244:247], v[40:43]
 ds_read_b64_tr_b16 a[198:199], v97 offset:2048
 v_mfma_f32_16x16x32_bf16 v[44:47], a[212:215], v[212:215], v[44:47]
 ds_read_b64_tr_b16 a[200:201], v96 offset:256
 v_mfma_f32_16x16x32_bf16 v[48:51], a[212:215], v[244:247], v[48:51]
 ds_read_b64_tr_b16 a[202:203], v96 offset:2304
 v_mfma_f32_16x16x32_bf16 v[52:55], a[216:219], v[212:215], v[52:55]
 ds_read_b64_tr_b16 a[204:205], v97 offset:256
 v_mfma_f32_16x16x32_bf16 v[56:59], a[216:219], v[244:247], v[56:59]
 ds_read_b64_tr_b16 a[206:207], v97 offset:2304
 v_mfma_f32_16x16x32_bf16 v[60:63], a[220:223], v[212:215], v[60:63]
 buffer_load_dwordx4 v137, s[56:59], s44 offen offset:1024 lds
 v_mfma_f32_16x16x32_bf16 v[64:67], a[220:223], v[244:247], v[64:67]
 ds_read_b64_tr_b16 a[208:209], v96 offset:4096
 s_waitcnt lgkmcnt(7)
 v_mfma_f32_16x16x32_bf16 v[36:39], a[224:227], v[216:219], v[36:39]
 ds_read_b64_tr_b16 a[210:211], v96 offset:6144
 v_mfma_f32_16x16x32_bf16 v[40:43], a[224:227], v[248:251], v[40:43]
 buffer_store_dwordx4 v[108:111], v2, s[4:7], s10 offen offset:0 sc1
 v_mfma_f32_16x16x32_bf16 v[44:47], a[228:231], v[216:219], v[44:47]
 ds_read_b64_tr_b16 a[212:213], v97 offset:4096
 v_cvt_pk_bf16_f32 v112, v24, v25
 v_mfma_f32_16x16x32_bf16 v[48:51], a[228:231], v[248:251], v[48:51]
 ds_read_b64_tr_b16 a[214:215], v97 offset:6144
 v_cvt_pk_bf16_f32 v113, v26, v27
 v_mfma_f32_16x16x32_bf16 v[52:55], a[232:235], v[216:219], v[52:55]
 ds_read_b64_tr_b16 a[216:217], v96 offset:4352
 v_cvt_pk_bf16_f32 v114, v32, v33
 v_mfma_f32_16x16x32_bf16 v[56:59], a[232:235], v[248:251], v[56:59]
 ds_read_b64_tr_b16 a[218:219], v96 offset:6400
 v_cvt_pk_bf16_f32 v115, v34, v35
 v_mfma_f32_16x16x32_bf16 v[60:63], a[236:239], v[216:219], v[60:63]
 buffer_load_dwordx4 v138, s[56:59], s44 offen offset:2048 lds
 v_mfma_f32_16x16x32_bf16 v[64:67], a[236:239], v[248:251], v[64:67]
 ds_read_b64_tr_b16 a[220:221], v97 offset:4352
 ds_read_b64_tr_b16 a[222:223], v97 offset:6400
 v_mfma_f32_16x16x32_bf16 v[36:39], a[240:243], v[220:223], v[36:39]
 ds_read_b64_tr_b16 a[224:225], v96 offset:8192
 buffer_store_dwordx4 v[112:115], v2, s[4:7], s10 offen offset:1024 sc1
 v_mfma_f32_16x16x32_bf16 v[40:43], a[240:243], v[252:255], v[40:43]
 ds_read_b64_tr_b16 a[226:227], v96 offset:10240
 v_mfma_f32_16x16x32_bf16 v[44:47], a[244:247], v[220:223], v[44:47]
 ds_read_b64_tr_b16 a[228:229], v97 offset:8192
 v_mfma_f32_16x16x32_bf16 v[48:51], a[244:247], v[252:255], v[48:51]
 ds_read_b64_tr_b16 a[230:231], v97 offset:10240
 v_mfma_f32_16x16x32_bf16 v[52:55], a[248:251], v[220:223], v[52:55]
 buffer_load_dwordx4 v139, s[56:59], s44 offen offset:3072 lds
 v_mfma_f32_16x16x32_bf16 v[56:59], a[248:251], v[252:255], v[56:59]
 ds_read_b64_tr_b16 a[232:233], v96 offset:8448
 ds_read_b64_tr_b16 a[234:235], v96 offset:10496
 v_mfma_f32_16x16x32_bf16 v[60:63], a[252:255], v[220:223], v[60:63]
 s_add_u32 s44, s44, 28672
 ds_read_b64_tr_b16 a[236:237], v97 offset:8448
 v_mfma_f32_16x16x32_bf16 v[64:67], a[252:255], v[252:255], v[64:67]
 ds_read_b64_tr_b16 a[238:239], v97 offset:10496
 s_add_u32 m0, s11, 0x21000
 v_mfma_f32_16x16x32_bf16 v[4:7], a[192:195], v[192:195], 0
 ds_read_b64_tr_b16 a[240:241], v96 offset:12288
 v_mfma_f32_16x16x32_bf16 v[8:11], a[192:195], v[224:227], 0
 ds_read_b64_tr_b16 a[242:243], v96 offset:14336
 s_waitcnt lgkmcnt(8)
 v_mfma_f32_16x16x32_bf16 v[12:15], a[196:199], v[192:195], 0
 buffer_load_dwordx4 v136, s[56:59], s44 offen offset:0 lds
 v_mfma_f32_16x16x32_bf16 v[16:19], a[196:199], v[224:227], 0
 ds_read_b64_tr_b16 a[244:245], v97 offset:12288
 ds_read_b64_tr_b16 a[246:247], v97 offset:14336
 v_mfma_f32_16x16x32_bf16 v[20:23], a[200:203], v[192:195], 0
 ds_read_b64_tr_b16 a[248:249], v96 offset:12544
 v_mfma_f32_16x16x32_bf16 v[24:27], a[200:203], v[224:227], 0
 ds_read_b64_tr_b16 a[250:251], v96 offset:14592
 v_cvt_pk_bf16_f32 v100, v36, v37
 v_mfma_f32_16x16x32_bf16 v[28:31], a[204:207], v[192:195], 0
 ds_read_b64_tr_b16 a[252:253], v97 offset:12544
 v_mfma_f32_16x16x32_bf16 v[32:35], a[204:207], v[224:227], 0
 ds_read_b64_tr_b16 a[254:255], v97 offset:14592
 v_cvt_pk_bf16_f32 v101, v38, v39
 v_mfma_f32_16x16x32_bf16 v[4:7], a[208:211], v[196:199], v[4:7]
 buffer_load_dwordx4 v137, s[56:59], s44 offen offset:1024 lds
 v_mfma_f32_16x16x32_bf16 v[8:11], a[208:211], v[228:231], v[8:11]
 ds_read_b64_tr_b16 a[192:193], v96 offset:16384
 ds_read_b64_tr_b16 a[194:195], v96 offset:18432
 v_mfma_f32_16x16x32_bf16 v[12:15], a[212:215], v[196:199], v[12:15]
 ds_read_b64_tr_b16 a[196:197], v97 offset:16384
 v_cvt_pk_bf16_f32 v102, v44, v45
 v_mfma_f32_16x16x32_bf16 v[16:19], a[212:215], v[228:231], v[16:19]
 ds_read_b64_tr_b16 a[198:199], v97 offset:18432
 v_mfma_f32_16x16x32_bf16 v[20:23], a[216:219], v[196:199], v[20:23]
 ds_read_b64_tr_b16 a[200:201], v96 offset:16640
 v_cvt_pk_bf16_f32 v103, v46, v47
 v_mfma_f32_16x16x32_bf16 v[24:27], a[216:219], v[228:231], v[24:27]
 ds_read_b64_tr_b16 a[202:203], v96 offset:18688
 v_mfma_f32_16x16x32_bf16 v[28:31], a[220:223], v[196:199], v[28:31]
 ds_read_b64_tr_b16 a[204:205], v97 offset:16640
 ds_read_b64_tr_b16 a[206:207], v97 offset:18688
 v_mfma_f32_16x16x32_bf16 v[32:35], a[220:223], v[228:231], v[32:35]
 buffer_load_dwordx4 v138, s[56:59], s44 offen offset:2048 lds
 v_mfma_f32_16x16x32_bf16 v[4:7], a[224:227], v[200:203], v[4:7]
 ds_read_b64_tr_b16 a[208:209], v96 offset:20480
 buffer_load_dwordx4 v139, s[56:59], s44 offen offset:3072 lds
 v_mfma_f32_16x16x32_bf16 v[8:11], a[224:227], v[232:235], v[8:11]
 ds_read_b64_tr_b16 a[210:211], v96 offset:22528
 s_sub_u32 s44, s44, 28544
 s_waitcnt lgkmcnt(7)
 v_mfma_f32_16x16x32_bf16 v[12:15], a[228:231], v[200:203], v[12:15]
 ds_read_b64_tr_b16 a[212:213], v97 offset:20480
 v_mfma_f32_16x16x32_bf16 v[16:19], a[228:231], v[232:235], v[16:19]
 ds_read_b64_tr_b16 a[214:215], v97 offset:22528
 v_mfma_f32_16x16x32_bf16 v[20:23], a[232:235], v[200:203], v[20:23]
 ds_read_b64_tr_b16 a[216:217], v96 offset:20736
 v_mfma_f32_16x16x32_bf16 v[24:27], a[232:235], v[232:235], v[24:27]
 ds_read_b64_tr_b16 a[218:219], v96 offset:22784
 v_mfma_f32_16x16x32_bf16 v[28:31], a[236:239], v[200:203], v[28:31]
 buffer_store_dwordx4 v[100:103], v2, s[4:7], s43 offen offset:2048 sc1
 v_mfma_f32_16x16x32_bf16 v[32:35], a[236:239], v[232:235], v[32:35]
 ds_read_b64_tr_b16 a[220:221], v97 offset:20736
 ds_read_b64_tr_b16 a[222:223], v97 offset:22784
 v_mfma_f32_16x16x32_bf16 v[4:7], a[240:243], v[204:207], v[4:7]
 ds_read_b64_tr_b16 a[224:225], v96 offset:24576
 v_cvt_pk_bf16_f32 v104, v52, v53
 v_mfma_f32_16x16x32_bf16 v[8:11], a[240:243], v[236:239], v[8:11]
 ds_read_b64_tr_b16 a[226:227], v96 offset:26624
 v_cvt_pk_bf16_f32 v105, v54, v55
 v_mfma_f32_16x16x32_bf16 v[12:15], a[244:247], v[204:207], v[12:15]
 ds_read_b64_tr_b16 a[228:229], v97 offset:24576
 v_cvt_pk_bf16_f32 v106, v60, v61
 v_mfma_f32_16x16x32_bf16 v[16:19], a[244:247], v[236:239], v[16:19]
 ds_read_b64_tr_b16 a[230:231], v97 offset:26624
 v_cvt_pk_bf16_f32 v107, v62, v63
 v_mfma_f32_16x16x32_bf16 v[20:23], a[248:251], v[204:207], v[20:23]
 ds_read_b64_tr_b16 a[232:233], v96 offset:24832
 v_mfma_f32_16x16x32_bf16 v[24:27], a[248:251], v[236:239], v[24:27]
 ds_read_b64_tr_b16 a[234:235], v96 offset:26880
 v_mfma_f32_16x16x32_bf16 v[28:31], a[252:255], v[204:207], v[28:31]
 ds_read_b64_tr_b16 a[236:237], v97 offset:24832
 ds_read_b64_tr_b16 a[238:239], v97 offset:26880
 v_mfma_f32_16x16x32_bf16 v[32:35], a[252:255], v[236:239], v[32:35]
 s_waitcnt vmcnt(21)
 s_barrier
 v_mfma_f32_16x16x32_bf16 v[4:7], a[192:195], v[208:211], v[4:7]
 ds_read_b64_tr_b16 a[240:241], v96 offset:28672
 v_mfma_f32_16x16x32_bf16 v[8:11], a[192:195], v[240:243], v[8:11]
 ds_read_b64_tr_b16 a[242:243], v96 offset:30720
 s_lshl_b32 s11, s8, 1
 s_waitcnt lgkmcnt(8)
 v_mfma_f32_16x16x32_bf16 v[12:15], a[196:199], v[208:211], v[12:15]
 ds_read_b64_tr_b16 a[244:245], v97 offset:28672
 ds_read_b64_tr_b16 a[246:247], v97 offset:30720
 v_mfma_f32_16x16x32_bf16 v[16:19], a[196:199], v[240:243], v[16:19]
 buffer_store_dwordx4 v[104:107], v2, s[4:7], s43 offen offset:3072 sc1
 v_mfma_f32_16x16x32_bf16 v[20:23], a[200:203], v[208:211], v[20:23]
 ds_read_b64_tr_b16 a[248:249], v96 offset:28928
 v_cvt_pk_bf16_f32 v108, v40, v41
 v_mfma_f32_16x16x32_bf16 v[24:27], a[200:203], v[240:243], v[24:27]
 ds_read_b64_tr_b16 a[250:251], v96 offset:30976
 v_cvt_pk_bf16_f32 v109, v42, v43
 v_mfma_f32_16x16x32_bf16 v[28:31], a[204:207], v[208:211], v[28:31]
 ds_read_b64_tr_b16 a[252:253], v97 offset:28928
 s_add_u32 m0, s11, 0x0
 v_mfma_f32_16x16x32_bf16 v[32:35], a[204:207], v[240:243], v[32:35]
 ds_read_b64_tr_b16 a[254:255], v97 offset:30976
 v_add_u32 v96, 0x10000, v166
 v_add_u32 v97, 0x10000, v167
 v_mfma_f32_16x16x32_bf16 v[4:7], a[208:211], v[212:215], v[4:7]
 ds_read_b64_tr_b16 a[192:193], v96 offset:0
 v_cvt_pk_bf16_f32 v110, v48, v49
 v_mfma_f32_16x16x32_bf16 v[8:11], a[208:211], v[244:247], v[8:11]
 ds_read_b64_tr_b16 a[194:195], v96 offset:2048
 v_cvt_pk_bf16_f32 v111, v50, v51
 v_mfma_f32_16x16x32_bf16 v[12:15], a[212:215], v[212:215], v[12:15]
 buffer_load_dwordx4 v136, s[56:59], s44 offen offset:0 lds
 v_mfma_f32_16x16x32_bf16 v[16:19], a[212:215], v[244:247], v[16:19]
 ds_read_b64_tr_b16 a[196:197], v97 offset:0
 ds_read_b64_tr_b16 a[198:199], v97 offset:2048
 v_mfma_f32_16x16x32_bf16 v[20:23], a[216:219], v[212:215], v[20:23]
 ds_read_b64_tr_b16 a[200:201], v96 offset:256
 v_mfma_f32_16x16x32_bf16 v[24:27], a[216:219], v[244:247], v[24:27]
 ds_read_b64_tr_b16 a[202:203], v96 offset:2304
 v_mfma_f32_16x16x32_bf16 v[28:31], a[220:223], v[212:215], v[28:31]
 ds_read_b64_tr_b16 a[204:205], v97 offset:256
 ds_read_b64_tr_b16 a[206:207], v97 offset:2304
 v_mfma_f32_16x16x32_bf16 v[32:35], a[220:223], v[244:247], v[32:35]
 buffer_store_dwordx4 v[108:111], v2, s[4:7], s10 offen offset:2048 sc1
 v_mfma_f32_16x16x32_bf16 v[4:7], a[224:227], v[216:219], v[4:7]
 buffer_load_dwordx4 v137, s[56:59], s44 offen offset:1024 lds
 v_mfma_f32_16x16x32_bf16 v[8:11], a[224:227], v[248:251], v[8:11]
 ds_read_b64_tr_b16 a[208:209], v96 offset:4096
 v_cvt_pk_bf16_f32 v112, v56, v57
 ds_read_b64_tr_b16 a[210:211], v96 offset:6144
 s_waitcnt lgkmcnt(8)
 v_mfma_f32_16x16x32_bf16 v[12:15], a[228:231], v[216:219], v[12:15]
 ds_read_b64_tr_b16 a[212:213], v97 offset:4096
 v_cvt_pk_bf16_f32 v113, v58, v59
 v_mfma_f32_16x16x32_bf16 v[16:19], a[228:231], v[248:251], v[16:19]
 ds_read_b64_tr_b16 a[214:215], v97 offset:6144
 v_cvt_pk_bf16_f32 v114, v64, v65
 v_mfma_f32_16x16x32_bf16 v[20:23], a[232:235], v[216:219], v[20:23]
 ds_read_b64_tr_b16 a[216:217], v96 offset:4352
 v_cvt_pk_bf16_f32 v115, v66, v67
 v_mfma_f32_16x16x32_bf16 v[24:27], a[232:235], v[248:251], v[24:27]
 ds_read_b64_tr_b16 a[218:219], v96 offset:6400
 v_mfma_f32_16x16x32_bf16 v[28:31], a[236:239], v[216:219], v[28:31]
 buffer_load_dwordx4 v138, s[56:59], s44 offen offset:2048 lds
 v_mfma_f32_16x16x32_bf16 v[32:35], a[236:239], v[248:251], v[32:35]
 ds_read_b64_tr_b16 a[220:221], v97 offset:4352
 ds_read_b64_tr_b16 a[222:223], v97 offset:6400
 v_mfma_f32_16x16x32_bf16 v[4:7], a[240:243], v[220:223], v[4:7]
 ds_read_b64_tr_b16 a[224:225], v96 offset:8192
 v_mfma_f32_16x16x32_bf16 v[8:11], a[240:243], v[252:255], v[8:11]
 ds_read_b64_tr_b16 a[226:227], v96 offset:10240
 v_mfma_f32_16x16x32_bf16 v[12:15], a[244:247], v[220:223], v[12:15]
 ds_read_b64_tr_b16 a[228:229], v97 offset:8192
 ds_read_b64_tr_b16 a[230:231], v97 offset:10240
 v_mfma_f32_16x16x32_bf16 v[16:19], a[244:247], v[252:255], v[16:19]
 buffer_store_dwordx4 v[112:115], v2, s[4:7], s10 offen offset:3072 sc1
 v_mfma_f32_16x16x32_bf16 v[20:23], a[248:251], v[220:223], v[20:23]
 buffer_load_dwordx4 v139, s[56:59], s44 offen offset:3072 lds
 v_mfma_f32_16x16x32_bf16 v[24:27], a[248:251], v[252:255], v[24:27]
 ds_read_b64_tr_b16 a[232:233], v96 offset:8448
 ds_read_b64_tr_b16 a[234:235], v96 offset:10496
 v_mfma_f32_16x16x32_bf16 v[28:31], a[252:255], v[220:223], v[28:31]
 s_add_u32 s43, s43, 0x1000
 s_add_u32 s44, s44, 28672
 s_add_u32 s10, s10, 0x1000
 v_mfma_f32_16x16x32_bf16 v[32:35], a[252:255], v[252:255], v[32:35]
 ds_read_b64_tr_b16 a[236:237], v97 offset:8448
 ds_read_b64_tr_b16 a[238:239], v97 offset:10496
 v_mfma_f32_16x16x32_bf16 v[36:39], a[192:195], v[192:195], 0
 s_add_u32 m0, s11, 0x1000
 ds_read_b64_tr_b16 a[240:241], v96 offset:12288
 v_mfma_f32_16x16x32_bf16 v[40:43], a[192:195], v[224:227], 0
 ds_read_b64_tr_b16 a[242:243], v96 offset:14336
 s_waitcnt lgkmcnt(6)
 v_mfma_f32_16x16x32_bf16 v[44:47], a[196:199], v[192:195], 0
 buffer_load_dwordx4 v136, s[56:59], s44 offen offset:0 lds
 v_mfma_f32_16x16x32_bf16 v[48:51], a[196:199], v[224:227], 0
 ds_read_b64_tr_b16 a[244:245], v97 offset:12288
 ds_read_b64_tr_b16 a[246:247], v97 offset:14336
 v_mfma_f32_16x16x32_bf16 v[52:55], a[200:203], v[192:195], 0
 ds_read_b64_tr_b16 a[248:249], v96 offset:12544
 v_mfma_f32_16x16x32_bf16 v[56:59], a[200:203], v[224:227], 0
 ds_read_b64_tr_b16 a[250:251], v96 offset:14592
 v_cvt_pk_bf16_f32 v100, v4, v5
 v_mfma_f32_16x16x32_bf16 v[60:63], a[204:207], v[192:195], 0
 ds_read_b64_tr_b16 a[252:253], v97 offset:12544
 v_mfma_f32_16x16x32_bf16 v[64:67], a[204:207], v[224:227], 0
 ds_read_b64_tr_b16 a[254:255], v97 offset:14592
 v_cvt_pk_bf16_f32 v101, v6, v7
 v_mfma_f32_16x16x32_bf16 v[36:39], a[208:211], v[196:199], v[36:39]
 buffer_load_dwordx4 v137, s[56:59], s44 offen offset:1024 lds
 v_mfma_f32_16x16x32_bf16 v[40:43], a[208:211], v[228:231], v[40:43]
 ds_read_b64_tr_b16 a[192:193], v96 offset:16384
 ds_read_b64_tr_b16 a[194:195], v96 offset:18432
 v_mfma_f32_16x16x32_bf16 v[44:47], a[212:215], v[196:199], v[44:47]
 ds_read_b64_tr_b16 a[196:197], v97 offset:16384
 v_cvt_pk_bf16_f32 v102, v12, v13
 v_mfma_f32_16x16x32_bf16 v[48:51], a[212:215], v[228:231], v[48:51]
 ds_read_b64_tr_b16 a[198:199], v97 offset:18432
 v_mfma_f32_16x16x32_bf16 v[52:55], a[216:219], v[196:199], v[52:55]
 ds_read_b64_tr_b16 a[200:201], v96 offset:16640
 v_mfma_f32_16x16x32_bf16 v[56:59], a[216:219], v[228:231], v[56:59]
 ds_read_b64_tr_b16 a[202:203], v96 offset:18688
 v_cvt_pk_bf16_f32 v103, v14, v15
 v_mfma_f32_16x16x32_bf16 v[60:63], a[220:223], v[196:199], v[60:63]
 ds_read_b64_tr_b16 a[204:205], v97 offset:16640
 ds_read_b64_tr_b16 a[206:207], v97 offset:18688
 v_mfma_f32_16x16x32_bf16 v[64:67], a[220:223], v[228:231], v[64:67]
 buffer_load_dwordx4 v138, s[56:59], s44 offen offset:2048 lds
 v_mfma_f32_16x16x32_bf16 v[36:39], a[224:227], v[200:203], v[36:39]
 ds_read_b64_tr_b16 a[208:209], v96 offset:20480
 buffer_load_dwordx4 v139, s[56:59], s44 offen offset:3072 lds
 v_mfma_f32_16x16x32_bf16 v[40:43], a[224:227], v[232:235], v[40:43]
 ds_read_b64_tr_b16 a[210:211], v96 offset:22528
 s_sub_u32 s44, s44, 28544
 v_mfma_f32_16x16x32_bf16 v[44:47], a[228:231], v[200:203], v[44:47]
 ds_read_b64_tr_b16 a[212:213], v97 offset:20480
 v_mfma_f32_16x16x32_bf16 v[48:51], a[228:231], v[232:235], v[48:51]
 ds_read_b64_tr_b16 a[214:215], v97 offset:22528
 s_waitcnt lgkmcnt(8)
 v_mfma_f32_16x16x32_bf16 v[52:55], a[232:235], v[200:203], v[52:55]
 ds_read_b64_tr_b16 a[216:217], v96 offset:20736
 v_mfma_f32_16x16x32_bf16 v[56:59], a[232:235], v[232:235], v[56:59]
 ds_read_b64_tr_b16 a[218:219], v96 offset:22784
 v_mfma_f32_16x16x32_bf16 v[60:63], a[236:239], v[200:203], v[60:63]
 ds_read_b64_tr_b16 a[220:221], v97 offset:20736
 ds_read_b64_tr_b16 a[222:223], v97 offset:22784
 v_mfma_f32_16x16x32_bf16 v[64:67], a[236:239], v[232:235], v[64:67]
 buffer_store_dwordx4 v[100:103], v2, s[4:7], s43 offen offset:0 sc1
 v_mfma_f32_16x16x32_bf16 v[36:39], a[240:243], v[204:207], v[36:39]
 ds_read_b64_tr_b16 a[224:225], v96 offset:24576
 v_cvt_pk_bf16_f32 v104, v20, v21
 v_mfma_f32_16x16x32_bf16 v[40:43], a[240:243], v[236:239], v[40:43]
 ds_read_b64_tr_b16 a[226:227], v96 offset:26624
 v_cvt_pk_bf16_f32 v105, v22, v23
 v_mfma_f32_16x16x32_bf16 v[44:47], a[244:247], v[204:207], v[44:47]
 ds_read_b64_tr_b16 a[228:229], v97 offset:24576
 v_cvt_pk_bf16_f32 v106, v28, v29
 v_mfma_f32_16x16x32_bf16 v[48:51], a[244:247], v[236:239], v[48:51]
 ds_read_b64_tr_b16 a[230:231], v97 offset:26624
 v_cvt_pk_bf16_f32 v107, v30, v31
 v_mfma_f32_16x16x32_bf16 v[52:55], a[248:251], v[204:207], v[52:55]
 ds_read_b64_tr_b16 a[232:233], v96 offset:24832
 v_mfma_f32_16x16x32_bf16 v[56:59], a[248:251], v[236:239], v[56:59]
 ds_read_b64_tr_b16 a[234:235], v96 offset:26880
 v_mfma_f32_16x16x32_bf16 v[60:63], a[252:255], v[204:207], v[60:63]
 ds_read_b64_tr_b16 a[236:237], v97 offset:24832
 ds_read_b64_tr_b16 a[238:239], v97 offset:26880
 v_mfma_f32_16x16x32_bf16 v[64:67], a[252:255], v[236:239], v[64:67]
 s_waitcnt vmcnt(25)
 s_barrier
 v_mfma_f32_16x16x32_bf16 v[36:39], a[192:195], v[208:211], v[36:39]
 ds_read_b64_tr_b16 a[240:241], v96 offset:28672
 v_mfma_f32_16x16x32_bf16 v[40:43], a[192:195], v[240:243], v[40:43]
 ds_read_b64_tr_b16 a[242:243], v96 offset:30720
 v_mfma_f32_16x16x32_bf16 v[44:47], a[196:199], v[208:211], v[44:47]
 ds_read_b64_tr_b16 a[244:245], v97 offset:28672
 s_add_u32 m0, s8, 0x8000
 v_mfma_f32_16x16x32_bf16 v[48:51], a[196:199], v[240:243], v[48:51]
 ds_read_b64_tr_b16 a[246:247], v97 offset:30720
 s_waitcnt lgkmcnt(8)
 v_mfma_f32_16x16x32_bf16 v[52:55], a[200:203], v[208:211], v[52:55]
 ds_read_b64_tr_b16 a[248:249], v96 offset:28928
 ds_read_b64_tr_b16 a[250:251], v96 offset:30976
 v_mfma_f32_16x16x32_bf16 v[56:59], a[200:203], v[240:243], v[56:59]
 buffer_store_dwordx4 v[104:107], v2, s[4:7], s43 offen offset:1024 sc1
 v_mfma_f32_16x16x32_bf16 v[60:63], a[204:207], v[208:211], v[60:63]
 ds_read_b64_tr_b16 a[252:253], v97 offset:28928
 v_cvt_pk_bf16_f32 v108, v8, v9
 v_mfma_f32_16x16x32_bf16 v[64:67], a[204:207], v[240:243], v[64:67]
 ds_read_b64_tr_b16 a[254:255], v97 offset:30976
 v_add_u32 v96, 0x18000, v166
 v_add_u32 v97, 0x18000, v167
 v_mfma_f32_16x16x32_bf16 v[36:39], a[208:211], v[212:215], v[36:39]
 ds_read_b64_tr_b16 a[192:193], v96 offset:0
 v_cvt_pk_bf16_f32 v109, v10, v11
 v_mfma_f32_16x16x32_bf16 v[40:43], a[208:211], v[244:247], v[40:43]
 ds_read_b64_tr_b16 a[194:195], v96 offset:2048
 v_cvt_pk_bf16_f32 v110, v16, v17
 v_mfma_f32_16x16x32_bf16 v[44:47], a[212:215], v[212:215], v[44:47]
 buffer_load_dwordx4 v140, s[48:51], s66 offen offset:0 lds
 v_mfma_f32_16x16x32_bf16 v[48:51], a[212:215], v[244:247], v[48:51]
 ds_read_b64_tr_b16 a[196:197], v97 offset:0
 ds_read_b64_tr_b16 a[198:199], v97 offset:2048
 v_mfma_f32_16x16x32_bf16 v[52:55], a[216:219], v[212:215], v[52:55]
 ds_read_b64_tr_b16 a[200:201], v96 offset:256
 v_cvt_pk_bf16_f32 v111, v18, v19
 v_mfma_f32_16x16x32_bf16 v[56:59], a[216:219], v[244:247], v[56:59]
 ds_read_b64_tr_b16 a[202:203], v96 offset:2304
 v_mfma_f32_16x16x32_bf16 v[60:63], a[220:223], v[212:215], v[60:63]
 ds_read_b64_tr_b16 a[204:205], v97 offset:256
 v_mfma_f32_16x16x32_bf16 v[64:67], a[220:223], v[244:247], v[64:67]
 ds_read_b64_tr_b16 a[206:207], v97 offset:2304
 v_mfma_f32_16x16x32_bf16 v[36:39], a[224:227], v[216:219], v[36:39]
 ds_read_b64_tr_b16 a[208:209], v96 offset:4096
 ds_read_b64_tr_b16 a[210:211], v96 offset:6144
 v_mfma_f32_16x16x32_bf16 v[40:43], a[224:227], v[248:251], v[40:43]
 buffer_load_dwordx4 v141, s[52:55], s66 offen offset:1024 lds
 v_mfma_f32_16x16x32_bf16 v[44:47], a[228:231], v[216:219], v[44:47]
 buffer_store_dwordx4 v[108:111], v2, s[4:7], s10 offen offset:0 sc1
 v_mfma_f32_16x16x32_bf16 v[48:51], a[228:231], v[248:251], v[48:51]
 ds_read_b64_tr_b16 a[212:213], v97 offset:4096
 ds_read_b64_tr_b16 a[214:215], v97 offset:6144
 s_waitcnt lgkmcnt(8)
 v_mfma_f32_16x16x32_bf16 v[52:55], a[232:235], v[216:219], v[52:55]
 ds_read_b64_tr_b16 a[216:217], v96 offset:4352
 v_cvt_pk_bf16_f32 v112, v24, v25
 v_mfma_f32_16x16x32_bf16 v[56:59], a[232:235], v[248:251], v[56:59]
 ds_read_b64_tr_b16 a[218:219], v96 offset:6400
 v_cvt_pk_bf16_f32 v113, v26, v27
 v_mfma_f32_16x16x32_bf16 v[60:63], a[236:239], v[216:219], v[60:63]
 ds_read_b64_tr_b16 a[220:221], v97 offset:4352
 v_cvt_pk_bf16_f32 v114, v32, v33
 v_mfma_f32_16x16x32_bf16 v[64:67], a[236:239], v[248:251], v[64:67]
 ds_read_b64_tr_b16 a[222:223], v97 offset:6400
 v_cvt_pk_bf16_f32 v115, v34, v35
 v_mfma_f32_16x16x32_bf16 v[36:39], a[240:243], v[220:223], v[36:39]
 buffer_load_dwordx4 v142, s[48:51], s66 offen offset:2048 lds
 v_mfma_f32_16x16x32_bf16 v[40:43], a[240:243], v[252:255], v[40:43]
 ds_read_b64_tr_b16 a[224:225], v96 offset:8192
 ds_read_b64_tr_b16 a[226:227], v96 offset:10240
 v_mfma_f32_16x16x32_bf16 v[44:47], a[244:247], v[220:223], v[44:47]
 ds_read_b64_tr_b16 a[228:229], v97 offset:8192
 buffer_load_dwordx4 v143, s[52:55], s66 offen offset:3072 lds
 v_mfma_f32_16x16x32_bf16 v[48:51], a[244:247], v[252:255], v[48:51]
 ds_read_b64_tr_b16 a[230:231], v97 offset:10240
 buffer_store_dwordx4 v[112:115], v2, s[4:7], s10 offen offset:1024 sc1
 v_mfma_f32_16x16x32_bf16 v[52:55], a[248:251], v[220:223], v[52:55]
 ds_read_b64_tr_b16 a[232:233], v96 offset:8448
 s_add_u32 s66, s66, 114688
 v_mfma_f32_16x16x32_bf16 v[56:59], a[248:251], v[252:255], v[56:59]
 ds_read_b64_tr_b16 a[234:235], v96 offset:10496
 v_mfma_f32_16x16x32_bf16 v[60:63], a[252:255], v[220:223], v[60:63]
 ds_read_b64_tr_b16 a[236:237], v97 offset:8448
 v_mfma_f32_16x16x32_bf16 v[64:67], a[252:255], v[252:255], v[64:67]
 ds_read_b64_tr_b16 a[238:239], v97 offset:10496
 v_mfma_f32_16x16x32_bf16 v[4:7], a[192:195], v[192:195], 0
 ds_read_b64_tr_b16 a[240:241], v96 offset:12288
 v_mfma_f32_16x16x32_bf16 v[8:11], a[192:195], v[224:227], 0
 ds_read_b64_tr_b16 a[242:243], v96 offset:14336
 v_mfma_f32_16x16x32_bf16 v[12:15], a[196:199], v[192:195], 0
 ds_read_b64_tr_b16 a[244:245], v97 offset:12288
 s_add_u32 m0, s8, 0xc000
 v_mfma_f32_16x16x32_bf16 v[16:19], a[196:199], v[224:227], 0
 ds_read_b64_tr_b16 a[246:247], v97 offset:14336
 s_waitcnt lgkmcnt(8)
 v_mfma_f32_16x16x32_bf16 v[20:23], a[200:203], v[192:195], 0
 ds_read_b64_tr_b16 a[248:249], v96 offset:12544
 v_mfma_f32_16x16x32_bf16 v[24:27], a[200:203], v[224:227], 0
 ds_read_b64_tr_b16 a[250:251], v96 offset:14592
 v_cvt_pk_bf16_f32 v100, v36, v37
 v_mfma_f32_16x16x32_bf16 v[28:31], a[204:207], v[192:195], 0
 ds_read_b64_tr_b16 a[252:253], v97 offset:12544
 v_mfma_f32_16x16x32_bf16 v[32:35], a[204:207], v[224:227], 0
 ds_read_b64_tr_b16 a[254:255], v97 offset:14592
 v_cvt_pk_bf16_f32 v101, v38, v39
 v_mfma_f32_16x16x32_bf16 v[4:7], a[208:211], v[196:199], v[4:7]
 ds_read_b64_tr_b16 a[192:193], v96 offset:16384
 v_mfma_f32_16x16x32_bf16 v[8:11], a[208:211], v[228:231], v[8:11]
 ds_read_b64_tr_b16 a[194:195], v96 offset:18432
 v_cvt_pk_bf16_f32 v102, v44, v45
 v_mfma_f32_16x16x32_bf16 v[12:15], a[212:215], v[196:199], v[12:15]
 buffer_load_dwordx4 v140, s[48:51], s66 offen offset:0 lds
 v_mfma_f32_16x16x32_bf16 v[16:19], a[212:215], v[228:231], v[16:19]
 ds_read_b64_tr_b16 a[196:197], v97 offset:16384
 ds_read_b64_tr_b16 a[198:199], v97 offset:18432
 v_mfma_f32_16x16x32_bf16 v[20:23], a[216:219], v[196:199], v[20:23]
 ds_read_b64_tr_b16 a[200:201], v96 offset:16640
 v_cvt_pk_bf16_f32 v103, v46, v47
 v_mfma_f32_16x16x32_bf16 v[24:27], a[216:219], v[228:231], v[24:27]
 ds_read_b64_tr_b16 a[202:203], v96 offset:18688
 v_mfma_f32_16x16x32_bf16 v[28:31], a[220:223], v[196:199], v[28:31]
 ds_read_b64_tr_b16 a[204:205], v97 offset:16640
 v_mfma_f32_16x16x32_bf16 v[32:35], a[220:223], v[228:231], v[32:35]
 ds_read_b64_tr_b16 a[206:207], v97 offset:18688
 v_mfma_f32_16x16x32_bf16 v[4:7], a[224:227], v[200:203], v[4:7]
 ds_read_b64_tr_b16 a[208:209], v96 offset:20480
 ds_read_b64_tr_b16 a[210:211], v96 offset:22528
 v_mfma_f32_16x16x32_bf16 v[8:11], a[224:227], v[232:235], v[8:11]
 buffer_load_dwordx4 v141, s[52:55], s66 offen offset:1024 lds
 v_mfma_f32_16x16x32_bf16 v[12:15], a[228:231], v[200:203], v[12:15]
 ds_read_b64_tr_b16 a[212:213], v97 offset:20480
 v_mfma_f32_16x16x32_bf16 v[16:19], a[228:231], v[232:235], v[16:19]
 ds_read_b64_tr_b16 a[214:215], v97 offset:22528
 s_waitcnt lgkmcnt(9)
 v_mfma_f32_16x16x32_bf16 v[20:23], a[232:235], v[200:203], v[20:23]
 ds_read_b64_tr_b16 a[216:217], v96 offset:20736
 v_mfma_f32_16x16x32_bf16 v[24:27], a[232:235], v[232:235], v[24:27]
 ds_read_b64_tr_b16 a[218:219], v96 offset:22784
 v_mfma_f32_16x16x32_bf16 v[28:31], a[236:239], v[200:203], v[28:31]
 buffer_store_dwordx4 v[100:103], v2, s[4:7], s43 offen offset:2048 sc1
 v_mfma_f32_16x16x32_bf16 v[32:35], a[236:239], v[232:235], v[32:35]
 ds_read_b64_tr_b16 a[220:221], v97 offset:20736
 ds_read_b64_tr_b16 a[222:223], v97 offset:22784
 v_mfma_f32_16x16x32_bf16 v[4:7], a[240:243], v[204:207], v[4:7]
 buffer_load_dwordx4 v142, s[48:51], s66 offen offset:2048 lds
 v_mfma_f32_16x16x32_bf16 v[8:11], a[240:243], v[236:239], v[8:11]
 ds_read_b64_tr_b16 a[224:225], v96 offset:24576
 v_cvt_pk_bf16_f32 v104, v52, v53
 ds_read_b64_tr_b16 a[226:227], v96 offset:26624
 v_mfma_f32_16x16x32_bf16 v[12:15], a[244:247], v[204:207], v[12:15]
 ds_read_b64_tr_b16 a[228:229], v97 offset:24576
 v_cvt_pk_bf16_f32 v105, v54, v55
 v_mfma_f32_16x16x32_bf16 v[16:19], a[244:247], v[236:239], v[16:19]
 ds_read_b64_tr_b16 a[230:231], v97 offset:26624
 v_cvt_pk_bf16_f32 v106, v60, v61
 v_mfma_f32_16x16x32_bf16 v[20:23], a[248:251], v[204:207], v[20:23]
 ds_read_b64_tr_b16 a[232:233], v96 offset:24832
 buffer_load_dwordx4 v143, s[52:55], s66 offen offset:3072 lds
 s_add_u32 s66, s66, 114688
 v_mfma_f32_16x16x32_bf16 v[24:27], a[248:251], v[236:239], v[24:27]
 ds_read_b64_tr_b16 a[234:235], v96 offset:26880
 v_cvt_pk_bf16_f32 v107, v62, v63
 v_mfma_f32_16x16x32_bf16 v[28:31], a[252:255], v[204:207], v[28:31]
 ds_read_b64_tr_b16 a[236:237], v97 offset:24832
 ds_read_b64_tr_b16 a[238:239], v97 offset:26880
 v_mfma_f32_16x16x32_bf16 v[32:35], a[252:255], v[236:239], v[32:35]
 s_waitcnt vmcnt(25)
 s_barrier
 v_mfma_f32_16x16x32_bf16 v[4:7], a[192:195], v[208:211], v[4:7]
 ds_read_b64_tr_b16 a[240:241], v96 offset:28672
 v_mfma_f32_16x16x32_bf16 v[8:11], a[192:195], v[240:243], v[8:11]
 ds_read_b64_tr_b16 a[242:243], v96 offset:30720
 s_add_u32 m0, s8, 0x10000
 s_waitcnt lgkmcnt(7)
 v_mfma_f32_16x16x32_bf16 v[12:15], a[196:199], v[208:211], v[12:15]
 ds_read_b64_tr_b16 a[244:245], v97 offset:28672
 ds_read_b64_tr_b16 a[246:247], v97 offset:30720
 v_mfma_f32_16x16x32_bf16 v[16:19], a[196:199], v[240:243], v[16:19]
 buffer_store_dwordx4 v[104:107], v2, s[4:7], s43 offen offset:3072 sc1
 v_mfma_f32_16x16x32_bf16 v[20:23], a[200:203], v[208:211], v[20:23]
 ds_read_b64_tr_b16 a[248:249], v96 offset:28928
 v_cvt_pk_bf16_f32 v108, v40, v41
 v_mfma_f32_16x16x32_bf16 v[24:27], a[200:203], v[240:243], v[24:27]
 ds_read_b64_tr_b16 a[250:251], v96 offset:30976
 v_cvt_pk_bf16_f32 v109, v42, v43
 v_mfma_f32_16x16x32_bf16 v[28:31], a[204:207], v[208:211], v[28:31]
 ds_read_b64_tr_b16 a[252:253], v97 offset:28928
 v_cvt_pk_bf16_f32 v110, v48, v49
 v_mfma_f32_16x16x32_bf16 v[32:35], a[204:207], v[240:243], v[32:35]
 ds_read_b64_tr_b16 a[254:255], v97 offset:30976
 v_add_u32 v96, 0x20000, v166
 v_add_u32 v97, 0x20000, v167
 v_mfma_f32_16x16x32_bf16 v[4:7], a[208:211], v[212:215], v[4:7]
 ds_read_b64_tr_b16 a[192:193], v96 offset:0
 v_cvt_pk_bf16_f32 v111, v50, v51
 v_mfma_f32_16x16x32_bf16 v[8:11], a[208:211], v[244:247], v[8:11]
 ds_read_b64_tr_b16 a[194:195], v96 offset:2048
 v_mfma_f32_16x16x32_bf16 v[12:15], a[212:215], v[212:215], v[12:15]
 buffer_load_dwordx4 v140, s[48:51], s66 offen offset:0 lds
 v_mfma_f32_16x16x32_bf16 v[16:19], a[212:215], v[244:247], v[16:19]
 ds_read_b64_tr_b16 a[196:197], v97 offset:0
 ds_read_b64_tr_b16 a[198:199], v97 offset:2048
 v_mfma_f32_16x16x32_bf16 v[20:23], a[216:219], v[212:215], v[20:23]
 ds_read_b64_tr_b16 a[200:201], v96 offset:256
 v_mfma_f32_16x16x32_bf16 v[24:27], a[216:219], v[244:247], v[24:27]
 ds_read_b64_tr_b16 a[202:203], v96 offset:2304
 v_mfma_f32_16x16x32_bf16 v[28:31], a[220:223], v[212:215], v[28:31]
 ds_read_b64_tr_b16 a[204:205], v97 offset:256
 ds_read_b64_tr_b16 a[206:207], v97 offset:2304
 v_mfma_f32_16x16x32_bf16 v[32:35], a[220:223], v[244:247], v[32:35]
 buffer_store_dwordx4 v[108:111], v2, s[4:7], s10 offen offset:2048 sc1
 v_mfma_f32_16x16x32_bf16 v[4:7], a[224:227], v[216:219], v[4:7]
 ds_read_b64_tr_b16 a[208:209], v96 offset:4096
 v_cvt_pk_bf16_f32 v112, v56, v57
 v_mfma_f32_16x16x32_bf16 v[8:11], a[224:227], v[248:251], v[8:11]
 buffer_load_dwordx4 v141, s[52:55], s66 offen offset:1024 lds
 ds_read_b64_tr_b16 a[210:211], v96 offset:6144
 s_waitcnt lgkmcnt(8)
 v_mfma_f32_16x16x32_bf16 v[12:15], a[228:231], v[216:219], v[12:15]
 ds_read_b64_tr_b16 a[212:213], v97 offset:4096
 v_cvt_pk_bf16_f32 v113, v58, v59
 v_mfma_f32_16x16x32_bf16 v[16:19], a[228:231], v[248:251], v[16:19]
 ds_read_b64_tr_b16 a[214:215], v97 offset:6144
 v_cvt_pk_bf16_f32 v114, v64, v65
 v_mfma_f32_16x16x32_bf16 v[20:23], a[232:235], v[216:219], v[20:23]
 ds_read_b64_tr_b16 a[216:217], v96 offset:4352
 v_cvt_pk_bf16_f32 v115, v66, v67
 v_mfma_f32_16x16x32_bf16 v[24:27], a[232:235], v[248:251], v[24:27]
 ds_read_b64_tr_b16 a[218:219], v96 offset:6400
 v_mfma_f32_16x16x32_bf16 v[28:31], a[236:239], v[216:219], v[28:31]
 ds_read_b64_tr_b16 a[220:221], v97 offset:4352
 v_mfma_f32_16x16x32_bf16 v[32:35], a[236:239], v[248:251], v[32:35]
 ds_read_b64_tr_b16 a[222:223], v97 offset:6400
 v_mfma_f32_16x16x32_bf16 v[4:7], a[240:243], v[220:223], v[4:7]
 buffer_load_dwordx4 v142, s[48:51], s66 offen offset:2048 lds
 v_mfma_f32_16x16x32_bf16 v[8:11], a[240:243], v[252:255], v[8:11]
 ds_read_b64_tr_b16 a[224:225], v96 offset:8192
 ds_read_b64_tr_b16 a[226:227], v96 offset:10240
 v_mfma_f32_16x16x32_bf16 v[12:15], a[244:247], v[220:223], v[12:15]
 ds_read_b64_tr_b16 a[228:229], v97 offset:8192
 ds_read_b64_tr_b16 a[230:231], v97 offset:10240
 v_mfma_f32_16x16x32_bf16 v[16:19], a[244:247], v[252:255], v[16:19]
 buffer_store_dwordx4 v[112:115], v2, s[4:7], s10 offen offset:3072 sc1
 v_mfma_f32_16x16x32_bf16 v[20:23], a[248:251], v[220:223], v[20:23]
 ds_read_b64_tr_b16 a[232:233], v96 offset:8448
 s_add_u32 s43, s43, 0x1000
 v_mfma_f32_16x16x32_bf16 v[24:27], a[248:251], v[252:255], v[24:27]
 ds_read_b64_tr_b16 a[234:235], v96 offset:10496
 buffer_load_dwordx4 v143, s[52:55], s66 offen offset:3072 lds
 s_add_u32 s66, s66, 114688
 v_mfma_f32_16x16x32_bf16 v[28:31], a[252:255], v[220:223], v[28:31]
 ds_read_b64_tr_b16 a[236:237], v97 offset:8448
 s_add_u32 s10, s10, 0x1000
 v_mfma_f32_16x16x32_bf16 v[32:35], a[252:255], v[252:255], v[32:35]
 ds_read_b64_tr_b16 a[238:239], v97 offset:10496
 v_mfma_f32_16x16x32_bf16 v[36:39], a[192:195], v[192:195], 0
 ds_read_b64_tr_b16 a[240:241], v96 offset:12288
 v_mfma_f32_16x16x32_bf16 v[40:43], a[192:195], v[224:227], 0
 ds_read_b64_tr_b16 a[242:243], v96 offset:14336
 s_waitcnt lgkmcnt(7)
 v_mfma_f32_16x16x32_bf16 v[44:47], a[196:199], v[192:195], 0
 ds_read_b64_tr_b16 a[244:245], v97 offset:12288
 s_add_u32 m0, s8, 0x14000
 v_mfma_f32_16x16x32_bf16 v[48:51], a[196:199], v[224:227], 0
 ds_read_b64_tr_b16 a[246:247], v97 offset:14336
 v_mfma_f32_16x16x32_bf16 v[52:55], a[200:203], v[192:195], 0
 ds_read_b64_tr_b16 a[248:249], v96 offset:12544
 v_mfma_f32_16x16x32_bf16 v[56:59], a[200:203], v[224:227], 0
 ds_read_b64_tr_b16 a[250:251], v96 offset:14592
 v_cvt_pk_bf16_f32 v100, v4, v5
 v_mfma_f32_16x16x32_bf16 v[60:63], a[204:207], v[192:195], 0
 ds_read_b64_tr_b16 a[252:253], v97 offset:12544
 v_mfma_f32_16x16x32_bf16 v[64:67], a[204:207], v[224:227], 0
 ds_read_b64_tr_b16 a[254:255], v97 offset:14592
 v_mfma_f32_16x16x32_bf16 v[36:39], a[208:211], v[196:199], v[36:39]
 ds_read_b64_tr_b16 a[192:193], v96 offset:16384
 v_cvt_pk_bf16_f32 v101, v6, v7
 v_mfma_f32_16x16x32_bf16 v[40:43], a[208:211], v[228:231], v[40:43]
 ds_read_b64_tr_b16 a[194:195], v96 offset:18432
 v_cvt_pk_bf16_f32 v102, v12, v13
 v_mfma_f32_16x16x32_bf16 v[44:47], a[212:215], v[196:199], v[44:47]
 buffer_load_dwordx4 v140, s[48:51], s66 offen offset:0 lds
 v_mfma_f32_16x16x32_bf16 v[48:51], a[212:215], v[228:231], v[48:51]
 ds_read_b64_tr_b16 a[196:197], v97 offset:16384
 ds_read_b64_tr_b16 a[198:199], v97 offset:18432
 v_mfma_f32_16x16x32_bf16 v[52:55], a[216:219], v[196:199], v[52:55]
 ds_read_b64_tr_b16 a[200:201], v96 offset:16640
 v_mfma_f32_16x16x32_bf16 v[56:59], a[216:219], v[228:231], v[56:59]
 ds_read_b64_tr_b16 a[202:203], v96 offset:18688
 v_cvt_pk_bf16_f32 v103, v14, v15
 v_mfma_f32_16x16x32_bf16 v[60:63], a[220:223], v[196:199], v[60:63]
 ds_read_b64_tr_b16 a[204:205], v97 offset:16640
 v_mfma_f32_16x16x32_bf16 v[64:67], a[220:223], v[228:231], v[64:67]
 ds_read_b64_tr_b16 a[206:207], v97 offset:18688
 v_mfma_f32_16x16x32_bf16 v[36:39], a[224:227], v[200:203], v[36:39]
 ds_read_b64_tr_b16 a[208:209], v96 offset:20480
 ds_read_b64_tr_b16 a[210:211], v96 offset:22528
 v_mfma_f32_16x16x32_bf16 v[40:43], a[224:227], v[232:235], v[40:43]
 buffer_load_dwordx4 v141, s[52:55], s66 offen offset:1024 lds
 s_waitcnt lgkmcnt(8)
 v_mfma_f32_16x16x32_bf16 v[44:47], a[228:231], v[200:203], v[44:47]
 ds_read_b64_tr_b16 a[212:213], v97 offset:20480
 v_mfma_f32_16x16x32_bf16 v[48:51], a[228:231], v[232:235], v[48:51]
 ds_read_b64_tr_b16 a[214:215], v97 offset:22528
 v_mfma_f32_16x16x32_bf16 v[52:55], a[232:235], v[200:203], v[52:55]
 ds_read_b64_tr_b16 a[216:217], v96 offset:20736
 v_mfma_f32_16x16x32_bf16 v[56:59], a[232:235], v[232:235], v[56:59]
 ds_read_b64_tr_b16 a[218:219], v96 offset:22784
 v_mfma_f32_16x16x32_bf16 v[60:63], a[236:239], v[200:203], v[60:63]
 ds_read_b64_tr_b16 a[220:221], v97 offset:20736
 ds_read_b64_tr_b16 a[222:223], v97 offset:22784
 v_mfma_f32_16x16x32_bf16 v[64:67], a[236:239], v[232:235], v[64:67]
 buffer_store_dwordx4 v[100:103], v2, s[4:7], s43 offen offset:0 sc1
 v_mfma_f32_16x16x32_bf16 v[36:39], a[240:243], v[204:207], v[36:39]
 buffer_load_dwordx4 v142, s[48:51], s66 offen offset:2048 lds
 v_mfma_f32_16x16x32_bf16 v[40:43], a[240:243], v[236:239], v[40:43]
 ds_read_b64_tr_b16 a[224:225], v96 offset:24576
 ds_read_b64_tr_b16 a[226:227], v96 offset:26624
 v_mfma_f32_16x16x32_bf16 v[44:47], a[244:247], v[204:207], v[44:47]
 v_cvt_pk_bf16_f32 v104, v20, v21
 ds_read_b64_tr_b16 a[228:229], v97 offset:24576
 v_mfma_f32_16x16x32_bf16 v[48:51], a[244:247], v[236:239], v[48:51]
 ds_read_b64_tr_b16 a[230:231], v97 offset:26624
 v_cvt_pk_bf16_f32 v105, v22, v23
 v_mfma_f32_16x16x32_bf16 v[52:55], a[248:251], v[204:207], v[52:55]
 ds_read_b64_tr_b16 a[232:233], v96 offset:24832
 buffer_load_dwordx4 v143, s[52:55], s66 offen offset:3072 lds
 s_add_u32 s66, s66, 114688
 v_mfma_f32_16x16x32_bf16 v[56:59], a[248:251], v[236:239], v[56:59]
 ds_read_b64_tr_b16 a[234:235], v96 offset:26880
 v_cvt_pk_bf16_f32 v106, v28, v29
 v_mfma_f32_16x16x32_bf16 v[60:63], a[252:255], v[204:207], v[60:63]
 ds_read_b64_tr_b16 a[236:237], v97 offset:24832
 ds_read_b64_tr_b16 a[238:239], v97 offset:26880
 v_mfma_f32_16x16x32_bf16 v[64:67], a[252:255], v[236:239], v[64:67]
 s_waitcnt vmcnt(25)
 s_barrier
 v_mfma_f32_16x16x32_bf16 v[36:39], a[192:195], v[208:211], v[36:39]
 ds_read_b64_tr_b16 a[240:241], v96 offset:28672
 v_cvt_pk_bf16_f32 v107, v30, v31
 v_mfma_f32_16x16x32_bf16 v[40:43], a[192:195], v[240:243], v[40:43]
 ds_read_b64_tr_b16 a[242:243], v96 offset:30720
 s_waitcnt lgkmcnt(7)
 v_mfma_f32_16x16x32_bf16 v[44:47], a[196:199], v[208:211], v[44:47]
 ds_read_b64_tr_b16 a[244:245], v97 offset:28672
 s_add_u32 m0, s8, 0x18000
 v_mfma_f32_16x16x32_bf16 v[48:51], a[196:199], v[240:243], v[48:51]
 ds_read_b64_tr_b16 a[246:247], v97 offset:30720
 v_mfma_f32_16x16x32_bf16 v[52:55], a[200:203], v[208:211], v[52:55]
 ds_read_b64_tr_b16 a[248:249], v96 offset:28928
 ds_read_b64_tr_b16 a[250:251], v96 offset:30976
 v_mfma_f32_16x16x32_bf16 v[56:59], a[200:203], v[240:243], v[56:59]
 buffer_store_dwordx4 v[104:107], v2, s[4:7], s43 offen offset:1024 sc1
 v_mfma_f32_16x16x32_bf16 v[60:63], a[204:207], v[208:211], v[60:63]
 ds_read_b64_tr_b16 a[252:253], v97 offset:28928
 v_cvt_pk_bf16_f32 v108, v8, v9
 v_mfma_f32_16x16x32_bf16 v[64:67], a[204:207], v[240:243], v[64:67]
 ds_read_b64_tr_b16 a[254:255], v97 offset:30976
 v_add_u32 v96, 0x0, v166
 v_add_u32 v97, 0x0, v167
 v_mfma_f32_16x16x32_bf16 v[36:39], a[208:211], v[212:215], v[36:39]
 ds_read_b64_tr_b16 a[192:193], v96 offset:0
 v_cvt_pk_bf16_f32 v109, v10, v11
 v_mfma_f32_16x16x32_bf16 v[40:43], a[208:211], v[244:247], v[40:43]
 ds_read_b64_tr_b16 a[194:195], v96 offset:2048
 v_cvt_pk_bf16_f32 v110, v16, v17
 v_mfma_f32_16x16x32_bf16 v[44:47], a[212:215], v[212:215], v[44:47]
 buffer_load_dwordx4 v140, s[48:51], s66 offen offset:0 lds
 v_mfma_f32_16x16x32_bf16 v[48:51], a[212:215], v[244:247], v[48:51]
 ds_read_b64_tr_b16 a[196:197], v97 offset:0
 ds_read_b64_tr_b16 a[198:199], v97 offset:2048
 v_mfma_f32_16x16x32_bf16 v[52:55], a[216:219], v[212:215], v[52:55]
 ds_read_b64_tr_b16 a[200:201], v96 offset:256
 v_cvt_pk_bf16_f32 v111, v18, v19
 v_mfma_f32_16x16x32_bf16 v[56:59], a[216:219], v[244:247], v[56:59]
 ds_read_b64_tr_b16 a[202:203], v96 offset:2304
 v_mfma_f32_16x16x32_bf16 v[60:63], a[220:223], v[212:215], v[60:63]
 ds_read_b64_tr_b16 a[204:205], v97 offset:256
 v_mfma_f32_16x16x32_bf16 v[64:67], a[220:223], v[244:247], v[64:67]
 ds_read_b64_tr_b16 a[206:207], v97 offset:2304
 v_mfma_f32_16x16x32_bf16 v[36:39], a[224:227], v[216:219], v[36:39]
 ds_read_b64_tr_b16 a[208:209], v96 offset:4096
 ds_read_b64_tr_b16 a[210:211], v96 offset:6144
 v_mfma_f32_16x16x32_bf16 v[40:43], a[224:227], v[248:251], v[40:43]
 buffer_load_dwordx4 v141, s[52:55], s66 offen offset:1024 lds
 s_waitcnt lgkmcnt(8)
 v_mfma_f32_16x16x32_bf16 v[44:47], a[228:231], v[216:219], v[44:47]
 buffer_store_dwordx4 v[108:111], v2, s[4:7], s10 offen offset:0 sc1
 v_mfma_f32_16x16x32_bf16 v[48:51], a[228:231], v[248:251], v[48:51]
 ds_read_b64_tr_b16 a[212:213], v97 offset:4096
 ds_read_b64_tr_b16 a[214:215], v97 offset:6144
 v_mfma_f32_16x16x32_bf16 v[52:55], a[232:235], v[216:219], v[52:55]
 ds_read_b64_tr_b16 a[216:217], v96 offset:4352
 v_cvt_pk_bf16_f32 v112, v24, v25
 v_mfma_f32_16x16x32_bf16 v[56:59], a[232:235], v[248:251], v[56:59]
 ds_read_b64_tr_b16 a[218:219], v96 offset:6400
 v_cvt_pk_bf16_f32 v113, v26, v27
 v_mfma_f32_16x16x32_bf16 v[60:63], a[236:239], v[216:219], v[60:63]
 ds_read_b64_tr_b16 a[220:221], v97 offset:4352
 v_cvt_pk_bf16_f32 v114, v32, v33
 v_mfma_f32_16x16x32_bf16 v[64:67], a[236:239], v[248:251], v[64:67]
 ds_read_b64_tr_b16 a[222:223], v97 offset:6400
 v_cvt_pk_bf16_f32 v115, v34, v35
 v_mfma_f32_16x16x32_bf16 v[36:39], a[240:243], v[220:223], v[36:39]
 buffer_load_dwordx4 v142, s[48:51], s66 offen offset:2048 lds
 v_mfma_f32_16x16x32_bf16 v[40:43], a[240:243], v[252:255], v[40:43]
 ds_read_b64_tr_b16 a[224:225], v96 offset:8192
 ds_read_b64_tr_b16 a[226:227], v96 offset:10240
 v_mfma_f32_16x16x32_bf16 v[44:47], a[244:247], v[220:223], v[44:47]
 ds_read_b64_tr_b16 a[228:229], v97 offset:8192
 buffer_load_dwordx4 v143, s[52:55], s66 offen offset:3072 lds
 v_mfma_f32_16x16x32_bf16 v[48:51], a[244:247], v[252:255], v[48:51]
 ds_read_b64_tr_b16 a[230:231], v97 offset:10240
 buffer_store_dwordx4 v[112:115], v2, s[4:7], s10 offen offset:1024 sc1
 v_mfma_f32_16x16x32_bf16 v[52:55], a[248:251], v[220:223], v[52:55]
 ds_read_b64_tr_b16 a[232:233], v96 offset:8448
 s_add_u32 s66, s66, 114688
 v_mfma_f32_16x16x32_bf16 v[56:59], a[248:251], v[252:255], v[56:59]
 ds_read_b64_tr_b16 a[234:235], v96 offset:10496
 v_mfma_f32_16x16x32_bf16 v[60:63], a[252:255], v[220:223], v[60:63]
 ds_read_b64_tr_b16 a[236:237], v97 offset:8448
 v_mfma_f32_16x16x32_bf16 v[64:67], a[252:255], v[252:255], v[64:67]
 ds_read_b64_tr_b16 a[238:239], v97 offset:10496
 v_mfma_f32_16x16x32_bf16 v[4:7], a[192:195], v[192:195], 0
 ds_read_b64_tr_b16 a[240:241], v96 offset:12288
 v_mfma_f32_16x16x32_bf16 v[8:11], a[192:195], v[224:227], 0
 ds_read_b64_tr_b16 a[242:243], v96 offset:14336
 s_waitcnt lgkmcnt(8)
 v_mfma_f32_16x16x32_bf16 v[12:15], a[196:199], v[192:195], 0
 ds_read_b64_tr_b16 a[244:245], v97 offset:12288
 s_add_u32 m0, s8, 0x1c000
 v_mfma_f32_16x16x32_bf16 v[16:19], a[196:199], v[224:227], 0
 ds_read_b64_tr_b16 a[246:247], v97 offset:14336
 v_mfma_f32_16x16x32_bf16 v[20:23], a[200:203], v[192:195], 0
 ds_read_b64_tr_b16 a[248:249], v96 offset:12544
 v_mfma_f32_16x16x32_bf16 v[24:27], a[200:203], v[224:227], 0
 ds_read_b64_tr_b16 a[250:251], v96 offset:14592
 v_cvt_pk_bf16_f32 v100, v36, v37
 v_mfma_f32_16x16x32_bf16 v[28:31], a[204:207], v[192:195], 0
 ds_read_b64_tr_b16 a[252:253], v97 offset:12544
 v_mfma_f32_16x16x32_bf16 v[32:35], a[204:207], v[224:227], 0
 ds_read_b64_tr_b16 a[254:255], v97 offset:14592
 v_cvt_pk_bf16_f32 v101, v38, v39
 v_mfma_f32_16x16x32_bf16 v[4:7], a[208:211], v[196:199], v[4:7]
 ds_read_b64_tr_b16 a[192:193], v96 offset:16384
 v_mfma_f32_16x16x32_bf16 v[8:11], a[208:211], v[228:231], v[8:11]
 ds_read_b64_tr_b16 a[194:195], v96 offset:18432
 v_cvt_pk_bf16_f32 v102, v44, v45
 v_mfma_f32_16x16x32_bf16 v[12:15], a[212:215], v[196:199], v[12:15]
 buffer_load_dwordx4 v140, s[48:51], s66 offen offset:0 lds
 v_mfma_f32_16x16x32_bf16 v[16:19], a[212:215], v[228:231], v[16:19]
 ds_read_b64_tr_b16 a[196:197], v97 offset:16384
 ds_read_b64_tr_b16 a[198:199], v97 offset:18432
 v_mfma_f32_16x16x32_bf16 v[20:23], a[216:219], v[196:199], v[20:23]
 ds_read_b64_tr_b16 a[200:201], v96 offset:16640
 v_cvt_pk_bf16_f32 v103, v46, v47
 v_mfma_f32_16x16x32_bf16 v[24:27], a[216:219], v[228:231], v[24:27]
 ds_read_b64_tr_b16 a[202:203], v96 offset:18688
 v_mfma_f32_16x16x32_bf16 v[28:31], a[220:223], v[196:199], v[28:31]
 ds_read_b64_tr_b16 a[204:205], v97 offset:16640
 v_mfma_f32_16x16x32_bf16 v[32:35], a[220:223], v[228:231], v[32:35]
 ds_read_b64_tr_b16 a[206:207], v97 offset:18688
 v_mfma_f32_16x16x32_bf16 v[4:7], a[224:227], v[200:203], v[4:7]
 ds_read_b64_tr_b16 a[208:209], v96 offset:20480
 ds_read_b64_tr_b16 a[210:211], v96 offset:22528
 v_mfma_f32_16x16x32_bf16 v[8:11], a[224:227], v[232:235], v[8:11]
 buffer_load_dwordx4 v141, s[52:55], s66 offen offset:1024 lds
 s_waitcnt lgkmcnt(8)
 v_mfma_f32_16x16x32_bf16 v[12:15], a[228:231], v[200:203], v[12:15]
 ds_read_b64_tr_b16 a[212:213], v97 offset:20480
 v_mfma_f32_16x16x32_bf16 v[16:19], a[228:231], v[232:235], v[16:19]
 ds_read_b64_tr_b16 a[214:215], v97 offset:22528
 v_mfma_f32_16x16x32_bf16 v[20:23], a[232:235], v[200:203], v[20:23]
 ds_read_b64_tr_b16 a[216:217], v96 offset:20736
 v_mfma_f32_16x16x32_bf16 v[24:27], a[232:235], v[232:235], v[24:27]
 ds_read_b64_tr_b16 a[218:219], v96 offset:22784
 v_mfma_f32_16x16x32_bf16 v[28:31], a[236:239], v[200:203], v[28:31]
 buffer_store_dwordx4 v[100:103], v2, s[4:7], s43 offen offset:2048 sc1
 v_mfma_f32_16x16x32_bf16 v[32:35], a[236:239], v[232:235], v[32:35]
 ds_read_b64_tr_b16 a[220:221], v97 offset:20736
 ds_read_b64_tr_b16 a[222:223], v97 offset:22784
 v_mfma_f32_16x16x32_bf16 v[4:7], a[240:243], v[204:207], v[4:7]
 buffer_load_dwordx4 v142, s[48:51], s66 offen offset:2048 lds
 v_mfma_f32_16x16x32_bf16 v[8:11], a[240:243], v[236:239], v[8:11]
 ds_read_b64_tr_b16 a[224:225], v96 offset:24576
 v_cvt_pk_bf16_f32 v104, v52, v53
 ds_read_b64_tr_b16 a[226:227], v96 offset:26624
 v_mfma_f32_16x16x32_bf16 v[12:15], a[244:247], v[204:207], v[12:15]
 ds_read_b64_tr_b16 a[228:229], v97 offset:24576
 v_cvt_pk_bf16_f32 v105, v54, v55
 v_mfma_f32_16x16x32_bf16 v[16:19], a[244:247], v[236:239], v[16:19]
 ds_read_b64_tr_b16 a[230:231], v97 offset:26624
 v_cvt_pk_bf16_f32 v106, v60, v61
 v_mfma_f32_16x16x32_bf16 v[20:23], a[248:251], v[204:207], v[20:23]
 ds_read_b64_tr_b16 a[232:233], v96 offset:24832
 buffer_load_dwordx4 v143, s[52:55], s66 offen offset:3072 lds
 v_mfma_f32_16x16x32_bf16 v[24:27], a[248:251], v[236:239], v[24:27]
 ds_read_b64_tr_b16 a[234:235], v96 offset:26880
 v_cvt_pk_bf16_f32 v107, v62, v63
 v_mfma_f32_16x16x32_bf16 v[28:31], a[252:255], v[204:207], v[28:31]
 ds_read_b64_tr_b16 a[236:237], v97 offset:24832
 s_add_u32 s66, s66, 114688
 v_mfma_f32_16x16x32_bf16 v[32:35], a[252:255], v[236:239], v[32:35]
 ds_read_b64_tr_b16 a[238:239], v97 offset:26880
 v_mfma_f32_16x16x32_bf16 v[4:7], a[192:195], v[208:211], v[4:7]
 ds_read_b64_tr_b16 a[240:241], v96 offset:28672
 v_mfma_f32_16x16x32_bf16 v[8:11], a[192:195], v[240:243], v[8:11]
 ds_read_b64_tr_b16 a[242:243], v96 offset:30720
 s_waitcnt lgkmcnt(7)
 v_mfma_f32_16x16x32_bf16 v[12:15], a[196:199], v[208:211], v[12:15]
 ds_read_b64_tr_b16 a[244:245], v97 offset:28672
 ds_read_b64_tr_b16 a[246:247], v97 offset:30720
 v_mfma_f32_16x16x32_bf16 v[16:19], a[196:199], v[240:243], v[16:19]
 buffer_store_dwordx4 v[104:107], v2, s[4:7], s43 offen offset:3072 sc1
 v_mfma_f32_16x16x32_bf16 v[20:23], a[200:203], v[208:211], v[20:23]
 ds_read_b64_tr_b16 a[248:249], v96 offset:28928
 v_cvt_pk_bf16_f32 v108, v40, v41
 v_mfma_f32_16x16x32_bf16 v[24:27], a[200:203], v[240:243], v[24:27]
 ds_read_b64_tr_b16 a[250:251], v96 offset:30976
 v_cvt_pk_bf16_f32 v109, v42, v43
 v_mfma_f32_16x16x32_bf16 v[28:31], a[204:207], v[208:211], v[28:31]
 ds_read_b64_tr_b16 a[252:253], v97 offset:28928
 v_cvt_pk_bf16_f32 v110, v48, v49
 v_mfma_f32_16x16x32_bf16 v[32:35], a[204:207], v[240:243], v[32:35]
 ds_read_b64_tr_b16 a[254:255], v97 offset:30976
 v_cvt_pk_bf16_f32 v111, v50, v51
 v_mfma_f32_16x16x32_bf16 v[4:7], a[208:211], v[212:215], v[4:7]
 buffer_store_dwordx4 v[108:111], v2, s[4:7], s10 offen offset:2048 sc1
 v_mfma_f32_16x16x32_bf16 v[8:11], a[208:211], v[244:247], v[8:11]
 v_mfma_f32_16x16x32_bf16 v[12:15], a[212:215], v[212:215], v[12:15]
 v_cvt_pk_bf16_f32 v112, v56, v57
 v_mfma_f32_16x16x32_bf16 v[16:19], a[212:215], v[244:247], v[16:19]
 v_mfma_f32_16x16x32_bf16 v[20:23], a[216:219], v[212:215], v[20:23]
 v_cvt_pk_bf16_f32 v113, v58, v59
 v_mfma_f32_16x16x32_bf16 v[24:27], a[216:219], v[244:247], v[24:27]
 v_mfma_f32_16x16x32_bf16 v[28:31], a[220:223], v[212:215], v[28:31]
 v_mfma_f32_16x16x32_bf16 v[32:35], a[220:223], v[244:247], v[32:35]
 v_cvt_pk_bf16_f32 v114, v64, v65
 v_mfma_f32_16x16x32_bf16 v[4:7], a[224:227], v[216:219], v[4:7]
 v_mfma_f32_16x16x32_bf16 v[8:11], a[224:227], v[248:251], v[8:11]
 v_cvt_pk_bf16_f32 v115, v66, v67
 s_waitcnt lgkmcnt(1)
 v_mfma_f32_16x16x32_bf16 v[12:15], a[228:231], v[216:219], v[12:15]
 v_mfma_f32_16x16x32_bf16 v[16:19], a[228:231], v[248:251], v[16:19]
 v_mfma_f32_16x16x32_bf16 v[20:23], a[232:235], v[216:219], v[20:23]
 buffer_store_dwordx4 v[112:115], v2, s[4:7], s10 offen offset:3072 sc1
 v_mfma_f32_16x16x32_bf16 v[24:27], a[232:235], v[248:251], v[24:27]
 v_mfma_f32_16x16x32_bf16 v[28:31], a[236:239], v[216:219], v[28:31]
 s_add_u32 s43, s43, 0x1000
 v_mfma_f32_16x16x32_bf16 v[32:35], a[236:239], v[248:251], v[32:35]
 v_mfma_f32_16x16x32_bf16 v[4:7], a[240:243], v[220:223], v[4:7]
 v_mfma_f32_16x16x32_bf16 v[8:11], a[240:243], v[252:255], v[8:11]
 s_add_u32 s10, s10, 0x1000
 v_mfma_f32_16x16x32_bf16 v[12:15], a[244:247], v[220:223], v[12:15]
 v_mfma_f32_16x16x32_bf16 v[16:19], a[244:247], v[252:255], v[16:19]
 v_mfma_f32_16x16x32_bf16 v[20:23], a[248:251], v[220:223], v[20:23]
 v_mfma_f32_16x16x32_bf16 v[24:27], a[248:251], v[252:255], v[24:27]
 s_waitcnt lgkmcnt(0)
 v_mfma_f32_16x16x32_bf16 v[28:31], a[252:255], v[220:223], v[28:31]
 v_mfma_f32_16x16x32_bf16 v[32:35], a[252:255], v[252:255], v[32:35]
 s_nop 7
 v_cvt_pk_bf16_f32 v100, v4, v5
 v_cvt_pk_bf16_f32 v101, v6, v7
 v_cvt_pk_bf16_f32 v102, v12, v13
 v_cvt_pk_bf16_f32 v103, v14, v15
 buffer_store_dwordx4 v[100:103], v2, s[4:7], s43 offen offset:0 sc1
 v_cvt_pk_bf16_f32 v104, v20, v21
 v_cvt_pk_bf16_f32 v105, v22, v23
 v_cvt_pk_bf16_f32 v106, v28, v29
 v_cvt_pk_bf16_f32 v107, v30, v31
 buffer_store_dwordx4 v[104:107], v2, s[4:7], s43 offen offset:1024 sc1
 v_cvt_pk_bf16_f32 v108, v8, v9
 v_cvt_pk_bf16_f32 v109, v10, v11
 v_cvt_pk_bf16_f32 v110, v16, v17
 v_cvt_pk_bf16_f32 v111, v18, v19
 buffer_store_dwordx4 v[108:111], v2, s[4:7], s10 offen offset:0 sc1
 v_cvt_pk_bf16_f32 v112, v24, v25
 v_cvt_pk_bf16_f32 v113, v26, v27
 v_cvt_pk_bf16_f32 v114, v32, v33
 v_cvt_pk_bf16_f32 v115, v34, v35
 buffer_store_dwordx4 v[112:115], v2, s[4:7], s10 offen offset:1024 sc1
 v_mov_b32 v116, 1
 v_and_b32 v117, 31, v1
 v_lshlrev_b32 v117, 2, v117
 s_waitcnt vmcnt(0)
 s_barrier
 buffer_store_dword v116, v117, s[4:7], s30 offen sc1
 s_load_dwordx2 s[12:13], s[0:1], 0
 v_and_b32 v212, 7, v1
 v_bfe_u32 v213, v1, 3, 1
 v_lshrrev_b32 v214, 5, v1
 v_lshl_add_u32 v213, v214, 1, v213
 v_bfe_u32 v214, v1, 4, 1
 v_and_b32 v215, 15, v1
 v_lshlrev_b32 v216, 3, v214
 v_sub_u32 v215, v215, v216
 v_and_b32 v216, 1, v215
 v_lshlrev_b32 v216, 4, v216
 v_mov_b32 v217, 0x3f80
 v_lshlrev_b32 v216, v216, v217
 v_lshrrev_b32 v215, 1, v215
 v_cmp_eq_u32 s[16:17], 0, v215
 v_cmp_eq_u32 s[18:19], 1, v215
 v_cmp_eq_u32 s[20:21], 2, v215
 v_cmp_eq_u32 s[22:23], 3, v215
 v_cndmask_b32 v244, 0, v216, s[16:17]
 v_cndmask_b32 v245, 0, v216, s[18:19]
 v_cndmask_b32 v246, 0, v216, s[20:21]
 v_cndmask_b32 v247, 0, v216, s[22:23]
 v_lshlrev_b32 v192, 4, v212
 v_lshl_add_u32 v192, v213, 8, v192
 v_lshl_add_u32 v192, v214, 10, v192
 v_mul_u32_u24 v193, 896, v212
 v_lshl_add_u32 v193, v213, 3, v193
 v_lshl_add_u32 v193, v214, 6, v193
 v_lshlrev_b32 v194, 3, v212
 v_add_u32 v194, 163584, v194
 s_cmp_eq_u32 s3, 3
 s_cselect_b32 s11, 0x40000000, 0
 s_lshl_b32 s9, s32, 4
 s_add_u32 s9, s9, s33
 s_mul_i32 s35, s9, 7168
 s_lshl_b32 s9, s3, 7
 s_add_u32 s35, s35, s9
 s_add_u32 s9, s35, s11
 s_waitcnt lgkmcnt(0)
 s_and_b32 s13, s13, 0xffff
 s_mov_b32 s14, 0x1c0000
 s_mov_b32 s15, 0x20000
 buffer_load_dwordx2 v[196:197], v193, s[12:15], s35 offen offset:0
 buffer_load_dwordx2 v[198:199], v193, s[12:15], s35 offen offset:32
 buffer_load_dwordx2 v[200:201], v193, s[12:15], s9 offen offset:512
 buffer_load_dwordx2 v[202:203], v193, s[12:15], s9 offen offset:544
 v_mov_b32 v220, 0x3f803f80
 v_mov_b32 v212, 0
 v_mov_b32 v214, 0
 v_mov_b32 v228, 0
 v_mov_b32 v229, 0
 v_mov_b32 v230, 0
 v_mov_b32 v231, 0
 v_mov_b32 v232, 0
 v_mov_b32 v233, 0
 v_mov_b32 v234, 0
 v_mov_b32 v235, 0
 v_mov_b32 v236, 0
 v_mov_b32 v237, 0
 v_mov_b32 v238, 0
 v_mov_b32 v239, 0
 v_mov_b32 v240, 0
 v_mov_b32 v241, 0
 v_mov_b32 v242, 0
 v_mov_b32 v243, 0
 s_and_b32 s20, s46, 0x5555
 s_mov_b32 s21, 0
 s_cmp_ge_u32 s2, 128
 s_cselect_b32 s23, -1, 0
 s_mov_b32 s38, 0x20000
 s_bitcmp1_b32 s46, 0
 s_cbranch_scc1 L3_p0
 v_mfma_f32_16x16x32_bf16 v[228:231], v[244:247], a[0:3], v[228:231]
 v_mfma_f32_16x16x32_bf16 v[232:235], v[244:247], a[4:7], v[232:235]
 v_mfma_f32_16x16x32_bf16 v[236:239], v[244:247], a[8:11], v[236:239]
 v_mfma_f32_16x16x32_bf16 v[240:243], v[244:247], a[12:15], v[240:243]
L3_p0:
 s_bitcmp1_b32 s46, 2
 s_cbranch_scc1 L3_p1
 v_mfma_f32_16x16x32_bf16 v[228:231], v[244:247], a[16:19], v[228:231]
 v_mfma_f32_16x16x32_bf16 v[232:235], v[244:247], a[20:23], v[232:235]
 v_mfma_f32_16x16x32_bf16 v[236:239], v[244:247], a[24:27], v[236:239]
 v_mfma_f32_16x16x32_bf16 v[240:243], v[244:247], a[28:31], v[240:243]
L3_p1:
 s_bitcmp1_b32 s46, 4
 s_cbranch_scc1 L3_p2
 v_mfma_f32_16x16x32_bf16 v[228:231], v[244:247], a[32:35], v[228:231]
 v_mfma_f32_16x16x32_bf16 v[232:235], v[244:247], a[36:39], v[232:235]
 v_mfma_f32_16x16x32_bf16 v[236:239], v[244:247], a[40:43], v[236:239]
 v_mfma_f32_16x16x32_bf16 v[240:243], v[244:247], a[44:47], v[240:243]
L3_p2:
 s_bitcmp1_b32 s46, 6
 s_cbranch_scc1 L3_p3
 v_mfma_f32_16x16x32_bf16 v[228:231], v[244:247], a[48:51], v[228:231]
 v_mfma_f32_16x16x32_bf16 v[232:235], v[244:247], a[52:55], v[232:235]
 v_mfma_f32_16x16x32_bf16 v[236:239], v[244:247], a[56:59], v[236:239]
 v_mfma_f32_16x16x32_bf16 v[240:243], v[244:247], a[60:63], v[240:243]
L3_p3:
 s_bitcmp1_b32 s46, 8
 s_cbranch_scc1 L3_p4
 v_mfma_f32_16x16x32_bf16 v[228:231], v[244:247], a[64:67], v[228:231]
 v_mfma_f32_16x16x32_bf16 v[232:235], v[244:247], a[68:71], v[232:235]
 v_mfma_f32_16x16x32_bf16 v[236:239], v[244:247], a[72:75], v[236:239]
 v_mfma_f32_16x16x32_bf16 v[240:243], v[244:247], a[76:79], v[240:243]
L3_p4:
 s_bitcmp1_b32 s46, 10
 s_cbranch_scc1 L3_p5
 v_mfma_f32_16x16x32_bf16 v[228:231], v[244:247], a[80:83], v[228:231]
 v_mfma_f32_16x16x32_bf16 v[232:235], v[244:247], a[84:87], v[232:235]
 v_mfma_f32_16x16x32_bf16 v[236:239], v[244:247], a[88:91], v[236:239]
 v_mfma_f32_16x16x32_bf16 v[240:243], v[244:247], a[92:95], v[240:243]
L3_p5:
 s_bitcmp1_b32 s46, 12
 s_cbranch_scc1 L3_p6
 v_mfma_f32_16x16x32_bf16 v[228:231], v[244:247], a[96:99], v[228:231]
 v_mfma_f32_16x16x32_bf16 v[232:235], v[244:247], a[100:103], v[232:235]
 v_mfma_f32_16x16x32_bf16 v[236:239], v[244:247], a[104:107], v[236:239]
 v_mfma_f32_16x16x32_bf16 v[240:243], v[244:247], a[108:111], v[240:243]
L3_p6:
 buffer_load_dword v227, v146, s[4:7], s37 offen sc1
 s_lshl_b32 s9, s64, 2
 s_add_u32 s9, s9, s3
 s_mul_i32 s40, s9, 28672
 s_add_u32 s40, s40, 0x5e00000
 s_add_u32 s41, s40, 14336
 s_mul_i32 s42, s9, 114688
 s_lshl_b32 s9, s65, 12
 s_add_u32 s42, s42, s9
 s_add_u32 s42, s42, 0x5400000
 s_lshr_b32 s60, s64, 3
 s_mul_i32 s60, s60, 14
 s_add_u32 s60, s60, s65
 s_lshl_b32 s60, s60, 2
 s_add_u32 s60, s60, s3
 s_mul_i32 s60, s60, 14336
 s_load_dwordx2 s[56:57], s[0:1], 72
 s_load_dwordx2 s[72:73], s[0:1], 80
 s_and_b32 s70, s2, 7
 s_lshr_b32 s61, s2, 7
 s_lshl_b32 s61, s61, 3
 s_add_u32 s70, s70, s61
 s_bfe_u32 s61, s2, 0x40003
 s_cmp_ge_u32 s61, 7
 s_cselect_b32 s9, 1, 0
 s_cselect_b32 s10, 7, 0
 s_sub_u32 s61, s61, s10
 s_lshl_b32 s47, s70, 1
 s_add_u32 s47, s47, s9
 v_add_u32 v162, 0x0, v2
 v_add_u32 v163, 0xe000, v2
 v_add_u32 v164, 0x1c000, v2
 v_add_u32 v165, 0x2a000, v2
 v_lshrrev_b32 v154, 5, v1
 v_bfe_u32 v155, v1, 2, 2
 v_lshl_add_u32 v155, v154, 2, v155
 v_mul_u32_u24 v155, 896, v155
 v_bfe_u32 v156, v1, 4, 1
 v_lshl_add_u32 v155, v156, 6, v155
 v_lshlrev_b32 v154, 1, v154
 v_and_b32 v157, 3, v1
 v_xor_b32 v154, v154, v157
 v_lshl_add_u32 v148, v154, 4, v155
 v_add_u32 v149, 6144, v148
 v_add_u32 v150, 12288, v148
 v_add_u32 v151, 18432, v148
 v_lshrrev_b32 v154, 4, v1
 v_lshlrev_b32 v154, 9, v154
 v_bfe_u32 v155, v1, 2, 2
 v_lshl_add_u32 v154, v155, 6, v154
 v_lshl_add_u32 v154, v156, 5, v154
 v_lshl_add_u32 v154, v157, 3, v154
 s_lshr_b32 s67, s3, 1
 s_add_u32 s67, s67, s3
 s_lshl_b32 s67, s67, 15
 v_add_u32 v152, s67, v154
 v_xor_b32 v153, 32, v152
 v_and_b32 v154, 7, v0
 v_lshrrev_b32 v155, 3, v0
 s_lshl_b32 s9, s47, 6
 v_add_u32 v156, s9, v155
 v_mul_u32_u24 v157, 896, v156
 v_lshl_add_u32 v157, v154, 4, v157
 s_lshl_b32 s9, s61, 7
 v_add_u32 v166, s9, v157
 v_add_u32 v167, 28672, v166
 v_lshrrev_b32 v157, 4, v156
 v_mul_u32_u24 v157, 14, v157
 v_lshrrev_b32 v158, 2, v154
 s_lshl_b32 s9, s61, 1
 v_add3_u32 v157, v157, v158, s9
 v_lshlrev_b32 v157, 10, v157
 v_and_b32 v158, 1, v154
 v_lshl_add_u32 v157, v158, 9, v157
 v_bfe_u32 v158, v154, 1, 1
 v_lshl_add_u32 v157, v158, 3, v157
 v_and_b32 v158, 15, v156
 v_lshl_add_u32 v170, v158, 4, v157
 v_and_b32 v158, 15, v155
 v_lshrrev_b32 v157, 1, v154
 v_mul_u32_u24 v157, 4416, v157
 v_lshl_add_u32 v157, v158, 4, v157
 v_and_b32 v154, 1, v154
 v_mul_u32_u24 v154, 544, v154
 v_lshrrev_b32 v155, 4, v155
 v_mul_u32_u24 v155, 1088, v155
 v_add3_u32 v168, v157, v154, v155
 v_lshrrev_b32 v154, 4, v1
 v_mul_u32_u24 v154, 272, v154
 v_and_b32 v155, 15, v1
 v_lshl_add_u32 v154, v155, 4, v154
 s_mul_i32 s9, s3, 17664
 v_add_u32 v169, s9, v154
 s_waitcnt lgkmcnt(0)
 s_and_b32 s57, s57, 0xffff
 s_mov_b32 s58, 0x188000
 s_mov_b32 s59, 0x20000
 s_and_b32 s73, s73, 0xffff
 s_mov_b32 s74, 0x1c0000
 s_mov_b32 s75, 0x20000
 s_mul_i32 s62, s3, 401408
 s_lshl_b32 s9, s61, 7
 s_add_u32 s62, s62, s9
 s_mul_i32 s63, s47, 229376
 s_mul_i32 s9, s3, 14336
 s_add_u32 s63, s63, s9
 s_add_u32 s63, s63, 0x5400000
 s_branch L3_loop2
L3_loop:
 buffer_load_dword v227, v146, s[4:7], s37 offen sc1
L3_loop2:
 s_waitcnt vmcnt(1)
 s_bitcmp1_b32 s21, 0
 s_cbranch_scc0 L3_a0
 v_mfma_f32_16x16x32_bf16 v[228:231], v[244:247], v[4:7], v[228:231]
 v_mfma_f32_16x16x32_bf16 v[232:235], v[244:247], v[8:11], v[232:235]
 v_mfma_f32_16x16x32_bf16 v[236:239], v[244:247], v[12:15], v[236:239]
 v_mfma_f32_16x16x32_bf16 v[240:243], v[244:247], v[16:19], v[240:243]
L3_a0:
 s_bitcmp1_b32 s21, 2
 s_cbranch_scc0 L3_a1
 v_mfma_f32_16x16x32_bf16 v[228:231], v[244:247], v[20:23], v[228:231]
 v_mfma_f32_16x16x32_bf16 v[232:235], v[244:247], v[24:27], v[232:235]
 v_mfma_f32_16x16x32_bf16 v[236:239], v[244:247], v[28:31], v[236:239]
 v_mfma_f32_16x16x32_bf16 v[240:243], v[244:247], v[32:35], v[240:243]
L3_a1:
 s_bitcmp1_b32 s21, 4
 s_cbranch_scc0 L3_a2
 v_mfma_f32_16x16x32_bf16 v[228:231], v[244:247], v[36:39], v[228:231]
 v_mfma_f32_16x16x32_bf16 v[232:235], v[244:247], v[40:43], v[232:235]
 v_mfma_f32_16x16x32_bf16 v[236:239], v[244:247], v[44:47], v[236:239]
 v_mfma_f32_16x16x32_bf16 v[240:243], v[244:247], v[48:51], v[240:243]
L3_a2:
 s_bitcmp1_b32 s21, 6
 s_cbranch_scc0 L3_a3
 v_mfma_f32_16x16x32_bf16 v[228:231], v[244:247], v[52:55], v[228:231]
 v_mfma_f32_16x16x32_bf16 v[232:235], v[244:247], v[56:59], v[232:235]
 v_mfma_f32_16x16x32_bf16 v[236:239], v[244:247], v[60:63], v[236:239]
 v_mfma_f32_16x16x32_bf16 v[240:243], v[244:247], v[64:67], v[240:243]
L3_a3:
 s_bitcmp1_b32 s21, 8
 s_cbranch_scc0 L3_a4
 v_mfma_f32_16x16x32_bf16 v[228:231], v[244:247], v[68:71], v[228:231]
 v_mfma_f32_16x16x32_bf16 v[232:235], v[244:247], v[72:75], v[232:235]
 v_mfma_f32_16x16x32_bf16 v[236:239], v[244:247], v[76:79], v[236:239]
 v_mfma_f32_16x16x32_bf16 v[240:243], v[244:247], v[80:83], v[240:243]
L3_a4:
 s_bitcmp1_b32 s21, 10
 s_cbranch_scc0 L3_a5
 v_mfma_f32_16x16x32_bf16 v[228:231], v[244:247], v[84:87], v[228:231]
 v_mfma_f32_16x16x32_bf16 v[232:235], v[244:247], v[88:91], v[232:235]
 v_mfma_f32_16x16x32_bf16 v[236:239], v[244:247], v[92:95], v[236:239]
 v_mfma_f32_16x16x32_bf16 v[240:243], v[244:247], v[96:99], v[240:243]
L3_a5:
 s_bitcmp1_b32 s21, 12
 s_cbranch_scc0 L3_a6
 v_mfma_f32_16x16x32_bf16 v[228:231], v[244:247], v[100:103], v[228:231]
 v_mfma_f32_16x16x32_bf16 v[232:235], v[244:247], v[104:107], v[232:235]
 v_mfma_f32_16x16x32_bf16 v[236:239], v[244:247], v[108:111], v[236:239]
 v_mfma_f32_16x16x32_bf16 v[240:243], v[244:247], v[112:115], v[240:243]
L3_a6:
 s_bitcmp1_b32 s21, 14
 s_cbranch_scc0 L3_a7
 v_mfma_f32_16x16x32_bf16 v[228:231], v[244:247], v[116:119], v[228:231]
 v_mfma_f32_16x16x32_bf16 v[232:235], v[244:247], v[120:123], v[232:235]
 v_mfma_f32_16x16x32_bf16 v[236:239], v[244:247], v[124:127], v[236:239]
 v_mfma_f32_16x16x32_bf16 v[240:243], v[244:247], v[128:131], v[240:243]
L3_a7:
 s_cmp_eq_u32 s20, 0
 s_cbranch_scc1 L3_sum
 s_waitcnt vmcnt(0)
 v_cmp_eq_u32 vcc, 1, v227
 s_sub_u32 s38, s38, 1
 s_cselect_b32 s22, -1, 0
 s_lshr_b32 s21, vcc_lo, 1
 s_and_b32 s21, s21, vcc_lo
 s_or_b32 s21, s21, s22
 s_and_b32 s21, s21, s20
 s_andn2_b32 s20, s20, s21
 s_bitcmp1_b32 s21, 0
 s_cbranch_scc0 L3_l0
 s_add_u32 s25, s2, 1
 s_and_b32 s25, s25, 7
 s_mul_i32 s25, s25, 28672
 s_add_u32 s9, s34, s25
 s_add_u32 s10, s39, s25
 buffer_load_dwordx4 v[4:7], v190, s[4:7], s9 offen offset:0 sc1
 buffer_load_dwordx4 v[8:11], v190, s[4:7], s9 offen offset:1024 sc1
 buffer_load_dwordx4 v[12:15], v190, s[4:7], s10 offen offset:0 sc1
 buffer_load_dwordx4 v[16:19], v190, s[4:7], s10 offen offset:1024 sc1
L3_l0:
 s_bitcmp1_b32 s21, 2
 s_cbranch_scc0 L3_l1
 s_add_u32 s25, s2, 2
 s_and_b32 s25, s25, 7
 s_mul_i32 s25, s25, 28672
 s_add_u32 s9, s34, s25
 s_add_u32 s10, s39, s25
 buffer_load_dwordx4 v[20:23], v190, s[4:7], s9 offen offset:0 sc1
 buffer_load_dwordx4 v[24:27], v190, s[4:7], s9 offen offset:1024 sc1
 buffer_load_dwordx4 v[28:31], v190, s[4:7], s10 offen offset:0 sc1
 buffer_load_dwordx4 v[32:35], v190, s[4:7], s10 offen offset:1024 sc1
L3_l1:
 s_bitcmp1_b32 s21, 4
 s_cbranch_scc0 L3_l2
 s_add_u32 s25, s2, 3
 s_and_b32 s25, s25, 7
 s_mul_i32 s25, s25, 28672
 s_add_u32 s9, s34, s25
 s_add_u32 s10, s39, s25
 buffer_load_dwordx4 v[36:39], v190, s[4:7], s9 offen offset:0 sc1
 buffer_load_dwordx4 v[40:43], v190, s[4:7], s9 offen offset:1024 sc1
 buffer_load_dwordx4 v[44:47], v190, s[4:7], s10 offen offset:0 sc1
 buffer_load_dwordx4 v[48:51], v190, s[4:7], s10 offen offset:1024 sc1
L3_l2:
 s_bitcmp1_b32 s21, 6
 s_cbranch_scc0 L3_l3
 s_add_u32 s25, s2, 4
 s_and_b32 s25, s25, 7
 s_mul_i32 s25, s25, 28672
 s_add_u32 s9, s34, s25
 s_add_u32 s10, s39, s25
 buffer_load_dwordx4 v[52:55], v190, s[4:7], s9 offen offset:0 sc1
 buffer_load_dwordx4 v[56:59], v190, s[4:7], s9 offen offset:1024 sc1
 buffer_load_dwordx4 v[60:63], v190, s[4:7], s10 offen offset:0 sc1
 buffer_load_dwordx4 v[64:67], v190, s[4:7], s10 offen offset:1024 sc1
L3_l3:
 s_bitcmp1_b32 s21, 8
 s_cbranch_scc0 L3_l4
 s_add_u32 s25, s2, 5
 s_and_b32 s25, s25, 7
 s_mul_i32 s25, s25, 28672
 s_add_u32 s9, s34, s25
 s_add_u32 s10, s39, s25
 buffer_load_dwordx4 v[68:71], v190, s[4:7], s9 offen offset:0 sc1
 buffer_load_dwordx4 v[72:75], v190, s[4:7], s9 offen offset:1024 sc1
 buffer_load_dwordx4 v[76:79], v190, s[4:7], s10 offen offset:0 sc1
 buffer_load_dwordx4 v[80:83], v190, s[4:7], s10 offen offset:1024 sc1
L3_l4:
 s_bitcmp1_b32 s21, 10
 s_cbranch_scc0 L3_l5
 s_add_u32 s25, s2, 6
 s_and_b32 s25, s25, 7
 s_mul_i32 s25, s25, 28672
 s_add_u32 s9, s34, s25
 s_add_u32 s10, s39, s25
 buffer_load_dwordx4 v[84:87], v190, s[4:7], s9 offen offset:0 sc1
 buffer_load_dwordx4 v[88:91], v190, s[4:7], s9 offen offset:1024 sc1
 buffer_load_dwordx4 v[92:95], v190, s[4:7], s10 offen offset:0 sc1
 buffer_load_dwordx4 v[96:99], v190, s[4:7], s10 offen offset:1024 sc1
L3_l5:
 s_bitcmp1_b32 s21, 12
 s_cbranch_scc0 L3_l6
 s_add_u32 s25, s2, 7
 s_and_b32 s25, s25, 7
 s_mul_i32 s25, s25, 28672
 s_add_u32 s9, s34, s25
 s_add_u32 s10, s39, s25
 buffer_load_dwordx4 v[100:103], v190, s[4:7], s9 offen offset:0 sc1
 buffer_load_dwordx4 v[104:107], v190, s[4:7], s9 offen offset:1024 sc1
 buffer_load_dwordx4 v[108:111], v190, s[4:7], s10 offen offset:0 sc1
 buffer_load_dwordx4 v[112:115], v190, s[4:7], s10 offen offset:1024 sc1
L3_l6:
 s_bitcmp1_b32 s21, 14
 s_cbranch_scc0 L3_l7
 s_add_u32 s25, s2, 8
 s_and_b32 s25, s25, 7
 s_mul_i32 s25, s25, 28672
 s_add_u32 s9, s34, s25
 s_add_u32 s10, s39, s25
 buffer_load_dwordx4 v[116:119], v190, s[4:7], s9 offen offset:0 sc1
 buffer_load_dwordx4 v[120:123], v190, s[4:7], s9 offen offset:1024 sc1
 buffer_load_dwordx4 v[124:127], v190, s[4:7], s10 offen offset:0 sc1
 buffer_load_dwordx4 v[128:131], v190, s[4:7], s10 offen offset:1024 sc1
L3_l7:
 s_cmp_lg_u32 s21, 0
 s_cbranch_scc1 L3_loop
 s_sleep 2
 s_branch L3_loop
L3_sum:
 s_waitcnt vmcnt(0)
 s_nop 7
 v_permlane16_swap_b32 v228, v232
 v_permlane16_swap_b32 v229, v233
 v_permlane16_swap_b32 v230, v234
 v_permlane16_swap_b32 v231, v235
 v_permlane16_swap_b32 v236, v240
 v_permlane16_swap_b32 v237, v241
 v_permlane16_swap_b32 v238, v242
 v_permlane16_swap_b32 v239, v243
 v_cvt_pk_bf16_f32 v222, v228, v229
 v_lshlrev_b32 v224, 16, v222
 v_and_b32 v225, 0xffff0000, v222
 v_lshlrev_b32 v226, 16, v196
 v_and_b32 v227, 0xffff0000, v196
 v_pk_add_f32 v[224:225], v[224:225], v[226:227]
 v_cvt_pk_bf16_f32 v204, v224, v225
 v_cvt_pk_bf16_f32 v222, v230, v231
 v_lshlrev_b32 v224, 16, v222
 v_and_b32 v225, 0xffff0000, v222
 v_lshlrev_b32 v226, 16, v197
 v_and_b32 v227, 0xffff0000, v197
 v_pk_add_f32 v[224:225], v[224:225], v[226:227]
 v_cvt_pk_bf16_f32 v205, v224, v225
 v_cvt_pk_bf16_f32 v222, v232, v233
 v_lshlrev_b32 v224, 16, v222
 v_and_b32 v225, 0xffff0000, v222
 v_lshlrev_b32 v226, 16, v198
 v_and_b32 v227, 0xffff0000, v198
 v_pk_add_f32 v[224:225], v[224:225], v[226:227]
 v_cvt_pk_bf16_f32 v206, v224, v225
 v_cvt_pk_bf16_f32 v222, v234, v235
 v_lshlrev_b32 v224, 16, v222
 v_and_b32 v225, 0xffff0000, v222
 v_lshlrev_b32 v226, 16, v199
 v_and_b32 v227, 0xffff0000, v199
 v_pk_add_f32 v[224:225], v[224:225], v[226:227]
 v_cvt_pk_bf16_f32 v207, v224, v225
 v_cvt_pk_bf16_f32 v222, v236, v237
 v_lshlrev_b32 v224, 16, v222
 v_and_b32 v225, 0xffff0000, v222
 v_lshlrev_b32 v226, 16, v200
 v_and_b32 v227, 0xffff0000, v200
 v_pk_add_f32 v[224:225], v[224:225], v[226:227]
 v_cvt_pk_bf16_f32 v208, v224, v225
 v_cvt_pk_bf16_f32 v222, v238, v239
 v_lshlrev_b32 v224, 16, v222
 v_and_b32 v225, 0xffff0000, v222
 v_lshlrev_b32 v226, 16, v201
 v_and_b32 v227, 0xffff0000, v201
 v_pk_add_f32 v[224:225], v[224:225], v[226:227]
 v_cvt_pk_bf16_f32 v209, v224, v225
 v_cvt_pk_bf16_f32 v222, v240, v241
 v_lshlrev_b32 v224, 16, v222
 v_and_b32 v225, 0xffff0000, v222
 v_lshlrev_b32 v226, 16, v202
 v_and_b32 v227, 0xffff0000, v202
 v_pk_add_f32 v[224:225], v[224:225], v[226:227]
 v_cvt_pk_bf16_f32 v210, v224, v225
 v_cvt_pk_bf16_f32 v222, v242, v243
 v_lshlrev_b32 v224, 16, v222
 v_and_b32 v225, 0xffff0000, v222
 v_lshlrev_b32 v226, 16, v203
 v_and_b32 v227, 0xffff0000, v203
 v_pk_add_f32 v[224:225], v[224:225], v[226:227]
 v_cvt_pk_bf16_f32 v211, v224, v225
 s_add_u32 s35, s36, 0x200000
 s_add_u32 s10, s35, s11
 s_add_u32 s10, s10, 0x2000
 buffer_store_dwordx4 v[204:207], v192, s[4:7], s35 offen sc1
 buffer_store_dwordx4 v[208:211], v192, s[4:7], s10 offen sc1
 s_nop 0
 v_dot2c_f32_bf16 v212, v204, v220
 v_dot2c_f32_bf16 v214, v204, v204
 v_dot2c_f32_bf16 v212, v205, v220
 v_dot2c_f32_bf16 v214, v205, v205
 v_dot2c_f32_bf16 v212, v206, v220
 v_dot2c_f32_bf16 v214, v206, v206
 v_dot2c_f32_bf16 v212, v207, v220
 v_dot2c_f32_bf16 v214, v207, v207
 v_dot2c_f32_bf16 v212, v208, v220
 v_dot2c_f32_bf16 v214, v208, v208
 v_dot2c_f32_bf16 v212, v209, v220
 v_dot2c_f32_bf16 v214, v209, v209
 v_dot2c_f32_bf16 v212, v210, v220
 v_dot2c_f32_bf16 v214, v210, v210
 v_dot2c_f32_bf16 v212, v211, v220
 v_dot2c_f32_bf16 v214, v211, v211
 s_nop 2
 v_add_f32_dpp v212, v212, v212 row_ror:8 row_mask:0xf bank_mask:0xf
 v_add_f32_dpp v214, v214, v214 row_ror:8 row_mask:0xf bank_mask:0xf
 v_mov_b32 v213, v212
 v_mov_b32 v215, v214
 s_nop 1
 v_permlane16_swap_b32 v212, v213
 v_permlane16_swap_b32 v214, v215
 v_add_f32 v212, v212, v213
 v_add_f32 v214, v214, v215
 v_mov_b32 v213, v212
 v_mov_b32 v215, v214
 s_nop 1
 v_permlane32_swap_b32 v212, v213
 v_permlane32_swap_b32 v214, v215
 v_add_f32 v212, v212, v213
 v_add_f32 v214, v214, v215
 v_mov_b32 v213, v214
 s_lshl_b32 s9, s3, 6
 v_add_u32 v216, s9, v194
 ds_write_b64 v216, v[212:213]
 s_add_u32 s11, s36, s11
 s_add_u32 s11, s11, 0x2000
 s_waitcnt lgkmcnt(0)
 s_barrier
 ds_read_b64 v[4:5], v194 offset:0
 ds_read_b64 v[6:7], v194 offset:64
 ds_read_b64 v[8:9], v194 offset:128
 ds_read_b64 v[10:11], v194 offset:192
 s_waitcnt lgkmcnt(0)
 v_pk_add_f32 v[4:5], v[4:5], v[6:7]
 v_pk_add_f32 v[8:9], v[8:9], v[10:11]
 v_add_f32 v212, v4, v8
 v_add_f32 v214, v5, v9
 s_mov_b32 s9, 0x3b124925
 v_mul_f32 v212, s9, v212
 v_mul_f32 v214, s9, v214
 v_fma_f32 v214, -v212, v212, v214
 v_max_f32 v214, 0, v214
 v_cvt_pk_bf16_f32 v212, v212, v212
 v_and_b32 v212, 0xffff0000, v212
 v_cvt_pk_bf16_f32 v214, v214, v214
 v_and_b32 v214, 0xffff0000, v214
 v_add_f32 v214, 0x3727c5ac, v214
 v_cvt_pk_bf16_f32 v214, v214, v214
 v_and_b32 v214, 0xffff0000, v214
 v_sqrt_f32 v214, v214
 s_nop 0
 v_cvt_pk_bf16_f32 v214, v214, v214
 v_and_b32 v214, 0xffff0000, v214
 v_rcp_f32 v214, v214
 s_nop 0
 v_mul_f32 v212, -v212, v214
 v_mov_b32 v213, v212
 v_mov_b32 v215, v214
 v_lshlrev_b32 v216, 16, v204
 v_and_b32 v217, 0xffff0000, v204
 v_pk_fma_f32 v[216:217], v[216:217], v[214:215], v[212:213]
 v_cvt_pk_bf16_f32 v204, v216, v217
 v_lshlrev_b32 v218, 16, v205
 v_and_b32 v219, 0xffff0000, v205
 v_pk_fma_f32 v[218:219], v[218:219], v[214:215], v[212:213]
 v_cvt_pk_bf16_f32 v205, v218, v219
 v_lshlrev_b32 v216, 16, v206
 v_and_b32 v217, 0xffff0000, v206
 v_pk_fma_f32 v[216:217], v[216:217], v[214:215], v[212:213]
 v_cvt_pk_bf16_f32 v206, v216, v217
 v_lshlrev_b32 v218, 16, v207
 v_and_b32 v219, 0xffff0000, v207
 v_pk_fma_f32 v[218:219], v[218:219], v[214:215], v[212:213]
 v_cvt_pk_bf16_f32 v207, v218, v219
 v_lshlrev_b32 v216, 16, v208
 v_and_b32 v217, 0xffff0000, v208
 v_pk_fma_f32 v[216:217], v[216:217], v[214:215], v[212:213]
 v_cvt_pk_bf16_f32 v208, v216, v217
 v_lshlrev_b32 v218, 16, v209
 v_and_b32 v219, 0xffff0000, v209
 v_pk_fma_f32 v[218:219], v[218:219], v[214:215], v[212:213]
 v_cvt_pk_bf16_f32 v209, v218, v219
 v_lshlrev_b32 v216, 16, v210
 v_and_b32 v217, 0xffff0000, v210
 v_pk_fma_f32 v[216:217], v[216:217], v[214:215], v[212:213]
 v_cvt_pk_bf16_f32 v210, v216, v217
 v_lshlrev_b32 v218, 16, v211
 v_and_b32 v219, 0xffff0000, v211
 v_pk_fma_f32 v[218:219], v[218:219], v[214:215], v[212:213]
 v_cvt_pk_bf16_f32 v211, v218, v219
 buffer_store_dwordx4 v[204:207], v192, s[4:7], s36 offen sc1
 buffer_store_dwordx4 v[208:211], v192, s[4:7], s11 offen sc1
 s_lshl_b32 s37, s32, 4
 s_add_u32 s37, s37, s33
 s_lshl_b32 s37, s37, 2
 s_add_u32 s37, s37, s3
 s_lshl_b32 s37, s37, 2
 s_add_u32 s37, s37, 0x5312000
 v_mov_b32 v220, 1
 v_mov_b32 v221, 0
 s_waitcnt vmcnt(0)
 s_cmp_eq_u32 s71, 0
 s_cbranch_scc1 L3_s_slow
 buffer_store_dword v220, v221, s[4:7], s37 offen
L3_s_back:
 s_cmp_ge_u32 s65, 14
 s_cbranch_scc1 L_end_seque
 s_lshl_b32 s43, s64, 2
 s_add_u32 s43, s43, s3
 s_lshl_b32 s43, s43, 6
 s_add_u32 s43, s43, 0x5312000
 v_min_u32 v219, 15, v1
 v_lshlrev_b32 v219, 2, v219
 v_add_u32 v224, 0x8000, v144
 v_add_u32 v225, 0x8000, v145
 ds_read_b64_tr_b16 a[128:129], v224 offset:0
 ds_read_b64_tr_b16 a[130:131], v224 offset:8192
 ds_read_b64_tr_b16 a[132:133], v225 offset:0
 ds_read_b64_tr_b16 a[134:135], v225 offset:8192
 ds_read_b64_tr_b16 a[136:137], v224 offset:256
 ds_read_b64_tr_b16 a[138:139], v224 offset:8448
 ds_read_b64_tr_b16 a[140:141], v225 offset:256
 ds_read_b64_tr_b16 a[142:143], v225 offset:8448
 ds_read_b64_tr_b16 a[144:145], v224 offset:512
 ds_read_b64_tr_b16 a[146:147], v224 offset:8704
 ds_read_b64_tr_b16 a[148:149], v225 offset:512
 ds_read_b64_tr_b16 a[150:151], v225 offset:8704
 ds_read_b64_tr_b16 a[152:153], v224 offset:768
 ds_read_b64_tr_b16 a[154:155], v224 offset:8960
 ds_read_b64_tr_b16 a[156:157], v225 offset:768
 ds_read_b64_tr_b16 a[158:159], v225 offset:8960
 ds_read_b64_tr_b16 a[160:161], v224 offset:1024
 ds_read_b64_tr_b16 a[162:163], v224 offset:9216
 ds_read_b64_tr_b16 a[164:165], v225 offset:1024
 ds_read_b64_tr_b16 a[166:167], v225 offset:9216
 ds_read_b64_tr_b16 a[168:169], v224 offset:1280
 ds_read_b64_tr_b16 a[170:171], v224 offset:9472
 ds_read_b64_tr_b16 a[172:173], v225 offset:1280
 ds_read_b64_tr_b16 a[174:175], v225 offset:9472
 ds_read_b64_tr_b16 a[176:177], v224 offset:1536
 ds_read_b64_tr_b16 a[178:179], v224 offset:9728
 ds_read_b64_tr_b16 a[180:181], v225 offset:1536
 ds_read_b64_tr_b16 a[182:183], v225 offset:9728
 ds_read_b64_tr_b16 a[184:185], v224 offset:1792
 ds_read_b64_tr_b16 a[186:187], v224 offset:9984
 ds_read_b64_tr_b16 a[188:189], v225 offset:1792
 ds_read_b64_tr_b16 a[190:191], v225 offset:9984
 s_mov_b32 s44, 0x20000
L4_hn_poll:
 buffer_load_dword v220, v219, s[4:7], s43 offen sc1
 s_waitcnt vmcnt(0)
 v_cmp_ne_u32 vcc, 1, v220
 s_cbranch_vccz L4_hn_done
 s_sleep 2
 s_sub_u32 s44, s44, 1
 s_cbranch_scc0 L4_hn_poll
L4_hn_done:
 s_cmp_eq_u32 s71, 0
 s_cbranch_scc1 L4_a_acq
L4_a_acqb:
 buffer_load_dwordx4 a[0:3], v2, s[4:7], s40 offen offset:0
 buffer_load_dwordx4 a[4:7], v2, s[4:7], s41 offen offset:0
 buffer_load_dwordx4 a[8:11], v2, s[4:7], s40 offen offset:1024
 buffer_load_dwordx4 a[12:15], v2, s[4:7], s41 offen offset:1024
 buffer_load_dwordx4 a[16:19], v2, s[4:7], s40 offen offset:2048
 buffer_load_dwordx4 a[20:23], v2, s[4:7], s41 offen offset:2048
 buffer_load_dwordx4 a[24:27], v2, s[4:7], s40 offen offset:3072
 buffer_load_dwordx4 a[28:31], v2, s[4:7], s41 offen offset:3072
 s_add_u32 s40, s40, 0x1000
 s_add_u32 s41, s41, 0x1000
 s_add_u32 s45, s42, 57344
 s_waitcnt vmcnt(7) lgkmcnt(0)
 v_mfma_f32_16x16x32_bf16 v[4:7], a[128:131], a[0:3], 0
 buffer_load_dwordx4 v[228:231], v2, s[56:59], s60 offen offset:0
 s_waitcnt vmcnt(7)
 v_mfma_f32_16x16x32_bf16 v[8:11], a[128:131], a[4:7], 0
 v_add_u32 v226, 0xc000, v144
 v_add_u32 v227, 0xc000, v145
 v_mfma_f32_16x16x32_bf16 v[12:15], a[132:135], a[0:3], 0
 ds_read_b64_tr_b16 a[128:129], v226 offset:0
 v_mfma_f32_16x16x32_bf16 v[16:19], a[132:135], a[4:7], 0
 ds_read_b64_tr_b16 a[130:131], v226 offset:8192
 v_mfma_f32_16x16x32_bf16 v[20:23], a[136:139], a[0:3], 0
 ds_read_b64_tr_b16 a[132:133], v227 offset:0
 v_mfma_f32_16x16x32_bf16 v[24:27], a[136:139], a[4:7], 0
 ds_read_b64_tr_b16 a[134:135], v227 offset:8192
 v_mfma_f32_16x16x32_bf16 v[28:31], a[140:143], a[0:3], 0
 ds_read_b64_tr_b16 a[136:137], v226 offset:256
 v_mfma_f32_16x16x32_bf16 v[32:35], a[140:143], a[4:7], 0
 buffer_load_dwordx4 a[32:35], v2, s[4:7], s40 offen offset:0
 v_mfma_f32_16x16x32_bf16 v[36:39], a[144:147], a[0:3], 0
 ds_read_b64_tr_b16 a[138:139], v226 offset:8448
 v_mfma_f32_16x16x32_bf16 v[40:43], a[144:147], a[4:7], 0
 ds_read_b64_tr_b16 a[140:141], v227 offset:256
 v_mfma_f32_16x16x32_bf16 v[44:47], a[148:151], a[0:3], 0
 ds_read_b64_tr_b16 a[142:143], v227 offset:8448
 v_mfma_f32_16x16x32_bf16 v[48:51], a[148:151], a[4:7], 0
 ds_read_b64_tr_b16 a[144:145], v226 offset:512
 v_mfma_f32_16x16x32_bf16 v[52:55], a[152:155], a[0:3], 0
 buffer_load_dwordx4 a[36:39], v2, s[4:7], s41 offen offset:0
 v_mfma_f32_16x16x32_bf16 v[56:59], a[152:155], a[4:7], 0
 ds_read_b64_tr_b16 a[146:147], v226 offset:8704
 s_add_u32 m0, s8, 0x0
 v_mfma_f32_16x16x32_bf16 v[60:63], a[156:159], a[0:3], 0
 ds_read_b64_tr_b16 a[148:149], v227 offset:512
 v_mfma_f32_16x16x32_bf16 v[64:67], a[156:159], a[4:7], 0
 ds_read_b64_tr_b16 a[150:151], v227 offset:8704
 v_mfma_f32_16x16x32_bf16 v[68:71], a[160:163], a[0:3], 0
 ds_read_b64_tr_b16 a[152:153], v226 offset:768
 v_mfma_f32_16x16x32_bf16 v[72:75], a[160:163], a[4:7], 0
 buffer_load_dwordx4 v140, s[48:51], s66 offen offset:0 lds
 v_mfma_f32_16x16x32_bf16 v[76:79], a[164:167], a[0:3], 0
 ds_read_b64_tr_b16 a[154:155], v226 offset:8960
 v_mfma_f32_16x16x32_bf16 v[80:83], a[164:167], a[4:7], 0
 ds_read_b64_tr_b16 a[156:157], v227 offset:768
 v_mfma_f32_16x16x32_bf16 v[84:87], a[168:171], a[0:3], 0
 ds_read_b64_tr_b16 a[158:159], v227 offset:8960
 v_mfma_f32_16x16x32_bf16 v[88:91], a[168:171], a[4:7], 0
 ds_read_b64_tr_b16 a[160:161], v226 offset:1024
 v_mfma_f32_16x16x32_bf16 v[92:95], a[172:175], a[0:3], 0
 ds_read_b64_tr_b16 a[162:163], v226 offset:9216
 v_mfma_f32_16x16x32_bf16 v[96:99], a[172:175], a[4:7], 0
 buffer_load_dwordx4 v141, s[52:55], s66 offen offset:1024 lds
 v_mfma_f32_16x16x32_bf16 v[100:103], a[176:179], a[0:3], 0
 ds_read_b64_tr_b16 a[164:165], v227 offset:1024
 v_mfma_f32_16x16x32_bf16 v[104:107], a[176:179], a[4:7], 0
 ds_read_b64_tr_b16 a[166:167], v227 offset:9216
 v_mfma_f32_16x16x32_bf16 v[108:111], a[180:183], a[0:3], 0
 ds_read_b64_tr_b16 a[168:169], v226 offset:1280
 v_mfma_f32_16x16x32_bf16 v[112:115], a[180:183], a[4:7], 0
 ds_read_b64_tr_b16 a[170:171], v226 offset:9472
 v_mfma_f32_16x16x32_bf16 v[116:119], a[184:187], a[0:3], 0
 buffer_load_dwordx4 v142, s[48:51], s66 offen offset:2048 lds
 v_mfma_f32_16x16x32_bf16 v[120:123], a[184:187], a[4:7], 0
 ds_read_b64_tr_b16 a[172:173], v227 offset:1280
 buffer_load_dwordx4 v143, s[52:55], s66 offen offset:3072 lds
 v_mfma_f32_16x16x32_bf16 v[124:127], a[188:191], a[0:3], 0
 ds_read_b64_tr_b16 a[174:175], v227 offset:9472
 s_add_u32 s66, s66, 114688
 v_mfma_f32_16x16x32_bf16 v[128:131], a[188:191], a[4:7], 0
 ds_read_b64_tr_b16 a[176:177], v226 offset:1536
 s_waitcnt vmcnt(12) lgkmcnt(7)
 v_mfma_f32_16x16x32_bf16 v[4:7], a[128:131], a[8:11], v[4:7]
 ds_read_b64_tr_b16 a[178:179], v226 offset:9728
 s_waitcnt vmcnt(11)
 v_mfma_f32_16x16x32_bf16 v[8:11], a[128:131], a[12:15], v[8:11]
 ds_read_b64_tr_b16 a[180:181], v227 offset:1536
 v_mfma_f32_16x16x32_bf16 v[12:15], a[132:135], a[8:11], v[12:15]
 ds_read_b64_tr_b16 a[182:183], v227 offset:9728
 v_mfma_f32_16x16x32_bf16 v[16:19], a[132:135], a[12:15], v[16:19]
 ds_read_b64_tr_b16 a[184:185], v226 offset:1792
 v_mfma_f32_16x16x32_bf16 v[20:23], a[136:139], a[8:11], v[20:23]
 ds_read_b64_tr_b16 a[186:187], v226 offset:9984
 v_mfma_f32_16x16x32_bf16 v[24:27], a[136:139], a[12:15], v[24:27]
 ds_read_b64_tr_b16 a[188:189], v227 offset:1792
 v_mfma_f32_16x16x32_bf16 v[28:31], a[140:143], a[8:11], v[28:31]
 ds_read_b64_tr_b16 a[190:191], v227 offset:9984
 v_add_u32 v224, 0x10000, v144
 v_mfma_f32_16x16x32_bf16 v[32:35], a[140:143], a[12:15], v[32:35]
 v_add_u32 v225, 0x10000, v145
 ds_read_b64_tr_b16 a[128:129], v224 offset:0
 v_mfma_f32_16x16x32_bf16 v[36:39], a[144:147], a[8:11], v[36:39]
 buffer_load_dwordx4 v[228:231], v2, s[56:59], s60 offen offset:1024
 v_mfma_f32_16x16x32_bf16 v[40:43], a[144:147], a[12:15], v[40:43]
 ds_read_b64_tr_b16 a[130:131], v224 offset:8192
 v_mfma_f32_16x16x32_bf16 v[44:47], a[148:151], a[8:11], v[44:47]
 ds_read_b64_tr_b16 a[132:133], v225 offset:0
 v_mfma_f32_16x16x32_bf16 v[48:51], a[148:151], a[12:15], v[48:51]
 ds_read_b64_tr_b16 a[134:135], v225 offset:8192
 v_mfma_f32_16x16x32_bf16 v[52:55], a[152:155], a[8:11], v[52:55]
 ds_read_b64_tr_b16 a[136:137], v224 offset:256
 ds_read_b64_tr_b16 a[138:139], v224 offset:8448
 v_mfma_f32_16x16x32_bf16 v[56:59], a[152:155], a[12:15], v[56:59]
 buffer_load_dwordx4 a[40:43], v2, s[4:7], s40 offen offset:1024
 v_mfma_f32_16x16x32_bf16 v[60:63], a[156:159], a[8:11], v[60:63]
 ds_read_b64_tr_b16 a[140:141], v225 offset:256
 v_mfma_f32_16x16x32_bf16 v[64:67], a[156:159], a[12:15], v[64:67]
 ds_read_b64_tr_b16 a[142:143], v225 offset:8448
 v_mfma_f32_16x16x32_bf16 v[68:71], a[160:163], a[8:11], v[68:71]
 ds_read_b64_tr_b16 a[144:145], v224 offset:512
 ds_read_b64_tr_b16 a[146:147], v224 offset:8704
 v_mfma_f32_16x16x32_bf16 v[72:75], a[160:163], a[12:15], v[72:75]
 buffer_load_dwordx4 a[44:47], v2, s[4:7], s41 offen offset:1024
 s_waitcnt lgkmcnt(9)
 v_mfma_f32_16x16x32_bf16 v[76:79], a[164:167], a[8:11], v[76:79]
 ds_read_b64_tr_b16 a[148:149], v225 offset:512
 s_add_u32 m0, s8, 0x4000
 v_mfma_f32_16x16x32_bf16 v[80:83], a[164:167], a[12:15], v[80:83]
 ds_read_b64_tr_b16 a[150:151], v225 offset:8704
 v_mfma_f32_16x16x32_bf16 v[84:87], a[168:171], a[8:11], v[84:87]
 ds_read_b64_tr_b16 a[152:153], v224 offset:768
 ds_read_b64_tr_b16 a[154:155], v224 offset:8960
 v_mfma_f32_16x16x32_bf16 v[88:91], a[168:171], a[12:15], v[88:91]
 buffer_load_dwordx4 v140, s[48:51], s66 offen offset:0 lds
 v_mfma_f32_16x16x32_bf16 v[92:95], a[172:175], a[8:11], v[92:95]
 ds_read_b64_tr_b16 a[156:157], v225 offset:768
 v_mfma_f32_16x16x32_bf16 v[96:99], a[172:175], a[12:15], v[96:99]
 ds_read_b64_tr_b16 a[158:159], v225 offset:8960
 v_mfma_f32_16x16x32_bf16 v[100:103], a[176:179], a[8:11], v[100:103]
 ds_read_b64_tr_b16 a[160:161], v224 offset:1024
 v_mfma_f32_16x16x32_bf16 v[104:107], a[176:179], a[12:15], v[104:107]
 ds_read_b64_tr_b16 a[162:163], v224 offset:9216
 v_mfma_f32_16x16x32_bf16 v[108:111], a[180:183], a[8:11], v[108:111]
 buffer_load_dwordx4 v141, s[52:55], s66 offen offset:1024 lds
 v_mfma_f32_16x16x32_bf16 v[112:115], a[180:183], a[12:15], v[112:115]
 ds_read_b64_tr_b16 a[164:165], v225 offset:1024
 ds_read_b64_tr_b16 a[166:167], v225 offset:9216
 v_mfma_f32_16x16x32_bf16 v[116:119], a[184:187], a[8:11], v[116:119]
 ds_read_b64_tr_b16 a[168:169], v224 offset:1280
 v_mfma_f32_16x16x32_bf16 v[120:123], a[184:187], a[12:15], v[120:123]
 ds_read_b64_tr_b16 a[170:171], v224 offset:9472
 ds_read_b64_tr_b16 a[172:173], v225 offset:1280
 v_mfma_f32_16x16x32_bf16 v[124:127], a[188:191], a[8:11], v[124:127]
 buffer_load_dwordx4 v142, s[48:51], s66 offen offset:2048 lds
 ds_read_b64_tr_b16 a[174:175], v225 offset:9472
 buffer_load_dwordx4 v143, s[52:55], s66 offen offset:3072 lds
 s_add_u32 s66, s66, 114688
 v_mfma_f32_16x16x32_bf16 v[128:131], a[188:191], a[12:15], v[128:131]
 s_barrier
 s_waitcnt vmcnt(17) lgkmcnt(7)
 v_mfma_f32_16x16x32_bf16 v[4:7], a[128:131], a[16:19], v[4:7]
 ds_read_b64_tr_b16 a[176:177], v224 offset:1536
 s_waitcnt vmcnt(16)
 v_mfma_f32_16x16x32_bf16 v[8:11], a[128:131], a[20:23], v[8:11]
 ds_read_b64_tr_b16 a[178:179], v224 offset:9728
 v_mfma_f32_16x16x32_bf16 v[12:15], a[132:135], a[16:19], v[12:15]
 ds_read_b64_tr_b16 a[180:181], v225 offset:1536
 v_mfma_f32_16x16x32_bf16 v[16:19], a[132:135], a[20:23], v[16:19]
 ds_read_b64_tr_b16 a[182:183], v225 offset:9728
 v_mfma_f32_16x16x32_bf16 v[20:23], a[136:139], a[16:19], v[20:23]
 ds_read_b64_tr_b16 a[184:185], v224 offset:1792
 v_mfma_f32_16x16x32_bf16 v[24:27], a[136:139], a[20:23], v[24:27]
 ds_read_b64_tr_b16 a[186:187], v224 offset:9984
 v_mfma_f32_16x16x32_bf16 v[28:31], a[140:143], a[16:19], v[28:31]
 ds_read_b64_tr_b16 a[188:189], v225 offset:1792
 v_mfma_f32_16x16x32_bf16 v[32:35], a[140:143], a[20:23], v[32:35]
 ds_read_b64_tr_b16 a[190:191], v225 offset:9984
 v_add_u32 v226, 0x14000, v144
 v_mfma_f32_16x16x32_bf16 v[36:39], a[144:147], a[16:19], v[36:39]
 v_add_u32 v227, 0x14000, v145
 ds_read_b64_tr_b16 a[128:129], v226 offset:0
 v_mfma_f32_16x16x32_bf16 v[40:43], a[144:147], a[20:23], v[40:43]
 buffer_load_dwordx4 v[228:231], v2, s[56:59], s60 offen offset:2048
 ds_read_b64_tr_b16 a[130:131], v226 offset:8192
 v_mfma_f32_16x16x32_bf16 v[44:47], a[148:151], a[16:19], v[44:47]
 ds_read_b64_tr_b16 a[132:133], v227 offset:0
 v_mfma_f32_16x16x32_bf16 v[48:51], a[148:151], a[20:23], v[48:51]
 ds_read_b64_tr_b16 a[134:135], v227 offset:8192
 v_mfma_f32_16x16x32_bf16 v[52:55], a[152:155], a[16:19], v[52:55]
 ds_read_b64_tr_b16 a[136:137], v226 offset:256
 ds_read_b64_tr_b16 a[138:139], v226 offset:8448
 v_mfma_f32_16x16x32_bf16 v[56:59], a[152:155], a[20:23], v[56:59]
 buffer_load_dwordx4 a[48:51], v2, s[4:7], s40 offen offset:2048
 v_mfma_f32_16x16x32_bf16 v[60:63], a[156:159], a[16:19], v[60:63]
 ds_read_b64_tr_b16 a[140:141], v227 offset:256
 v_mfma_f32_16x16x32_bf16 v[64:67], a[156:159], a[20:23], v[64:67]
 ds_read_b64_tr_b16 a[142:143], v227 offset:8448
 s_waitcnt lgkmcnt(8)
 v_mfma_f32_16x16x32_bf16 v[68:71], a[160:163], a[16:19], v[68:71]
 ds_read_b64_tr_b16 a[144:145], v226 offset:512
 ds_read_b64_tr_b16 a[146:147], v226 offset:8704
 v_mfma_f32_16x16x32_bf16 v[72:75], a[160:163], a[20:23], v[72:75]
 buffer_load_dwordx4 a[52:55], v2, s[4:7], s41 offen offset:2048
 v_mfma_f32_16x16x32_bf16 v[76:79], a[164:167], a[16:19], v[76:79]
 ds_read_b64_tr_b16 a[148:149], v227 offset:512
 s_add_u32 m0, s8, 0x20000
 v_mfma_f32_16x16x32_bf16 v[80:83], a[164:167], a[20:23], v[80:83]
 ds_read_b64_tr_b16 a[150:151], v227 offset:8704
 v_mfma_f32_16x16x32_bf16 v[84:87], a[168:171], a[16:19], v[84:87]
 ds_read_b64_tr_b16 a[152:153], v226 offset:768
 ds_read_b64_tr_b16 a[154:155], v226 offset:8960
 v_mfma_f32_16x16x32_bf16 v[88:91], a[168:171], a[20:23], v[88:91]
 buffer_load_dwordx4 v140, s[48:51], s66 offen offset:0 lds
 v_mfma_f32_16x16x32_bf16 v[92:95], a[172:175], a[16:19], v[92:95]
 ds_read_b64_tr_b16 a[156:157], v227 offset:768
 v_mfma_f32_16x16x32_bf16 v[96:99], a[172:175], a[20:23], v[96:99]
 ds_read_b64_tr_b16 a[158:159], v227 offset:8960
 v_mfma_f32_16x16x32_bf16 v[100:103], a[176:179], a[16:19], v[100:103]
 ds_read_b64_tr_b16 a[160:161], v226 offset:1024
 v_mfma_f32_16x16x32_bf16 v[104:107], a[176:179], a[20:23], v[104:107]
 ds_read_b64_tr_b16 a[162:163], v226 offset:9216
 v_mfma_f32_16x16x32_bf16 v[108:111], a[180:183], a[16:19], v[108:111]
 buffer_load_dwordx4 v141, s[52:55], s66 offen offset:1024 lds
 v_mfma_f32_16x16x32_bf16 v[112:115], a[180:183], a[20:23], v[112:115]
 ds_read_b64_tr_b16 a[164:165], v227 offset:1024
 ds_read_b64_tr_b16 a[166:167], v227 offset:9216
 v_mfma_f32_16x16x32_bf16 v[116:119], a[184:187], a[16:19], v[116:119]
 ds_read_b64_tr_b16 a[168:169], v226 offset:1280
 v_mfma_f32_16x16x32_bf16 v[120:123], a[184:187], a[20:23], v[120:123]
 ds_read_b64_tr_b16 a[170:171], v226 offset:9472
 v_mfma_f32_16x16x32_bf16 v[124:127], a[188:191], a[16:19], v[124:127]
 buffer_load_dwordx4 v142, s[48:51], s66 offen offset:2048 lds
 buffer_load_dwordx4 v143, s[52:55], s66 offen offset:3072 lds
 s_add_u32 s66, s66, 114688
 v_mfma_f32_16x16x32_bf16 v[128:131], a[188:191], a[20:23], v[128:131]
 ds_read_b64_tr_b16 a[172:173], v227 offset:1280
 ds_read_b64_tr_b16 a[174:175], v227 offset:9472
 s_waitcnt vmcnt(22) lgkmcnt(8)
 v_mfma_f32_16x16x32_bf16 v[4:7], a[128:131], a[24:27], v[4:7]
 ds_read_b64_tr_b16 a[176:177], v226 offset:1536
 s_waitcnt vmcnt(21)
 v_mfma_f32_16x16x32_bf16 v[8:11], a[128:131], a[28:31], v[8:11]
 ds_read_b64_tr_b16 a[178:179], v226 offset:9728
 v_mfma_f32_16x16x32_bf16 v[12:15], a[132:135], a[24:27], v[12:15]
 ds_read_b64_tr_b16 a[180:181], v227 offset:1536
 v_mfma_f32_16x16x32_bf16 v[16:19], a[132:135], a[28:31], v[16:19]
 ds_read_b64_tr_b16 a[182:183], v227 offset:9728
 v_mfma_f32_16x16x32_bf16 v[20:23], a[136:139], a[24:27], v[20:23]
 ds_read_b64_tr_b16 a[184:185], v226 offset:1792
 v_mfma_f32_16x16x32_bf16 v[24:27], a[136:139], a[28:31], v[24:27]
 ds_read_b64_tr_b16 a[186:187], v226 offset:9984
 v_mfma_f32_16x16x32_bf16 v[28:31], a[140:143], a[24:27], v[28:31]
 ds_read_b64_tr_b16 a[188:189], v227 offset:1792
 v_mfma_f32_16x16x32_bf16 v[32:35], a[140:143], a[28:31], v[32:35]
 ds_read_b64_tr_b16 a[190:191], v227 offset:9984
 v_add_u32 v224, 0x18000, v144
 v_mfma_f32_16x16x32_bf16 v[36:39], a[144:147], a[24:27], v[36:39]
 v_add_u32 v225, 0x18000, v145
 ds_read_b64_tr_b16 a[128:129], v224 offset:0
 v_mfma_f32_16x16x32_bf16 v[40:43], a[144:147], a[28:31], v[40:43]
 buffer_load_dwordx4 v[228:231], v2, s[56:59], s60 offen offset:3072
 ds_read_b64_tr_b16 a[130:131], v224 offset:8192
 v_mfma_f32_16x16x32_bf16 v[44:47], a[148:151], a[24:27], v[44:47]
 ds_read_b64_tr_b16 a[132:133], v225 offset:0
 s_add_u32 s60, s60, 0x1000
 v_mfma_f32_16x16x32_bf16 v[48:51], a[148:151], a[28:31], v[48:51]
 ds_read_b64_tr_b16 a[134:135], v225 offset:8192
 v_mfma_f32_16x16x32_bf16 v[52:55], a[152:155], a[24:27], v[52:55]
 ds_read_b64_tr_b16 a[136:137], v224 offset:256
 ds_read_b64_tr_b16 a[138:139], v224 offset:8448
 v_mfma_f32_16x16x32_bf16 v[56:59], a[152:155], a[28:31], v[56:59]
 buffer_load_dwordx4 a[56:59], v2, s[4:7], s40 offen offset:3072
 v_mfma_f32_16x16x32_bf16 v[60:63], a[156:159], a[24:27], v[60:63]
 ds_read_b64_tr_b16 a[140:141], v225 offset:256
 v_mfma_f32_16x16x32_bf16 v[64:67], a[156:159], a[28:31], v[64:67]
 ds_read_b64_tr_b16 a[142:143], v225 offset:8448
 s_waitcnt lgkmcnt(8)
 v_mfma_f32_16x16x32_bf16 v[68:71], a[160:163], a[24:27], v[68:71]
 ds_read_b64_tr_b16 a[144:145], v224 offset:512
 ds_read_b64_tr_b16 a[146:147], v224 offset:8704
 v_mfma_f32_16x16x32_bf16 v[72:75], a[160:163], a[28:31], v[72:75]
 buffer_load_dwordx4 a[60:63], v2, s[4:7], s41 offen offset:3072
 v_mfma_f32_16x16x32_bf16 v[76:79], a[164:167], a[24:27], v[76:79]
 s_add_u32 s40, s40, 0x1000
 ds_read_b64_tr_b16 a[148:149], v225 offset:512
 v_mfma_f32_16x16x32_bf16 v[80:83], a[164:167], a[28:31], v[80:83]
 s_add_u32 s41, s41, 0x1000
 ds_read_b64_tr_b16 a[150:151], v225 offset:8704
 v_mfma_f32_16x16x32_bf16 v[84:87], a[168:171], a[24:27], v[84:87]
 s_add_u32 m0, s8, 0x24000
 ds_read_b64_tr_b16 a[152:153], v224 offset:768
 v_mfma_f32_16x16x32_bf16 v[88:91], a[168:171], a[28:31], v[88:91]
 buffer_load_dwordx4 v140, s[48:51], s66 offen offset:0 lds
 ds_read_b64_tr_b16 a[154:155], v224 offset:8960
 v_mfma_f32_16x16x32_bf16 v[92:95], a[172:175], a[24:27], v[92:95]
 ds_read_b64_tr_b16 a[156:157], v225 offset:768
 v_mfma_f32_16x16x32_bf16 v[96:99], a[172:175], a[28:31], v[96:99]
 ds_read_b64_tr_b16 a[158:159], v225 offset:8960
 v_mfma_f32_16x16x32_bf16 v[100:103], a[176:179], a[24:27], v[100:103]
 ds_read_b64_tr_b16 a[160:161], v224 offset:1024
 v_mfma_f32_16x16x32_bf16 v[104:107], a[176:179], a[28:31], v[104:107]
 ds_read_b64_tr_b16 a[162:163], v224 offset:9216
 v_mfma_f32_16x16x32_bf16 v[108:111], a[180:183], a[24:27], v[108:111]
 buffer_load_dwordx4 v141, s[52:55], s66 offen offset:1024 lds
 v_mfma_f32_16x16x32_bf16 v[112:115], a[180:183], a[28:31], v[112:115]
 ds_read_b64_tr_b16 a[164:165], v225 offset:1024
 ds_read_b64_tr_b16 a[166:167], v225 offset:9216
 v_mfma_f32_16x16x32_bf16 v[116:119], a[184:187], a[24:27], v[116:119]
 ds_read_b64_tr_b16 a[168:169], v224 offset:1280
 v_mfma_f32_16x16x32_bf16 v[120:123], a[184:187], a[28:31], v[120:123]
 ds_read_b64_tr_b16 a[170:171], v224 offset:9472
 ds_read_b64_tr_b16 a[172:173], v225 offset:1280
 v_mfma_f32_16x16x32_bf16 v[124:127], a[188:191], a[24:27], v[124:127]
 buffer_load_dwordx4 v142, s[48:51], s66 offen offset:2048 lds
 ds_read_b64_tr_b16 a[174:175], v225 offset:9472
 buffer_load_dwordx4 v143, s[52:55], s66 offen offset:3072 lds
 s_add_u32 s66, s66, 114688
 v_mfma_f32_16x16x32_bf16 v[128:131], a[188:191], a[28:31], v[128:131]
 s_waitcnt vmcnt(21)
 s_barrier
 s_waitcnt lgkmcnt(7)
 v_mfma_f32_16x16x32_bf16 v[4:7], a[128:131], a[32:35], v[4:7]
 ds_read_b64_tr_b16 a[176:177], v224 offset:1536
 v_mfma_f32_16x16x32_bf16 v[8:11], a[128:131], a[36:39], v[8:11]
 ds_read_b64_tr_b16 a[178:179], v224 offset:9728
 v_mfma_f32_16x16x32_bf16 v[12:15], a[132:135], a[32:35], v[12:15]
 ds_read_b64_tr_b16 a[180:181], v225 offset:1536
 v_mfma_f32_16x16x32_bf16 v[16:19], a[132:135], a[36:39], v[16:19]
 ds_read_b64_tr_b16 a[182:183], v225 offset:9728
 v_mfma_f32_16x16x32_bf16 v[20:23], a[136:139], a[32:35], v[20:23]
 ds_read_b64_tr_b16 a[184:185], v224 offset:1792
 v_mfma_f32_16x16x32_bf16 v[24:27], a[136:139], a[36:39], v[24:27]
 ds_read_b64_tr_b16 a[186:187], v224 offset:9984
 v_mfma_f32_16x16x32_bf16 v[28:31], a[140:143], a[32:35], v[28:31]
 ds_read_b64_tr_b16 a[188:189], v225 offset:1792
 v_mfma_f32_16x16x32_bf16 v[32:35], a[140:143], a[36:39], v[32:35]
 ds_read_b64_tr_b16 a[190:191], v225 offset:9984
 v_add_u32 v226, 0x1c000, v144
 v_mfma_f32_16x16x32_bf16 v[36:39], a[144:147], a[32:35], v[36:39]
 v_add_u32 v227, 0x1c000, v145
 ds_read_b64_tr_b16 a[128:129], v226 offset:0
 v_mfma_f32_16x16x32_bf16 v[40:43], a[144:147], a[36:39], v[40:43]
 buffer_load_dwordx4 v[228:231], v2, s[56:59], s60 offen offset:0
 ds_read_b64_tr_b16 a[130:131], v226 offset:8192
 v_mfma_f32_16x16x32_bf16 v[44:47], a[148:151], a[32:35], v[44:47]
 ds_read_b64_tr_b16 a[132:133], v227 offset:0
 v_mfma_f32_16x16x32_bf16 v[48:51], a[148:151], a[36:39], v[48:51]
 ds_read_b64_tr_b16 a[134:135], v227 offset:8192
 v_mfma_f32_16x16x32_bf16 v[52:55], a[152:155], a[32:35], v[52:55]
 ds_read_b64_tr_b16 a[136:137], v226 offset:256
 ds_read_b64_tr_b16 a[138:139], v226 offset:8448
 v_mfma_f32_16x16x32_bf16 v[56:59], a[152:155], a[36:39], v[56:59]
 buffer_load_dwordx4 a[64:67], v2, s[4:7], s40 offen offset:0
 v_mfma_f32_16x16x32_bf16 v[60:63], a[156:159], a[32:35], v[60:63]
 ds_read_b64_tr_b16 a[140:141], v227 offset:256
 v_mfma_f32_16x16x32_bf16 v[64:67], a[156:159], a[36:39], v[64:67]
 ds_read_b64_tr_b16 a[142:143], v227 offset:8448
 s_waitcnt lgkmcnt(8)
 v_mfma_f32_16x16x32_bf16 v[68:71], a[160:163], a[32:35], v[68:71]
 ds_read_b64_tr_b16 a[144:145], v226 offset:512
 ds_read_b64_tr_b16 a[146:147], v226 offset:8704
 v_mfma_f32_16x16x32_bf16 v[72:75], a[160:163], a[36:39], v[72:75]
 buffer_load_dwordx4 a[68:71], v2, s[4:7], s41 offen offset:0
 v_mfma_f32_16x16x32_bf16 v[76:79], a[164:167], a[32:35], v[76:79]
 ds_read_b64_tr_b16 a[148:149], v227 offset:512
 s_add_u32 m0, s8, 0x8000
 v_mfma_f32_16x16x32_bf16 v[80:83], a[164:167], a[36:39], v[80:83]
 ds_read_b64_tr_b16 a[150:151], v227 offset:8704
 v_mfma_f32_16x16x32_bf16 v[84:87], a[168:171], a[32:35], v[84:87]
 ds_read_b64_tr_b16 a[152:153], v226 offset:768
 ds_read_b64_tr_b16 a[154:155], v226 offset:8960
 v_mfma_f32_16x16x32_bf16 v[88:91], a[168:171], a[36:39], v[88:91]
 buffer_load_dwordx4 v140, s[48:51], s66 offen offset:0 lds
 v_mfma_f32_16x16x32_bf16 v[92:95], a[172:175], a[32:35], v[92:95]
 ds_read_b64_tr_b16 a[156:157], v227 offset:768
 v_mfma_f32_16x16x32_bf16 v[96:99], a[172:175], a[36:39], v[96:99]
 ds_read_b64_tr_b16 a[158:159], v227 offset:8960
 v_mfma_f32_16x16x32_bf16 v[100:103], a[176:179], a[32:35], v[100:103]
 ds_read_b64_tr_b16 a[160:161], v226 offset:1024
 v_mfma_f32_16x16x32_bf16 v[104:107], a[176:179], a[36:39], v[104:107]
 ds_read_b64_tr_b16 a[162:163], v226 offset:9216
 v_mfma_f32_16x16x32_bf16 v[108:111], a[180:183], a[32:35], v[108:111]
 buffer_load_dwordx4 v141, s[52:55], s66 offen offset:1024 lds
 v_mfma_f32_16x16x32_bf16 v[112:115], a[180:183], a[36:39], v[112:115]
 ds_read_b64_tr_b16 a[164:165], v227 offset:1024
 ds_read_b64_tr_b16 a[166:167], v227 offset:9216
 v_mfma_f32_16x16x32_bf16 v[116:119], a[184:187], a[32:35], v[116:119]
 ds_read_b64_tr_b16 a[168:169], v226 offset:1280
 v_mfma_f32_16x16x32_bf16 v[120:123], a[184:187], a[36:39], v[120:123]
 ds_read_b64_tr_b16 a[170:171], v226 offset:9472
 v_mfma_f32_16x16x32_bf16 v[124:127], a[188:191], a[32:35], v[124:127]
 buffer_load_dwordx4 v142, s[48:51], s66 offen offset:2048 lds
 buffer_load_dwordx4 v143, s[52:55], s66 offen offset:3072 lds
 s_add_u32 s66, s66, 114688
 v_mfma_f32_16x16x32_bf16 v[128:131], a[188:191], a[36:39], v[128:131]
 ds_read_b64_tr_b16 a[172:173], v227 offset:1280
 ds_read_b64_tr_b16 a[174:175], v227 offset:9472
 s_waitcnt vmcnt(26) lgkmcnt(8)
 v_mfma_f32_16x16x32_bf16 v[4:7], a[128:131], a[40:43], v[4:7]
 ds_read_b64_tr_b16 a[176:177], v226 offset:1536
 s_waitcnt vmcnt(25)
 v_mfma_f32_16x16x32_bf16 v[8:11], a[128:131], a[44:47], v[8:11]
 ds_read_b64_tr_b16 a[178:179], v226 offset:9728
 v_mfma_f32_16x16x32_bf16 v[12:15], a[132:135], a[40:43], v[12:15]
 ds_read_b64_tr_b16 a[180:181], v227 offset:1536
 v_mfma_f32_16x16x32_bf16 v[16:19], a[132:135], a[44:47], v[16:19]
 ds_read_b64_tr_b16 a[182:183], v227 offset:9728
 v_mfma_f32_16x16x32_bf16 v[20:23], a[136:139], a[40:43], v[20:23]
 ds_read_b64_tr_b16 a[184:185], v226 offset:1792
 v_mfma_f32_16x16x32_bf16 v[24:27], a[136:139], a[44:47], v[24:27]
 ds_read_b64_tr_b16 a[186:187], v226 offset:9984
 v_mfma_f32_16x16x32_bf16 v[28:31], a[140:143], a[40:43], v[28:31]
 ds_read_b64_tr_b16 a[188:189], v227 offset:1792
 v_mfma_f32_16x16x32_bf16 v[32:35], a[140:143], a[44:47], v[32:35]
 ds_read_b64_tr_b16 a[190:191], v227 offset:9984
 v_add_u32 v224, 0x0, v144
 v_mfma_f32_16x16x32_bf16 v[36:39], a[144:147], a[40:43], v[36:39]
 v_add_u32 v225, 0x0, v145
 ds_read_b64_tr_b16 a[128:129], v224 offset:0
 v_mfma_f32_16x16x32_bf16 v[40:43], a[144:147], a[44:47], v[40:43]
 buffer_load_dwordx4 v[228:231], v2, s[56:59], s60 offen offset:1024
 ds_read_b64_tr_b16 a[130:131], v224 offset:8192
 v_mfma_f32_16x16x32_bf16 v[44:47], a[148:151], a[40:43], v[44:47]
 ds_read_b64_tr_b16 a[132:133], v225 offset:0
 v_mfma_f32_16x16x32_bf16 v[48:51], a[148:151], a[44:47], v[48:51]
 ds_read_b64_tr_b16 a[134:135], v225 offset:8192
 v_mfma_f32_16x16x32_bf16 v[52:55], a[152:155], a[40:43], v[52:55]
 ds_read_b64_tr_b16 a[136:137], v224 offset:256
 ds_read_b64_tr_b16 a[138:139], v224 offset:8448
 v_mfma_f32_16x16x32_bf16 v[56:59], a[152:155], a[44:47], v[56:59]
 buffer_load_dwordx4 a[72:75], v2, s[4:7], s40 offen offset:1024
 v_mfma_f32_16x16x32_bf16 v[60:63], a[156:159], a[40:43], v[60:63]
 ds_read_b64_tr_b16 a[140:141], v225 offset:256
 v_mfma_f32_16x16x32_bf16 v[64:67], a[156:159], a[44:47], v[64:67]
 ds_read_b64_tr_b16 a[142:143], v225 offset:8448
 s_waitcnt lgkmcnt(8)
 v_mfma_f32_16x16x32_bf16 v[68:71], a[160:163], a[40:43], v[68:71]
 ds_read_b64_tr_b16 a[144:145], v224 offset:512
 ds_read_b64_tr_b16 a[146:147], v224 offset:8704
 v_mfma_f32_16x16x32_bf16 v[72:75], a[160:163], a[44:47], v[72:75]
 buffer_load_dwordx4 a[76:79], v2, s[4:7], s41 offen offset:1024
 v_mfma_f32_16x16x32_bf16 v[76:79], a[164:167], a[40:43], v[76:79]
 ds_read_b64_tr_b16 a[148:149], v225 offset:512
 s_add_u32 m0, s8, 0xc000
 v_mfma_f32_16x16x32_bf16 v[80:83], a[164:167], a[44:47], v[80:83]
 ds_read_b64_tr_b16 a[150:151], v225 offset:8704
 v_mfma_f32_16x16x32_bf16 v[84:87], a[168:171], a[40:43], v[84:87]
 ds_read_b64_tr_b16 a[152:153], v224 offset:768
 ds_read_b64_tr_b16 a[154:155], v224 offset:8960
 v_mfma_f32_16x16x32_bf16 v[88:91], a[168:171], a[44:47], v[88:91]
 buffer_load_dwordx4 v140, s[48:51], s66 offen offset:0 lds
 v_mfma_f32_16x16x32_bf16 v[92:95], a[172:175], a[40:43], v[92:95]
 ds_read_b64_tr_b16 a[156:157], v225 offset:768
 v_mfma_f32_16x16x32_bf16 v[96:99], a[172:175], a[44:47], v[96:99]
 ds_read_b64_tr_b16 a[158:159], v225 offset:8960
 v_mfma_f32_16x16x32_bf16 v[100:103], a[176:179], a[40:43], v[100:103]
 ds_read_b64_tr_b16 a[160:161], v224 offset:1024
 v_mfma_f32_16x16x32_bf16 v[104:107], a[176:179], a[44:47], v[104:107]
 ds_read_b64_tr_b16 a[162:163], v224 offset:9216
 v_mfma_f32_16x16x32_bf16 v[108:111], a[180:183], a[40:43], v[108:111]
 buffer_load_dwordx4 v141, s[52:55], s66 offen offset:1024 lds
 v_mfma_f32_16x16x32_bf16 v[112:115], a[180:183], a[44:47], v[112:115]
 ds_read_b64_tr_b16 a[164:165], v225 offset:1024
 ds_read_b64_tr_b16 a[166:167], v225 offset:9216
 v_mfma_f32_16x16x32_bf16 v[116:119], a[184:187], a[40:43], v[116:119]
 ds_read_b64_tr_b16 a[168:169], v224 offset:1280
 v_mfma_f32_16x16x32_bf16 v[120:123], a[184:187], a[44:47], v[120:123]
 ds_read_b64_tr_b16 a[170:171], v224 offset:9472
 ds_read_b64_tr_b16 a[172:173], v225 offset:1280
 v_mfma_f32_16x16x32_bf16 v[124:127], a[188:191], a[40:43], v[124:127]
 buffer_load_dwordx4 v142, s[48:51], s66 offen offset:2048 lds
 ds_read_b64_tr_b16 a[174:175], v225 offset:9472
 buffer_load_dwordx4 v143, s[52:55], s66 offen offset:3072 lds
 s_add_u32 s66, s66, 114688
 v_mfma_f32_16x16x32_bf16 v[128:131], a[188:191], a[44:47], v[128:131]
 s_waitcnt vmcnt(21)
 s_barrier
 s_waitcnt lgkmcnt(7)
 v_mfma_f32_16x16x32_bf16 v[4:7], a[128:131], a[48:51], v[4:7]
 ds_read_b64_tr_b16 a[176:177], v224 offset:1536
 v_mfma_f32_16x16x32_bf16 v[8:11], a[128:131], a[52:55], v[8:11]
 ds_read_b64_tr_b16 a[178:179], v224 offset:9728
 v_mfma_f32_16x16x32_bf16 v[12:15], a[132:135], a[48:51], v[12:15]
 ds_read_b64_tr_b16 a[180:181], v225 offset:1536
 v_mfma_f32_16x16x32_bf16 v[16:19], a[132:135], a[52:55], v[16:19]
 ds_read_b64_tr_b16 a[182:183], v225 offset:9728
 v_mfma_f32_16x16x32_bf16 v[20:23], a[136:139], a[48:51], v[20:23]
 ds_read_b64_tr_b16 a[184:185], v224 offset:1792
 v_mfma_f32_16x16x32_bf16 v[24:27], a[136:139], a[52:55], v[24:27]
 ds_read_b64_tr_b16 a[186:187], v224 offset:9984
 v_mfma_f32_16x16x32_bf16 v[28:31], a[140:143], a[48:51], v[28:31]
 ds_read_b64_tr_b16 a[188:189], v225 offset:1792
 v_mfma_f32_16x16x32_bf16 v[32:35], a[140:143], a[52:55], v[32:35]
 ds_read_b64_tr_b16 a[190:191], v225 offset:9984
 v_add_u32 v226, 0x4000, v144
 v_mfma_f32_16x16x32_bf16 v[36:39], a[144:147], a[48:51], v[36:39]
 v_add_u32 v227, 0x4000, v145
 ds_read_b64_tr_b16 a[128:129], v226 offset:0
 v_mfma_f32_16x16x32_bf16 v[40:43], a[144:147], a[52:55], v[40:43]
 buffer_load_dwordx4 v[228:231], v2, s[56:59], s60 offen offset:2048
 ds_read_b64_tr_b16 a[130:131], v226 offset:8192
 v_mfma_f32_16x16x32_bf16 v[44:47], a[148:151], a[48:51], v[44:47]
 ds_read_b64_tr_b16 a[132:133], v227 offset:0
 v_mfma_f32_16x16x32_bf16 v[48:51], a[148:151], a[52:55], v[48:51]
 ds_read_b64_tr_b16 a[134:135], v227 offset:8192
 v_mfma_f32_16x16x32_bf16 v[52:55], a[152:155], a[48:51], v[52:55]
 ds_read_b64_tr_b16 a[136:137], v226 offset:256
 ds_read_b64_tr_b16 a[138:139], v226 offset:8448
 v_mfma_f32_16x16x32_bf16 v[56:59], a[152:155], a[52:55], v[56:59]
 buffer_load_dwordx4 a[80:83], v2, s[4:7], s40 offen offset:2048
 v_mfma_f32_16x16x32_bf16 v[60:63], a[156:159], a[48:51], v[60:63]
 ds_read_b64_tr_b16 a[140:141], v227 offset:256
 v_mfma_f32_16x16x32_bf16 v[64:67], a[156:159], a[52:55], v[64:67]
 ds_read_b64_tr_b16 a[142:143], v227 offset:8448
 s_waitcnt lgkmcnt(8)
 v_mfma_f32_16x16x32_bf16 v[68:71], a[160:163], a[48:51], v[68:71]
 ds_read_b64_tr_b16 a[144:145], v226 offset:512
 ds_read_b64_tr_b16 a[146:147], v226 offset:8704
 v_mfma_f32_16x16x32_bf16 v[72:75], a[160:163], a[52:55], v[72:75]
 buffer_load_dwordx4 a[84:87], v2, s[4:7], s41 offen offset:2048
 v_mfma_f32_16x16x32_bf16 v[76:79], a[164:167], a[48:51], v[76:79]
 ds_read_b64_tr_b16 a[148:149], v227 offset:512
 s_add_u32 m0, s8, 0x10000
 v_mfma_f32_16x16x32_bf16 v[80:83], a[164:167], a[52:55], v[80:83]
 ds_read_b64_tr_b16 a[150:151], v227 offset:8704
 v_mfma_f32_16x16x32_bf16 v[84:87], a[168:171], a[48:51], v[84:87]
 ds_read_b64_tr_b16 a[152:153], v226 offset:768
 ds_read_b64_tr_b16 a[154:155], v226 offset:8960
 v_mfma_f32_16x16x32_bf16 v[88:91], a[168:171], a[52:55], v[88:91]
 buffer_load_dwordx4 v140, s[48:51], s66 offen offset:0 lds
 v_mfma_f32_16x16x32_bf16 v[92:95], a[172:175], a[48:51], v[92:95]
 ds_read_b64_tr_b16 a[156:157], v227 offset:768
 v_mfma_f32_16x16x32_bf16 v[96:99], a[172:175], a[52:55], v[96:99]
 ds_read_b64_tr_b16 a[158:159], v227 offset:8960
 v_mfma_f32_16x16x32_bf16 v[100:103], a[176:179], a[48:51], v[100:103]
 ds_read_b64_tr_b16 a[160:161], v226 offset:1024
 v_mfma_f32_16x16x32_bf16 v[104:107], a[176:179], a[52:55], v[104:107]
 ds_read_b64_tr_b16 a[162:163], v226 offset:9216
 v_mfma_f32_16x16x32_bf16 v[108:111], a[180:183], a[48:51], v[108:111]
 buffer_load_dwordx4 v141, s[52:55], s66 offen offset:1024 lds
 v_mfma_f32_16x16x32_bf16 v[112:115], a[180:183], a[52:55], v[112:115]
 ds_read_b64_tr_b16 a[164:165], v227 offset:1024
 ds_read_b64_tr_b16 a[166:167], v227 offset:9216
 v_mfma_f32_16x16x32_bf16 v[116:119], a[184:187], a[48:51], v[116:119]
 ds_read_b64_tr_b16 a[168:169], v226 offset:1280
 v_mfma_f32_16x16x32_bf16 v[120:123], a[184:187], a[52:55], v[120:123]
 ds_read_b64_tr_b16 a[170:171], v226 offset:9472
 v_mfma_f32_16x16x32_bf16 v[124:127], a[188:191], a[48:51], v[124:127]
 buffer_load_dwordx4 v142, s[48:51], s66 offen offset:2048 lds
 buffer_load_dwordx4 v143, s[52:55], s66 offen offset:3072 lds
 s_add_u32 s66, s66, 114688
 v_mfma_f32_16x16x32_bf16 v[128:131], a[188:191], a[52:55], v[128:131]
 ds_read_b64_tr_b16 a[172:173], v227 offset:1280
 ds_read_b64_tr_b16 a[174:175], v227 offset:9472
 s_waitcnt vmcnt(26) lgkmcnt(8)
 v_mfma_f32_16x16x32_bf16 v[4:7], a[128:131], a[56:59], v[4:7]
 ds_read_b64_tr_b16 a[176:177], v226 offset:1536
 s_waitcnt vmcnt(25)
 v_mfma_f32_16x16x32_bf16 v[8:11], a[128:131], a[60:63], v[8:11]
 ds_read_b64_tr_b16 a[178:179], v226 offset:9728
 v_mfma_f32_16x16x32_bf16 v[12:15], a[132:135], a[56:59], v[12:15]
 ds_read_b64_tr_b16 a[180:181], v227 offset:1536
 v_mfma_f32_16x16x32_bf16 v[16:19], a[132:135], a[60:63], v[16:19]
 ds_read_b64_tr_b16 a[182:183], v227 offset:9728
 v_mfma_f32_16x16x32_bf16 v[20:23], a[136:139], a[56:59], v[20:23]
 ds_read_b64_tr_b16 a[184:185], v226 offset:1792
 v_mfma_f32_16x16x32_bf16 v[24:27], a[136:139], a[60:63], v[24:27]
 ds_read_b64_tr_b16 a[186:187], v226 offset:9984
 v_mfma_f32_16x16x32_bf16 v[28:31], a[140:143], a[56:59], v[28:31]
 ds_read_b64_tr_b16 a[188:189], v227 offset:1792
 v_mfma_f32_16x16x32_bf16 v[32:35], a[140:143], a[60:63], v[32:35]
 ds_read_b64_tr_b16 a[190:191], v227 offset:9984
 v_add_u32 v224, 0x20000, v144
 v_mfma_f32_16x16x32_bf16 v[36:39], a[144:147], a[56:59], v[36:39]
 v_add_u32 v225, 0x20000, v145
 ds_read_b64_tr_b16 a[128:129], v224 offset:0
 v_mfma_f32_16x16x32_bf16 v[40:43], a[144:147], a[60:63], v[40:43]
 buffer_load_dwordx4 v[228:231], v2, s[56:59], s60 offen offset:3072
 ds_read_b64_tr_b16 a[130:131], v224 offset:8192
 v_mfma_f32_16x16x32_bf16 v[44:47], a[148:151], a[56:59], v[44:47]
 ds_read_b64_tr_b16 a[132:133], v225 offset:0
 s_add_u32 s60, s60, 0x1000
 v_mfma_f32_16x16x32_bf16 v[48:51], a[148:151], a[60:63], v[48:51]
 ds_read_b64_tr_b16 a[134:135], v225 offset:8192
 v_mfma_f32_16x16x32_bf16 v[52:55], a[152:155], a[56:59], v[52:55]
 ds_read_b64_tr_b16 a[136:137], v224 offset:256
 ds_read_b64_tr_b16 a[138:139], v224 offset:8448
 v_mfma_f32_16x16x32_bf16 v[56:59], a[152:155], a[60:63], v[56:59]
 buffer_load_dwordx4 a[88:91], v2, s[4:7], s40 offen offset:3072
 v_mfma_f32_16x16x32_bf16 v[60:63], a[156:159], a[56:59], v[60:63]
 ds_read_b64_tr_b16 a[140:141], v225 offset:256
 v_mfma_f32_16x16x32_bf16 v[64:67], a[156:159], a[60:63], v[64:67]
 ds_read_b64_tr_b16 a[142:143], v225 offset:8448
 s_waitcnt lgkmcnt(8)
 v_mfma_f32_16x16x32_bf16 v[68:71], a[160:163], a[56:59], v[68:71]
 ds_read_b64_tr_b16 a[144:145], v224 offset:512
 ds_read_b64_tr_b16 a[146:147], v224 offset:8704
 v_mfma_f32_16x16x32_bf16 v[72:75], a[160:163], a[60:63], v[72:75]
 buffer_load_dwordx4 a[92:95], v2, s[4:7], s41 offen offset:3072
 v_mfma_f32_16x16x32_bf16 v[76:79], a[164:167], a[56:59], v[76:79]
 s_add_u32 s40, s40, 0x1000
 ds_read_b64_tr_b16 a[148:149], v225 offset:512
 v_mfma_f32_16x16x32_bf16 v[80:83], a[164:167], a[60:63], v[80:83]
 s_add_u32 s41, s41, 0x1000
 ds_read_b64_tr_b16 a[150:151], v225 offset:8704
 v_mfma_f32_16x16x32_bf16 v[84:87], a[168:171], a[56:59], v[84:87]
 s_add_u32 m0, s8, 0x14000
 ds_read_b64_tr_b16 a[152:153], v224 offset:768
 v_mfma_f32_16x16x32_bf16 v[88:91], a[168:171], a[60:63], v[88:91]
 buffer_load_dwordx4 v140, s[48:51], s66 offen offset:0 lds
 ds_read_b64_tr_b16 a[154:155], v224 offset:8960
 v_mfma_f32_16x16x32_bf16 v[92:95], a[172:175], a[56:59], v[92:95]
 ds_read_b64_tr_b16 a[156:157], v225 offset:768
 v_mfma_f32_16x16x32_bf16 v[96:99], a[172:175], a[60:63], v[96:99]
 ds_read_b64_tr_b16 a[158:159], v225 offset:8960
 v_mfma_f32_16x16x32_bf16 v[100:103], a[176:179], a[56:59], v[100:103]
 ds_read_b64_tr_b16 a[160:161], v224 offset:1024
 v_mfma_f32_16x16x32_bf16 v[104:107], a[176:179], a[60:63], v[104:107]
 ds_read_b64_tr_b16 a[162:163], v224 offset:9216
 v_mfma_f32_16x16x32_bf16 v[108:111], a[180:183], a[56:59], v[108:111]
 buffer_load_dwordx4 v141, s[52:55], s66 offen offset:1024 lds
 v_mfma_f32_16x16x32_bf16 v[112:115], a[180:183], a[60:63], v[112:115]
 ds_read_b64_tr_b16 a[164:165], v225 offset:1024
 ds_read_b64_tr_b16 a[166:167], v225 offset:9216
 v_mfma_f32_16x16x32_bf16 v[116:119], a[184:187], a[56:59], v[116:119]
 ds_read_b64_tr_b16 a[168:169], v224 offset:1280
 v_mfma_f32_16x16x32_bf16 v[120:123], a[184:187], a[60:63], v[120:123]
 ds_read_b64_tr_b16 a[170:171], v224 offset:9472
 ds_read_b64_tr_b16 a[172:173], v225 offset:1280
 v_mfma_f32_16x16x32_bf16 v[124:127], a[188:191], a[56:59], v[124:127]
 buffer_load_dwordx4 v142, s[48:51], s66 offen offset:2048 lds
 ds_read_b64_tr_b16 a[174:175], v225 offset:9472
 buffer_load_dwordx4 v143, s[52:55], s66 offen offset:3072 lds
 s_add_u32 s66, s66, 114688
 v_mfma_f32_16x16x32_bf16 v[128:131], a[188:191], a[60:63], v[128:131]
 s_waitcnt vmcnt(21)
 s_barrier
 s_waitcnt lgkmcnt(7)
 v_mfma_f32_16x16x32_bf16 v[4:7], a[128:131], a[64:67], v[4:7]
 ds_read_b64_tr_b16 a[176:177], v224 offset:1536
 v_mfma_f32_16x16x32_bf16 v[8:11], a[128:131], a[68:71], v[8:11]
 ds_read_b64_tr_b16 a[178:179], v224 offset:9728
 v_mfma_f32_16x16x32_bf16 v[12:15], a[132:135], a[64:67], v[12:15]
 ds_read_b64_tr_b16 a[180:181], v225 offset:1536
 v_mfma_f32_16x16x32_bf16 v[16:19], a[132:135], a[68:71], v[16:19]
 ds_read_b64_tr_b16 a[182:183], v225 offset:9728
 v_mfma_f32_16x16x32_bf16 v[20:23], a[136:139], a[64:67], v[20:23]
 ds_read_b64_tr_b16 a[184:185], v224 offset:1792
 v_mfma_f32_16x16x32_bf16 v[24:27], a[136:139], a[68:71], v[24:27]
 ds_read_b64_tr_b16 a[186:187], v224 offset:9984
 v_mfma_f32_16x16x32_bf16 v[28:31], a[140:143], a[64:67], v[28:31]
 ds_read_b64_tr_b16 a[188:189], v225 offset:1792
 v_mfma_f32_16x16x32_bf16 v[32:35], a[140:143], a[68:71], v[32:35]
 ds_read_b64_tr_b16 a[190:191], v225 offset:9984
 v_add_u32 v226, 0x24000, v144
 v_mfma_f32_16x16x32_bf16 v[36:39], a[144:147], a[64:67], v[36:39]
 v_add_u32 v227, 0x24000, v145
 ds_read_b64_tr_b16 a[128:129], v226 offset:0
 v_mfma_f32_16x16x32_bf16 v[40:43], a[144:147], a[68:71], v[40:43]
 buffer_load_dwordx4 v[228:231], v2, s[56:59], s60 offen offset:0
 ds_read_b64_tr_b16 a[130:131], v226 offset:8192
 v_mfma_f32_16x16x32_bf16 v[44:47], a[148:151], a[64:67], v[44:47]
 ds_read_b64_tr_b16 a[132:133], v227 offset:0
 v_mfma_f32_16x16x32_bf16 v[48:51], a[148:151], a[68:71], v[48:51]
 ds_read_b64_tr_b16 a[134:135], v227 offset:8192
 v_mfma_f32_16x16x32_bf16 v[52:55], a[152:155], a[64:67], v[52:55]
 ds_read_b64_tr_b16 a[136:137], v226 offset:256
 v_mfma_f32_16x16x32_bf16 v[56:59], a[152:155], a[68:71], v[56:59]
 ds_read_b64_tr_b16 a[138:139], v226 offset:8448
 v_mfma_f32_16x16x32_bf16 v[60:63], a[156:159], a[64:67], v[60:63]
 ds_read_b64_tr_b16 a[140:141], v227 offset:256
 v_mfma_f32_16x16x32_bf16 v[64:67], a[156:159], a[68:71], v[64:67]
 ds_read_b64_tr_b16 a[142:143], v227 offset:8448
 s_waitcnt lgkmcnt(8)
 v_mfma_f32_16x16x32_bf16 v[68:71], a[160:163], a[64:67], v[68:71]
 ds_read_b64_tr_b16 a[144:145], v226 offset:512
 v_mfma_f32_16x16x32_bf16 v[72:75], a[160:163], a[68:71], v[72:75]
 ds_read_b64_tr_b16 a[146:147], v226 offset:8704
 v_mfma_f32_16x16x32_bf16 v[76:79], a[164:167], a[64:67], v[76:79]
 ds_read_b64_tr_b16 a[148:149], v227 offset:512
 ds_read_b64_tr_b16 a[150:151], v227 offset:8704
 v_mfma_f32_16x16x32_bf16 v[80:83], a[164:167], a[68:71], v[80:83]
 buffer_load_dwordx4 a[96:99], v2, s[4:7], s40 offen offset:0
 v_mfma_f32_16x16x32_bf16 v[84:87], a[168:171], a[64:67], v[84:87]
 ds_read_b64_tr_b16 a[152:153], v226 offset:768
 v_mfma_f32_16x16x32_bf16 v[88:91], a[168:171], a[68:71], v[88:91]
 ds_read_b64_tr_b16 a[154:155], v226 offset:8960
 v_mfma_f32_16x16x32_bf16 v[92:95], a[172:175], a[64:67], v[92:95]
 ds_read_b64_tr_b16 a[156:157], v227 offset:768
 v_mfma_f32_16x16x32_bf16 v[96:99], a[172:175], a[68:71], v[96:99]
 ds_read_b64_tr_b16 a[158:159], v227 offset:8960
 v_mfma_f32_16x16x32_bf16 v[100:103], a[176:179], a[64:67], v[100:103]
 ds_read_b64_tr_b16 a[160:161], v226 offset:1024
 v_mfma_f32_16x16x32_bf16 v[104:107], a[176:179], a[68:71], v[104:107]
 ds_read_b64_tr_b16 a[162:163], v226 offset:9216
 v_mfma_f32_16x16x32_bf16 v[108:111], a[180:183], a[64:67], v[108:111]
 ds_read_b64_tr_b16 a[164:165], v227 offset:1024
 v_mfma_f32_16x16x32_bf16 v[112:115], a[180:183], a[68:71], v[112:115]
 ds_read_b64_tr_b16 a[166:167], v227 offset:9216
 v_mfma_f32_16x16x32_bf16 v[116:119], a[184:187], a[64:67], v[116:119]
 ds_read_b64_tr_b16 a[168:169], v226 offset:1280
 v_mfma_f32_16x16x32_bf16 v[120:123], a[184:187], a[68:71], v[120:123]
 ds_read_b64_tr_b16 a[170:171], v226 offset:9472
 v_mfma_f32_16x16x32_bf16 v[124:127], a[188:191], a[64:67], v[124:127]
 buffer_load_dwordx4 a[100:103], v2, s[4:7], s41 offen offset:0
 v_mfma_f32_16x16x32_bf16 v[128:131], a[188:191], a[68:71], v[128:131]
 ds_read_b64_tr_b16 a[172:173], v227 offset:1280
 ds_read_b64_tr_b16 a[174:175], v227 offset:9472
 s_waitcnt vmcnt(22) lgkmcnt(9)
 v_mfma_f32_16x16x32_bf16 v[4:7], a[128:131], a[72:75], v[4:7]
 ds_read_b64_tr_b16 a[176:177], v226 offset:1536
 s_waitcnt vmcnt(21)
 v_mfma_f32_16x16x32_bf16 v[8:11], a[128:131], a[76:79], v[8:11]
 ds_read_b64_tr_b16 a[178:179], v226 offset:9728
 v_mfma_f32_16x16x32_bf16 v[12:15], a[132:135], a[72:75], v[12:15]
 ds_read_b64_tr_b16 a[180:181], v227 offset:1536
 v_mfma_f32_16x16x32_bf16 v[16:19], a[132:135], a[76:79], v[16:19]
 ds_read_b64_tr_b16 a[182:183], v227 offset:9728
 v_mfma_f32_16x16x32_bf16 v[20:23], a[136:139], a[72:75], v[20:23]
 ds_read_b64_tr_b16 a[184:185], v226 offset:1792
 v_mfma_f32_16x16x32_bf16 v[24:27], a[136:139], a[76:79], v[24:27]
 ds_read_b64_tr_b16 a[186:187], v226 offset:9984
 v_mfma_f32_16x16x32_bf16 v[28:31], a[140:143], a[72:75], v[28:31]
 ds_read_b64_tr_b16 a[188:189], v227 offset:1792
 v_mfma_f32_16x16x32_bf16 v[32:35], a[140:143], a[76:79], v[32:35]
 ds_read_b64_tr_b16 a[190:191], v227 offset:9984
 v_add_u32 v224, 0x8000, v144
 v_mfma_f32_16x16x32_bf16 v[36:39], a[144:147], a[72:75], v[36:39]
 v_add_u32 v225, 0x8000, v145
 ds_read_b64_tr_b16 a[128:129], v224 offset:0
 v_mfma_f32_16x16x32_bf16 v[40:43], a[144:147], a[76:79], v[40:43]
 buffer_load_dwordx4 v[228:231], v2, s[56:59], s60 offen offset:1024
 ds_read_b64_tr_b16 a[130:131], v224 offset:8192
 v_mfma_f32_16x16x32_bf16 v[44:47], a[148:151], a[72:75], v[44:47]
 ds_read_b64_tr_b16 a[132:133], v225 offset:0
 v_mfma_f32_16x16x32_bf16 v[48:51], a[148:151], a[76:79], v[48:51]
 ds_read_b64_tr_b16 a[134:135], v225 offset:8192
 v_mfma_f32_16x16x32_bf16 v[52:55], a[152:155], a[72:75], v[52:55]
 ds_read_b64_tr_b16 a[136:137], v224 offset:256
 v_mfma_f32_16x16x32_bf16 v[56:59], a[152:155], a[76:79], v[56:59]
 ds_read_b64_tr_b16 a[138:139], v224 offset:8448
 s_waitcnt lgkmcnt(8)
 v_mfma_f32_16x16x32_bf16 v[60:63], a[156:159], a[72:75], v[60:63]
 ds_read_b64_tr_b16 a[140:141], v225 offset:256
 v_mfma_f32_16x16x32_bf16 v[64:67], a[156:159], a[76:79], v[64:67]
 ds_read_b64_tr_b16 a[142:143], v225 offset:8448
 v_mfma_f32_16x16x32_bf16 v[68:71], a[160:163], a[72:75], v[68:71]
 ds_read_b64_tr_b16 a[144:145], v224 offset:512
 v_mfma_f32_16x16x32_bf16 v[72:75], a[160:163], a[76:79], v[72:75]
 ds_read_b64_tr_b16 a[146:147], v224 offset:8704
 v_mfma_f32_16x16x32_bf16 v[76:79], a[164:167], a[72:75], v[76:79]
 ds_read_b64_tr_b16 a[148:149], v225 offset:512
 ds_read_b64_tr_b16 a[150:151], v225 offset:8704
 v_mfma_f32_16x16x32_bf16 v[80:83], a[164:167], a[76:79], v[80:83]
 buffer_load_dwordx4 a[104:107], v2, s[4:7], s40 offen offset:1024
 v_mfma_f32_16x16x32_bf16 v[84:87], a[168:171], a[72:75], v[84:87]
 ds_read_b64_tr_b16 a[152:153], v224 offset:768
 v_mfma_f32_16x16x32_bf16 v[88:91], a[168:171], a[76:79], v[88:91]
 ds_read_b64_tr_b16 a[154:155], v224 offset:8960
 v_mfma_f32_16x16x32_bf16 v[92:95], a[172:175], a[72:75], v[92:95]
 ds_read_b64_tr_b16 a[156:157], v225 offset:768
 v_mfma_f32_16x16x32_bf16 v[96:99], a[172:175], a[76:79], v[96:99]
 ds_read_b64_tr_b16 a[158:159], v225 offset:8960
 v_mfma_f32_16x16x32_bf16 v[100:103], a[176:179], a[72:75], v[100:103]
 ds_read_b64_tr_b16 a[160:161], v224 offset:1024
 v_mfma_f32_16x16x32_bf16 v[104:107], a[176:179], a[76:79], v[104:107]
 ds_read_b64_tr_b16 a[162:163], v224 offset:9216
 v_mfma_f32_16x16x32_bf16 v[108:111], a[180:183], a[72:75], v[108:111]
 ds_read_b64_tr_b16 a[164:165], v225 offset:1024
 v_mfma_f32_16x16x32_bf16 v[112:115], a[180:183], a[76:79], v[112:115]
 ds_read_b64_tr_b16 a[166:167], v225 offset:9216
 v_mfma_f32_16x16x32_bf16 v[116:119], a[184:187], a[72:75], v[116:119]
 ds_read_b64_tr_b16 a[168:169], v224 offset:1280
 v_mfma_f32_16x16x32_bf16 v[120:123], a[184:187], a[76:79], v[120:123]
 ds_read_b64_tr_b16 a[170:171], v224 offset:9472
 ds_read_b64_tr_b16 a[172:173], v225 offset:1280
 s_waitcnt lgkmcnt(10)
 v_mfma_f32_16x16x32_bf16 v[124:127], a[188:191], a[72:75], v[124:127]
 buffer_load_dwordx4 a[108:111], v2, s[4:7], s41 offen offset:1024
 ds_read_b64_tr_b16 a[174:175], v225 offset:9472
 v_mfma_f32_16x16x32_bf16 v[128:131], a[188:191], a[76:79], v[128:131]
 s_waitcnt vmcnt(6)
 s_barrier
 v_mfma_f32_16x16x32_bf16 v[4:7], a[128:131], a[80:83], v[4:7]
 ds_read_b64_tr_b16 a[176:177], v224 offset:1536
 v_mfma_f32_16x16x32_bf16 v[8:11], a[128:131], a[84:87], v[8:11]
 ds_read_b64_tr_b16 a[178:179], v224 offset:9728
 v_mfma_f32_16x16x32_bf16 v[12:15], a[132:135], a[80:83], v[12:15]
 ds_read_b64_tr_b16 a[180:181], v225 offset:1536
 v_mfma_f32_16x16x32_bf16 v[16:19], a[132:135], a[84:87], v[16:19]
 ds_read_b64_tr_b16 a[182:183], v225 offset:9728
 v_mfma_f32_16x16x32_bf16 v[20:23], a[136:139], a[80:83], v[20:23]
 ds_read_b64_tr_b16 a[184:185], v224 offset:1792
 v_mfma_f32_16x16x32_bf16 v[24:27], a[136:139], a[84:87], v[24:27]
 ds_read_b64_tr_b16 a[186:187], v224 offset:9984
 v_mfma_f32_16x16x32_bf16 v[28:31], a[140:143], a[80:83], v[28:31]
 ds_read_b64_tr_b16 a[188:189], v225 offset:1792
 v_mfma_f32_16x16x32_bf16 v[32:35], a[140:143], a[84:87], v[32:35]
 ds_read_b64_tr_b16 a[190:191], v225 offset:9984
 v_add_u32 v226, 0xc000, v144
 v_mfma_f32_16x16x32_bf16 v[36:39], a[144:147], a[80:83], v[36:39]
 v_add_u32 v227, 0xc000, v145
 ds_read_b64_tr_b16 a[128:129], v226 offset:0
 v_mfma_f32_16x16x32_bf16 v[40:43], a[144:147], a[84:87], v[40:43]
 buffer_load_dwordx4 v[228:231], v2, s[56:59], s60 offen offset:2048
 ds_read_b64_tr_b16 a[130:131], v226 offset:8192
 v_mfma_f32_16x16x32_bf16 v[44:47], a[148:151], a[80:83], v[44:47]
 ds_read_b64_tr_b16 a[132:133], v227 offset:0
 v_mfma_f32_16x16x32_bf16 v[48:51], a[148:151], a[84:87], v[48:51]
 ds_read_b64_tr_b16 a[134:135], v227 offset:8192
 s_waitcnt lgkmcnt(8)
 v_mfma_f32_16x16x32_bf16 v[52:55], a[152:155], a[80:83], v[52:55]
 ds_read_b64_tr_b16 a[136:137], v226 offset:256
 v_mfma_f32_16x16x32_bf16 v[56:59], a[152:155], a[84:87], v[56:59]
 ds_read_b64_tr_b16 a[138:139], v226 offset:8448
 v_mfma_f32_16x16x32_bf16 v[60:63], a[156:159], a[80:83], v[60:63]
 ds_read_b64_tr_b16 a[140:141], v227 offset:256
 v_mfma_f32_16x16x32_bf16 v[64:67], a[156:159], a[84:87], v[64:67]
 ds_read_b64_tr_b16 a[142:143], v227 offset:8448
 v_mfma_f32_16x16x32_bf16 v[68:71], a[160:163], a[80:83], v[68:71]
 ds_read_b64_tr_b16 a[144:145], v226 offset:512
 v_mfma_f32_16x16x32_bf16 v[72:75], a[160:163], a[84:87], v[72:75]
 ds_read_b64_tr_b16 a[146:147], v226 offset:8704
 v_mfma_f32_16x16x32_bf16 v[76:79], a[164:167], a[80:83], v[76:79]
 ds_read_b64_tr_b16 a[148:149], v227 offset:512
 v_mfma_f32_16x16x32_bf16 v[80:83], a[164:167], a[84:87], v[80:83]
 ds_read_b64_tr_b16 a[150:151], v227 offset:8704
 v_mfma_f32_16x16x32_bf16 v[84:87], a[168:171], a[80:83], v[84:87]
 ds_read_b64_tr_b16 a[152:153], v226 offset:768
 v_mfma_f32_16x16x32_bf16 v[88:91], a[168:171], a[84:87], v[88:91]
 ds_read_b64_tr_b16 a[154:155], v226 offset:8960
 v_mfma_f32_16x16x32_bf16 v[92:95], a[172:175], a[80:83], v[92:95]
 ds_read_b64_tr_b16 a[156:157], v227 offset:768
 v_mfma_f32_16x16x32_bf16 v[96:99], a[172:175], a[84:87], v[96:99]
 ds_read_b64_tr_b16 a[158:159], v227 offset:8960
 v_mfma_f32_16x16x32_bf16 v[100:103], a[176:179], a[80:83], v[100:103]
 ds_read_b64_tr_b16 a[160:161], v226 offset:1024
 v_mfma_f32_16x16x32_bf16 v[104:107], a[176:179], a[84:87], v[104:107]
 ds_read_b64_tr_b16 a[162:163], v226 offset:9216
 v_mfma_f32_16x16x32_bf16 v[108:111], a[180:183], a[80:83], v[108:111]
 ds_read_b64_tr_b16 a[164:165], v227 offset:1024
 v_mfma_f32_16x16x32_bf16 v[112:115], a[180:183], a[84:87], v[112:115]
 ds_read_b64_tr_b16 a[166:167], v227 offset:9216
 s_waitcnt lgkmcnt(10)
 v_mfma_f32_16x16x32_bf16 v[116:119], a[184:187], a[80:83], v[116:119]
 ds_read_b64_tr_b16 a[168:169], v226 offset:1280
 v_mfma_f32_16x16x32_bf16 v[120:123], a[184:187], a[84:87], v[120:123]
 ds_read_b64_tr_b16 a[170:171], v226 offset:9472
 v_mfma_f32_16x16x32_bf16 v[124:127], a[188:191], a[80:83], v[124:127]
 ds_read_b64_tr_b16 a[172:173], v227 offset:1280
 v_mfma_f32_16x16x32_bf16 v[128:131], a[188:191], a[84:87], v[128:131]
 ds_read_b64_tr_b16 a[174:175], v227 offset:9472
 v_mfma_f32_16x16x32_bf16 v[4:7], a[128:131], a[88:91], v[4:7]
 ds_read_b64_tr_b16 a[176:177], v226 offset:1536
 v_mfma_f32_16x16x32_bf16 v[8:11], a[128:131], a[92:95], v[8:11]
 ds_read_b64_tr_b16 a[178:179], v226 offset:9728
 v_mfma_f32_16x16x32_bf16 v[12:15], a[132:135], a[88:91], v[12:15]
 ds_read_b64_tr_b16 a[180:181], v227 offset:1536
 v_mfma_f32_16x16x32_bf16 v[16:19], a[132:135], a[92:95], v[16:19]
 ds_read_b64_tr_b16 a[182:183], v227 offset:9728
 v_mfma_f32_16x16x32_bf16 v[20:23], a[136:139], a[88:91], v[20:23]
 ds_read_b64_tr_b16 a[184:185], v226 offset:1792
 v_mfma_f32_16x16x32_bf16 v[24:27], a[136:139], a[92:95], v[24:27]
 ds_read_b64_tr_b16 a[186:187], v226 offset:9984
 v_mfma_f32_16x16x32_bf16 v[28:31], a[140:143], a[88:91], v[28:31]
 ds_read_b64_tr_b16 a[188:189], v227 offset:1792
 v_mfma_f32_16x16x32_bf16 v[32:35], a[140:143], a[92:95], v[32:35]
 ds_read_b64_tr_b16 a[190:191], v227 offset:9984
 v_add_u32 v224, 0x10000, v144
 v_mfma_f32_16x16x32_bf16 v[36:39], a[144:147], a[88:91], v[36:39]
 v_add_u32 v225, 0x10000, v145
 ds_read_b64_tr_b16 a[128:129], v224 offset:0
 v_mfma_f32_16x16x32_bf16 v[40:43], a[144:147], a[92:95], v[40:43]
 buffer_load_dwordx4 v[228:231], v2, s[56:59], s60 offen offset:3072
 ds_read_b64_tr_b16 a[130:131], v224 offset:8192
 s_waitcnt lgkmcnt(8)
 v_mfma_f32_16x16x32_bf16 v[44:47], a[148:151], a[88:91], v[44:47]
 v_add_u32 v226, 0x14000, v144
 v_add_u32 v227, 0x14000, v145
 v_mfma_f32_16x16x32_bf16 v[48:51], a[148:151], a[92:95], v[48:51]
 ds_read_b64_tr_b16 a[132:133], v226 offset:0
 ds_read_b64_tr_b16 a[134:135], v226 offset:8192
 v_mfma_f32_16x16x32_bf16 v[52:55], a[152:155], a[88:91], v[52:55]
 ds_read_b64_tr_b16 a[136:137], v225 offset:0
 v_mfma_f32_16x16x32_bf16 v[56:59], a[152:155], a[92:95], v[56:59]
 ds_read_b64_tr_b16 a[138:139], v225 offset:8192
 v_mfma_f32_16x16x32_bf16 v[60:63], a[156:159], a[88:91], v[60:63]
 ds_read_b64_tr_b16 a[140:141], v227 offset:0
 v_mfma_f32_16x16x32_bf16 v[64:67], a[156:159], a[92:95], v[64:67]
 ds_read_b64_tr_b16 a[142:143], v227 offset:8192
 v_mfma_f32_16x16x32_bf16 v[68:71], a[160:163], a[88:91], v[68:71]
 ds_read_b64_tr_b16 a[144:145], v224 offset:1024
 s_add_u32 s60, s60, 0x1000
 v_mfma_f32_16x16x32_bf16 v[72:75], a[160:163], a[92:95], v[72:75]
 ds_read_b64_tr_b16 a[146:147], v224 offset:9216
 v_mfma_f32_16x16x32_bf16 v[76:79], a[164:167], a[88:91], v[76:79]
 ds_read_b64_tr_b16 a[148:149], v226 offset:1024
 v_mfma_f32_16x16x32_bf16 v[80:83], a[164:167], a[92:95], v[80:83]
 ds_read_b64_tr_b16 a[150:151], v226 offset:9216
 v_mfma_f32_16x16x32_bf16 v[84:87], a[168:171], a[88:91], v[84:87]
 ds_read_b64_tr_b16 a[152:153], v225 offset:1024
 v_mfma_f32_16x16x32_bf16 v[88:91], a[168:171], a[92:95], v[88:91]
 ds_read_b64_tr_b16 a[154:155], v225 offset:9216
 v_mfma_f32_16x16x32_bf16 v[92:95], a[172:175], a[88:91], v[92:95]
 ds_read_b64_tr_b16 a[156:157], v227 offset:1024
 v_mfma_f32_16x16x32_bf16 v[96:99], a[172:175], a[92:95], v[96:99]
 ds_read_b64_tr_b16 a[158:159], v227 offset:9216
 v_mfma_f32_16x16x32_bf16 v[100:103], a[176:179], a[88:91], v[100:103]
 ds_read_b64_tr_b16 a[160:161], v224 offset:256
 v_mfma_f32_16x16x32_bf16 v[104:107], a[176:179], a[92:95], v[104:107]
 ds_read_b64_tr_b16 a[162:163], v224 offset:8448
 s_waitcnt lgkmcnt(9)
 v_mfma_f32_16x16x32_bf16 v[108:111], a[180:183], a[88:91], v[108:111]
 ds_read_b64_tr_b16 a[164:165], v226 offset:256
 v_mfma_f32_16x16x32_bf16 v[112:115], a[180:183], a[92:95], v[112:115]
 ds_read_b64_tr_b16 a[166:167], v226 offset:8448
 v_mfma_f32_16x16x32_bf16 v[116:119], a[184:187], a[88:91], v[116:119]
 ds_read_b64_tr_b16 a[168:169], v225 offset:256
 v_mfma_f32_16x16x32_bf16 v[120:123], a[184:187], a[92:95], v[120:123]
 ds_read_b64_tr_b16 a[170:171], v225 offset:8448
 v_mfma_f32_16x16x32_bf16 v[124:127], a[188:191], a[88:91], v[124:127]
 ds_read_b64_tr_b16 a[172:173], v227 offset:256
 ds_read_b64_tr_b16 a[174:175], v227 offset:8448
 v_mfma_f32_16x16x32_bf16 v[128:131], a[188:191], a[92:95], v[128:131]
 s_barrier
 s_waitcnt vmcnt(6)
 v_mfma_f32_16x16x32_bf16 v[4:7], a[128:131], a[96:99], v[4:7]
 ds_read_b64_tr_b16 a[176:177], v224 offset:1280
 s_waitcnt vmcnt(5)
 v_mfma_f32_16x16x32_bf16 v[8:11], a[128:131], a[100:103], v[8:11]
 ds_read_b64_tr_b16 a[178:179], v224 offset:9472
 s_waitcnt vmcnt(3)
 v_mfma_f32_16x16x32_bf16 v[4:7], a[132:135], a[104:107], v[4:7]
 ds_read_b64_tr_b16 a[180:181], v226 offset:1280
 s_waitcnt vmcnt(2)
 v_mfma_f32_16x16x32_bf16 v[8:11], a[132:135], a[108:111], v[8:11]
 ds_read_b64_tr_b16 a[182:183], v226 offset:9472
 v_mfma_f32_16x16x32_bf16 v[12:15], a[136:139], a[96:99], v[12:15]
 ds_read_b64_tr_b16 a[184:185], v225 offset:1280
 v_mfma_f32_16x16x32_bf16 v[16:19], a[136:139], a[100:103], v[16:19]
 ds_read_b64_tr_b16 a[186:187], v225 offset:9472
 v_mfma_f32_16x16x32_bf16 v[12:15], a[140:143], a[104:107], v[12:15]
 ds_read_b64_tr_b16 a[188:189], v227 offset:1280
 v_mfma_f32_16x16x32_bf16 v[16:19], a[140:143], a[108:111], v[16:19]
 ds_read_b64_tr_b16 a[190:191], v227 offset:9472
 s_waitcnt lgkmcnt(9)
 v_mfma_f32_16x16x32_bf16 v[68:71], a[144:147], a[96:99], v[68:71]
 ds_read_b64_tr_b16 a[128:129], v224 offset:512
 ds_read_b64_tr_b16 a[130:131], v224 offset:8704
 v_mfma_f32_16x16x32_bf16 v[72:75], a[144:147], a[100:103], v[72:75]
 buffer_load_dwordx4 v[228:231], v2, s[56:59], s60 offen offset:0
 v_mfma_f32_16x16x32_bf16 v[68:71], a[148:151], a[104:107], v[68:71]
 ds_read_b64_tr_b16 a[132:133], v226 offset:512
 s_add_u32 m0, s67, 0x0
 v_mfma_f32_16x16x32_bf16 v[72:75], a[148:151], a[108:111], v[72:75]
 ds_read_b64_tr_b16 a[134:135], v226 offset:8704
 v_mfma_f32_16x16x32_bf16 v[76:79], a[152:155], a[96:99], v[76:79]
 ds_read_b64_tr_b16 a[136:137], v225 offset:512
 v_mfma_f32_16x16x32_bf16 v[80:83], a[152:155], a[100:103], v[80:83]
 ds_read_b64_tr_b16 a[138:139], v225 offset:8704
 v_mfma_f32_16x16x32_bf16 v[76:79], a[156:159], a[104:107], v[76:79]
 ds_read_b64_tr_b16 a[140:141], v227 offset:512
 ds_read_b64_tr_b16 a[142:143], v227 offset:8704
 v_mfma_f32_16x16x32_bf16 v[80:83], a[156:159], a[108:111], v[80:83]
 buffer_load_dwordx4 v148, s[56:59], s62 offen offset:0 lds
 v_mfma_f32_16x16x32_bf16 v[20:23], a[160:163], a[96:99], v[20:23]
 ds_read_b64_tr_b16 a[144:145], v224 offset:1536
 v_mfma_f32_16x16x32_bf16 v[24:27], a[160:163], a[100:103], v[24:27]
 ds_read_b64_tr_b16 a[146:147], v224 offset:9728
 v_mfma_f32_16x16x32_bf16 v[20:23], a[164:167], a[104:107], v[20:23]
 ds_read_b64_tr_b16 a[148:149], v226 offset:1536
 v_mfma_f32_16x16x32_bf16 v[24:27], a[164:167], a[108:111], v[24:27]
 ds_read_b64_tr_b16 a[150:151], v226 offset:9728
 v_mul_f32 v4, v4, v68
 v_mfma_f32_16x16x32_bf16 v[28:31], a[168:171], a[96:99], v[28:31]
 ds_read_b64_tr_b16 a[152:153], v225 offset:1536
 ds_read_b64_tr_b16 a[154:155], v225 offset:9728
 v_mfma_f32_16x16x32_bf16 v[32:35], a[168:171], a[100:103], v[32:35]
 buffer_load_dwordx4 v149, s[56:59], s62 offen offset:1024 lds
 s_waitcnt lgkmcnt(8)
 v_mfma_f32_16x16x32_bf16 v[28:31], a[172:175], a[104:107], v[28:31]
 ds_read_b64_tr_b16 a[156:157], v227 offset:1536
 v_mul_f32 v5, v5, v69
 v_mfma_f32_16x16x32_bf16 v[32:35], a[172:175], a[108:111], v[32:35]
 ds_read_b64_tr_b16 a[158:159], v227 offset:9728
 v_mul_f32 v6, v6, v70
 v_mfma_f32_16x16x32_bf16 v[84:87], a[176:179], a[96:99], v[84:87]
 ds_read_b64_tr_b16 a[160:161], v224 offset:768
 v_mul_f32 v7, v7, v71
 v_mfma_f32_16x16x32_bf16 v[88:91], a[176:179], a[100:103], v[88:91]
 ds_read_b64_tr_b16 a[162:163], v224 offset:8960
 v_mul_f32 v12, v12, v76
 v_mfma_f32_16x16x32_bf16 v[84:87], a[180:183], a[104:107], v[84:87]
 ds_read_b64_tr_b16 a[164:165], v226 offset:768
 ds_read_b64_tr_b16 a[166:167], v226 offset:8960
 v_mfma_f32_16x16x32_bf16 v[88:91], a[180:183], a[108:111], v[88:91]
 buffer_load_dwordx4 v150, s[56:59], s62 offen offset:2048 lds
 buffer_load_dwordx4 v151, s[56:59], s62 offen offset:3072 lds
 v_mfma_f32_16x16x32_bf16 v[92:95], a[184:187], a[96:99], v[92:95]
 ds_read_b64_tr_b16 a[168:169], v225 offset:768
 v_mul_f32 v13, v13, v77
 s_add_u32 s62, s62, 28672
 v_mfma_f32_16x16x32_bf16 v[96:99], a[184:187], a[100:103], v[96:99]
 ds_read_b64_tr_b16 a[170:171], v225 offset:8960
 v_mul_f32 v14, v14, v78
 v_mfma_f32_16x16x32_bf16 v[92:95], a[188:191], a[104:107], v[92:95]
 ds_read_b64_tr_b16 a[172:173], v227 offset:768
 v_mul_f32 v15, v15, v79
 v_mfma_f32_16x16x32_bf16 v[96:99], a[188:191], a[108:111], v[96:99]
 v_cvt_pk_bf16_f32 v232, v4, v5
 ds_read_b64_tr_b16 a[174:175], v227 offset:8960
 v_mfma_f32_16x16x32_bf16 v[36:39], a[128:131], a[96:99], v[36:39]
 v_cvt_pk_bf16_f32 v233, v6, v7
 ds_read_b64_tr_b16 a[176:177], v224 offset:1792
 v_mfma_f32_16x16x32_bf16 v[40:43], a[128:131], a[100:103], v[40:43]
 v_cvt_pk_bf16_f32 v234, v12, v13
 v_cvt_pk_bf16_f32 v235, v14, v15
 ds_read_b64_tr_b16 a[178:179], v224 offset:9984
 v_mfma_f32_16x16x32_bf16 v[36:39], a[132:135], a[104:107], v[36:39]
 buffer_store_dwordx4 v[232:235], v2, s[4:7], s42 offen offset:0 sc1
 v_mfma_f32_16x16x32_bf16 v[40:43], a[132:135], a[108:111], v[40:43]
 ds_read_b64_tr_b16 a[180:181], v226 offset:1792
 v_mul_f32 v8, v8, v72
 ds_read_b64_tr_b16 a[182:183], v226 offset:9984
 v_mfma_f32_16x16x32_bf16 v[44:47], a[136:139], a[96:99], v[44:47]
 v_mul_f32 v9, v9, v73
 v_mul_f32 v10, v10, v74
 v_mfma_f32_16x16x32_bf16 v[48:51], a[136:139], a[100:103], v[48:51]
 v_mul_f32 v11, v11, v75
 ds_read_b64_tr_b16 a[184:185], v225 offset:1792
 ds_read_b64_tr_b16 a[186:187], v225 offset:9984
 s_waitcnt lgkmcnt(6)
 v_mfma_f32_16x16x32_bf16 v[44:47], a[140:143], a[104:107], v[44:47]
 v_mul_f32 v16, v16, v80
 v_mul_f32 v17, v17, v81
 v_mfma_f32_16x16x32_bf16 v[48:51], a[140:143], a[108:111], v[48:51]
 v_mul_f32 v18, v18, v82
 ds_read_b64_tr_b16 a[188:189], v227 offset:1792
 ds_read_b64_tr_b16 a[190:191], v227 offset:9984
 v_mfma_f32_16x16x32_bf16 v[100:103], a[144:147], a[96:99], v[100:103]
 v_mul_f32 v19, v19, v83
 v_cvt_pk_bf16_f32 v236, v8, v9
 v_mfma_f32_16x16x32_bf16 v[104:107], a[144:147], a[100:103], v[104:107]
 v_cvt_pk_bf16_f32 v237, v10, v11
 v_cvt_pk_bf16_f32 v238, v16, v17
 v_mfma_f32_16x16x32_bf16 v[100:103], a[148:151], a[104:107], v[100:103]
 buffer_load_dwordx4 v[228:231], v2, s[56:59], s60 offen offset:1024
 v_mfma_f32_16x16x32_bf16 v[104:107], a[148:151], a[108:111], v[104:107]
 v_cvt_pk_bf16_f32 v239, v18, v19
 s_add_u32 m0, s67, 0x1000
 v_mfma_f32_16x16x32_bf16 v[108:111], a[152:155], a[96:99], v[108:111]
 buffer_store_dwordx4 v[236:239], v2, s[4:7], s45 offen offset:0 sc1
 v_mfma_f32_16x16x32_bf16 v[112:115], a[152:155], a[100:103], v[112:115]
 v_mul_f32 v20, v20, v84
 v_mul_f32 v21, v21, v85
 v_mfma_f32_16x16x32_bf16 v[108:111], a[156:159], a[104:107], v[108:111]
 v_mul_f32 v22, v22, v86
 v_mul_f32 v23, v23, v87
 v_mfma_f32_16x16x32_bf16 v[112:115], a[156:159], a[108:111], v[112:115]
 v_mul_f32 v28, v28, v92
 v_mul_f32 v29, v29, v93
 v_mfma_f32_16x16x32_bf16 v[52:55], a[160:163], a[96:99], v[52:55]
 v_mul_f32 v30, v30, v94
 v_mul_f32 v31, v31, v95
 v_mfma_f32_16x16x32_bf16 v[56:59], a[160:163], a[100:103], v[56:59]
 buffer_load_dwordx4 v148, s[56:59], s62 offen offset:0 lds
 v_mfma_f32_16x16x32_bf16 v[52:55], a[164:167], a[104:107], v[52:55]
 v_cvt_pk_bf16_f32 v232, v20, v21
 v_cvt_pk_bf16_f32 v233, v22, v23
 v_mfma_f32_16x16x32_bf16 v[56:59], a[164:167], a[108:111], v[56:59]
 v_cvt_pk_bf16_f32 v234, v28, v29
 v_cvt_pk_bf16_f32 v235, v30, v31
 v_mfma_f32_16x16x32_bf16 v[60:63], a[168:171], a[96:99], v[60:63]
 buffer_store_dwordx4 v[232:235], v2, s[4:7], s42 offen offset:1024 sc1
 v_mfma_f32_16x16x32_bf16 v[64:67], a[168:171], a[100:103], v[64:67]
 v_mul_f32 v24, v24, v88
 v_mul_f32 v25, v25, v89
 v_mfma_f32_16x16x32_bf16 v[60:63], a[172:175], a[104:107], v[60:63]
 v_mul_f32 v26, v26, v90
 v_mul_f32 v27, v27, v91
 v_mfma_f32_16x16x32_bf16 v[64:67], a[172:175], a[108:111], v[64:67]
 buffer_load_dwordx4 v149, s[56:59], s62 offen offset:1024 lds
 s_waitcnt lgkmcnt(0)
 v_mfma_f32_16x16x32_bf16 v[116:119], a[176:179], a[96:99], v[116:119]
 v_mul_f32 v32, v32, v96
 v_mul_f32 v33, v33, v97
 v_mfma_f32_16x16x32_bf16 v[120:123], a[176:179], a[100:103], v[120:123]
 v_mul_f32 v34, v34, v98
 v_mul_f32 v35, v35, v99
 v_mfma_f32_16x16x32_bf16 v[116:119], a[180:183], a[104:107], v[116:119]
 v_cvt_pk_bf16_f32 v236, v24, v25
 v_cvt_pk_bf16_f32 v237, v26, v27
 v_mfma_f32_16x16x32_bf16 v[120:123], a[180:183], a[108:111], v[120:123]
 v_cvt_pk_bf16_f32 v238, v32, v33
 v_cvt_pk_bf16_f32 v239, v34, v35
 v_mfma_f32_16x16x32_bf16 v[124:127], a[184:187], a[96:99], v[124:127]
 buffer_store_dwordx4 v[236:239], v2, s[4:7], s45 offen offset:1024 sc1
 v_mfma_f32_16x16x32_bf16 v[128:131], a[184:187], a[100:103], v[128:131]
 v_mul_f32 v36, v36, v100
 v_mul_f32 v37, v37, v101
 v_mfma_f32_16x16x32_bf16 v[124:127], a[188:191], a[104:107], v[124:127]
 buffer_load_dwordx4 v150, s[56:59], s62 offen offset:2048 lds
 buffer_load_dwordx4 v151, s[56:59], s62 offen offset:3072 lds
 s_add_u32 s62, s62, 28672
 v_mfma_f32_16x16x32_bf16 v[128:131], a[188:191], a[108:111], v[128:131]
 v_mul_f32 v38, v38, v102
 v_mul_f32 v39, v39, v103
 v_mul_f32 v44, v44, v108
 v_mul_f32 v45, v45, v109
 v_mul_f32 v46, v46, v110
 v_mul_f32 v47, v47, v111
 v_cvt_pk_bf16_f32 v232, v36, v37
 v_cvt_pk_bf16_f32 v233, v38, v39
 v_cvt_pk_bf16_f32 v234, v44, v45
 v_cvt_pk_bf16_f32 v235, v46, v47
 buffer_store_dwordx4 v[232:235], v2, s[4:7], s42 offen offset:2048 sc1
 v_mul_f32 v40, v40, v104
 v_mul_f32 v41, v41, v105
 v_mul_f32 v42, v42, v106
 v_mul_f32 v43, v43, v107
 v_mul_f32 v48, v48, v112
 v_mul_f32 v49, v49, v113
 v_mul_f32 v50, v50, v114
 v_mul_f32 v51, v51, v115
 v_cvt_pk_bf16_f32 v236, v40, v41
 v_cvt_pk_bf16_f32 v237, v42, v43
 v_cvt_pk_bf16_f32 v238, v48, v49
 v_cvt_pk_bf16_f32 v239, v50, v51
 buffer_store_dwordx4 v[236:239], v2, s[4:7], s45 offen offset:2048 sc1
 s_nop 7
 v_pk_mul_f32 v[52:53], v[52:53], v[116:117]
 v_pk_mul_f32 v[54:55], v[54:55], v[118:119]
 v_pk_mul_f32 v[60:61], v[60:61], v[124:125]
 v_pk_mul_f32 v[62:63], v[62:63], v[126:127]
 v_cvt_pk_bf16_f32 v232, v52, v53
 v_cvt_pk_bf16_f32 v233, v54, v55
 v_cvt_pk_bf16_f32 v234, v60, v61
 v_cvt_pk_bf16_f32 v235, v62, v63
 buffer_store_dwordx4 v[232:235], v2, s[4:7], s42 offen offset:3072 sc1
 v_pk_mul_f32 v[56:57], v[56:57], v[120:121]
 v_pk_mul_f32 v[58:59], v[58:59], v[122:123]
 v_pk_mul_f32 v[64:65], v[64:65], v[128:129]
 v_pk_mul_f32 v[66:67], v[66:67], v[130:131]
 v_cvt_pk_bf16_f32 v236, v56, v57
 v_cvt_pk_bf16_f32 v237, v58, v59
 v_cvt_pk_bf16_f32 v238, v64, v65
 v_cvt_pk_bf16_f32 v239, v66, v67
 buffer_store_dwordx4 v[236:239], v2, s[4:7], s45 offen offset:3072 sc1
 s_lshl_b32 s43, s64, 4
 s_add_u32 s43, s43, s65
 s_lshl_b32 s43, s43, 2
 s_add_u32 s43, s43, s3
 s_lshl_b32 s43, s43, 2
 s_add_u32 s43, s43, 0x5313000
 v_mov_b32 v216, 1
 v_mov_b32 v217, 0
 s_add_u32 m0, s67, 0x2000
 s_nop 0
 buffer_load_dwordx4 v148, s[56:59], s62 offen offset:0 lds
 buffer_load_dwordx4 v149, s[56:59], s62 offen offset:1024 lds
 buffer_load_dwordx4 v150, s[56:59], s62 offen offset:2048 lds
 buffer_load_dwordx4 v151, s[56:59], s62 offen offset:3072 lds
 s_add_u32 s62, s62, 28672
 s_add_u32 m0, s67, 0x3000
 s_nop 0
 buffer_load_dwordx4 v148, s[56:59], s62 offen offset:0 lds
 buffer_load_dwordx4 v149, s[56:59], s62 offen offset:1024 lds
 buffer_load_dwordx4 v150, s[56:59], s62 offen offset:2048 lds
 buffer_load_dwordx4 v151, s[56:59], s62 offen offset:3072 lds
 s_add_u32 s62, s62, 28672
 s_add_u32 m0, s67, 0x4000
 s_nop 0
 buffer_load_dwordx4 v148, s[56:59], s62 offen offset:0 lds
 buffer_load_dwordx4 v149, s[56:59], s62 offen offset:1024 lds
 buffer_load_dwordx4 v150, s[56:59], s62 offen offset:2048 lds
 buffer_load_dwordx4 v151, s[56:59], s62 offen offset:3072 lds
 s_add_u32 s62, s62, 28672
 s_waitcnt vmcnt(12)
 s_cmp_eq_u32 s71, 0
 s_cbranch_scc1 L4_s_slow
 buffer_store_dword v216, v217, s[4:7], s43 offen
L4_s_back:
 s_add_u32 m0, s67, 0x5000
 s_nop 0
 buffer_load_dwordx4 v148, s[56:59], s62 offen offset:0 lds
 buffer_load_dwordx4 v149, s[56:59], s62 offen offset:1024 lds
 buffer_load_dwordx4 v150, s[56:59], s62 offen offset:2048 lds
 buffer_load_dwordx4 v151, s[56:59], s62 offen offset:3072 lds
 s_add_u32 s62, s62, 28672
 s_add_u32 m0, s67, 0x6000
 s_nop 0
 buffer_load_dwordx4 v148, s[56:59], s62 offen offset:0 lds
 buffer_load_dwordx4 v149, s[56:59], s62 offen offset:1024 lds
 buffer_load_dwordx4 v150, s[56:59], s62 offen offset:2048 lds
 buffer_load_dwordx4 v151, s[56:59], s62 offen offset:3072 lds
 s_add_u32 s62, s62, 28672
 s_add_u32 m0, s67, 0x7000
 s_nop 0
 buffer_load_dwordx4 v148, s[56:59], s62 offen offset:0 lds
 buffer_load_dwordx4 v149, s[56:59], s62 offen offset:1024 lds
 buffer_load_dwordx4 v150, s[56:59], s62 offen offset:2048 lds
 buffer_load_dwordx4 v151, s[56:59], s62 offen offset:3072 lds
 s_add_u32 s62, s62, 28672
 s_lshl_b32 s68, s70, 8
 s_add_u32 s68, s68, 0x5313000
 s_and_b32 s9, s47, 1
 s_lshl_b32 s9, s9, 3
 s_add_u32 s68, s68, s9
 s_mul_i32 s9, s3, 7
 s_lshr_b32 s9, s9, 1
 v_lshrrev_b32 v157, 1, v1
 v_min_u32 v157, 3, v157
 v_add_u32 v157, s9, v157
 v_lshlrev_b32 v157, 4, v157
 v_and_b32 v158, 1, v1
 v_lshl_add_u32 v157, v158, 2, v157
 s_mov_b32 s69, 0x20000
L5_m_poll:
 buffer_load_dword v158, v157, s[4:7], s68 offen sc1
 s_waitcnt vmcnt(0)
 v_cmp_ne_u32 vcc, 1, v158
 s_cbranch_vccz L5_m_done
 s_sleep 2
 s_sub_u32 s69, s69, 1
 s_cbranch_scc0 L5_m_poll
L5_m_done:
 s_cmp_eq_u32 s71, 0
 s_cbranch_scc1 L5_a_acq
L5_a_acqb:
 buffer_load_dwordx4 v[4:7], v162, s[4:7], s63 offen offset:0
 buffer_load_dwordx4 v[8:11], v163, s[4:7], s63 offen offset:0
 buffer_load_dwordx4 v[12:15], v164, s[4:7], s63 offen offset:0
 buffer_load_dwordx4 v[16:19], v165, s[4:7], s63 offen offset:0
 buffer_load_dwordx4 v[20:23], v162, s[4:7], s63 offen offset:1024
 buffer_load_dwordx4 v[24:27], v163, s[4:7], s63 offen offset:1024
 buffer_load_dwordx4 v[28:31], v164, s[4:7], s63 offen offset:1024
 buffer_load_dwordx4 v[32:35], v165, s[4:7], s63 offen offset:1024
 buffer_load_dwordx4 v[36:39], v162, s[4:7], s63 offen offset:2048
 buffer_load_dwordx4 v[40:43], v163, s[4:7], s63 offen offset:2048
 buffer_load_dwordx4 v[44:47], v164, s[4:7], s63 offen offset:2048
 buffer_load_dwordx4 v[48:51], v165, s[4:7], s63 offen offset:2048
 buffer_load_dwordx4 v[52:55], v162, s[4:7], s63 offen offset:3072
 buffer_load_dwordx4 v[56:59], v163, s[4:7], s63 offen offset:3072
 buffer_load_dwordx4 v[60:63], v164, s[4:7], s63 offen offset:3072
 buffer_load_dwordx4 v[64:67], v165, s[4:7], s63 offen offset:3072
 s_add_u32 s63, s63, 0x1000
 buffer_load_dwordx4 v[68:71], v162, s[4:7], s63 offen offset:0
 buffer_load_dwordx4 v[72:75], v163, s[4:7], s63 offen offset:0
 buffer_load_dwordx4 v[76:79], v164, s[4:7], s63 offen offset:0
 buffer_load_dwordx4 v[80:83], v165, s[4:7], s63 offen offset:0
 buffer_load_dwordx4 v[84:87], v162, s[4:7], s63 offen offset:1024
 buffer_load_dwordx4 v[88:91], v163, s[4:7], s63 offen offset:1024
 buffer_load_dwordx4 v[92:95], v164, s[4:7], s63 offen offset:1024
 buffer_load_dwordx4 v[96:99], v165, s[4:7], s63 offen offset:1024
 buffer_load_dwordx4 v[100:103], v162, s[4:7], s63 offen offset:2048
 buffer_load_dwordx4 v[104:107], v163, s[4:7], s63 offen offset:2048
 buffer_load_dwordx4 v[108:111], v164, s[4:7], s63 offen offset:2048
 buffer_load_dwordx4 v[112:115], v165, s[4:7], s63 offen offset:2048
 ds_read_b64_tr_b16 v[180:181], v152 offset:0
 ds_read_b64_tr_b16 v[182:183], v152 offset:2048
 ds_read_b64_tr_b16 v[184:185], v153 offset:0
 ds_read_b64_tr_b16 v[186:187], v153 offset:2048
 ds_read_b64_tr_b16 v[188:189], v152 offset:256
 ds_read_b64_tr_b16 v[190:191], v152 offset:2304
 ds_read_b64_tr_b16 v[192:193], v153 offset:256
 ds_read_b64_tr_b16 v[194:195], v153 offset:2304
 s_waitcnt vmcnt(27) lgkmcnt(6)
 v_mfma_f32_16x16x32_bf16 a[0:3], v[180:183], v[4:7], 0
 buffer_load_dwordx4 v[116:119], v162, s[4:7], s63 offen offset:3072
 s_waitcnt vmcnt(27)
 v_mfma_f32_16x16x32_bf16 a[4:7], v[180:183], v[8:11], 0
 buffer_load_dwordx4 v[120:123], v163, s[4:7], s63 offen offset:3072
 s_waitcnt vmcnt(27)
 v_mfma_f32_16x16x32_bf16 a[8:11], v[180:183], v[12:15], 0
 s_waitcnt vmcnt(26)
 v_mfma_f32_16x16x32_bf16 a[12:15], v[180:183], v[16:19], 0
 buffer_load_dwordx4 v[124:127], v164, s[4:7], s63 offen offset:3072
 s_waitcnt lgkmcnt(4)
 v_mfma_f32_16x16x32_bf16 a[16:19], v[184:187], v[4:7], 0
 buffer_load_dwordx4 v[128:131], v165, s[4:7], s63 offen offset:3072
 v_mfma_f32_16x16x32_bf16 a[20:23], v[184:187], v[8:11], 0
 v_mfma_f32_16x16x32_bf16 a[24:27], v[184:187], v[12:15], 0
 s_add_u32 s63, s63, 0x1000
 v_mfma_f32_16x16x32_bf16 a[28:31], v[184:187], v[16:19], 0
 s_waitcnt lgkmcnt(2)
 v_mfma_f32_16x16x32_bf16 a[32:35], v[188:191], v[4:7], 0
 v_mfma_f32_16x16x32_bf16 a[36:39], v[188:191], v[8:11], 0
 ds_read_b64_tr_b16 v[196:197], v152 offset:4096
 ds_read_b64_tr_b16 v[198:199], v152 offset:6144
 v_mfma_f32_16x16x32_bf16 a[40:43], v[188:191], v[12:15], 0
 ds_read_b64_tr_b16 v[200:201], v153 offset:4096
 ds_read_b64_tr_b16 v[202:203], v153 offset:6144
 v_mfma_f32_16x16x32_bf16 a[44:47], v[188:191], v[16:19], 0
 ds_read_b64_tr_b16 v[204:205], v152 offset:4352
 ds_read_b64_tr_b16 v[206:207], v152 offset:6400
 s_waitcnt lgkmcnt(6)
 v_mfma_f32_16x16x32_bf16 a[48:51], v[192:195], v[4:7], 0
 ds_read_b64_tr_b16 v[208:209], v153 offset:4352
 ds_read_b64_tr_b16 v[210:211], v153 offset:6400
 v_mfma_f32_16x16x32_bf16 a[52:55], v[192:195], v[8:11], 0
 v_mfma_f32_16x16x32_bf16 a[56:59], v[192:195], v[12:15], 0
 v_mfma_f32_16x16x32_bf16 a[60:63], v[192:195], v[16:19], 0
 s_waitcnt vmcnt(27) lgkmcnt(6)
 v_mfma_f32_16x16x32_bf16 a[0:3], v[196:199], v[20:23], a[0:3]
 buffer_load_dwordx4 v[4:7], v162, s[4:7], s63 offen offset:0
 s_waitcnt vmcnt(27)
 v_mfma_f32_16x16x32_bf16 a[4:7], v[196:199], v[24:27], a[4:7]
 buffer_load_dwordx4 v[8:11], v163, s[4:7], s63 offen offset:0
 s_waitcnt vmcnt(27)
 v_mfma_f32_16x16x32_bf16 a[8:11], v[196:199], v[28:31], a[8:11]
 buffer_load_dwordx4 v[12:15], v164, s[4:7], s63 offen offset:0
 s_waitcnt vmcnt(27)
 v_mfma_f32_16x16x32_bf16 a[12:15], v[196:199], v[32:35], a[12:15]
 buffer_load_dwordx4 v[16:19], v165, s[4:7], s63 offen offset:0
 s_waitcnt lgkmcnt(4)
 v_mfma_f32_16x16x32_bf16 a[16:19], v[200:203], v[20:23], a[16:19]
 s_add_u32 m0, s67, 0x0
 v_mfma_f32_16x16x32_bf16 a[20:23], v[200:203], v[24:27], a[20:23]
 buffer_load_dwordx4 v148, s[56:59], s62 offen offset:0 lds
 v_mfma_f32_16x16x32_bf16 a[24:27], v[200:203], v[28:31], a[24:27]
 buffer_load_dwordx4 v149, s[56:59], s62 offen offset:1024 lds
 v_mfma_f32_16x16x32_bf16 a[28:31], v[200:203], v[32:35], a[28:31]
 buffer_load_dwordx4 v150, s[56:59], s62 offen offset:2048 lds
 s_waitcnt lgkmcnt(0)
 v_mfma_f32_16x16x32_bf16 a[32:35], v[204:207], v[20:23], a[32:35]
 buffer_load_dwordx4 v151, s[56:59], s62 offen offset:3072 lds
 v_mfma_f32_16x16x32_bf16 a[36:39], v[204:207], v[24:27], a[36:39]
 s_add_u32 s62, s62, 28672
 ds_read_b64_tr_b16 v[180:181], v152 offset:8192
 ds_read_b64_tr_b16 v[182:183], v152 offset:10240
 v_mfma_f32_16x16x32_bf16 a[40:43], v[204:207], v[28:31], a[40:43]
 ds_read_b64_tr_b16 v[184:185], v153 offset:8192
 ds_read_b64_tr_b16 v[186:187], v153 offset:10240
 v_mfma_f32_16x16x32_bf16 a[44:47], v[204:207], v[32:35], a[44:47]
 ds_read_b64_tr_b16 v[188:189], v152 offset:8448
 ds_read_b64_tr_b16 v[190:191], v152 offset:10496
 v_mfma_f32_16x16x32_bf16 a[48:51], v[208:211], v[20:23], a[48:51]
 ds_read_b64_tr_b16 v[192:193], v153 offset:8448
 ds_read_b64_tr_b16 v[194:195], v153 offset:10496
 v_mfma_f32_16x16x32_bf16 a[52:55], v[208:211], v[24:27], a[52:55]
 v_mfma_f32_16x16x32_bf16 a[56:59], v[208:211], v[28:31], a[56:59]
 v_mfma_f32_16x16x32_bf16 a[60:63], v[208:211], v[32:35], a[60:63]
 s_waitcnt vmcnt(31) lgkmcnt(6)
 v_mfma_f32_16x16x32_bf16 a[0:3], v[180:183], v[36:39], a[0:3]
 buffer_load_dwordx4 v[20:23], v162, s[4:7], s63 offen offset:1024
 s_waitcnt vmcnt(31)
 v_mfma_f32_16x16x32_bf16 a[4:7], v[180:183], v[40:43], a[4:7]
 buffer_load_dwordx4 v[24:27], v163, s[4:7], s63 offen offset:1024
 s_waitcnt vmcnt(31)
 v_mfma_f32_16x16x32_bf16 a[8:11], v[180:183], v[44:47], a[8:11]
 buffer_load_dwordx4 v[28:31], v164, s[4:7], s63 offen offset:1024
 s_waitcnt vmcnt(31)
 v_mfma_f32_16x16x32_bf16 a[12:15], v[180:183], v[48:51], a[12:15]
 buffer_load_dwordx4 v[32:35], v165, s[4:7], s63 offen offset:1024
 s_waitcnt lgkmcnt(4)
 v_mfma_f32_16x16x32_bf16 a[16:19], v[184:187], v[36:39], a[16:19]
 s_add_u32 m0, s67, 0x1000
 v_mfma_f32_16x16x32_bf16 a[20:23], v[184:187], v[40:43], a[20:23]
 buffer_load_dwordx4 v148, s[56:59], s62 offen offset:0 lds
 v_mfma_f32_16x16x32_bf16 a[24:27], v[184:187], v[44:47], a[24:27]
 buffer_load_dwordx4 v149, s[56:59], s62 offen offset:1024 lds
 v_mfma_f32_16x16x32_bf16 a[28:31], v[184:187], v[48:51], a[28:31]
 buffer_load_dwordx4 v150, s[56:59], s62 offen offset:2048 lds
 s_waitcnt lgkmcnt(0)
 v_mfma_f32_16x16x32_bf16 a[32:35], v[188:191], v[36:39], a[32:35]
 buffer_load_dwordx4 v151, s[56:59], s62 offen offset:3072 lds
 v_mfma_f32_16x16x32_bf16 a[36:39], v[188:191], v[40:43], a[36:39]
 s_add_u32 s62, s62, 28672
 ds_read_b64_tr_b16 v[196:197], v152 offset:12288
 ds_read_b64_tr_b16 v[198:199], v152 offset:14336
 v_mfma_f32_16x16x32_bf16 a[40:43], v[188:191], v[44:47], a[40:43]
 ds_read_b64_tr_b16 v[200:201], v153 offset:12288
 ds_read_b64_tr_b16 v[202:203], v153 offset:14336
 v_mfma_f32_16x16x32_bf16 a[44:47], v[188:191], v[48:51], a[44:47]
 ds_read_b64_tr_b16 v[204:205], v152 offset:12544
 ds_read_b64_tr_b16 v[206:207], v152 offset:14592
 v_mfma_f32_16x16x32_bf16 a[48:51], v[192:195], v[36:39], a[48:51]
 ds_read_b64_tr_b16 v[208:209], v153 offset:12544
 ds_read_b64_tr_b16 v[210:211], v153 offset:14592
 v_mfma_f32_16x16x32_bf16 a[52:55], v[192:195], v[40:43], a[52:55]
 v_mfma_f32_16x16x32_bf16 a[56:59], v[192:195], v[44:47], a[56:59]
 v_mfma_f32_16x16x32_bf16 a[60:63], v[192:195], v[48:51], a[60:63]
 s_waitcnt vmcnt(35) lgkmcnt(6)
 v_mfma_f32_16x16x32_bf16 a[0:3], v[196:199], v[52:55], a[0:3]
 buffer_load_dwordx4 v[36:39], v162, s[4:7], s63 offen offset:2048
 s_waitcnt vmcnt(35)
 v_mfma_f32_16x16x32_bf16 a[4:7], v[196:199], v[56:59], a[4:7]
 buffer_load_dwordx4 v[40:43], v163, s[4:7], s63 offen offset:2048
 s_waitcnt vmcnt(35)
 v_mfma_f32_16x16x32_bf16 a[8:11], v[196:199], v[60:63], a[8:11]
 buffer_load_dwordx4 v[44:47], v164, s[4:7], s63 offen offset:2048
 s_waitcnt vmcnt(35)
 v_mfma_f32_16x16x32_bf16 a[12:15], v[196:199], v[64:67], a[12:15]
 buffer_load_dwordx4 v[48:51], v165, s[4:7], s63 offen offset:2048
 s_waitcnt lgkmcnt(4)
 v_mfma_f32_16x16x32_bf16 a[16:19], v[200:203], v[52:55], a[16:19]
 s_add_u32 m0, s67, 0x2000
 v_mfma_f32_16x16x32_bf16 a[20:23], v[200:203], v[56:59], a[20:23]
 buffer_load_dwordx4 v148, s[56:59], s62 offen offset:0 lds
 v_mfma_f32_16x16x32_bf16 a[24:27], v[200:203], v[60:63], a[24:27]
 buffer_load_dwordx4 v149, s[56:59], s62 offen offset:1024 lds
 v_mfma_f32_16x16x32_bf16 a[28:31], v[200:203], v[64:67], a[28:31]
 buffer_load_dwordx4 v150, s[56:59], s62 offen offset:2048 lds
 s_waitcnt lgkmcnt(0)
 v_mfma_f32_16x16x32_bf16 a[32:35], v[204:207], v[52:55], a[32:35]
 buffer_load_dwordx4 v151, s[56:59], s62 offen offset:3072 lds
 v_mfma_f32_16x16x32_bf16 a[36:39], v[204:207], v[56:59], a[36:39]
 s_add_u32 s62, s62, 28672
 ds_read_b64_tr_b16 v[180:181], v152 offset:16384
 ds_read_b64_tr_b16 v[182:183], v152 offset:18432
 v_mfma_f32_16x16x32_bf16 a[40:43], v[204:207], v[60:63], a[40:43]
 ds_read_b64_tr_b16 v[184:185], v153 offset:16384
 ds_read_b64_tr_b16 v[186:187], v153 offset:18432
 v_mfma_f32_16x16x32_bf16 a[44:47], v[204:207], v[64:67], a[44:47]
 ds_read_b64_tr_b16 v[188:189], v152 offset:16640
 ds_read_b64_tr_b16 v[190:191], v152 offset:18688
 v_mfma_f32_16x16x32_bf16 a[48:51], v[208:211], v[52:55], a[48:51]
 ds_read_b64_tr_b16 v[192:193], v153 offset:16640
 ds_read_b64_tr_b16 v[194:195], v153 offset:18688
 v_mfma_f32_16x16x32_bf16 a[52:55], v[208:211], v[56:59], a[52:55]
 v_mfma_f32_16x16x32_bf16 a[56:59], v[208:211], v[60:63], a[56:59]
 v_mfma_f32_16x16x32_bf16 a[60:63], v[208:211], v[64:67], a[60:63]
 s_waitcnt vmcnt(39) lgkmcnt(6)
 v_mfma_f32_16x16x32_bf16 a[0:3], v[180:183], v[68:71], a[0:3]
 buffer_load_dwordx4 v[52:55], v162, s[4:7], s63 offen offset:3072
 s_waitcnt vmcnt(39)
 v_mfma_f32_16x16x32_bf16 a[4:7], v[180:183], v[72:75], a[4:7]
 buffer_load_dwordx4 v[56:59], v163, s[4:7], s63 offen offset:3072
 s_waitcnt vmcnt(39)
 v_mfma_f32_16x16x32_bf16 a[8:11], v[180:183], v[76:79], a[8:11]
 buffer_load_dwordx4 v[60:63], v164, s[4:7], s63 offen offset:3072
 s_waitcnt vmcnt(39)
 v_mfma_f32_16x16x32_bf16 a[12:15], v[180:183], v[80:83], a[12:15]
 buffer_load_dwordx4 v[64:67], v165, s[4:7], s63 offen offset:3072
 s_waitcnt lgkmcnt(4)
 v_mfma_f32_16x16x32_bf16 a[16:19], v[184:187], v[68:71], a[16:19]
 s_add_u32 s63, s63, 0x1000
 v_mfma_f32_16x16x32_bf16 a[20:23], v[184:187], v[72:75], a[20:23]
 s_add_u32 m0, s67, 0x3000
 v_mfma_f32_16x16x32_bf16 a[24:27], v[184:187], v[76:79], a[24:27]
 buffer_load_dwordx4 v148, s[56:59], s62 offen offset:0 lds
 v_mfma_f32_16x16x32_bf16 a[28:31], v[184:187], v[80:83], a[28:31]
 buffer_load_dwordx4 v149, s[56:59], s62 offen offset:1024 lds
 s_waitcnt lgkmcnt(0)
 v_mfma_f32_16x16x32_bf16 a[32:35], v[188:191], v[68:71], a[32:35]
 buffer_load_dwordx4 v150, s[56:59], s62 offen offset:2048 lds
 v_mfma_f32_16x16x32_bf16 a[36:39], v[188:191], v[72:75], a[36:39]
 buffer_load_dwordx4 v151, s[56:59], s62 offen offset:3072 lds
 ds_read_b64_tr_b16 v[196:197], v152 offset:20480
 ds_read_b64_tr_b16 v[198:199], v152 offset:22528
 v_mfma_f32_16x16x32_bf16 a[40:43], v[188:191], v[76:79], a[40:43]
 s_add_u32 s62, s62, 28672
 ds_read_b64_tr_b16 v[200:201], v153 offset:20480
 ds_read_b64_tr_b16 v[202:203], v153 offset:22528
 v_mfma_f32_16x16x32_bf16 a[44:47], v[188:191], v[80:83], a[44:47]
 ds_read_b64_tr_b16 v[204:205], v152 offset:20736
 ds_read_b64_tr_b16 v[206:207], v152 offset:22784
 v_mfma_f32_16x16x32_bf16 a[48:51], v[192:195], v[68:71], a[48:51]
 ds_read_b64_tr_b16 v[208:209], v153 offset:20736
 ds_read_b64_tr_b16 v[210:211], v153 offset:22784
 v_mfma_f32_16x16x32_bf16 a[52:55], v[192:195], v[72:75], a[52:55]
 v_mfma_f32_16x16x32_bf16 a[56:59], v[192:195], v[76:79], a[56:59]
 v_mfma_f32_16x16x32_bf16 a[60:63], v[192:195], v[80:83], a[60:63]
 s_waitcnt vmcnt(43) lgkmcnt(6)
 v_mfma_f32_16x16x32_bf16 a[0:3], v[196:199], v[84:87], a[0:3]
 buffer_load_dwordx4 v[68:71], v162, s[4:7], s63 offen offset:0
 s_waitcnt vmcnt(43)
 v_mfma_f32_16x16x32_bf16 a[4:7], v[196:199], v[88:91], a[4:7]
 buffer_load_dwordx4 v[72:75], v163, s[4:7], s63 offen offset:0
 s_waitcnt vmcnt(43)
 v_mfma_f32_16x16x32_bf16 a[8:11], v[196:199], v[92:95], a[8:11]
 buffer_load_dwordx4 v[76:79], v164, s[4:7], s63 offen offset:0
 s_waitcnt vmcnt(43)
 v_mfma_f32_16x16x32_bf16 a[12:15], v[196:199], v[96:99], a[12:15]
 buffer_load_dwordx4 v[80:83], v165, s[4:7], s63 offen offset:0
 s_waitcnt lgkmcnt(4)
 v_mfma_f32_16x16x32_bf16 a[16:19], v[200:203], v[84:87], a[16:19]
 s_add_u32 m0, s67, 0x4000
 v_mfma_f32_16x16x32_bf16 a[20:23], v[200:203], v[88:91], a[20:23]
 buffer_load_dwordx4 v148, s[56:59], s62 offen offset:0 lds
 v_mfma_f32_16x16x32_bf16 a[24:27], v[200:203], v[92:95], a[24:27]
 buffer_load_dwordx4 v149, s[56:59], s62 offen offset:1024 lds
 v_mfma_f32_16x16x32_bf16 a[28:31], v[200:203], v[96:99], a[28:31]
 buffer_load_dwordx4 v150, s[56:59], s62 offen offset:2048 lds
 s_waitcnt lgkmcnt(0)
 v_mfma_f32_16x16x32_bf16 a[32:35], v[204:207], v[84:87], a[32:35]
 buffer_load_dwordx4 v151, s[56:59], s62 offen offset:3072 lds
 v_mfma_f32_16x16x32_bf16 a[36:39], v[204:207], v[88:91], a[36:39]
 s_add_u32 s62, s62, 28672
 ds_read_b64_tr_b16 v[180:181], v152 offset:24576
 ds_read_b64_tr_b16 v[182:183], v152 offset:26624
 v_mfma_f32_16x16x32_bf16 a[40:43], v[204:207], v[92:95], a[40:43]
 ds_read_b64_tr_b16 v[184:185], v153 offset:24576
 ds_read_b64_tr_b16 v[186:187], v153 offset:26624
 v_mfma_f32_16x16x32_bf16 a[44:47], v[204:207], v[96:99], a[44:47]
 ds_read_b64_tr_b16 v[188:189], v152 offset:24832
 ds_read_b64_tr_b16 v[190:191], v152 offset:26880
 v_mfma_f32_16x16x32_bf16 a[48:51], v[208:211], v[84:87], a[48:51]
 ds_read_b64_tr_b16 v[192:193], v153 offset:24832
 ds_read_b64_tr_b16 v[194:195], v153 offset:26880
 v_mfma_f32_16x16x32_bf16 a[52:55], v[208:211], v[88:91], a[52:55]
 v_mfma_f32_16x16x32_bf16 a[56:59], v[208:211], v[92:95], a[56:59]
 v_mfma_f32_16x16x32_bf16 a[60:63], v[208:211], v[96:99], a[60:63]
 s_waitcnt vmcnt(47) lgkmcnt(6)
 v_mfma_f32_16x16x32_bf16 a[0:3], v[180:183], v[100:103], a[0:3]
 buffer_load_dwordx4 v[84:87], v162, s[4:7], s63 offen offset:1024
 s_waitcnt vmcnt(47)
 v_mfma_f32_16x16x32_bf16 a[4:7], v[180:183], v[104:107], a[4:7]
 buffer_load_dwordx4 v[88:91], v163, s[4:7], s63 offen offset:1024
 s_waitcnt vmcnt(47)
 v_mfma_f32_16x16x32_bf16 a[8:11], v[180:183], v[108:111], a[8:11]
 buffer_load_dwordx4 v[92:95], v164, s[4:7], s63 offen offset:1024
 s_waitcnt vmcnt(47)
 v_mfma_f32_16x16x32_bf16 a[12:15], v[180:183], v[112:115], a[12:15]
 buffer_load_dwordx4 v[96:99], v165, s[4:7], s63 offen offset:1024
 s_waitcnt lgkmcnt(4)
 v_mfma_f32_16x16x32_bf16 a[16:19], v[184:187], v[100:103], a[16:19]
 s_add_u32 m0, s67, 0x5000
 v_mfma_f32_16x16x32_bf16 a[20:23], v[184:187], v[104:107], a[20:23]
 buffer_load_dwordx4 v148, s[56:59], s62 offen offset:0 lds
 v_mfma_f32_16x16x32_bf16 a[24:27], v[184:187], v[108:111], a[24:27]
 buffer_load_dwordx4 v149, s[56:59], s62 offen offset:1024 lds
 v_mfma_f32_16x16x32_bf16 a[28:31], v[184:187], v[112:115], a[28:31]
 buffer_load_dwordx4 v150, s[56:59], s62 offen offset:2048 lds
 s_waitcnt lgkmcnt(0)
 v_mfma_f32_16x16x32_bf16 a[32:35], v[188:191], v[100:103], a[32:35]
 buffer_load_dwordx4 v151, s[56:59], s62 offen offset:3072 lds
 v_mfma_f32_16x16x32_bf16 a[36:39], v[188:191], v[104:107], a[36:39]
 s_add_u32 s62, s62, 28672
 ds_read_b64_tr_b16 v[196:197], v152 offset:28672
 ds_read_b64_tr_b16 v[198:199], v152 offset:30720
 v_mfma_f32_16x16x32_bf16 a[40:43], v[188:191], v[108:111], a[40:43]
 ds_read_b64_tr_b16 v[200:201], v153 offset:28672
 ds_read_b64_tr_b16 v[202:203], v153 offset:30720
 v_mfma_f32_16x16x32_bf16 a[44:47], v[188:191], v[112:115], a[44:47]
 ds_read_b64_tr_b16 v[204:205], v152 offset:28928
 ds_read_b64_tr_b16 v[206:207], v152 offset:30976
 v_mfma_f32_16x16x32_bf16 a[48:51], v[192:195], v[100:103], a[48:51]
 ds_read_b64_tr_b16 v[208:209], v153 offset:28928
 ds_read_b64_tr_b16 v[210:211], v153 offset:30976
 v_mfma_f32_16x16x32_bf16 a[52:55], v[192:195], v[104:107], a[52:55]
 v_mfma_f32_16x16x32_bf16 a[56:59], v[192:195], v[108:111], a[56:59]
 v_mfma_f32_16x16x32_bf16 a[60:63], v[192:195], v[112:115], a[60:63]
 s_waitcnt vmcnt(51) lgkmcnt(6)
 v_mfma_f32_16x16x32_bf16 a[0:3], v[196:199], v[116:119], a[0:3]
 s_waitcnt vmcnt(50)
 v_mfma_f32_16x16x32_bf16 a[4:7], v[196:199], v[120:123], a[4:7]
 s_waitcnt vmcnt(49)
 v_mfma_f32_16x16x32_bf16 a[8:11], v[196:199], v[124:127], a[8:11]
 s_waitcnt vmcnt(48)
 v_mfma_f32_16x16x32_bf16 a[12:15], v[196:199], v[128:131], a[12:15]
 s_waitcnt lgkmcnt(4)
 v_mfma_f32_16x16x32_bf16 a[16:19], v[200:203], v[116:119], a[16:19]
 v_mfma_f32_16x16x32_bf16 a[20:23], v[200:203], v[120:123], a[20:23]
 v_mfma_f32_16x16x32_bf16 a[24:27], v[200:203], v[124:127], a[24:27]
 v_mfma_f32_16x16x32_bf16 a[28:31], v[200:203], v[128:131], a[28:31]
 s_waitcnt lgkmcnt(2)
 v_mfma_f32_16x16x32_bf16 a[32:35], v[204:207], v[116:119], a[32:35]
 v_mfma_f32_16x16x32_bf16 a[36:39], v[204:207], v[120:123], a[36:39]
 s_waitcnt vmcnt(40)
 ds_read_b64_tr_b16 v[180:181], v152 offset:0
 ds_read_b64_tr_b16 v[182:183], v152 offset:2048
 v_mfma_f32_16x16x32_bf16 a[40:43], v[204:207], v[124:127], a[40:43]
 ds_read_b64_tr_b16 v[184:185], v153 offset:0
 ds_read_b64_tr_b16 v[186:187], v153 offset:2048
 v_mfma_f32_16x16x32_bf16 a[44:47], v[204:207], v[128:131], a[44:47]
 ds_read_b64_tr_b16 v[188:189], v152 offset:256
 ds_read_b64_tr_b16 v[190:191], v152 offset:2304
 s_waitcnt lgkmcnt(6)
 v_mfma_f32_16x16x32_bf16 a[48:51], v[208:211], v[116:119], a[48:51]
 ds_read_b64_tr_b16 v[192:193], v153 offset:256
 ds_read_b64_tr_b16 v[194:195], v153 offset:2304
 v_mfma_f32_16x16x32_bf16 a[52:55], v[208:211], v[120:123], a[52:55]
 v_mfma_f32_16x16x32_bf16 a[56:59], v[208:211], v[124:127], a[56:59]
 v_mfma_f32_16x16x32_bf16 a[60:63], v[208:211], v[128:131], a[60:63]
 s_waitcnt lgkmcnt(6)
 v_mfma_f32_16x16x32_bf16 a[0:3], v[180:183], v[4:7], a[0:3]
 v_mfma_f32_16x16x32_bf16 a[4:7], v[180:183], v[8:11], a[4:7]
 v_mfma_f32_16x16x32_bf16 a[8:11], v[180:183], v[12:15], a[8:11]
 v_mfma_f32_16x16x32_bf16 a[12:15], v[180:183], v[16:19], a[12:15]
 s_waitcnt lgkmcnt(4)
 v_mfma_f32_16x16x32_bf16 a[16:19], v[184:187], v[4:7], a[16:19]
 v_mfma_f32_16x16x32_bf16 a[20:23], v[184:187], v[8:11], a[20:23]
 v_mfma_f32_16x16x32_bf16 a[24:27], v[184:187], v[12:15], a[24:27]
 v_mfma_f32_16x16x32_bf16 a[28:31], v[184:187], v[16:19], a[28:31]
 s_waitcnt lgkmcnt(2)
 v_mfma_f32_16x16x32_bf16 a[32:35], v[188:191], v[4:7], a[32:35]
 v_mfma_f32_16x16x32_bf16 a[36:39], v[188:191], v[8:11], a[36:39]
 s_waitcnt vmcnt(32)
 ds_read_b64_tr_b16 v[196:197], v152 offset:4096
 ds_read_b64_tr_b16 v[198:199], v152 offset:6144
 v_mfma_f32_16x16x32_bf16 a[40:43], v[188:191], v[12:15], a[40:43]
 ds_read_b64_tr_b16 v[200:201], v153 offset:4096
 ds_read_b64_tr_b16 v[202:203], v153 offset:6144
 v_mfma_f32_16x16x32_bf16 a[44:47], v[188:191], v[16:19], a[44:47]
 ds_read_b64_tr_b16 v[204:205], v152 offset:4352
 ds_read_b64_tr_b16 v[206:207], v152 offset:6400
 s_waitcnt lgkmcnt(6)
 v_mfma_f32_16x16x32_bf16 a[48:51], v[192:195], v[4:7], a[48:51]
 ds_read_b64_tr_b16 v[208:209], v153 offset:4352
 ds_read_b64_tr_b16 v[210:211], v153 offset:6400
 v_mfma_f32_16x16x32_bf16 a[52:55], v[192:195], v[8:11], a[52:55]
 v_mfma_f32_16x16x32_bf16 a[56:59], v[192:195], v[12:15], a[56:59]
 v_mfma_f32_16x16x32_bf16 a[60:63], v[192:195], v[16:19], a[60:63]
 s_waitcnt lgkmcnt(6)
 v_mfma_f32_16x16x32_bf16 a[0:3], v[196:199], v[20:23], a[0:3]
 v_mfma_f32_16x16x32_bf16 a[4:7], v[196:199], v[24:27], a[4:7]
 v_mfma_f32_16x16x32_bf16 a[8:11], v[196:199], v[28:31], a[8:11]
 v_mfma_f32_16x16x32_bf16 a[12:15], v[196:199], v[32:35], a[12:15]
 s_waitcnt lgkmcnt(4)
 v_mfma_f32_16x16x32_bf16 a[16:19], v[200:203], v[20:23], a[16:19]
 v_mfma_f32_16x16x32_bf16 a[20:23], v[200:203], v[24:27], a[20:23]
 v_mfma_f32_16x16x32_bf16 a[24:27], v[200:203], v[28:31], a[24:27]
 v_mfma_f32_16x16x32_bf16 a[28:31], v[200:203], v[32:35], a[28:31]
 s_waitcnt lgkmcnt(2)
 v_mfma_f32_16x16x32_bf16 a[32:35], v[204:207], v[20:23], a[32:35]
 v_mfma_f32_16x16x32_bf16 a[36:39], v[204:207], v[24:27], a[36:39]
 s_waitcnt vmcnt(24)
 ds_read_b64_tr_b16 v[180:181], v152 offset:8192
 ds_read_b64_tr_b16 v[182:183], v152 offset:10240
 v_mfma_f32_16x16x32_bf16 a[40:43], v[204:207], v[28:31], a[40:43]
 ds_read_b64_tr_b16 v[184:185], v153 offset:8192
 ds_read_b64_tr_b16 v[186:187], v153 offset:10240
 v_mfma_f32_16x16x32_bf16 a[44:47], v[204:207], v[32:35], a[44:47]
 ds_read_b64_tr_b16 v[188:189], v152 offset:8448
 ds_read_b64_tr_b16 v[190:191], v152 offset:10496
 s_waitcnt lgkmcnt(6)
 v_mfma_f32_16x16x32_bf16 a[48:51], v[208:211], v[20:23], a[48:51]
 ds_read_b64_tr_b16 v[192:193], v153 offset:8448
 ds_read_b64_tr_b16 v[194:195], v153 offset:10496
 v_mfma_f32_16x16x32_bf16 a[52:55], v[208:211], v[24:27], a[52:55]
 v_mfma_f32_16x16x32_bf16 a[56:59], v[208:211], v[28:31], a[56:59]
 v_mfma_f32_16x16x32_bf16 a[60:63], v[208:211], v[32:35], a[60:63]
 s_waitcnt lgkmcnt(6)
 v_mfma_f32_16x16x32_bf16 a[0:3], v[180:183], v[36:39], a[0:3]
 v_mfma_f32_16x16x32_bf16 a[4:7], v[180:183], v[40:43], a[4:7]
 v_mfma_f32_16x16x32_bf16 a[8:11], v[180:183], v[44:47], a[8:11]
 v_mfma_f32_16x16x32_bf16 a[12:15], v[180:183], v[48:51], a[12:15]
 s_waitcnt lgkmcnt(4)
 v_mfma_f32_16x16x32_bf16 a[16:19], v[184:187], v[36:39], a[16:19]
 v_mfma_f32_16x16x32_bf16 a[20:23], v[184:187], v[40:43], a[20:23]
 v_mfma_f32_16x16x32_bf16 a[24:27], v[184:187], v[44:47], a[24:27]
 v_mfma_f32_16x16x32_bf16 a[28:31], v[184:187], v[48:51], a[28:31]
 s_waitcnt lgkmcnt(2)
 v_mfma_f32_16x16x32_bf16 a[32:35], v[188:191], v[36:39], a[32:35]
 v_mfma_f32_16x16x32_bf16 a[36:39], v[188:191], v[40:43], a[36:39]
 s_waitcnt vmcnt(16)
 ds_read_b64_tr_b16 v[196:197], v152 offset:12288
 ds_read_b64_tr_b16 v[198:199], v152 offset:14336
 v_mfma_f32_16x16x32_bf16 a[40:43], v[188:191], v[44:47], a[40:43]
 ds_read_b64_tr_b16 v[200:201], v153 offset:12288
 ds_read_b64_tr_b16 v[202:203], v153 offset:14336
 v_mfma_f32_16x16x32_bf16 a[44:47], v[188:191], v[48:51], a[44:47]
 ds_read_b64_tr_b16 v[204:205], v152 offset:12544
 ds_read_b64_tr_b16 v[206:207], v152 offset:14592
 s_waitcnt lgkmcnt(6)
 v_mfma_f32_16x16x32_bf16 a[48:51], v[192:195], v[36:39], a[48:51]
 ds_read_b64_tr_b16 v[208:209], v153 offset:12544
 ds_read_b64_tr_b16 v[210:211], v153 offset:14592
 v_mfma_f32_16x16x32_bf16 a[52:55], v[192:195], v[40:43], a[52:55]
 v_mfma_f32_16x16x32_bf16 a[56:59], v[192:195], v[44:47], a[56:59]
 v_mfma_f32_16x16x32_bf16 a[60:63], v[192:195], v[48:51], a[60:63]
 s_waitcnt lgkmcnt(6)
 v_mfma_f32_16x16x32_bf16 a[0:3], v[196:199], v[52:55], a[0:3]
 s_mov_b32 s9, 0x6000000
 s_mov_b32 s10, 0x6007000
 v_mfma_f32_16x16x32_bf16 a[4:7], v[196:199], v[56:59], a[4:7]
 buffer_load_dwordx2 v[172:173], v170, s[4:7], s9 offen offset:0
 v_mfma_f32_16x16x32_bf16 a[8:11], v[196:199], v[60:63], a[8:11]
 v_mfma_f32_16x16x32_bf16 a[12:15], v[196:199], v[64:67], a[12:15]
 buffer_load_dwordx2 v[174:175], v170, s[4:7], s9 offen offset:256
 s_waitcnt lgkmcnt(4)
 v_mfma_f32_16x16x32_bf16 a[16:19], v[200:203], v[52:55], a[16:19]
 v_mfma_f32_16x16x32_bf16 a[20:23], v[200:203], v[56:59], a[20:23]
 buffer_load_dwordx2 v[176:177], v170, s[4:7], s10 offen offset:0
 v_mfma_f32_16x16x32_bf16 a[24:27], v[200:203], v[60:63], a[24:27]
 v_mfma_f32_16x16x32_bf16 a[28:31], v[200:203], v[64:67], a[28:31]
 buffer_load_dwordx2 v[178:179], v170, s[4:7], s10 offen offset:256
 s_waitcnt lgkmcnt(2)
 v_mfma_f32_16x16x32_bf16 a[32:35], v[204:207], v[52:55], a[32:35]
 v_mfma_f32_16x16x32_bf16 a[36:39], v[204:207], v[56:59], a[36:39]
 s_waitcnt vmcnt(12)
 ds_read_b64_tr_b16 v[180:181], v152 offset:16384
 ds_read_b64_tr_b16 v[182:183], v152 offset:18432
 v_mfma_f32_16x16x32_bf16 a[40:43], v[204:207], v[60:63], a[40:43]
 ds_read_b64_tr_b16 v[184:185], v153 offset:16384
 ds_read_b64_tr_b16 v[186:187], v153 offset:18432
 v_mfma_f32_16x16x32_bf16 a[44:47], v[204:207], v[64:67], a[44:47]
 ds_read_b64_tr_b16 v[188:189], v152 offset:16640
 ds_read_b64_tr_b16 v[190:191], v152 offset:18688
 s_waitcnt lgkmcnt(6)
 v_mfma_f32_16x16x32_bf16 a[48:51], v[208:211], v[52:55], a[48:51]
 ds_read_b64_tr_b16 v[192:193], v153 offset:16640
 ds_read_b64_tr_b16 v[194:195], v153 offset:18688
 v_mfma_f32_16x16x32_bf16 a[52:55], v[208:211], v[56:59], a[52:55]
 v_mfma_f32_16x16x32_bf16 a[56:59], v[208:211], v[60:63], a[56:59]
 v_mfma_f32_16x16x32_bf16 a[60:63], v[208:211], v[64:67], a[60:63]
 s_waitcnt lgkmcnt(6)
 v_mfma_f32_16x16x32_bf16 a[0:3], v[180:183], v[68:71], a[0:3]
 v_mfma_f32_16x16x32_bf16 a[4:7], v[180:183], v[72:75], a[4:7]
 v_mfma_f32_16x16x32_bf16 a[8:11], v[180:183], v[76:79], a[8:11]
 v_mfma_f32_16x16x32_bf16 a[12:15], v[180:183], v[80:83], a[12:15]
 s_waitcnt lgkmcnt(4)
 v_mfma_f32_16x16x32_bf16 a[16:19], v[184:187], v[68:71], a[16:19]
 v_mfma_f32_16x16x32_bf16 a[20:23], v[184:187], v[72:75], a[20:23]
 v_mfma_f32_16x16x32_bf16 a[24:27], v[184:187], v[76:79], a[24:27]
 v_mfma_f32_16x16x32_bf16 a[28:31], v[184:187], v[80:83], a[28:31]
 s_waitcnt lgkmcnt(2)
 v_mfma_f32_16x16x32_bf16 a[32:35], v[188:191], v[68:71], a[32:35]
 v_mfma_f32_16x16x32_bf16 a[36:39], v[188:191], v[72:75], a[36:39]
 s_waitcnt vmcnt(4)
 ds_read_b64_tr_b16 v[196:197], v152 offset:20480
 ds_read_b64_tr_b16 v[198:199], v152 offset:22528
 v_mfma_f32_16x16x32_bf16 a[40:43], v[188:191], v[76:79], a[40:43]
 ds_read_b64_tr_b16 v[200:201], v153 offset:20480
 ds_read_b64_tr_b16 v[202:203], v153 offset:22528
 v_mfma_f32_16x16x32_bf16 a[44:47], v[188:191], v[80:83], a[44:47]
 ds_read_b64_tr_b16 v[204:205], v152 offset:20736
 ds_read_b64_tr_b16 v[206:207], v152 offset:22784
 s_waitcnt lgkmcnt(6)
 v_mfma_f32_16x16x32_bf16 a[48:51], v[192:195], v[68:71], a[48:51]
 ds_read_b64_tr_b16 v[208:209], v153 offset:20736
 ds_read_b64_tr_b16 v[210:211], v153 offset:22784
 v_mfma_f32_16x16x32_bf16 a[52:55], v[192:195], v[72:75], a[52:55]
 v_mfma_f32_16x16x32_bf16 a[56:59], v[192:195], v[76:79], a[56:59]
 v_mfma_f32_16x16x32_bf16 a[60:63], v[192:195], v[80:83], a[60:63]
 s_waitcnt lgkmcnt(6)
 v_mfma_f32_16x16x32_bf16 a[0:3], v[196:199], v[84:87], a[0:3]
 v_mfma_f32_16x16x32_bf16 a[4:7], v[196:199], v[88:91], a[4:7]
 v_mfma_f32_16x16x32_bf16 a[8:11], v[196:199], v[92:95], a[8:11]
 v_mfma_f32_16x16x32_bf16 a[12:15], v[196:199], v[96:99], a[12:15]
 s_waitcnt lgkmcnt(4)
 v_mfma_f32_16x16x32_bf16 a[16:19], v[200:203], v[84:87], a[16:19]
 v_mfma_f32_16x16x32_bf16 a[20:23], v[200:203], v[88:91], a[20:23]
 v_mfma_f32_16x16x32_bf16 a[24:27], v[200:203], v[92:95], a[24:27]
 v_mfma_f32_16x16x32_bf16 a[28:31], v[200:203], v[96:99], a[28:31]
 s_waitcnt lgkmcnt(2)
 v_mfma_f32_16x16x32_bf16 a[32:35], v[204:207], v[84:87], a[32:35]
 v_mfma_f32_16x16x32_bf16 a[36:39], v[204:207], v[88:91], a[36:39]
 v_mfma_f32_16x16x32_bf16 a[40:43], v[204:207], v[92:95], a[40:43]
 v_mfma_f32_16x16x32_bf16 a[44:47], v[204:207], v[96:99], a[44:47]
 s_waitcnt lgkmcnt(0)
 v_mfma_f32_16x16x32_bf16 a[48:51], v[208:211], v[84:87], a[48:51]
 v_mfma_f32_16x16x32_bf16 a[52:55], v[208:211], v[88:91], a[52:55]
 v_mfma_f32_16x16x32_bf16 a[56:59], v[208:211], v[92:95], a[56:59]
 v_mfma_f32_16x16x32_bf16 a[60:63], v[208:211], v[96:99], a[60:63]
 s_barrier
 s_nop 4
 ds_write_b128 v169, a[0:3] offset:0
 ds_write_b128 v169, a[4:7] offset:1088
 ds_write_b128 v169, a[8:11] offset:2176
 ds_write_b128 v169, a[12:15] offset:3264
 ds_write_b128 v169, a[16:19] offset:4416
 ds_write_b128 v169, a[20:23] offset:5504
 ds_write_b128 v169, a[24:27] offset:6592
 ds_write_b128 v169, a[28:31] offset:7680
 ds_write_b128 v169, a[32:35] offset:8832
 ds_write_b128 v169, a[36:39] offset:9920
 ds_write_b128 v169, a[40:43] offset:11008
 ds_write_b128 v169, a[44:47] offset:12096
 ds_write_b128 v169, a[48:51] offset:13248
 ds_write_b128 v169, a[52:55] offset:14336
 ds_write_b128 v169, a[56:59] offset:15424
 ds_write_b128 v169, a[60:63] offset:16512
 s_waitcnt lgkmcnt(0)
 s_barrier
 ds_read_b128 v[216:219], v168 offset:0
 ds_read_b128 v[220:223], v168 offset:272
 ds_read_b128 v[224:227], v168 offset:17664
 ds_read_b128 v[228:231], v168 offset:17936
 ds_read_b128 v[232:235], v168 offset:35328
 ds_read_b128 v[236:239], v168 offset:35600
 ds_read_b128 v[240:243], v168 offset:52992
 ds_read_b128 v[244:247], v168 offset:53264
 s_waitcnt lgkmcnt(5)
 v_add_f32 v132, v216, v224
 v_add_f32 v133, v217, v225
 v_add_f32 v134, v218, v226
 v_add_f32 v135, v219, v227
 s_waitcnt lgkmcnt(4)
 v_add_f32 v136, v220, v228
 v_add_f32 v137, v221, v229
 v_add_f32 v138, v222, v230
 v_add_f32 v139, v223, v231
 s_waitcnt lgkmcnt(1)
 v_add_f32 v232, v232, v240
 v_add_f32 v233, v233, v241
 v_add_f32 v234, v234, v242
 v_add_f32 v235, v235, v243
 s_waitcnt lgkmcnt(0)
 v_add_f32 v236, v236, v244
 v_add_f32 v237, v237, v245
 v_add_f32 v238, v238, v246
 v_add_f32 v239, v239, v247
 v_add_f32 v132, v132, v232
 v_add_f32 v133, v133, v233
 v_add_f32 v134, v134, v234
 v_add_f32 v135, v135, v235
 v_add_f32 v136, v136, v236
 v_add_f32 v137, v137, v237
 v_add_f32 v138, v138, v238
 v_add_f32 v139, v139, v239
 v_cvt_pk_bf16_f32 v154, v132, v133
 v_lshlrev_b32 v155, 16, v154
 v_and_b32 v156, 0xffff0000, v154
 s_waitcnt vmcnt(3)
 v_lshlrev_b32 v157, 16, v172
 v_and_b32 v158, 0xffff0000, v172
 v_add_f32 v155, v155, v157
 v_add_f32 v156, v156, v158
 v_cvt_pk_bf16_f32 v132, v155, v156
 v_cvt_pk_bf16_f32 v154, v134, v135
 v_lshlrev_b32 v155, 16, v154
 v_and_b32 v156, 0xffff0000, v154
 v_lshlrev_b32 v157, 16, v173
 v_and_b32 v158, 0xffff0000, v173
 v_add_f32 v155, v155, v157
 v_add_f32 v156, v156, v158
 v_cvt_pk_bf16_f32 v133, v155, v156
 v_cvt_pk_bf16_f32 v154, v136, v137
 v_lshlrev_b32 v155, 16, v154
 v_and_b32 v156, 0xffff0000, v154
 s_waitcnt vmcnt(2)
 v_lshlrev_b32 v157, 16, v174
 v_and_b32 v158, 0xffff0000, v174
 v_add_f32 v155, v155, v157
 v_add_f32 v156, v156, v158
 v_cvt_pk_bf16_f32 v134, v155, v156
 v_cvt_pk_bf16_f32 v154, v138, v139
 v_lshlrev_b32 v155, 16, v154
 v_and_b32 v156, 0xffff0000, v154
 v_lshlrev_b32 v157, 16, v175
 v_and_b32 v158, 0xffff0000, v175
 v_add_f32 v155, v155, v157
 v_add_f32 v156, v156, v158
 v_cvt_pk_bf16_f32 v135, v155, v156
 buffer_store_dwordx4 v[132:135], v166, s[72:75], 0 offen
 ds_read_b128 v[216:219], v168 offset:2176
 ds_read_b128 v[220:223], v168 offset:2448
 ds_read_b128 v[224:227], v168 offset:19840
 ds_read_b128 v[228:231], v168 offset:20112
 ds_read_b128 v[232:235], v168 offset:37504
 ds_read_b128 v[236:239], v168 offset:37776
 ds_read_b128 v[240:243], v168 offset:55168
 ds_read_b128 v[244:247], v168 offset:55440
 s_waitcnt lgkmcnt(5)
 v_add_f32 v140, v216, v224
 v_add_f32 v141, v217, v225
 v_add_f32 v142, v218, v226
 v_add_f32 v143, v219, v227
 s_waitcnt lgkmcnt(4)
 v_add_f32 v144, v220, v228
 v_add_f32 v145, v221, v229
 v_add_f32 v146, v222, v230
 v_add_f32 v147, v223, v231
 s_waitcnt lgkmcnt(1)
 v_add_f32 v232, v232, v240
 v_add_f32 v233, v233, v241
 v_add_f32 v234, v234, v242
 v_add_f32 v235, v235, v243
 s_waitcnt lgkmcnt(0)
 v_add_f32 v236, v236, v244
 v_add_f32 v237, v237, v245
 v_add_f32 v238, v238, v246
 v_add_f32 v239, v239, v247
 v_add_f32 v140, v140, v232
 v_add_f32 v141, v141, v233
 v_add_f32 v142, v142, v234
 v_add_f32 v143, v143, v235
 v_add_f32 v144, v144, v236
 v_add_f32 v145, v145, v237
 v_add_f32 v146, v146, v238
 v_add_f32 v147, v147, v239
 v_cvt_pk_bf16_f32 v154, v140, v141
 v_lshlrev_b32 v155, 16, v154
 v_and_b32 v156, 0xffff0000, v154
 s_waitcnt vmcnt(2)
 v_lshlrev_b32 v157, 16, v176
 v_and_b32 v158, 0xffff0000, v176
 v_add_f32 v155, v155, v157
 v_add_f32 v156, v156, v158
 v_cvt_pk_bf16_f32 v140, v155, v156
 v_cvt_pk_bf16_f32 v154, v142, v143
 v_lshlrev_b32 v155, 16, v154
 v_and_b32 v156, 0xffff0000, v154
 v_lshlrev_b32 v157, 16, v177
 v_and_b32 v158, 0xffff0000, v177
 v_add_f32 v155, v155, v157
 v_add_f32 v156, v156, v158
 v_cvt_pk_bf16_f32 v141, v155, v156
 v_cvt_pk_bf16_f32 v154, v144, v145
 v_lshlrev_b32 v155, 16, v154
 v_and_b32 v156, 0xffff0000, v154
 s_waitcnt vmcnt(1)
 v_lshlrev_b32 v157, 16, v178
 v_and_b32 v158, 0xffff0000, v178
 v_add_f32 v155, v155, v157
 v_add_f32 v156, v156, v158
 v_cvt_pk_bf16_f32 v142, v155, v156
 v_cvt_pk_bf16_f32 v154, v146, v147
 v_lshlrev_b32 v155, 16, v154
 v_and_b32 v156, 0xffff0000, v154
 v_lshlrev_b32 v157, 16, v179
 v_and_b32 v158, 0xffff0000, v179
 v_add_f32 v155, v155, v157
 v_add_f32 v156, v156, v158
 v_cvt_pk_bf16_f32 v143, v155, v156
 buffer_store_dwordx4 v[140:143], v167, s[72:75], 0 offen
L_end_seque:
 s_endpgm
L4_s_slow:
 buffer_store_dword v216, v217, s[4:7], s43 offen sc1
 s_branch L4_s_back
L3_s_slow:
 buffer_store_dword v220, v221, s[4:7], s37 offen sc1
 s_branch L3_s_back
L2_ps_slow:
 buffer_store_dword v126, v127, s[4:7], s30 offen sc1
 s_branch L2_ps_back
L2_qs_slow:
 buffer_store_dword v126, v127, s[4:7], s30 offen sc1
 s_branch L2_qs_back
L2_ps2_slow:
 buffer_store_dword v126, v127, s[4:7], s30 offen sc1
 s_branch L2_ps2_back
L1_kvs_slow:
 buffer_store_dword v148, v149, s[4:7], s34 offen sc1
 s_branch L1_kvs_back
L1_K_cw:
 s_mov_b32 s11, 0x20000
L1_K_poll:
 buffer_load_dword v3, v151, s[28:31], 0 offen sc1
 s_waitcnt vmcnt(0)
 v_and_b32 v152, 0xff, v3
 v_cmp_ne_u32 vcc, 32, v152
 s_cbranch_vccz L1_K_got
 s_sub_u32 s11, s11, 1
 s_cbranch_scc0 L1_K_poll
 s_branch L1_K_got
L1_V_cw:
 s_mov_b32 s11, 0x20000
L1_V_poll:
 buffer_load_dword v3, v151, s[28:31], 0 offen sc1
 s_waitcnt vmcnt(0)
 v_and_b32 v152, 0xff, v3
 v_cmp_ne_u32 vcc, 32, v152
 s_cbranch_vccz L1_V_got
 s_sub_u32 s11, s11, 1
 s_cbranch_scc0 L1_V_poll
 s_branch L1_V_got
L1_kvw:
 s_mov_b32 s37, 0x20000
L1_kv_poll:
 buffer_load_dword v3, v150, s[4:7], s32 offen sc1
 s_waitcnt vmcnt(0)
 v_cmp_ne_u32 vcc, 1, v3
 s_cbranch_vccz L1_kv_done
 s_sleep 2
 s_sub_u32 s37, s37, 1
 s_cbranch_scc0 L1_kv_poll
L1_kv_done:
 s_branch L1_kvok
L1_kva_acq:
 buffer_inv sc1
 s_waitcnt vmcnt(0)
 s_branch L1_kva_acqb
L2_ev3:
 v_cmp_ne_u32 vcc, 1, v3
 s_cbranch_vccnz L2_ev3r
 s_lshl_b32 s10, s70, 10
 s_add_u32 s10, s10, 0x5200000
 buffer_load_dwordx4 v[92:95], v2, s[4:7], s10 offen
 s_lshl_b32 s10, s70, 14
 s_add_u32 s10, s10, 0x4a00000
 buffer_load_dwordx4 v[192:195], v2, s[4:7], s10 offen offset:0
 buffer_load_dwordx4 v[196:199], v2, s[4:7], s10 offen offset:1024
 buffer_load_dwordx4 v[200:203], v2, s[4:7], s10 offen offset:2048
 buffer_load_dwordx4 v[204:207], v2, s[4:7], s10 offen offset:3072
 s_add_u32 s10, s10, 0x1000
 buffer_load_dwordx4 v[208:211], v2, s[4:7], s10 offen offset:0
 buffer_load_dwordx4 v[212:215], v2, s[4:7], s10 offen offset:1024
 buffer_load_dwordx4 v[216:219], v2, s[4:7], s10 offen offset:2048
 buffer_load_dwordx4 v[220:223], v2, s[4:7], s10 offen offset:3072
 s_add_u32 s10, s10, 0x1000
 buffer_load_dwordx4 v[224:227], v2, s[4:7], s10 offen offset:0
 buffer_load_dwordx4 v[228:231], v2, s[4:7], s10 offen offset:1024
 buffer_load_dwordx4 v[232:235], v2, s[4:7], s10 offen offset:2048
 buffer_load_dwordx4 v[236:239], v2, s[4:7], s10 offen offset:3072
 s_add_u32 s10, s10, 0x1000
 buffer_load_dwordx4 v[240:243], v2, s[4:7], s10 offen offset:0
 buffer_load_dwordx4 v[244:247], v2, s[4:7], s10 offen offset:1024
 buffer_load_dwordx4 v[248:251], v2, s[4:7], s10 offen offset:2048
 buffer_load_dwordx4 v[252:255], v2, s[4:7], s10 offen offset:3072
 s_mov_b32 s47, 1
 s_branch L2_ev3r
L2_pub2:
 v_mov_b32 v126, 1
 v_mov_b32 v127, 0
 s_mov_b32 s47, 0
 s_cmp_eq_u32 s71, 0
 s_cbranch_scc1 L2_ps2_slow
 buffer_store_dword v126, v127, s[4:7], s30 offen
L2_ps2_back:
 s_branch L2_pub2r
L2_qa_acq:
 buffer_inv sc1
 s_waitcnt vmcnt(0)
 s_branch L2_qa_acqb
L2_pubq:
 s_waitcnt vmcnt(8)
 v_mov_b32 v126, 1
 v_mov_b32 v127, 0
 s_mov_b32 s47, 0
 s_cmp_eq_u32 s71, 0
 s_cbranch_scc1 L2_qs_slow
 buffer_store_dword v126, v127, s[4:7], s30 offen
L2_qs_back:
 s_add_u32 s30, s30, 16384
 s_branch L2_pubqr
L2_pa_acq:
 buffer_inv sc1
 s_waitcnt vmcnt(0)
 s_branch L2_pa_acqb
L4_a_acq:
 buffer_inv sc1
 s_waitcnt vmcnt(0)
 s_branch L4_a_acqb
L5_a_acq:
 buffer_inv sc1
 s_waitcnt vmcnt(0)
 s_branch L5_a_acqb
L_last:
 s_endpgm
.section .rodata,"a"
.p2align 6
.amdhsa_kernel sequential_preLN__compressed_kv_cla__glu_gated_bilinear__prompt_kernel
  .amdhsa_next_free_vgpr 512
  .amdhsa_next_free_sgpr 102
  .amdhsa_accum_offset 256
  .amdhsa_group_segment_fixed_size 0
  .amdhsa_kernarg_size 104
  .amdhsa_user_sgpr_count 2
  .amdhsa_user_sgpr_kernarg_segment_ptr 1
  .amdhsa_system_sgpr_workgroup_id_x 1
  .amdhsa_float_denorm_mode_32 3
.end_amdhsa_kernel
```
